```python
import torch

def _softmax(x, axis=-1):
    return torch.softmax(x, dim=axis)
def _gelu(x):
    return torch.nn.functional.gelu(x, approximate="tanh")
def _silu(x):
    return torch.nn.functional.silu(x)
def _sigmoid(x):
    return torch.sigmoid(x)
def _layernorm(x, axis=-1, eps=1e-5):
    m = x.mean(dim=axis, keepdim=True)
    v = x.var(dim=axis, keepdim=True, unbiased=False)
    return (x - m) / torch.sqrt(v + eps)
def _scatter_add(tgt, idx, src, axis=0):
    return tgt.clone().index_add_(axis, idx, src)
def _segment_sum(src, seg, n):
    out = torch.zeros((n,) + src.shape[1:], dtype=src.dtype)
    return out.index_add_(0, seg, src)
def _pad(x, pw):
    flat = tuple(v for pair in reversed(pw) for v in pair)
    return torch.nn.functional.pad(x, flat)

kernel_name = 'gated_mix__sliding_local_dilated__grouped_kv_mqa__prompt'

def setup_inputs():

    _w = (lambda a: (lambda t: t.to(torch.bfloat16) if t.is_floating_point() else t)(torch.as_tensor(a)))
    def _A_setup():
        B, S, D = 1, 2048, 640
        return {
            "x": _w((lambda *s: torch.randn(*s, dtype=torch.bfloat16) * 0.05)(B, S, D)),
            "wqkv": _w((lambda *s: torch.randn(*s, dtype=torch.bfloat16) * 0.8)(D, 3 * D)),
            "wo": _w((lambda *s: torch.randn(*s, dtype=torch.bfloat16) * 0.05)(D, D)),
        }
    _A_in = _A_setup()

    def _B_setup():
        B, S, D, H = 1, 2048, 640, 32
        Dh = D // H
        return {
            "x": _w((lambda *s: torch.randn(*s, dtype=torch.bfloat16) * 0.05)(B, S, D)),
            "wq": _w((lambda *s: torch.randn(*s, dtype=torch.bfloat16) * 1.6)(D, H * Dh)),
            "wk": _w((lambda *s: torch.randn(*s, dtype=torch.bfloat16) * 1.6)(D, Dh)),
            "wv": _w((lambda *s: torch.randn(*s, dtype=torch.bfloat16) * 0.2)(D, Dh)),
            "wo": _w((lambda *s: torch.randn(*s, dtype=torch.bfloat16) * 0.2)(H * Dh, D)),
        }
    _B_in = _B_setup()

    return {
        "A_x": _A_in["x"],
        "A_wqkv": _A_in["wqkv"],
        "A_wo": _A_in["wo"],
        "B_x": _B_in["x"],
        "B_wq": _B_in["wq"],
        "B_wk": _B_in["wk"],
        "B_wv": _B_in["wv"],
        "B_wo": _B_in["wo"],
        "gate_w": _w((lambda *s: torch.randn(*s, dtype=torch.bfloat16) * 0.05)(640) * 16.0),
    }

def reference(A_x, A_wqkv, A_wo, B_x, B_wq, B_wk, B_wv, B_wo, gate_w):
    def _A_ref(x, wqkv, wo):
        B, S, D = x.shape
        H = 32; Dh = D // H
        W, dil = 8, 2
        qkv = (lambda x, *d: x.permute(*d))((x @ wqkv).reshape(B, S, 3, H, Dh), 2, 0, 3, 1, 4)
        q, k, v = qkv[0], qkv[1], qkv[2]
        scale = Dh ** -0.5
        pos = torch.arange(S)
        off = torch.arange(W) * dil
        idx = pos[:, None] - off[None, :]
        mask = idx >= 0
        idx_c = torch.where(mask, idx, 0).reshape(-1)
        kg = k[:, :, idx_c, :].reshape(B, H, S, W, Dh)
        vg = v[:, :, idx_c, :].reshape(B, H, S, W, Dh)
        logits = torch.einsum("bhsd,bhswd->bhsw", q, kg) * scale
        logits = torch.where(mask[None, None, :, :], logits, -1e9)
        attn = _softmax(logits, axis=-1)
        o = torch.einsum("bhsw,bhswd->bhsd", attn, vg)
        return (lambda x, *d: x.permute(*d))(o, 0, 2, 1, 3).reshape(B, S, D) @ wo

    def _B_ref(x, wq, wk, wv, wo):
        B, S, D = x.shape
        H = 32
        Dh = D // H
        q = (lambda x, *d: x.permute(*d))((x @ wq).reshape(B, S, H, Dh), 0, 2, 1, 3)
        k = x @ wk
        v = x @ wv
        scores = torch.einsum("bhqd,bkd->bhqk", q, k) * (Dh ** -0.5)
        p = _softmax(scores, axis=-1)
        o = torch.einsum("bhqk,bkd->bhqd", p, v)
        return (lambda x, *d: x.permute(*d))(o, 0, 2, 1, 3).reshape(B, S, H * Dh) @ wo

    x = A_x
    g = _sigmoid((x * gate_w).sum(-1, keepdims=True))
    a = _A_ref(x, A_wqkv, A_wo)
    b = _B_ref(x, B_wq, B_wk, B_wv, B_wo)
    return g * a + (1 - g) * b
```

```asm
; @launch grid=(256,1,1) block=(512,1,1) lds=163840
.amdgcn_target "amdgcn-amd-amdhsa--gfx950"
.text
.globl gated_mix__sliding_local_dilated__grouped_kv_mqa__prompt_kernel
.p2align 8
.type gated_mix__sliding_local_dilated__grouped_kv_mqa__prompt_kernel,@function
gated_mix__sliding_local_dilated__grouped_kv_mqa__prompt_kernel:
    s_cmp_ge_u32 s2, 256
    s_cbranch_scc1 L_end
    s_load_dwordx16 s[16:31], s[0:1], 0
    s_load_dwordx8 s[32:39], s[0:1], 64
    s_getpc_b64 s[8:9]
L_pc0:
    v_lshrrev_b32 v4, 6, v0
    v_and_b32 v1, 63, v0
    s_lshr_b32 s11, s2, 3
    v_readfirstlane_b32 s3, v4
    s_lshl_b32 s76, s11, 7
    s_cmp_lg_u32 s3, 0
    s_cbranch_scc1 L_nopf
    s_mov_b32 exec_hi, 0
    v_lshlrev_b32 v4, 12, v1
    v_add_u32 v4, s76, v4
    v_min_u32 v4, L_code_end-L_pc0, v4
    v_mov_b32 v5, s9
    v_add_co_u32 v4, vcc, s8, v4
    s_nop 1
    v_addc_co_u32 v5, vcc, 0, v5, vcc
    global_load_dword v0, v[4:5], off
    s_mov_b64 exec, -1
L_nopf:
    s_and_b32 s10, s2, 7
    s_and_b32 s4, s11, 3
    s_lshl2_add_u32 s4, s10, s4
    s_lshr_b32 s5, s11, 2
    s_and_b32 s12, s4, 1
    s_mul_i32 s12, s12, 5
    s_and_b32 s13, s4, 3
    s_lshl_b32 s13, s13, 2
    s_lshr_b32 s13, 0x8350, s13
    s_and_b32 s13, s13, 15
    s_lshr_b32 s14, s5, 1
    v_mov_b32 v2, 162816
    v_lshlrev_b32 v17, 4, v1
    v_lshrrev_b32 v4, 3, v1
    v_mul_u32_u24 v4, 1280, v4
    v_lshrrev_b32 v5, 4, v1
    v_xor_b32 v5, v5, v1
    v_and_b32 v5, 7, v5
    v_lshl_add_u32 v15, v5, 4, v4
    v_xor_b32 v16, 64, v15
    v_add_u32 v16, 10240, v16
    s_lshl2_add_u32 s84, s4, s14
    s_mul_i32 s85, s84, 20480
    s_lshl_b32 s86, s14, 11
    s_lshr_b32 s76, s3, 1
    s_add_u32 s76, s76, 8
    s_lshl_b32 s77, s76, 7
    s_add_u32 s77, s77, s85
    s_lshl_b32 s78, s76, 13
    s_add_u32 s78, s78, s86
    s_and_b32 s79, s3, 1
    s_lshl_b32 s80, s79, 10
    s_add_u32 s78, s78, s80
    s_cmp_eq_u32 s79, 1
    s_cselect_b64 vcc, -1, 0
    v_cndmask_b32 v18, v15, v16, vcc
    s_xor_b32 s80, s80, 1024
    s_add_u32 s81, s80, 158720
    s_cmp_eq_u32 s3, 4
    s_cselect_b32 s80, 24576, s80
    s_cselect_b32 s81, 106496, s81
    s_cmp_lt_u32 s3, 4
    s_cselect_b32 s77, s77, s80
    s_cselect_b32 s78, s78, s81
    s_cselect_b64 vcc, -1, 0
    v_cndmask_b32 v18, v17, v18, vcc
    s_lshl_b32 s80, s3, 7
    s_add_u32 s80, s80, s85
    s_lshl_b32 s81, s3, 13
    s_add_u32 s81, s81, s86
    s_lshl_b32 s82, s3, 10
    s_waitcnt lgkmcnt(0)
    s_mov_b32 s40, s16
    s_mov_b32 s41, s17
    s_mov_b32 s42, 2621440
    s_mov_b32 s43, 0x20000
    s_mov_b32 m0, s81
    s_bitcmp1_b32 s5, 0
    buffer_load_dwordx4 v15, s[40:43], s80 offen lds
    s_cselect_b32 s56, s28, s26
    s_cselect_b32 s57, s29, s27
    s_add_u32 m0, s81, 1024
    s_mov_b32 s58, 25600
    buffer_load_dwordx4 v16, s[40:43], s80 offen lds
    s_mov_b32 s59, 0x20000
    s_add_u32 m0, s82, 81920
    s_nop 0
    buffer_load_dwordx4 v17, s[56:59], s82 offen lds
    s_add_u32 s82, s82, 8192
    s_add_u32 m0, s82, 81920
    s_nop 0
    buffer_load_dwordx4 v17, s[56:59], s82 offen lds
    s_add_u32 s82, s82, 8192
    s_add_u32 m0, s82, 81920
    s_nop 0
    buffer_load_dwordx4 v17, s[56:59], s82 offen lds
    s_cmp_eq_u32 s3, 4
    s_cselect_b32 s64, s56, s32
    s_cselect_b32 s65, s57, s33
    s_cselect_b32 s66, s58, 1280
    s_cmp_lt_u32 s3, 4
    s_cselect_b32 s64, s16, s64
    s_cselect_b32 s65, s17, s65
    s_cselect_b32 s66, s42, s66
    s_mov_b32 s67, 0x20000
    s_mov_b32 m0, s78
    s_mov_b32 s72, s38
    s_mov_b32 s73, s39
    s_mov_b32 s74, 67108864
    s_mov_b32 s75, 0x20000
    buffer_load_dwordx4 v18, s[64:67], s77 offen lds
    v_lshlrev_b32 v19, 2, v1
    v_add_u32 v19, 160768, v19
    v_cmp_eq_u32 vcc, 0, v1
    s_cmp_lt_u32 s3, 4
    s_nop 0
    v_cndmask_b32 v19, v19, v2, vcc
    v_cndmask_b32 v3, 0, 1, vcc
    s_cbranch_scc1 L_M
L_G:
    s_setprio 1
    s_sub_u32 s15, s3, 4
    s_cmp_eq_u32 s3, 7
    s_cbranch_scc1 L_P0
    s_mov_b32 s52, s24
    s_mov_b32 s53, s25
    s_mov_b32 s54, 819200
    s_mov_b32 s55, 0x20000
    s_mul_i32 s83, s5, 160
    v_add_u32 v4, 0, v1
    v_mul_u32_u24 v5, 6554, v4
    v_lshrrev_b32 v5, 16, v5
    v_mul_u32_u24 v6, 10, v5
    v_sub_u32 v4, v4, v6
    v_and_b32 v6, 0x13, v5
    v_and_b32 v7, 4, v5
    v_lshl_or_b32 v6, v7, 1, v6
    v_bfe_u32 v7, v5, 3, 1
    v_lshl_or_b32 v6, v7, 2, v6
    v_mul_u32_u24 v6, 1280, v6
    v_lshl_add_u32 v4, v4, 4, v6
    v_add_u32 v10, s83, v4
    v_add_u32 v4, 64, v1
    v_mul_u32_u24 v5, 6554, v4
    v_lshrrev_b32 v5, 16, v5
    v_mul_u32_u24 v6, 10, v5
    v_sub_u32 v4, v4, v6
    v_and_b32 v6, 0x13, v5
    v_and_b32 v7, 4, v5
    v_lshl_or_b32 v6, v7, 1, v6
    v_bfe_u32 v7, v5, 3, 1
    v_lshl_or_b32 v6, v7, 2, v6
    v_mul_u32_u24 v6, 1280, v6
    v_lshl_add_u32 v4, v4, 4, v6
    v_add_u32 v11, s83, v4
    v_add_u32 v4, 128, v1
    v_mul_u32_u24 v5, 6554, v4
    v_lshrrev_b32 v5, 16, v5
    v_mul_u32_u24 v6, 10, v5
    v_sub_u32 v4, v4, v6
    v_and_b32 v6, 0x13, v5
    v_and_b32 v7, 4, v5
    v_lshl_or_b32 v6, v7, 1, v6
    v_bfe_u32 v7, v5, 3, 1
    v_lshl_or_b32 v6, v7, 2, v6
    v_mul_u32_u24 v6, 1280, v6
    v_lshl_add_u32 v4, v4, 4, v6
    v_add_u32 v12, s83, v4
    v_add_u32 v4, 192, v1
    v_mul_u32_u24 v5, 6554, v4
    v_lshrrev_b32 v5, 16, v5
    v_mul_u32_u24 v6, 10, v5
    v_sub_u32 v4, v4, v6
    v_and_b32 v6, 0x13, v5
    v_and_b32 v7, 4, v5
    v_lshl_or_b32 v6, v7, 1, v6
    v_bfe_u32 v7, v5, 3, 1
    v_lshl_or_b32 v6, v7, 2, v6
    v_mul_u32_u24 v6, 1280, v6
    v_lshl_add_u32 v4, v4, 4, v6
    v_add_u32 v13, s83, v4
    v_add_u32 v4, 256, v1
    v_mul_u32_u24 v5, 6554, v4
    v_lshrrev_b32 v5, 16, v5
    v_mul_u32_u24 v6, 10, v5
    v_sub_u32 v4, v4, v6
    v_and_b32 v6, 0x13, v5
    v_and_b32 v7, 4, v5
    v_lshl_or_b32 v6, v7, 1, v6
    v_bfe_u32 v7, v5, 3, 1
    v_lshl_or_b32 v6, v7, 2, v6
    v_mul_u32_u24 v6, 1280, v6
    v_lshl_add_u32 v4, v4, 4, v6
    v_add_u32 v14, s83, v4
    s_add_u32 s80, s13, s15
    s_cmp_ge_u32 s80, 10
    s_cselect_b32 s77, 10, 0
    s_sub_u32 s80, s80, s77
    s_mul_i32 s80, s80, 81920
    s_mul_i32 s81, s15, 10240
    s_add_u32 s79, s80, 40960
    s_add_u32 m0, s81, 117760
    s_nop 0
    buffer_load_dwordx4 v10, s[52:55], s80 offen lds
    s_mul_i32 s76, s5, 160
    s_lshl_b32 s77, s15, 6
    v_add_u32 v4, s77, v1
    v_add_u32 v4, 0, v4
    v_mul_u32_u24 v5, 2185, v4
    v_lshrrev_b32 v5, 16, v5
    v_mul_u32_u24 v6, 30, v5
    v_sub_u32 v4, v4, v6
    v_and_b32 v6, 0x13, v5
    v_and_b32 v7, 4, v5
    v_lshl_or_b32 v6, v7, 1, v6
    v_bfe_u32 v7, v5, 3, 1
    v_lshl_or_b32 v6, v7, 2, v6
    v_mul_u32_u24 v6, 3840, v6
    v_mul_u32_u24 v7, 26, v4
    v_lshrrev_b32 v7, 8, v7
    v_mul_u32_u24 v7, 1120, v7
    v_lshl_add_u32 v4, v4, 4, v6
    v_add3_u32 v20, v4, v7, s76
    v_add_u32 v4, s77, v1
    s_add_u32 m0, s81, 118784
    s_nop 0
    buffer_load_dwordx4 v11, s[52:55], s80 offen lds
    v_add_u32 v4, 256, v4
    v_mul_u32_u24 v5, 2185, v4
    v_lshrrev_b32 v5, 16, v5
    v_mul_u32_u24 v6, 30, v5
    v_sub_u32 v4, v4, v6
    v_and_b32 v6, 0x13, v5
    v_and_b32 v7, 4, v5
    v_lshl_or_b32 v6, v7, 1, v6
    v_bfe_u32 v7, v5, 3, 1
    v_lshl_or_b32 v6, v7, 2, v6
    v_mul_u32_u24 v6, 3840, v6
    v_mul_u32_u24 v7, 26, v4
    v_lshrrev_b32 v7, 8, v7
    v_mul_u32_u24 v7, 1120, v7
    v_lshl_add_u32 v4, v4, 4, v6
    v_add3_u32 v21, v4, v7, s76
    v_add_u32 v4, s77, v1
    v_add_u32 v4, 512, v4
    v_mul_u32_u24 v5, 2185, v4
    v_lshrrev_b32 v5, 16, v5
    s_add_u32 m0, s81, 119808
    s_nop 0
    buffer_load_dwordx4 v12, s[52:55], s80 offen lds
    v_mul_u32_u24 v6, 30, v5
    v_sub_u32 v4, v4, v6
    v_and_b32 v6, 0x13, v5
    v_and_b32 v7, 4, v5
    v_lshl_or_b32 v6, v7, 1, v6
    v_bfe_u32 v7, v5, 3, 1
    v_lshl_or_b32 v6, v7, 2, v6
    v_mul_u32_u24 v6, 3840, v6
    v_mul_u32_u24 v7, 26, v4
    v_lshrrev_b32 v7, 8, v7
    v_mul_u32_u24 v7, 1120, v7
    v_lshl_add_u32 v4, v4, 4, v6
    v_add3_u32 v22, v4, v7, s76
    v_add_u32 v4, s77, v1
    v_add_u32 v4, 768, v4
    v_mul_u32_u24 v5, 2185, v4
    v_lshrrev_b32 v5, 16, v5
    v_mul_u32_u24 v6, 30, v5
    v_sub_u32 v4, v4, v6
    v_and_b32 v6, 0x13, v5
    v_and_b32 v7, 4, v5
    v_lshl_or_b32 v6, v7, 1, v6
    v_bfe_u32 v7, v5, 3, 1
    v_lshl_or_b32 v6, v7, 2, v6
    s_add_u32 m0, s81, 120832
    s_nop 0
    buffer_load_dwordx4 v13, s[52:55], s80 offen lds
    v_mul_u32_u24 v6, 3840, v6
    v_mul_u32_u24 v7, 26, v4
    v_lshrrev_b32 v7, 8, v7
    v_mul_u32_u24 v7, 1120, v7
    v_lshl_add_u32 v4, v4, 4, v6
    v_add3_u32 v23, v4, v7, s76
    v_and_b32 v4, 15, v1
    v_lshrrev_b32 v5, 1, v4
    v_lshrrev_b32 v6, 4, v1
    v_xor_b32 v5, v5, v6
    v_lshlrev_b32 v5, 4, v5
    v_lshl_add_u32 v226, v4, 7, v5
    s_and_b32 s76, s15, 1
    s_lshl_b32 s76, s76, 12
    s_lshl_b32 s64, s12, 13
    s_sub_u32 s65, 40960, s64
    s_add_u32 s77, s76, s64
    v_add_u32 v24, s77, v226
    s_add_u32 s77, s76, s65
    s_add_u32 m0, s81, 121856
    s_nop 0
    buffer_load_dwordx4 v14, s[52:55], s80 offen lds
    v_add_u32 v26, s77, v226
    v_xor_b32 v25, 64, v24
    v_xor_b32 v27, 64, v26
    s_mul_i32 s8, s12, 245760
    s_sub_u32 s9, 1228800, s8
    s_lshr_b32 s76, s2, 3
    s_lshl2_add_u32 s76, s76, s15
    s_mul_i32 s76, s76, 6400
    v_lshlrev_b32 v30, 7, v1
    v_add_u32 v30, s76, v30
    v_lshrrev_b32 v4, 5, v1
    v_bfe_u32 v5, v1, 2, 3
    v_lshl_add_u32 v4, v4, 4, v5
    v_mul_u32_u24 v4, 480, v4
    v_and_b32 v5, 3, v1
    v_lshl_add_u32 v28, v5, 3, v4
    v_add_u32 v28, 102400, v28
    v_and_b32 v4, 15, v1
    v_lshrrev_b32 v5, 4, v1
    s_lshr_b32 s76, s15, 1
    s_mul_i32 s76, s76, 80
    s_and_b32 s78, s15, 1
    s_mul_i32 s77, s78, 5120
    s_add_u32 s76, s76, s77
    s_add_u32 m0, s81, 122880
    s_nop 0
    buffer_load_dwordx4 v10, s[52:55], s79 offen lds
    v_mul_u32_u24 v6, 320, v4
    v_lshl_add_u32 v6, v5, 4, v6
    s_add_u32 s77, s76, 102400
    v_add_u32 v192, s77, v6
    s_add_u32 s77, s76, 112640
    v_add_u32 v193, s77, v6
    v_min_u32 v7, 7, v4
    v_mul_u32_u24 v7, 320, v7
    v_lshl_add_u32 v7, v5, 4, v7
    v_add_u32 v194, s77, v7
    v_lshrrev_b32 v6, 2, v1
    v_and_b32 v7, 3, v1
    v_mul_u32_u24 v8, 320, v6
    v_lshl_add_u32 v8, v7, 3, v8
    s_add_u32 s77, s76, 125440
    v_add_u32 v195, s77, v8
    v_min_u32 v6, 7, v6
    s_add_u32 m0, s81, 123904
    s_nop 0
    buffer_load_dwordx4 v11, s[52:55], s79 offen lds
    v_mul_u32_u24 v8, 320, v6
    v_lshl_add_u32 v8, v7, 3, v8
    v_add_u32 v196, s77, v8
    v_cmp_eq_u32 vcc, 0, v7
    v_mov_b32 v6, 162944
    v_add_u32 v8, 32, v195
    v_add_u32 v9, 5152, v196
    v_cndmask_b32 v197, v6, v8, vcc
    v_cndmask_b32 v198, v6, v9, vcc
    v_add_u32 v8, 192, v195
    v_add_u32 v9, 5312, v196
    v_cndmask_b32 v199, v6, v8, vcc
    v_cndmask_b32 v200, v6, v9, vcc
    v_add_u32 v8, 40, v195
    v_add_u32 v9, 5160, v196
    v_cndmask_b32 v201, v6, v8, vcc
    v_cndmask_b32 v202, v6, v9, vcc
    v_add_u32 v8, 200, v195
    v_add_u32 v9, 5320, v196
    v_cndmask_b32 v203, v6, v8, vcc
    v_cndmask_b32 v204, v6, v9, vcc
    s_add_u32 m0, s81, 124928
    s_nop 0
    buffer_load_dwordx4 v12, s[52:55], s79 offen lds
    v_mul_u32_u24 v205, 160, v4
    v_lshl_add_u32 v205, v5, 3, v205
    v_add_u32 v205, 102400, v205
    s_lshl_b32 s77, s78, 7
    v_lshl_add_u32 v207, v4, 3, v2
    v_add_u32 v207, s77, v207
    v_lshrrev_b32 v6, 3, v4
    v_mul_u32_u24 v6, 40960, v6
    v_and_b32 v7, 7, v4
    v_lshl_add_u32 v6, v7, 5, v6
    v_and_b32 v7, 1, v5
    v_lshl_add_u32 v6, v7, 4, v6
    v_lshrrev_b32 v7, 1, v5
    v_lshl_add_u32 v206, v7, 8, v6
    v_lshlrev_b32 v224, 5, v4
    v_lshl_add_u32 v224, v5, 3, v224
    v_bfe_u32 v6, v1, 1, 4
    s_add_u32 m0, s81, 125952
    s_nop 0
    buffer_load_dwordx4 v13, s[52:55], s79 offen lds
    v_mul_u32_u24 v6, 160, v6
    v_lshrrev_b32 v7, 5, v1
    v_lshl_add_u32 v6, v7, 5, v6
    v_and_b32 v7, 1, v1
    v_lshl_add_u32 v225, v7, 4, v6
    s_or_b32 s78, s78, s4
    s_cselect_b32 s78, 0, 8
    v_lshlrev_b32 v5, 2, v5
    v_sub_u32 v6, v5, v4
    v_mov_b32 v7, 4048155338
    v_add_u32 v8, -1, v6
    v_cmp_gt_u32 vcc, 8, v8
    s_nop 1
    v_cndmask_b32 v208, v7, 0, vcc
    v_add_u32 v8, 0, v5
    v_cmp_le_u32 vcc, s78, v8
    s_nop 1
    v_cndmask_b32 v208, v7, v208, vcc
    v_add_u32 v8, 0, v6
    v_cmp_gt_u32 vcc, 8, v8
    s_nop 1
    v_cndmask_b32 v209, v7, 0, vcc
    v_add_u32 v8, 1, v5
    v_cmp_le_u32 vcc, s78, v8
    s_nop 1
    v_cndmask_b32 v209, v7, v209, vcc
    v_add_u32 v8, 1, v6
    v_cmp_gt_u32 vcc, 8, v8
    s_nop 1
    v_cndmask_b32 v210, v7, 0, vcc
    s_add_u32 m0, s81, 126976
    s_nop 0
    buffer_load_dwordx4 v14, s[52:55], s79 offen lds
    v_add_u32 v8, 2, v5
    v_cmp_le_u32 vcc, s78, v8
    s_nop 1
    v_cndmask_b32 v210, v7, v210, vcc
    v_add_u32 v8, 2, v6
    v_cmp_gt_u32 vcc, 8, v8
    s_nop 1
    v_cndmask_b32 v211, v7, 0, vcc
    v_add_u32 v8, 3, v5
    v_cmp_le_u32 vcc, s78, v8
    s_nop 1
    v_cndmask_b32 v211, v7, v211, vcc
    v_add_u32 v8, 15, v6
    v_cmp_gt_u32 vcc, 8, v8
    s_nop 1
    v_cndmask_b32 v212, v7, 0, vcc
    v_add_u32 v8, 16, v6
    v_cmp_gt_u32 vcc, 8, v8
    s_nop 1
    v_cndmask_b32 v213, v7, 0, vcc
    v_add_u32 v8, 17, v6
    v_cmp_gt_u32 vcc, 8, v8
    s_nop 1
    v_cndmask_b32 v214, v7, 0, vcc
    v_add_u32 v8, 18, v6
    v_cmp_gt_u32 vcc, 8, v8
    s_nop 1
    v_cndmask_b32 v215, v7, 0, vcc
    s_waitcnt vmcnt(10)
    s_barrier
    s_cmp_eq_u32 s3, 5
    s_cbranch_scc1 L_ld5
    s_cmp_eq_u32 s3, 6
    s_cbranch_scc1 L_ld6
    s_waitcnt vmcnt(0)
    ds_add_u32 v19, v3 offset:0
    s_add_u32 s80, s13, 3
    s_cmp_ge_u32 s80, 10
    s_cselect_b32 s77, 10, 0
    s_sub_u32 s80, s80, s77
    s_mul_i32 s80, s80, 81920
    s_mov_b32 m0, 148480
    s_nop 0
    buffer_load_dwordx4 v10, s[52:55], s80 offen lds
    s_mov_b32 m0, 149504
    s_nop 0
    buffer_load_dwordx4 v11, s[52:55], s80 offen lds
    s_mov_b32 m0, 150528
    s_nop 0
    buffer_load_dwordx4 v12, s[52:55], s80 offen lds
    s_mov_b32 m0, 151552
    s_nop 0
    buffer_load_dwordx4 v13, s[52:55], s80 offen lds
    s_mov_b32 m0, 152576
    s_nop 0
    buffer_load_dwordx4 v14, s[52:55], s80 offen lds
    s_add_u32 s79, s80, 40960
    s_mov_b32 m0, 153600
    s_nop 0
    buffer_load_dwordx4 v10, s[52:55], s79 offen lds
    s_mov_b32 m0, 154624
    s_nop 0
    buffer_load_dwordx4 v11, s[52:55], s79 offen lds
    s_mov_b32 m0, 155648
    s_nop 0
    buffer_load_dwordx4 v12, s[52:55], s79 offen lds
    s_mov_b32 m0, 156672
    s_nop 0
    buffer_load_dwordx4 v13, s[52:55], s79 offen lds
    s_mov_b32 m0, 157696
    s_nop 0
    buffer_load_dwordx4 v14, s[52:55], s79 offen lds
    s_waitcnt vmcnt(0)
    ds_add_u32 v19, v3 offset:12
    s_mov_b32 s7, 0x20000
Lp_1:
    ds_read_b32 v4, v2 offset:64
    s_waitcnt lgkmcnt(0)
    v_readfirstlane_b32 s76, v4
    s_nop 0
    s_cmp_ge_u32 s76, 4
    s_cbranch_scc1 Lpd_2
    s_sub_u32 s7, s7, 1
    s_cmp_lg_u32 s7, 0
    s_cbranch_scc1 Lp_1
Lpd_2:
    s_add_u32 s80, s13, 7
    s_cmp_ge_u32 s80, 10
    s_cselect_b32 s77, 10, 0
    s_sub_u32 s80, s80, s77
    s_mul_i32 s80, s80, 81920
    s_mov_b32 m0, 117760
    s_nop 0
    buffer_load_dwordx4 v10, s[52:55], s80 offen lds
    s_mov_b32 m0, 118784
    s_nop 0
    buffer_load_dwordx4 v11, s[52:55], s80 offen lds
    s_mov_b32 m0, 119808
    s_nop 0
    buffer_load_dwordx4 v12, s[52:55], s80 offen lds
    s_mov_b32 m0, 120832
    s_nop 0
    buffer_load_dwordx4 v13, s[52:55], s80 offen lds
    s_mov_b32 m0, 121856
    s_nop 0
    buffer_load_dwordx4 v14, s[52:55], s80 offen lds
    s_add_u32 s79, s80, 40960
    s_mov_b32 m0, 122880
    s_nop 0
    buffer_load_dwordx4 v10, s[52:55], s79 offen lds
    s_mov_b32 m0, 123904
    s_nop 0
    buffer_load_dwordx4 v11, s[52:55], s79 offen lds
    s_mov_b32 m0, 124928
    s_nop 0
    buffer_load_dwordx4 v12, s[52:55], s79 offen lds
    s_mov_b32 m0, 125952
    s_nop 0
    buffer_load_dwordx4 v13, s[52:55], s79 offen lds
    s_mov_b32 m0, 126976
    s_nop 0
    buffer_load_dwordx4 v14, s[52:55], s79 offen lds
    s_mov_b32 s7, 0x20000
Lp_3:
    ds_read_b32 v4, v2 offset:72
    s_waitcnt lgkmcnt(0)
    v_readfirstlane_b32 s76, v4
    s_nop 0
    s_cmp_ge_u32 s76, 4
    s_cbranch_scc1 Lpd_4
    s_sub_u32 s7, s7, 1
    s_cmp_lg_u32 s7, 0
    s_cbranch_scc1 Lp_3
Lpd_4:
    s_add_u32 s80, s13, 9
    s_cmp_ge_u32 s80, 10
    s_cselect_b32 s77, 10, 0
    s_sub_u32 s80, s80, s77
    s_mul_i32 s80, s80, 81920
    s_mov_b32 m0, 138240
    s_nop 0
    buffer_load_dwordx4 v10, s[52:55], s80 offen lds
    s_mov_b32 m0, 139264
    s_nop 0
    buffer_load_dwordx4 v11, s[52:55], s80 offen lds
    s_mov_b32 m0, 140288
    s_nop 0
    buffer_load_dwordx4 v12, s[52:55], s80 offen lds
    s_mov_b32 m0, 141312
    s_nop 0
    buffer_load_dwordx4 v13, s[52:55], s80 offen lds
    s_mov_b32 m0, 142336
    s_nop 0
    buffer_load_dwordx4 v14, s[52:55], s80 offen lds
    s_add_u32 s79, s80, 40960
    s_mov_b32 m0, 143360
    s_nop 0
    buffer_load_dwordx4 v10, s[52:55], s79 offen lds
    s_mov_b32 m0, 144384
    s_nop 0
    buffer_load_dwordx4 v11, s[52:55], s79 offen lds
    s_mov_b32 m0, 145408
    s_nop 0
    buffer_load_dwordx4 v12, s[52:55], s79 offen lds
    s_mov_b32 m0, 146432
    s_nop 0
    buffer_load_dwordx4 v13, s[52:55], s79 offen lds
    s_mov_b32 m0, 147456
    s_nop 0
    buffer_load_dwordx4 v14, s[52:55], s79 offen lds
    s_waitcnt vmcnt(10)
    ds_add_u32 v19, v3 offset:28
    s_waitcnt vmcnt(0)
    ds_add_u32 v19, v3 offset:36
    s_branch L_g_join
L_ld5:
    s_add_u32 s80, s13, 4
    s_cmp_ge_u32 s80, 10
    s_cselect_b32 s77, 10, 0
    s_sub_u32 s80, s80, s77
    s_mul_i32 s80, s80, 81920
    s_mov_b32 m0, 107520
    s_nop 0
    buffer_load_dwordx4 v10, s[52:55], s80 offen lds
    s_mov_b32 m0, 108544
    s_nop 0
    buffer_load_dwordx4 v11, s[52:55], s80 offen lds
    s_mov_b32 m0, 109568
    s_nop 0
    buffer_load_dwordx4 v12, s[52:55], s80 offen lds
    s_mov_b32 m0, 110592
    s_nop 0
    buffer_load_dwordx4 v13, s[52:55], s80 offen lds
    s_mov_b32 m0, 111616
    s_nop 0
    buffer_load_dwordx4 v14, s[52:55], s80 offen lds
    s_add_u32 s79, s80, 40960
    s_mov_b32 m0, 112640
    s_nop 0
    buffer_load_dwordx4 v10, s[52:55], s79 offen lds
    s_mov_b32 m0, 113664
    s_nop 0
    buffer_load_dwordx4 v11, s[52:55], s79 offen lds
    s_mov_b32 m0, 114688
    s_nop 0
    buffer_load_dwordx4 v12, s[52:55], s79 offen lds
    s_mov_b32 m0, 115712
    s_nop 0
    buffer_load_dwordx4 v13, s[52:55], s79 offen lds
    s_mov_b32 m0, 116736
    s_nop 0
    buffer_load_dwordx4 v14, s[52:55], s79 offen lds
    s_waitcnt vmcnt(10)
    ds_add_u32 v19, v3 offset:4
    s_waitcnt vmcnt(0)
    ds_add_u32 v19, v3 offset:16
    s_mov_b32 s7, 0x20000
Lp_5:
    ds_read_b32 v4, v2 offset:68
    s_waitcnt lgkmcnt(0)
    v_readfirstlane_b32 s76, v4
    s_nop 0
    s_cmp_ge_u32 s76, 4
    s_cbranch_scc1 Lpd_6
    s_sub_u32 s7, s7, 1
    s_cmp_lg_u32 s7, 0
    s_cbranch_scc1 Lp_5
Lpd_6:
    s_add_u32 s80, s13, 8
    s_cmp_ge_u32 s80, 10
    s_cselect_b32 s77, 10, 0
    s_sub_u32 s80, s80, s77
    s_mul_i32 s80, s80, 81920
    s_mov_b32 m0, 128000
    s_nop 0
    buffer_load_dwordx4 v10, s[52:55], s80 offen lds
    s_mov_b32 m0, 129024
    s_nop 0
    buffer_load_dwordx4 v11, s[52:55], s80 offen lds
    s_mov_b32 m0, 130048
    s_nop 0
    buffer_load_dwordx4 v12, s[52:55], s80 offen lds
    s_mov_b32 m0, 131072
    s_nop 0
    buffer_load_dwordx4 v13, s[52:55], s80 offen lds
    s_mov_b32 m0, 132096
    s_nop 0
    buffer_load_dwordx4 v14, s[52:55], s80 offen lds
    s_add_u32 s79, s80, 40960
    s_mov_b32 m0, 133120
    s_nop 0
    buffer_load_dwordx4 v10, s[52:55], s79 offen lds
    s_mov_b32 m0, 134144
    s_nop 0
    buffer_load_dwordx4 v11, s[52:55], s79 offen lds
    s_mov_b32 m0, 135168
    s_nop 0
    buffer_load_dwordx4 v12, s[52:55], s79 offen lds
    s_mov_b32 m0, 136192
    s_nop 0
    buffer_load_dwordx4 v13, s[52:55], s79 offen lds
    s_mov_b32 m0, 137216
    s_nop 0
    buffer_load_dwordx4 v14, s[52:55], s79 offen lds
    s_waitcnt vmcnt(0)
    ds_add_u32 v19, v3 offset:32
    s_branch L_g_join
L_ld6:
    s_waitcnt vmcnt(0)
    ds_add_u32 v19, v3 offset:8
    s_cmp_eq_u32 s14, 0
    s_cbranch_scc1 Lxs_7
    s_lshl_b32 s84, s4, 2
    s_add_u32 s84, s84, 0
    s_mul_i32 s84, s84, 20480
    s_add_u32 s81, s13, 5
    s_cmp_ge_u32 s81, 10
    s_cselect_b32 s77, 10, 0
    s_sub_u32 s81, s81, s77
    s_lshl_b32 s82, s81, 7
    s_add_u32 s82, s82, s84
    s_lshl_b32 s83, s81, 13
    s_add_u32 m0, s83, 0
    s_nop 0
    buffer_load_dwordx4 v15, s[40:43], s82 offen lds
    s_add_u32 m0, s83, 1024
    s_nop 0
    buffer_load_dwordx4 v16, s[40:43], s82 offen lds
    s_add_u32 s81, s13, 6
    s_cmp_ge_u32 s81, 10
    s_cselect_b32 s77, 10, 0
    s_sub_u32 s81, s81, s77
    s_lshl_b32 s82, s81, 7
    s_add_u32 s82, s82, s84
    s_lshl_b32 s83, s81, 13
    s_add_u32 m0, s83, 0
    s_nop 0
    buffer_load_dwordx4 v15, s[40:43], s82 offen lds
    s_add_u32 m0, s83, 1024
    s_nop 0
    buffer_load_dwordx4 v16, s[40:43], s82 offen lds
    s_add_u32 s81, s13, 7
    s_cmp_ge_u32 s81, 10
    s_cselect_b32 s77, 10, 0
    s_sub_u32 s81, s81, s77
    s_lshl_b32 s82, s81, 7
    s_add_u32 s82, s82, s84
    s_lshl_b32 s83, s81, 13
    s_add_u32 m0, s83, 0
    s_nop 0
    buffer_load_dwordx4 v15, s[40:43], s82 offen lds
    s_add_u32 m0, s83, 1024
    s_nop 0
    buffer_load_dwordx4 v16, s[40:43], s82 offen lds
    s_add_u32 s81, s13, 8
    s_cmp_ge_u32 s81, 10
    s_cselect_b32 s77, 10, 0
    s_sub_u32 s81, s81, s77
    s_lshl_b32 s82, s81, 7
    s_add_u32 s82, s82, s84
    s_lshl_b32 s83, s81, 13
    s_add_u32 m0, s83, 0
    s_nop 0
    buffer_load_dwordx4 v15, s[40:43], s82 offen lds
    s_add_u32 m0, s83, 1024
    s_nop 0
    buffer_load_dwordx4 v16, s[40:43], s82 offen lds
    s_add_u32 s81, s13, 9
    s_cmp_ge_u32 s81, 10
    s_cselect_b32 s77, 10, 0
    s_sub_u32 s81, s81, s77
    s_lshl_b32 s82, s81, 7
    s_add_u32 s82, s82, s84
    s_lshl_b32 s83, s81, 13
    s_add_u32 m0, s83, 0
    s_nop 0
    buffer_load_dwordx4 v15, s[40:43], s82 offen lds
    s_add_u32 m0, s83, 1024
    s_nop 0
    buffer_load_dwordx4 v16, s[40:43], s82 offen lds
Lxs_7:
    s_cmp_eq_u32 s14, 1
    s_cbranch_scc1 Lxs_8
    s_lshl_b32 s84, s4, 2
    s_add_u32 s84, s84, 1
    s_mul_i32 s84, s84, 20480
    s_add_u32 s81, s13, 5
    s_cmp_ge_u32 s81, 10
    s_cselect_b32 s77, 10, 0
    s_sub_u32 s81, s81, s77
    s_lshl_b32 s82, s81, 7
    s_add_u32 s82, s82, s84
    s_lshl_b32 s83, s81, 13
    s_add_u32 m0, s83, 2048
    s_nop 0
    buffer_load_dwordx4 v15, s[40:43], s82 offen lds
    s_add_u32 m0, s83, 3072
    s_nop 0
    buffer_load_dwordx4 v16, s[40:43], s82 offen lds
    s_add_u32 s81, s13, 6
    s_cmp_ge_u32 s81, 10
    s_cselect_b32 s77, 10, 0
    s_sub_u32 s81, s81, s77
    s_lshl_b32 s82, s81, 7
    s_add_u32 s82, s82, s84
    s_lshl_b32 s83, s81, 13
    s_add_u32 m0, s83, 2048
    s_nop 0
    buffer_load_dwordx4 v15, s[40:43], s82 offen lds
    s_add_u32 m0, s83, 3072
    s_nop 0
    buffer_load_dwordx4 v16, s[40:43], s82 offen lds
    s_add_u32 s81, s13, 7
    s_cmp_ge_u32 s81, 10
    s_cselect_b32 s77, 10, 0
    s_sub_u32 s81, s81, s77
    s_lshl_b32 s82, s81, 7
    s_add_u32 s82, s82, s84
    s_lshl_b32 s83, s81, 13
    s_add_u32 m0, s83, 2048
    s_nop 0
    buffer_load_dwordx4 v15, s[40:43], s82 offen lds
    s_add_u32 m0, s83, 3072
    s_nop 0
    buffer_load_dwordx4 v16, s[40:43], s82 offen lds
    s_add_u32 s81, s13, 8
    s_cmp_ge_u32 s81, 10
    s_cselect_b32 s77, 10, 0
    s_sub_u32 s81, s81, s77
    s_lshl_b32 s82, s81, 7
    s_add_u32 s82, s82, s84
    s_lshl_b32 s83, s81, 13
    s_add_u32 m0, s83, 2048
    s_nop 0
    buffer_load_dwordx4 v15, s[40:43], s82 offen lds
    s_add_u32 m0, s83, 3072
    s_nop 0
    buffer_load_dwordx4 v16, s[40:43], s82 offen lds
    s_add_u32 s81, s13, 9
    s_cmp_ge_u32 s81, 10
    s_cselect_b32 s77, 10, 0
    s_sub_u32 s81, s81, s77
    s_lshl_b32 s82, s81, 7
    s_add_u32 s82, s82, s84
    s_lshl_b32 s83, s81, 13
    s_add_u32 m0, s83, 2048
    s_nop 0
    buffer_load_dwordx4 v15, s[40:43], s82 offen lds
    s_add_u32 m0, s83, 3072
    s_nop 0
    buffer_load_dwordx4 v16, s[40:43], s82 offen lds
Lxs_8:
    s_cmp_eq_u32 s14, 2
    s_cbranch_scc1 Lxs_9
    s_lshl_b32 s84, s4, 2
    s_add_u32 s84, s84, 2
    s_mul_i32 s84, s84, 20480
    s_add_u32 s81, s13, 5
    s_cmp_ge_u32 s81, 10
    s_cselect_b32 s77, 10, 0
    s_sub_u32 s81, s81, s77
    s_lshl_b32 s82, s81, 7
    s_add_u32 s82, s82, s84
    s_lshl_b32 s83, s81, 13
    s_add_u32 m0, s83, 4096
    s_nop 0
    buffer_load_dwordx4 v15, s[40:43], s82 offen lds
    s_add_u32 m0, s83, 5120
    s_nop 0
    buffer_load_dwordx4 v16, s[40:43], s82 offen lds
    s_add_u32 s81, s13, 6
    s_cmp_ge_u32 s81, 10
    s_cselect_b32 s77, 10, 0
    s_sub_u32 s81, s81, s77
    s_lshl_b32 s82, s81, 7
    s_add_u32 s82, s82, s84
    s_lshl_b32 s83, s81, 13
    s_add_u32 m0, s83, 4096
    s_nop 0
    buffer_load_dwordx4 v15, s[40:43], s82 offen lds
    s_add_u32 m0, s83, 5120
    s_nop 0
    buffer_load_dwordx4 v16, s[40:43], s82 offen lds
    s_add_u32 s81, s13, 7
    s_cmp_ge_u32 s81, 10
    s_cselect_b32 s77, 10, 0
    s_sub_u32 s81, s81, s77
    s_lshl_b32 s82, s81, 7
    s_add_u32 s82, s82, s84
    s_lshl_b32 s83, s81, 13
    s_add_u32 m0, s83, 4096
    s_nop 0
    buffer_load_dwordx4 v15, s[40:43], s82 offen lds
    s_add_u32 m0, s83, 5120
    s_nop 0
    buffer_load_dwordx4 v16, s[40:43], s82 offen lds
    s_add_u32 s81, s13, 8
    s_cmp_ge_u32 s81, 10
    s_cselect_b32 s77, 10, 0
    s_sub_u32 s81, s81, s77
    s_lshl_b32 s82, s81, 7
    s_add_u32 s82, s82, s84
    s_lshl_b32 s83, s81, 13
    s_add_u32 m0, s83, 4096
    s_nop 0
    buffer_load_dwordx4 v15, s[40:43], s82 offen lds
    s_add_u32 m0, s83, 5120
    s_nop 0
    buffer_load_dwordx4 v16, s[40:43], s82 offen lds
    s_add_u32 s81, s13, 9
    s_cmp_ge_u32 s81, 10
    s_cselect_b32 s77, 10, 0
    s_sub_u32 s81, s81, s77
    s_lshl_b32 s82, s81, 7
    s_add_u32 s82, s82, s84
    s_lshl_b32 s83, s81, 13
    s_add_u32 m0, s83, 4096
    s_nop 0
    buffer_load_dwordx4 v15, s[40:43], s82 offen lds
    s_add_u32 m0, s83, 5120
    s_nop 0
    buffer_load_dwordx4 v16, s[40:43], s82 offen lds
Lxs_9:
    s_cmp_eq_u32 s14, 3
    s_cbranch_scc1 Lxs_10
    s_lshl_b32 s84, s4, 2
    s_add_u32 s84, s84, 3
    s_mul_i32 s84, s84, 20480
    s_add_u32 s81, s13, 5
    s_cmp_ge_u32 s81, 10
    s_cselect_b32 s77, 10, 0
    s_sub_u32 s81, s81, s77
    s_lshl_b32 s82, s81, 7
    s_add_u32 s82, s82, s84
    s_lshl_b32 s83, s81, 13
    s_add_u32 m0, s83, 6144
    s_nop 0
    buffer_load_dwordx4 v15, s[40:43], s82 offen lds
    s_add_u32 m0, s83, 7168
    s_nop 0
    buffer_load_dwordx4 v16, s[40:43], s82 offen lds
    s_add_u32 s81, s13, 6
    s_cmp_ge_u32 s81, 10
    s_cselect_b32 s77, 10, 0
    s_sub_u32 s81, s81, s77
    s_lshl_b32 s82, s81, 7
    s_add_u32 s82, s82, s84
    s_lshl_b32 s83, s81, 13
    s_add_u32 m0, s83, 6144
    s_nop 0
    buffer_load_dwordx4 v15, s[40:43], s82 offen lds
    s_add_u32 m0, s83, 7168
    s_nop 0
    buffer_load_dwordx4 v16, s[40:43], s82 offen lds
    s_add_u32 s81, s13, 7
    s_cmp_ge_u32 s81, 10
    s_cselect_b32 s77, 10, 0
    s_sub_u32 s81, s81, s77
    s_lshl_b32 s82, s81, 7
    s_add_u32 s82, s82, s84
    s_lshl_b32 s83, s81, 13
    s_add_u32 m0, s83, 6144
    s_nop 0
    buffer_load_dwordx4 v15, s[40:43], s82 offen lds
    s_add_u32 m0, s83, 7168
    s_nop 0
    buffer_load_dwordx4 v16, s[40:43], s82 offen lds
    s_add_u32 s81, s13, 8
    s_cmp_ge_u32 s81, 10
    s_cselect_b32 s77, 10, 0
    s_sub_u32 s81, s81, s77
    s_lshl_b32 s82, s81, 7
    s_add_u32 s82, s82, s84
    s_lshl_b32 s83, s81, 13
    s_add_u32 m0, s83, 6144
    s_nop 0
    buffer_load_dwordx4 v15, s[40:43], s82 offen lds
    s_add_u32 m0, s83, 7168
    s_nop 0
    buffer_load_dwordx4 v16, s[40:43], s82 offen lds
    s_add_u32 s81, s13, 9
    s_cmp_ge_u32 s81, 10
    s_cselect_b32 s77, 10, 0
    s_sub_u32 s81, s81, s77
    s_lshl_b32 s82, s81, 7
    s_add_u32 s82, s82, s84
    s_lshl_b32 s83, s81, 13
    s_add_u32 m0, s83, 6144
    s_nop 0
    buffer_load_dwordx4 v15, s[40:43], s82 offen lds
    s_add_u32 m0, s83, 7168
    s_nop 0
    buffer_load_dwordx4 v16, s[40:43], s82 offen lds
Lxs_10:
    s_mov_b32 s7, 0x20000
Lp_11:
    ds_read_b32 v4, v2 offset:116
    s_waitcnt lgkmcnt(0)
    v_readfirstlane_b32 s76, v4
    s_nop 0
    s_cmp_ge_u32 s76, 1
    s_cbranch_scc1 Lpd_12
    s_sub_u32 s7, s7, 1
    s_cmp_lg_u32 s7, 0
    s_cbranch_scc1 Lp_11
Lpd_12:
    s_add_u32 s80, s13, 5
    s_cmp_ge_u32 s80, 10
    s_cselect_b32 s77, 10, 0
    s_sub_u32 s80, s80, s77
    s_mul_i32 s80, s80, 81920
    s_mov_b32 m0, 81920
    s_nop 0
    buffer_load_dwordx4 v10, s[52:55], s80 offen lds
    s_mov_b32 m0, 82944
    s_nop 0
    buffer_load_dwordx4 v11, s[52:55], s80 offen lds
    s_mov_b32 m0, 83968
    s_nop 0
    buffer_load_dwordx4 v12, s[52:55], s80 offen lds
    s_mov_b32 m0, 84992
    s_nop 0
    buffer_load_dwordx4 v13, s[52:55], s80 offen lds
    s_mov_b32 m0, 86016
    s_nop 0
    buffer_load_dwordx4 v14, s[52:55], s80 offen lds
    s_add_u32 s79, s80, 40960
    s_mov_b32 m0, 87040
    s_nop 0
    buffer_load_dwordx4 v10, s[52:55], s79 offen lds
    s_mov_b32 m0, 88064
    s_nop 0
    buffer_load_dwordx4 v11, s[52:55], s79 offen lds
    s_mov_b32 m0, 89088
    s_nop 0
    buffer_load_dwordx4 v12, s[52:55], s79 offen lds
    s_mov_b32 m0, 90112
    s_nop 0
    buffer_load_dwordx4 v13, s[52:55], s79 offen lds
    s_mov_b32 m0, 91136
    s_nop 0
    buffer_load_dwordx4 v14, s[52:55], s79 offen lds
    s_add_u32 s80, s13, 6
    s_cmp_ge_u32 s80, 10
    s_cselect_b32 s77, 10, 0
    s_sub_u32 s80, s80, s77
    s_mul_i32 s80, s80, 81920
    s_mov_b32 m0, 92160
    s_nop 0
    buffer_load_dwordx4 v10, s[52:55], s80 offen lds
    s_mov_b32 m0, 93184
    s_nop 0
    buffer_load_dwordx4 v11, s[52:55], s80 offen lds
    s_mov_b32 m0, 94208
    s_nop 0
    buffer_load_dwordx4 v12, s[52:55], s80 offen lds
    s_mov_b32 m0, 95232
    s_nop 0
    buffer_load_dwordx4 v13, s[52:55], s80 offen lds
    s_mov_b32 m0, 96256
    s_nop 0
    buffer_load_dwordx4 v14, s[52:55], s80 offen lds
    s_add_u32 s79, s80, 40960
    s_mov_b32 m0, 97280
    s_nop 0
    buffer_load_dwordx4 v10, s[52:55], s79 offen lds
    s_mov_b32 m0, 98304
    s_nop 0
    buffer_load_dwordx4 v11, s[52:55], s79 offen lds
    s_mov_b32 m0, 99328
    s_nop 0
    buffer_load_dwordx4 v12, s[52:55], s79 offen lds
    s_mov_b32 m0, 100352
    s_nop 0
    buffer_load_dwordx4 v13, s[52:55], s79 offen lds
    s_mov_b32 m0, 101376
    s_nop 0
    buffer_load_dwordx4 v14, s[52:55], s79 offen lds
    s_waitcnt vmcnt(10)
    ds_add_u32 v19, v3 offset:20
    s_waitcnt vmcnt(0)
    ds_add_u32 v19, v3 offset:24
    s_branch L_g_join
L_P0:
    v_mov_b32 v9, 0
    buffer_load_dword v249, v9, s[72:75], 0 offen sc1
    v_and_b32 v4, 15, v1
    v_lshrrev_b32 v5, 1, v4
    v_lshrrev_b32 v6, 4, v1
    v_xor_b32 v5, v5, v6
    v_lshlrev_b32 v5, 4, v5
    v_lshl_add_u32 v244, v4, 7, v5
    v_add_u32 v244, s86, v244
    v_add_u32 v246, 40960, v244
    v_xor_b32 v245, 64, v244
    v_xor_b32 v247, 64, v246
    v_lshrrev_b32 v4, 4, v1
    v_bfe_u32 v5, v1, 2, 2
    v_lshl_add_u32 v4, v4, 3, v5
    v_mul_u32_u24 v4, 40, v4
    v_and_b32 v5, 3, v1
    v_lshl_add_u32 v248, v5, 3, v4
    v_add_u32 v248, 81920, v248
    s_lshl_b32 s84, s84, 4
    s_waitcnt vmcnt(1)
    s_barrier
    s_bitcmp1_b32 s5, 0
    s_cbranch_scc1 L_P0V
    ds_read_b128 v[20:23], v244 offset:0
    ds_read_b64_tr_b16 v[24:25], v248 offset:0
    ds_read_b64_tr_b16 v[26:27], v248 offset:160
    ds_read_b64_tr_b16 v[28:29], v248 offset:32
    ds_read_b64_tr_b16 v[30:31], v248 offset:192
    ds_read_b128 v[32:35], v245 offset:0
    ds_read_b64_tr_b16 v[36:37], v248 offset:1280
    ds_read_b64_tr_b16 v[38:39], v248 offset:1440
    ds_read_b64_tr_b16 v[40:41], v248 offset:1312
    ds_read_b64_tr_b16 v[42:43], v248 offset:1472
    ds_read_b128 v[44:47], v244 offset:8192
    ds_read_b64_tr_b16 v[48:49], v248 offset:2560
    ds_read_b64_tr_b16 v[50:51], v248 offset:2720
    ds_read_b64_tr_b16 v[52:53], v248 offset:2592
    ds_read_b64_tr_b16 v[54:55], v248 offset:2752
    s_waitcnt lgkmcnt(10)
    v_mfma_f32_16x16x32_bf16 v[240:243], v[24:27], v[20:23], 0
    v_mfma_f32_16x16x32_bf16 v[236:239], v[28:31], v[20:23], 0
    ds_read_b128 v[56:59], v245 offset:8192
    ds_read_b64_tr_b16 v[60:61], v248 offset:3840
    ds_read_b64_tr_b16 v[62:63], v248 offset:4000
    ds_read_b64_tr_b16 v[64:65], v248 offset:3872
    ds_read_b64_tr_b16 v[66:67], v248 offset:4032
    s_waitcnt lgkmcnt(10)
    v_mfma_f32_16x16x32_bf16 v[240:243], v[36:39], v[32:35], v[240:243]
    v_mfma_f32_16x16x32_bf16 v[236:239], v[40:43], v[32:35], v[236:239]
    ds_read_b128 v[68:71], v244 offset:16384
    ds_read_b64_tr_b16 v[72:73], v248 offset:5120
    ds_read_b64_tr_b16 v[74:75], v248 offset:5280
    ds_read_b64_tr_b16 v[76:77], v248 offset:5152
    ds_read_b64_tr_b16 v[78:79], v248 offset:5312
    s_waitcnt lgkmcnt(10)
    v_mfma_f32_16x16x32_bf16 v[240:243], v[48:51], v[44:47], v[240:243]
    v_mfma_f32_16x16x32_bf16 v[236:239], v[52:55], v[44:47], v[236:239]
    ds_read_b128 v[80:83], v245 offset:16384
    ds_read_b64_tr_b16 v[84:85], v248 offset:6400
    ds_read_b64_tr_b16 v[86:87], v248 offset:6560
    ds_read_b64_tr_b16 v[88:89], v248 offset:6432
    ds_read_b64_tr_b16 v[90:91], v248 offset:6592
    s_waitcnt lgkmcnt(10)
    v_mfma_f32_16x16x32_bf16 v[240:243], v[60:63], v[56:59], v[240:243]
    v_mfma_f32_16x16x32_bf16 v[236:239], v[64:67], v[56:59], v[236:239]
    ds_read_b128 v[92:95], v244 offset:24576
    ds_read_b64_tr_b16 v[96:97], v248 offset:7680
    ds_read_b64_tr_b16 v[98:99], v248 offset:7840
    ds_read_b64_tr_b16 v[100:101], v248 offset:7712
    ds_read_b64_tr_b16 v[102:103], v248 offset:7872
    s_waitcnt lgkmcnt(10)
    v_mfma_f32_16x16x32_bf16 v[240:243], v[72:75], v[68:71], v[240:243]
    v_mfma_f32_16x16x32_bf16 v[236:239], v[76:79], v[68:71], v[236:239]
    ds_read_b128 v[104:107], v245 offset:24576
    ds_read_b64_tr_b16 v[108:109], v248 offset:8960
    ds_read_b64_tr_b16 v[110:111], v248 offset:9120
    ds_read_b64_tr_b16 v[112:113], v248 offset:8992
    ds_read_b64_tr_b16 v[114:115], v248 offset:9152
    s_waitcnt lgkmcnt(10)
    v_mfma_f32_16x16x32_bf16 v[240:243], v[84:87], v[80:83], v[240:243]
    v_mfma_f32_16x16x32_bf16 v[236:239], v[88:91], v[80:83], v[236:239]
    ds_read_b128 v[116:119], v244 offset:32768
    ds_read_b64_tr_b16 v[120:121], v248 offset:10240
    ds_read_b64_tr_b16 v[122:123], v248 offset:10400
    ds_read_b64_tr_b16 v[124:125], v248 offset:10272
    ds_read_b64_tr_b16 v[126:127], v248 offset:10432
    s_waitcnt lgkmcnt(10)
    v_mfma_f32_16x16x32_bf16 v[240:243], v[96:99], v[92:95], v[240:243]
    v_mfma_f32_16x16x32_bf16 v[236:239], v[100:103], v[92:95], v[236:239]
    ds_read_b128 v[128:131], v245 offset:32768
    ds_read_b64_tr_b16 v[132:133], v248 offset:11520
    ds_read_b64_tr_b16 v[134:135], v248 offset:11680
    ds_read_b64_tr_b16 v[136:137], v248 offset:11552
    ds_read_b64_tr_b16 v[138:139], v248 offset:11712
    s_waitcnt lgkmcnt(10)
    v_mfma_f32_16x16x32_bf16 v[240:243], v[108:111], v[104:107], v[240:243]
    v_mfma_f32_16x16x32_bf16 v[236:239], v[112:115], v[104:107], v[236:239]
    ds_read_b128 v[140:143], v246 offset:0
    ds_read_b64_tr_b16 v[144:145], v248 offset:12800
    ds_read_b64_tr_b16 v[146:147], v248 offset:12960
    ds_read_b64_tr_b16 v[148:149], v248 offset:12832
    ds_read_b64_tr_b16 v[150:151], v248 offset:12992
    s_waitcnt lgkmcnt(10)
    v_mfma_f32_16x16x32_bf16 v[240:243], v[120:123], v[116:119], v[240:243]
    v_mfma_f32_16x16x32_bf16 v[236:239], v[124:127], v[116:119], v[236:239]
    ds_read_b128 v[152:155], v247 offset:0
    ds_read_b64_tr_b16 v[156:157], v248 offset:14080
    ds_read_b64_tr_b16 v[158:159], v248 offset:14240
    ds_read_b64_tr_b16 v[160:161], v248 offset:14112
    ds_read_b64_tr_b16 v[162:163], v248 offset:14272
    s_waitcnt lgkmcnt(10)
    v_mfma_f32_16x16x32_bf16 v[240:243], v[132:135], v[128:131], v[240:243]
    v_mfma_f32_16x16x32_bf16 v[236:239], v[136:139], v[128:131], v[236:239]
    ds_read_b128 v[164:167], v246 offset:8192
    ds_read_b64_tr_b16 v[168:169], v248 offset:15360
    ds_read_b64_tr_b16 v[170:171], v248 offset:15520
    ds_read_b64_tr_b16 v[172:173], v248 offset:15392
    ds_read_b64_tr_b16 v[174:175], v248 offset:15552
    s_waitcnt lgkmcnt(10)
    v_mfma_f32_16x16x32_bf16 v[240:243], v[144:147], v[140:143], v[240:243]
    v_mfma_f32_16x16x32_bf16 v[236:239], v[148:151], v[140:143], v[236:239]
    ds_read_b128 v[176:179], v247 offset:8192
    ds_read_b64_tr_b16 v[180:181], v248 offset:16640
    ds_read_b64_tr_b16 v[182:183], v248 offset:16800
    ds_read_b64_tr_b16 v[184:185], v248 offset:16672
    ds_read_b64_tr_b16 v[186:187], v248 offset:16832
    s_waitcnt lgkmcnt(10)
    v_mfma_f32_16x16x32_bf16 v[240:243], v[156:159], v[152:155], v[240:243]
    v_mfma_f32_16x16x32_bf16 v[236:239], v[160:163], v[152:155], v[236:239]
    ds_read_b128 v[188:191], v246 offset:16384
    ds_read_b64_tr_b16 v[192:193], v248 offset:17920
    ds_read_b64_tr_b16 v[194:195], v248 offset:18080
    ds_read_b64_tr_b16 v[196:197], v248 offset:17952
    ds_read_b64_tr_b16 v[198:199], v248 offset:18112
    s_waitcnt lgkmcnt(10)
    v_mfma_f32_16x16x32_bf16 v[240:243], v[168:171], v[164:167], v[240:243]
    v_mfma_f32_16x16x32_bf16 v[236:239], v[172:175], v[164:167], v[236:239]
    ds_read_b128 v[200:203], v247 offset:16384
    ds_read_b64_tr_b16 v[204:205], v248 offset:19200
    ds_read_b64_tr_b16 v[206:207], v248 offset:19360
    ds_read_b64_tr_b16 v[208:209], v248 offset:19232
    ds_read_b64_tr_b16 v[210:211], v248 offset:19392
    s_waitcnt lgkmcnt(10)
    v_mfma_f32_16x16x32_bf16 v[240:243], v[180:183], v[176:179], v[240:243]
    v_mfma_f32_16x16x32_bf16 v[236:239], v[184:187], v[176:179], v[236:239]
    ds_read_b128 v[20:23], v246 offset:24576
    ds_read_b64_tr_b16 v[24:25], v248 offset:20480
    ds_read_b64_tr_b16 v[26:27], v248 offset:20640
    ds_read_b64_tr_b16 v[28:29], v248 offset:20512
    ds_read_b64_tr_b16 v[30:31], v248 offset:20672
    s_waitcnt lgkmcnt(10)
    v_mfma_f32_16x16x32_bf16 v[240:243], v[192:195], v[188:191], v[240:243]
    v_mfma_f32_16x16x32_bf16 v[236:239], v[196:199], v[188:191], v[236:239]
    ds_read_b128 v[32:35], v247 offset:24576
    ds_read_b64_tr_b16 v[36:37], v248 offset:21760
    ds_read_b64_tr_b16 v[38:39], v248 offset:21920
    ds_read_b64_tr_b16 v[40:41], v248 offset:21792
    ds_read_b64_tr_b16 v[42:43], v248 offset:21952
    s_waitcnt lgkmcnt(10)
    v_mfma_f32_16x16x32_bf16 v[240:243], v[204:207], v[200:203], v[240:243]
    v_mfma_f32_16x16x32_bf16 v[236:239], v[208:211], v[200:203], v[236:239]
    ds_read_b128 v[44:47], v246 offset:32768
    ds_read_b64_tr_b16 v[48:49], v248 offset:23040
    ds_read_b64_tr_b16 v[50:51], v248 offset:23200
    ds_read_b64_tr_b16 v[52:53], v248 offset:23072
    ds_read_b64_tr_b16 v[54:55], v248 offset:23232
    s_waitcnt lgkmcnt(10)
    v_mfma_f32_16x16x32_bf16 v[240:243], v[24:27], v[20:23], v[240:243]
    v_mfma_f32_16x16x32_bf16 v[236:239], v[28:31], v[20:23], v[236:239]
    ds_read_b128 v[56:59], v247 offset:32768
    ds_read_b64_tr_b16 v[60:61], v248 offset:24320
    ds_read_b64_tr_b16 v[62:63], v248 offset:24480
    ds_read_b64_tr_b16 v[64:65], v248 offset:24352
    ds_read_b64_tr_b16 v[66:67], v248 offset:24512
    s_waitcnt lgkmcnt(10)
    v_mfma_f32_16x16x32_bf16 v[240:243], v[36:39], v[32:35], v[240:243]
    v_mfma_f32_16x16x32_bf16 v[236:239], v[40:43], v[32:35], v[236:239]
    s_waitcnt lgkmcnt(5)
    v_mfma_f32_16x16x32_bf16 v[240:243], v[48:51], v[44:47], v[240:243]
    v_mfma_f32_16x16x32_bf16 v[236:239], v[52:55], v[44:47], v[236:239]
    s_waitcnt lgkmcnt(0)
    ds_add_u32 v19, v3 offset:116
    v_mfma_f32_16x16x32_bf16 v[240:243], v[60:63], v[56:59], v[240:243]
    v_mfma_f32_16x16x32_bf16 v[236:239], v[64:67], v[56:59], v[236:239]
    v_and_b32 v4, 15, v1
    s_and_b32 s77, s84, 16
    v_add_u32 v4, s77, v4
    v_lshlrev_b32 v7, 3, v4
    v_lshrrev_b32 v5, 5, v1
    v_lshlrev_b32 v5, 9, v5
    v_lshl_add_u32 v4, v4, 4, v5
    v_bfe_u32 v5, v1, 4, 1
    v_lshl_add_u32 v4, v5, 3, v4
    s_lshr_b32 s76, s84, 5
    s_mul_i32 s76, s76, 1408
    s_add_u32 s76, s76, 262144
    v_mov_b32 v6, 0
    v_cvt_pk_bf16_f32 v240, v240, v241
    v_cvt_pk_bf16_f32 v241, v242, v243
    v_cvt_pk_bf16_f32 v236, v236, v237
    v_cvt_pk_bf16_f32 v237, v238, v239
    buffer_store_dwordx2 v[240:241], v4, s[72:75], s76 offen sc1
    s_mov_b32 exec_hi, 0
    s_mov_b32 exec_lo, 0xffff0000
    v_mov_b32 v236, 0x3f803f80
    v_mov_b32 v237, 0x3f80
    v_lshl_add_u32 v7, v1, 3, 64
    v_add_u32 v7, 64, v7
    s_mov_b32 exec_lo, -1
    buffer_store_dwordx2 v[236:237], v7, s[72:75], s76 offen offset:1024 sc1
    s_mov_b32 exec_lo, 0xffff
    v_dot2_f32_bf16 v6, v236, v236, v6
    v_dot2_f32_bf16 v6, v237, v237, v6
    s_mov_b64 exec, -1
    v_dot2_f32_bf16 v6, v240, v240, v6
    v_dot2_f32_bf16 v6, v241, v241, v6
    s_nop 2
    v_mov_b32 v7, v6
    s_nop 1
    v_permlane16_swap_b32 v6, v7
    v_add_f32 v6, v6, v7
    v_mov_b32 v7, v6
    s_nop 1
    v_permlane32_swap_b32 v6, v7
    v_add_f32 v6, v6, v7
    s_nop 1
    v_max_f32_dpp v6, v6, v6 row_ror:8 row_mask:0xf bank_mask:0xf
    s_nop 1
    v_max_f32_dpp v6, v6, v6 row_ror:4 row_mask:0xf bank_mask:0xf
    s_nop 1
    v_max_f32_dpp v6, v6, v6 row_ror:2 row_mask:0xf bank_mask:0xf
    s_nop 1
    v_max_f32_dpp v6, v6, v6 row_ror:1 row_mask:0xf bank_mask:0xf
    v_mov_b32 v9, v6
    s_branch L_P0pub
L_P0V:
    ds_read_b128 v[20:23], v244 offset:0
    ds_read_b64_tr_b16 v[24:25], v248 offset:0
    ds_read_b64_tr_b16 v[26:27], v248 offset:160
    ds_read_b64_tr_b16 v[28:29], v248 offset:32
    ds_read_b64_tr_b16 v[30:31], v248 offset:192
    ds_read_b128 v[32:35], v245 offset:0
    ds_read_b64_tr_b16 v[36:37], v248 offset:1280
    ds_read_b64_tr_b16 v[38:39], v248 offset:1440
    ds_read_b64_tr_b16 v[40:41], v248 offset:1312
    ds_read_b64_tr_b16 v[42:43], v248 offset:1472
    ds_read_b128 v[44:47], v244 offset:8192
    ds_read_b64_tr_b16 v[48:49], v248 offset:2560
    ds_read_b64_tr_b16 v[50:51], v248 offset:2720
    ds_read_b64_tr_b16 v[52:53], v248 offset:2592
    ds_read_b64_tr_b16 v[54:55], v248 offset:2752
    s_waitcnt lgkmcnt(10)
    v_mfma_f32_16x16x32_bf16 v[240:243], v[20:23], v[24:27], 0
    v_mfma_f32_16x16x32_bf16 v[236:239], v[20:23], v[28:31], 0
    ds_read_b128 v[56:59], v245 offset:8192
    ds_read_b64_tr_b16 v[60:61], v248 offset:3840
    ds_read_b64_tr_b16 v[62:63], v248 offset:4000
    ds_read_b64_tr_b16 v[64:65], v248 offset:3872
    ds_read_b64_tr_b16 v[66:67], v248 offset:4032
    s_waitcnt lgkmcnt(10)
    v_mfma_f32_16x16x32_bf16 v[240:243], v[32:35], v[36:39], v[240:243]
    v_mfma_f32_16x16x32_bf16 v[236:239], v[32:35], v[40:43], v[236:239]
    ds_read_b128 v[68:71], v244 offset:16384
    ds_read_b64_tr_b16 v[72:73], v248 offset:5120
    ds_read_b64_tr_b16 v[74:75], v248 offset:5280
    ds_read_b64_tr_b16 v[76:77], v248 offset:5152
    ds_read_b64_tr_b16 v[78:79], v248 offset:5312
    s_waitcnt lgkmcnt(10)
    v_mfma_f32_16x16x32_bf16 v[240:243], v[44:47], v[48:51], v[240:243]
    v_mfma_f32_16x16x32_bf16 v[236:239], v[44:47], v[52:55], v[236:239]
    ds_read_b128 v[80:83], v245 offset:16384
    ds_read_b64_tr_b16 v[84:85], v248 offset:6400
    ds_read_b64_tr_b16 v[86:87], v248 offset:6560
    ds_read_b64_tr_b16 v[88:89], v248 offset:6432
    ds_read_b64_tr_b16 v[90:91], v248 offset:6592
    s_waitcnt lgkmcnt(10)
    v_mfma_f32_16x16x32_bf16 v[240:243], v[56:59], v[60:63], v[240:243]
    v_mfma_f32_16x16x32_bf16 v[236:239], v[56:59], v[64:67], v[236:239]
    ds_read_b128 v[92:95], v244 offset:24576
    ds_read_b64_tr_b16 v[96:97], v248 offset:7680
    ds_read_b64_tr_b16 v[98:99], v248 offset:7840
    ds_read_b64_tr_b16 v[100:101], v248 offset:7712
    ds_read_b64_tr_b16 v[102:103], v248 offset:7872
    s_waitcnt lgkmcnt(10)
    v_mfma_f32_16x16x32_bf16 v[240:243], v[68:71], v[72:75], v[240:243]
    v_mfma_f32_16x16x32_bf16 v[236:239], v[68:71], v[76:79], v[236:239]
    ds_read_b128 v[104:107], v245 offset:24576
    ds_read_b64_tr_b16 v[108:109], v248 offset:8960
    ds_read_b64_tr_b16 v[110:111], v248 offset:9120
    ds_read_b64_tr_b16 v[112:113], v248 offset:8992
    ds_read_b64_tr_b16 v[114:115], v248 offset:9152
    s_waitcnt lgkmcnt(10)
    v_mfma_f32_16x16x32_bf16 v[240:243], v[80:83], v[84:87], v[240:243]
    v_mfma_f32_16x16x32_bf16 v[236:239], v[80:83], v[88:91], v[236:239]
    ds_read_b128 v[116:119], v244 offset:32768
    ds_read_b64_tr_b16 v[120:121], v248 offset:10240
    ds_read_b64_tr_b16 v[122:123], v248 offset:10400
    ds_read_b64_tr_b16 v[124:125], v248 offset:10272
    ds_read_b64_tr_b16 v[126:127], v248 offset:10432
    s_waitcnt lgkmcnt(10)
    v_mfma_f32_16x16x32_bf16 v[240:243], v[92:95], v[96:99], v[240:243]
    v_mfma_f32_16x16x32_bf16 v[236:239], v[92:95], v[100:103], v[236:239]
    ds_read_b128 v[128:131], v245 offset:32768
    ds_read_b64_tr_b16 v[132:133], v248 offset:11520
    ds_read_b64_tr_b16 v[134:135], v248 offset:11680
    ds_read_b64_tr_b16 v[136:137], v248 offset:11552
    ds_read_b64_tr_b16 v[138:139], v248 offset:11712
    s_waitcnt lgkmcnt(10)
    v_mfma_f32_16x16x32_bf16 v[240:243], v[104:107], v[108:111], v[240:243]
    v_mfma_f32_16x16x32_bf16 v[236:239], v[104:107], v[112:115], v[236:239]
    ds_read_b128 v[140:143], v246 offset:0
    ds_read_b64_tr_b16 v[144:145], v248 offset:12800
    ds_read_b64_tr_b16 v[146:147], v248 offset:12960
    ds_read_b64_tr_b16 v[148:149], v248 offset:12832
    ds_read_b64_tr_b16 v[150:151], v248 offset:12992
    s_waitcnt lgkmcnt(10)
    v_mfma_f32_16x16x32_bf16 v[240:243], v[116:119], v[120:123], v[240:243]
    v_mfma_f32_16x16x32_bf16 v[236:239], v[116:119], v[124:127], v[236:239]
    ds_read_b128 v[152:155], v247 offset:0
    ds_read_b64_tr_b16 v[156:157], v248 offset:14080
    ds_read_b64_tr_b16 v[158:159], v248 offset:14240
    ds_read_b64_tr_b16 v[160:161], v248 offset:14112
    ds_read_b64_tr_b16 v[162:163], v248 offset:14272
    s_waitcnt lgkmcnt(10)
    v_mfma_f32_16x16x32_bf16 v[240:243], v[128:131], v[132:135], v[240:243]
    v_mfma_f32_16x16x32_bf16 v[236:239], v[128:131], v[136:139], v[236:239]
    ds_read_b128 v[164:167], v246 offset:8192
    ds_read_b64_tr_b16 v[168:169], v248 offset:15360
    ds_read_b64_tr_b16 v[170:171], v248 offset:15520
    ds_read_b64_tr_b16 v[172:173], v248 offset:15392
    ds_read_b64_tr_b16 v[174:175], v248 offset:15552
    s_waitcnt lgkmcnt(10)
    v_mfma_f32_16x16x32_bf16 v[240:243], v[140:143], v[144:147], v[240:243]
    v_mfma_f32_16x16x32_bf16 v[236:239], v[140:143], v[148:151], v[236:239]
    ds_read_b128 v[176:179], v247 offset:8192
    ds_read_b64_tr_b16 v[180:181], v248 offset:16640
    ds_read_b64_tr_b16 v[182:183], v248 offset:16800
    ds_read_b64_tr_b16 v[184:185], v248 offset:16672
    ds_read_b64_tr_b16 v[186:187], v248 offset:16832
    s_waitcnt lgkmcnt(10)
    v_mfma_f32_16x16x32_bf16 v[240:243], v[152:155], v[156:159], v[240:243]
    v_mfma_f32_16x16x32_bf16 v[236:239], v[152:155], v[160:163], v[236:239]
    ds_read_b128 v[188:191], v246 offset:16384
    ds_read_b64_tr_b16 v[192:193], v248 offset:17920
    ds_read_b64_tr_b16 v[194:195], v248 offset:18080
    ds_read_b64_tr_b16 v[196:197], v248 offset:17952
    ds_read_b64_tr_b16 v[198:199], v248 offset:18112
    s_waitcnt lgkmcnt(10)
    v_mfma_f32_16x16x32_bf16 v[240:243], v[164:167], v[168:171], v[240:243]
    v_mfma_f32_16x16x32_bf16 v[236:239], v[164:167], v[172:175], v[236:239]
    ds_read_b128 v[200:203], v247 offset:16384
    ds_read_b64_tr_b16 v[204:205], v248 offset:19200
    ds_read_b64_tr_b16 v[206:207], v248 offset:19360
    ds_read_b64_tr_b16 v[208:209], v248 offset:19232
    ds_read_b64_tr_b16 v[210:211], v248 offset:19392
    s_waitcnt lgkmcnt(10)
    v_mfma_f32_16x16x32_bf16 v[240:243], v[176:179], v[180:183], v[240:243]
    v_mfma_f32_16x16x32_bf16 v[236:239], v[176:179], v[184:187], v[236:239]
    ds_read_b128 v[20:23], v246 offset:24576
    ds_read_b64_tr_b16 v[24:25], v248 offset:20480
    ds_read_b64_tr_b16 v[26:27], v248 offset:20640
    ds_read_b64_tr_b16 v[28:29], v248 offset:20512
    ds_read_b64_tr_b16 v[30:31], v248 offset:20672
    s_waitcnt lgkmcnt(10)
    v_mfma_f32_16x16x32_bf16 v[240:243], v[188:191], v[192:195], v[240:243]
    v_mfma_f32_16x16x32_bf16 v[236:239], v[188:191], v[196:199], v[236:239]
    ds_read_b128 v[32:35], v247 offset:24576
    ds_read_b64_tr_b16 v[36:37], v248 offset:21760
    ds_read_b64_tr_b16 v[38:39], v248 offset:21920
    ds_read_b64_tr_b16 v[40:41], v248 offset:21792
    ds_read_b64_tr_b16 v[42:43], v248 offset:21952
    s_waitcnt lgkmcnt(10)
    v_mfma_f32_16x16x32_bf16 v[240:243], v[200:203], v[204:207], v[240:243]
    v_mfma_f32_16x16x32_bf16 v[236:239], v[200:203], v[208:211], v[236:239]
    ds_read_b128 v[44:47], v246 offset:32768
    ds_read_b64_tr_b16 v[48:49], v248 offset:23040
    ds_read_b64_tr_b16 v[50:51], v248 offset:23200
    ds_read_b64_tr_b16 v[52:53], v248 offset:23072
    ds_read_b64_tr_b16 v[54:55], v248 offset:23232
    s_waitcnt lgkmcnt(10)
    v_mfma_f32_16x16x32_bf16 v[240:243], v[20:23], v[24:27], v[240:243]
    v_mfma_f32_16x16x32_bf16 v[236:239], v[20:23], v[28:31], v[236:239]
    ds_read_b128 v[56:59], v247 offset:32768
    ds_read_b64_tr_b16 v[60:61], v248 offset:24320
    ds_read_b64_tr_b16 v[62:63], v248 offset:24480
    ds_read_b64_tr_b16 v[64:65], v248 offset:24352
    ds_read_b64_tr_b16 v[66:67], v248 offset:24512
    s_waitcnt lgkmcnt(10)
    v_mfma_f32_16x16x32_bf16 v[240:243], v[32:35], v[36:39], v[240:243]
    v_mfma_f32_16x16x32_bf16 v[236:239], v[32:35], v[40:43], v[236:239]
    s_waitcnt lgkmcnt(5)
    v_mfma_f32_16x16x32_bf16 v[240:243], v[44:47], v[48:51], v[240:243]
    v_mfma_f32_16x16x32_bf16 v[236:239], v[44:47], v[52:55], v[236:239]
    s_waitcnt lgkmcnt(0)
    ds_add_u32 v19, v3 offset:116
    v_mfma_f32_16x16x32_bf16 v[240:243], v[56:59], v[60:63], v[240:243]
    v_mfma_f32_16x16x32_bf16 v[236:239], v[56:59], v[64:67], v[236:239]
    v_and_b32 v4, 15, v1
    v_lshrrev_b32 v5, 5, v1
    v_bfe_u32 v6, v1, 4, 1
    v_lshlrev_b32 v6, 3, v6
    v_lshl_add_u32 v6, v4, 4, v6
    v_lshl_add_u32 v7, v5, 7, v6
    v_lshl_add_u32 v5, v5, 8, v6
    s_mul_i32 s76, s84, 48
    s_add_u32 s76, s76, 393216
    v_cvt_pk_bf16_f32 v240, v240, v241
    v_cvt_pk_bf16_f32 v241, v242, v243
    v_cvt_pk_bf16_f32 v236, v236, v237
    v_cvt_pk_bf16_f32 v237, v238, v239
    buffer_store_dwordx2 v[240:241], v5, s[72:75], s76 offen sc1
    s_mov_b32 exec_lo, 0x00f000f0
    s_mov_b32 exec_hi, 0x00f000f0
    v_mov_b32 v236, 0x3f803f80
    v_mov_b32 v237, 0x3f803f80
    s_mov_b32 exec_lo, 0x00ff00ff
    s_mov_b32 exec_hi, 0x00ff00ff
    buffer_store_dwordx2 v[236:237], v7, s[72:75], s76 offen offset:512 sc1
    s_mov_b64 exec, -1
    v_mov_b32 v9, 0
L_P0pub:
    s_waitcnt vmcnt(2)
    v_readfirstlane_b32 s6, v249
    s_nop 0
    s_mul_i32 s6, s6, 0x41C64E6D
    s_add_u32 s6, s6, 0x3039
    v_mov_b32 v8, s6
    s_getreg_b32 s87, hwreg(HW_REG_XCC_ID, 0, 4)
    v_add_u32 v9, 15, v9
    v_and_b32 v9, -16, v9
    v_or_b32 v9, s87, v9
    s_lshl_b32 s76, s2, 3
    s_add_u32 s76, s76, 4096
    v_mov_b32 v4, 0
    s_waitcnt vmcnt(0)
    s_mov_b64 exec, 1
    buffer_store_dwordx2 v[8:9], v4, s[72:75], s76 offen sc1
    ds_write_b32 v2, v8 offset:632
    s_mov_b64 exec, -1
    s_mul_i32 s83, s5, 160
    v_add_u32 v4, 0, v1
    v_mul_u32_u24 v5, 6554, v4
    v_lshrrev_b32 v5, 16, v5
    v_mul_u32_u24 v6, 10, v5
    v_sub_u32 v4, v4, v6
    v_and_b32 v6, 0x13, v5
    v_and_b32 v7, 4, v5
    v_lshl_or_b32 v6, v7, 1, v6
    v_bfe_u32 v7, v5, 3, 1
    v_lshl_or_b32 v6, v7, 2, v6
    v_mul_u32_u24 v6, 1280, v6
    v_lshl_add_u32 v4, v4, 4, v6
    v_add_u32 v10, s83, v4
    v_add_u32 v4, 64, v1
    v_mul_u32_u24 v5, 6554, v4
    v_lshrrev_b32 v5, 16, v5
    v_mul_u32_u24 v6, 10, v5
    v_sub_u32 v4, v4, v6
    v_and_b32 v6, 0x13, v5
    v_and_b32 v7, 4, v5
    v_lshl_or_b32 v6, v7, 1, v6
    v_bfe_u32 v7, v5, 3, 1
    v_lshl_or_b32 v6, v7, 2, v6
    v_mul_u32_u24 v6, 1280, v6
    v_lshl_add_u32 v4, v4, 4, v6
    v_add_u32 v11, s83, v4
    v_add_u32 v4, 128, v1
    v_mul_u32_u24 v5, 6554, v4
    v_lshrrev_b32 v5, 16, v5
    v_mul_u32_u24 v6, 10, v5
    v_sub_u32 v4, v4, v6
    v_and_b32 v6, 0x13, v5
    v_and_b32 v7, 4, v5
    v_lshl_or_b32 v6, v7, 1, v6
    v_bfe_u32 v7, v5, 3, 1
    v_lshl_or_b32 v6, v7, 2, v6
    v_mul_u32_u24 v6, 1280, v6
    v_lshl_add_u32 v4, v4, 4, v6
    v_add_u32 v12, s83, v4
    v_add_u32 v4, 192, v1
    v_mul_u32_u24 v5, 6554, v4
    v_lshrrev_b32 v5, 16, v5
    v_mul_u32_u24 v6, 10, v5
    v_sub_u32 v4, v4, v6
    v_and_b32 v6, 0x13, v5
    v_and_b32 v7, 4, v5
    v_lshl_or_b32 v6, v7, 1, v6
    v_bfe_u32 v7, v5, 3, 1
    v_lshl_or_b32 v6, v7, 2, v6
    v_mul_u32_u24 v6, 1280, v6
    v_lshl_add_u32 v4, v4, 4, v6
    v_add_u32 v13, s83, v4
    v_add_u32 v4, 256, v1
    v_mul_u32_u24 v5, 6554, v4
    v_lshrrev_b32 v5, 16, v5
    v_mul_u32_u24 v6, 10, v5
    v_sub_u32 v4, v4, v6
    v_and_b32 v6, 0x13, v5
    v_and_b32 v7, 4, v5
    v_lshl_or_b32 v6, v7, 1, v6
    v_bfe_u32 v7, v5, 3, 1
    v_lshl_or_b32 v6, v7, 2, v6
    v_mul_u32_u24 v6, 1280, v6
    v_lshl_add_u32 v4, v4, 4, v6
    v_add_u32 v14, s83, v4
    s_mul_i32 s76, s5, 160
    s_lshl_b32 s77, s15, 6
    v_add_u32 v4, s77, v1
    v_add_u32 v4, 0, v4
    v_mul_u32_u24 v5, 2185, v4
    v_lshrrev_b32 v5, 16, v5
    v_mul_u32_u24 v6, 30, v5
    v_sub_u32 v4, v4, v6
    v_and_b32 v6, 0x13, v5
    v_and_b32 v7, 4, v5
    v_lshl_or_b32 v6, v7, 1, v6
    v_bfe_u32 v7, v5, 3, 1
    v_lshl_or_b32 v6, v7, 2, v6
    v_mul_u32_u24 v6, 3840, v6
    v_mul_u32_u24 v7, 26, v4
    v_lshrrev_b32 v7, 8, v7
    v_mul_u32_u24 v7, 1120, v7
    v_lshl_add_u32 v4, v4, 4, v6
    v_add3_u32 v20, v4, v7, s76
    v_add_u32 v4, s77, v1
    v_add_u32 v4, 256, v4
    v_mul_u32_u24 v5, 2185, v4
    v_lshrrev_b32 v5, 16, v5
    v_mul_u32_u24 v6, 30, v5
    v_sub_u32 v4, v4, v6
    v_and_b32 v6, 0x13, v5
    v_and_b32 v7, 4, v5
    v_lshl_or_b32 v6, v7, 1, v6
    v_bfe_u32 v7, v5, 3, 1
    v_lshl_or_b32 v6, v7, 2, v6
    v_mul_u32_u24 v6, 3840, v6
    v_mul_u32_u24 v7, 26, v4
    v_lshrrev_b32 v7, 8, v7
    v_mul_u32_u24 v7, 1120, v7
    v_lshl_add_u32 v4, v4, 4, v6
    v_add3_u32 v21, v4, v7, s76
    v_add_u32 v4, s77, v1
    v_add_u32 v4, 512, v4
    v_mul_u32_u24 v5, 2185, v4
    v_lshrrev_b32 v5, 16, v5
    v_mul_u32_u24 v6, 30, v5
    v_sub_u32 v4, v4, v6
    v_and_b32 v6, 0x13, v5
    v_and_b32 v7, 4, v5
    v_lshl_or_b32 v6, v7, 1, v6
    v_bfe_u32 v7, v5, 3, 1
    v_lshl_or_b32 v6, v7, 2, v6
    v_mul_u32_u24 v6, 3840, v6
    v_mul_u32_u24 v7, 26, v4
    v_lshrrev_b32 v7, 8, v7
    v_mul_u32_u24 v7, 1120, v7
    v_lshl_add_u32 v4, v4, 4, v6
    v_add3_u32 v22, v4, v7, s76
    v_add_u32 v4, s77, v1
    v_add_u32 v4, 768, v4
    v_mul_u32_u24 v5, 2185, v4
    v_lshrrev_b32 v5, 16, v5
    v_mul_u32_u24 v6, 30, v5
    v_sub_u32 v4, v4, v6
    v_and_b32 v6, 0x13, v5
    v_and_b32 v7, 4, v5
    v_lshl_or_b32 v6, v7, 1, v6
    v_bfe_u32 v7, v5, 3, 1
    v_lshl_or_b32 v6, v7, 2, v6
    v_mul_u32_u24 v6, 3840, v6
    v_mul_u32_u24 v7, 26, v4
    v_lshrrev_b32 v7, 8, v7
    v_mul_u32_u24 v7, 1120, v7
    v_lshl_add_u32 v4, v4, 4, v6
    v_add3_u32 v23, v4, v7, s76
    v_and_b32 v4, 15, v1
    v_lshrrev_b32 v5, 1, v4
    v_lshrrev_b32 v6, 4, v1
    v_xor_b32 v5, v5, v6
    v_lshlrev_b32 v5, 4, v5
    v_lshl_add_u32 v226, v4, 7, v5
    s_and_b32 s76, s15, 1
    s_lshl_b32 s76, s76, 12
    s_lshl_b32 s64, s12, 13
    s_sub_u32 s65, 40960, s64
    s_add_u32 s77, s76, s64
    v_add_u32 v24, s77, v226
    s_add_u32 s77, s76, s65
    v_add_u32 v26, s77, v226
    v_xor_b32 v25, 64, v24
    v_xor_b32 v27, 64, v26
    s_mul_i32 s8, s12, 245760
    s_sub_u32 s9, 1228800, s8
    s_lshr_b32 s76, s2, 3
    s_lshl2_add_u32 s76, s76, s15
    s_mul_i32 s76, s76, 6400
    v_lshlrev_b32 v30, 7, v1
    v_add_u32 v30, s76, v30
    v_lshrrev_b32 v4, 5, v1
    v_bfe_u32 v5, v1, 2, 3
    v_lshl_add_u32 v4, v4, 4, v5
    v_mul_u32_u24 v4, 480, v4
    v_and_b32 v5, 3, v1
    v_lshl_add_u32 v28, v5, 3, v4
    v_add_u32 v28, 102400, v28
    v_and_b32 v4, 15, v1
    v_lshrrev_b32 v5, 4, v1
    s_lshr_b32 s76, s15, 1
    s_mul_i32 s76, s76, 80
    s_and_b32 s78, s15, 1
    s_mul_i32 s77, s78, 5120
    s_add_u32 s76, s76, s77
    v_mul_u32_u24 v6, 320, v4
    v_lshl_add_u32 v6, v5, 4, v6
    s_add_u32 s77, s76, 102400
    v_add_u32 v192, s77, v6
    s_add_u32 s77, s76, 112640
    v_add_u32 v193, s77, v6
    v_min_u32 v7, 7, v4
    v_mul_u32_u24 v7, 320, v7
    v_lshl_add_u32 v7, v5, 4, v7
    v_add_u32 v194, s77, v7
    v_lshrrev_b32 v6, 2, v1
    v_and_b32 v7, 3, v1
    v_mul_u32_u24 v8, 320, v6
    v_lshl_add_u32 v8, v7, 3, v8
    s_add_u32 s77, s76, 125440
    v_add_u32 v195, s77, v8
    v_min_u32 v6, 7, v6
    v_mul_u32_u24 v8, 320, v6
    v_lshl_add_u32 v8, v7, 3, v8
    v_add_u32 v196, s77, v8
    v_cmp_eq_u32 vcc, 0, v7
    v_mov_b32 v6, 162944
    v_add_u32 v8, 32, v195
    v_add_u32 v9, 5152, v196
    v_cndmask_b32 v197, v6, v8, vcc
    v_cndmask_b32 v198, v6, v9, vcc
    v_add_u32 v8, 192, v195
    v_add_u32 v9, 5312, v196
    v_cndmask_b32 v199, v6, v8, vcc
    v_cndmask_b32 v200, v6, v9, vcc
    v_add_u32 v8, 40, v195
    v_add_u32 v9, 5160, v196
    v_cndmask_b32 v201, v6, v8, vcc
    v_cndmask_b32 v202, v6, v9, vcc
    v_add_u32 v8, 200, v195
    v_add_u32 v9, 5320, v196
    v_cndmask_b32 v203, v6, v8, vcc
    v_cndmask_b32 v204, v6, v9, vcc
    v_mul_u32_u24 v205, 160, v4
    v_lshl_add_u32 v205, v5, 3, v205
    v_add_u32 v205, 102400, v205
    s_lshl_b32 s77, s78, 7
    v_lshl_add_u32 v207, v4, 3, v2
    v_add_u32 v207, s77, v207
    v_lshrrev_b32 v6, 3, v4
    v_mul_u32_u24 v6, 40960, v6
    v_and_b32 v7, 7, v4
    v_lshl_add_u32 v6, v7, 5, v6
    v_and_b32 v7, 1, v5
    v_lshl_add_u32 v6, v7, 4, v6
    v_lshrrev_b32 v7, 1, v5
    v_lshl_add_u32 v206, v7, 8, v6
    v_lshlrev_b32 v224, 5, v4
    v_lshl_add_u32 v224, v5, 3, v224
    v_bfe_u32 v6, v1, 1, 4
    v_mul_u32_u24 v6, 160, v6
    v_lshrrev_b32 v7, 5, v1
    v_lshl_add_u32 v6, v7, 5, v6
    v_and_b32 v7, 1, v1
    v_lshl_add_u32 v225, v7, 4, v6
    s_or_b32 s78, s78, s4
    s_cselect_b32 s78, 0, 8
    v_lshlrev_b32 v5, 2, v5
    v_sub_u32 v6, v5, v4
    v_mov_b32 v7, 4048155338
    v_add_u32 v8, -1, v6
    v_cmp_gt_u32 vcc, 8, v8
    s_nop 1
    v_cndmask_b32 v208, v7, 0, vcc
    v_add_u32 v8, 0, v5
    v_cmp_le_u32 vcc, s78, v8
    s_nop 1
    v_cndmask_b32 v208, v7, v208, vcc
    v_add_u32 v8, 0, v6
    v_cmp_gt_u32 vcc, 8, v8
    s_nop 1
    v_cndmask_b32 v209, v7, 0, vcc
    v_add_u32 v8, 1, v5
    v_cmp_le_u32 vcc, s78, v8
    s_nop 1
    v_cndmask_b32 v209, v7, v209, vcc
    v_add_u32 v8, 1, v6
    v_cmp_gt_u32 vcc, 8, v8
    s_nop 1
    v_cndmask_b32 v210, v7, 0, vcc
    v_add_u32 v8, 2, v5
    v_cmp_le_u32 vcc, s78, v8
    s_nop 1
    v_cndmask_b32 v210, v7, v210, vcc
    v_add_u32 v8, 2, v6
    v_cmp_gt_u32 vcc, 8, v8
    s_nop 1
    v_cndmask_b32 v211, v7, 0, vcc
    v_add_u32 v8, 3, v5
    v_cmp_le_u32 vcc, s78, v8
    s_nop 1
    v_cndmask_b32 v211, v7, v211, vcc
    v_add_u32 v8, 15, v6
    v_cmp_gt_u32 vcc, 8, v8
    s_nop 1
    v_cndmask_b32 v212, v7, 0, vcc
    v_add_u32 v8, 16, v6
    v_cmp_gt_u32 vcc, 8, v8
    s_nop 1
    v_cndmask_b32 v213, v7, 0, vcc
    v_add_u32 v8, 17, v6
    v_cmp_gt_u32 vcc, 8, v8
    s_nop 1
    v_cndmask_b32 v214, v7, 0, vcc
    v_add_u32 v8, 18, v6
    v_cmp_gt_u32 vcc, 8, v8
    s_nop 1
    v_cndmask_b32 v215, v7, 0, vcc
    s_mov_b32 s44, s18
    s_mov_b32 s45, s19
    s_mov_b32 s46, 2457600
    s_mov_b32 s47, 0x20000
    s_lshl_b32 s10, s15, 10
    s_add_u32 s10, s10, 102400
    s_mov_b32 s7, 0x20000
Lp_13:
    ds_read_b32 v4, v2 offset:80
    s_waitcnt lgkmcnt(0)
    v_readfirstlane_b32 s76, v4
    s_nop 0
    s_cmp_ge_u32 s76, 4
    s_cbranch_scc1 Lpd_14
    s_sub_u32 s7, s7, 1
    s_cmp_lg_u32 s7, 0
    s_cbranch_scc1 Lp_13
Lpd_14:
    s_add_u32 m0, s10, 0
    s_nop 0
    buffer_load_dwordx4 v20, s[44:47], s8 offen lds
    s_add_u32 m0, s10, 4096
    s_nop 0
    buffer_load_dwordx4 v21, s[44:47], s8 offen lds
    s_add_u32 m0, s10, 8192
    s_nop 0
    buffer_load_dwordx4 v22, s[44:47], s8 offen lds
    s_mov_b32 s7, 0x20000
Lp_15:
    ds_read_b32 v4, v2 offset:84
    s_waitcnt lgkmcnt(0)
    v_readfirstlane_b32 s76, v4
    s_nop 0
    s_cmp_ge_u32 s76, 4
    s_cbranch_scc1 Lpd_16
    s_sub_u32 s7, s7, 1
    s_cmp_lg_u32 s7, 0
    s_cbranch_scc1 Lp_15
Lpd_16:
    v_lshlrev_b32 v4, 5, v1
    s_movk_i32 s76, 4096
    s_mov_b32 s7, 0x8000
L_gpoll:
    buffer_load_dwordx4 v[120:123], v4, s[72:75], s76 offen sc1
    buffer_load_dwordx4 v[124:127], v4, s[72:75], s76 offen offset:16 sc1
    s_waitcnt vmcnt(0)
    v_cmp_eq_u32 vcc, s6, v120
    v_cmp_eq_u32 s[78:79], s6, v122
    v_cmp_eq_u32 s[80:81], s6, v124
    v_cmp_eq_u32 s[82:83], s6, v126
    s_and_b64 vcc, vcc, s[78:79]
    s_and_b64 s[80:81], s[80:81], s[82:83]
    s_and_b64 vcc, vcc, s[80:81]
    s_cmp_eq_u64 vcc, -1
    s_cbranch_scc1 L_gdone
    s_sleep 4
    s_sub_u32 s7, s7, 1
    s_cmp_lg_u32 s7, 0
    s_cbranch_scc1 L_gpoll
L_gdone:
    ds_add_u32 v19, v3 offset:40
    s_bitcmp1_b32 s2, 0
    s_cselect_b64 vcc, -1, 0
    v_cndmask_b32 v128, v121, v123, vcc
    v_cndmask_b32 v129, v125, v127, vcc
    s_bitcmp1_b32 s2, 1
    s_cselect_b64 vcc, -1, 0
    v_cndmask_b32 v128, v128, v129, vcc
    v_and_b32 v128, 15, v128
    v_cmp_ne_u32 vcc, s87, v128
    s_bfe_u32 s78, s2, 0x10002
    s_lshl_b32 s78, 0x55555555, s78
    s_or_b32 s79, vcc_lo, vcc_hi
    s_and_b32 s79, s79, s78
    s_cselect_b32 s79, 0, 1
    v_mov_b32 v128, s79
    v_max3_f32 v121, v121, v123, v125
    v_max_f32 v121, v121, v127
    s_nop 1
    v_max_f32_dpp v121, v121, v121 row_ror:8 row_mask:0xf bank_mask:0xf
    s_nop 1
    v_max_f32_dpp v121, v121, v121 row_ror:4 row_mask:0xf bank_mask:0xf
    s_nop 1
    v_max_f32_dpp v121, v121, v121 row_ror:2 row_mask:0xf bank_mask:0xf
    s_nop 1
    v_max_f32_dpp v121, v121, v121 row_ror:1 row_mask:0xf bank_mask:0xf
    v_mov_b32 v122, v121
    s_nop 1
    v_permlane16_swap_b32 v121, v122
    v_max_f32 v121, v121, v122
    v_mov_b32 v122, v121
    s_nop 1
    v_permlane32_swap_b32 v121, v122
    v_max_f32 v121, v121, v122
    s_mov_b64 exec, 1
    ds_write_b32 v2, v121 offset:120
    ds_write_b32 v2, v128 offset:112
    s_cmp_lg_u32 s2, 0
    s_cbranch_scc1 L_noepoch
    v_mov_b32 v4, 0
    v_mov_b32 v8, s6
    buffer_store_dword v8, v4, s[72:75], 0 offen sc1
L_noepoch:
    s_mov_b64 exec, -1
    s_branch L_g_join2
L_g_join:
    s_mov_b32 s44, s18
    s_mov_b32 s45, s19
    s_mov_b32 s46, 2457600
    s_mov_b32 s47, 0x20000
    s_lshl_b32 s10, s15, 10
    s_add_u32 s10, s10, 102400
    s_mul_i32 s78, s2, 3
    s_add_u32 s78, s78, s15
    s_mul_i32 s78, s78, 3200
    v_lshlrev_b32 v4, 7, v1
    s_mov_b32 exec_lo, 0x1ffffff
    s_mov_b32 exec_hi, 0
    buffer_load_dword v0, v4, s[44:47], s78 offen
    s_mov_b64 exec, -1
    s_mov_b32 s7, 0x20000
Lp_17:
    ds_read_b32 v4, v2 offset:80
    s_waitcnt lgkmcnt(0)
    v_readfirstlane_b32 s76, v4
    s_nop 0
    s_cmp_ge_u32 s76, 4
    s_cbranch_scc1 Lpd_18
    s_sub_u32 s7, s7, 1
    s_cmp_lg_u32 s7, 0
    s_cbranch_scc1 Lp_17
Lpd_18:
    s_mov_b32 s7, 0x20000
Lp_19:
    ds_read_b32 v4, v2 offset:116
    s_waitcnt lgkmcnt(0)
    v_readfirstlane_b32 s76, v4
    s_nop 0
    s_cmp_ge_u32 s76, 1
    s_cbranch_scc1 Lpd_20
    s_sub_u32 s7, s7, 1
    s_cmp_lg_u32 s7, 0
    s_cbranch_scc1 Lp_19
Lpd_20:
    s_add_u32 m0, s10, 0
    s_nop 0
    buffer_load_dwordx4 v20, s[44:47], s8 offen lds
    s_add_u32 m0, s10, 4096
    s_nop 0
    buffer_load_dwordx4 v21, s[44:47], s8 offen lds
    s_add_u32 m0, s10, 8192
    s_nop 0
    buffer_load_dwordx4 v22, s[44:47], s8 offen lds
    s_add_u32 m0, s10, 12288
    s_nop 0
    buffer_load_dwordx4 v23, s[44:47], s8 offen lds
L_g_join2:
    s_waitcnt vmcnt(0) lgkmcnt(0)
    s_setprio 0
    s_barrier
    s_branch L_gmain
L_M:
    s_lshl2_add_u32 s84, s4, s3
    s_mul_i32 s84, s84, 20480
    s_lshl_b32 s85, s3, 11
    s_cmp_lg_u32 s3, 0
    s_cbranch_scc1 L_m_noinit
    v_mov_b64 v[4:5], 0
    v_mov_b64 v[6:7], 0
    v_add_u32 v8, v17, v2
    ds_write_b128 v8, v[4:7]
    v_mov_b32 v4, 0x3f803f80
    v_mov_b32 v5, 0x3f803f80
    ds_write_b64 v2, v[4:5] offset:128
L_m_noinit:
    v_and_b32 v4, 15, v1
    v_lshrrev_b32 v5, 1, v4
    v_lshrrev_b32 v6, 4, v1
    v_xor_b32 v5, v5, v6
    v_lshlrev_b32 v5, 4, v5
    v_lshl_add_u32 v76, v4, 7, v5
    v_add_u32 v76, s85, v76
    v_lshrrev_b32 v4, 5, v1
    v_bfe_u32 v5, v1, 2, 3
    v_lshl_add_u32 v4, v4, 4, v5
    v_mul_u32_u24 v4, 160, v4
    v_and_b32 v5, 3, v1
    v_lshl_add_u32 v77, v5, 3, v4
    v_add_u32 v77, 81920, v77
    v_and_b32 v4, 48, v1
    v_add_u32 v79, 158720, v4
    v_and_b32 v4, 31, v1
    v_lshrrev_b32 v5, 5, v1
    v_min_u32 v230, 32, v1
    v_lshlrev_b32 v230, 3, v230
    v_lshlrev_b32 v6, 8, v5
    v_lshl_add_u32 v231, v4, 4, v6
    v_lshlrev_b32 v6, 7, v5
    v_lshl_add_u32 v6, v4, 4, v6
    v_add_u32 v6, 256, v6
    v_cmp_lt_u32 vcc, 15, v4
    s_nop 1
    v_cndmask_b32 v231, v231, v6, vcc
    v_mov_b32 v7, 0x7fffffff
    v_cmp_lt_u32 vcc, 20, v4
    s_nop 1
    v_cndmask_b32 v231, v231, v7, vcc
    s_and_b32 s10, s3, 1
    s_mul_i32 s8, s10, 45056
    s_add_u32 s8, s8, 262144
    s_mul_i32 s9, s10, 49152
    s_add_u32 s9, s9, 393216
    v_mul_u32_u24 v6, 160, v4
    v_lshl_add_u32 v6, v5, 4, v6
    s_lshr_b32 s76, s3, 1
    s_mul_i32 s76, s76, 80
    s_add_u32 s76, s76, 148480
    s_mul_i32 s77, s10, 5120
    v_add_u32 v6, s76, v6
    v_add_u32 v10, s77, v6
    s_sub_u32 s77, 5120, s77
    v_add_u32 v11, s77, v6
    s_lshl_b32 s77, s10, 7
    v_lshl_add_u32 v12, v4, 2, v2
    v_add_u32 v12, s77, v12
    v_mov_b32 v228, 0xdddddddd
    v_and_b32 v4, 15, v1
    v_lshrrev_b32 v5, 4, v1
    s_lshl_b32 s77, s3, 4
    v_add_u32 v4, s77, v4
    v_mul_u32_u24 v13, 160, v4
    v_lshl_add_u32 v13, v5, 3, v13
    v_add_u32 v13, 148480, v13
    v_lshl_add_u32 v14, v4, 2, v2
    v_mov_b64 v[232:233], 0
    v_mov_b64 v[234:235], 0
    v_mov_b64 v[236:237], 0
    v_mov_b64 v[238:239], 0
    v_mov_b64 v[240:241], 0
    v_mov_b64 v[242:243], 0
    v_mov_b64 v[244:245], 0
    v_mov_b64 v[246:247], 0
    v_mov_b64 v[248:249], 0
    v_mov_b64 v[250:251], 0
    v_mov_b64 v[252:253], 0
    v_mov_b64 v[254:255], 0
    v_mov_b64 v[84:85], 0
    v_mov_b64 v[86:87], 0
    v_mov_b64 v[88:89], 0
    v_mov_b64 v[90:91], 0
    v_mov_b64 v[92:93], 0
    v_mov_b64 v[94:95], 0
    v_mov_b64 v[96:97], 0
    v_mov_b64 v[98:99], 0
    v_mov_b64 v[100:101], 0
    v_mov_b64 v[102:103], 0
    v_mov_b64 v[104:105], 0
    v_mov_b64 v[106:107], 0
    v_mov_b64 v[108:109], 0
    v_mov_b64 v[110:111], 0
    v_mov_b64 v[112:113], 0
    v_mov_b64 v[114:115], 0
    v_mov_b64 v[116:117], 0
    v_mov_b64 v[118:119], 0
    v_mov_b64 v[120:121], 0
    v_mov_b64 v[122:123], 0
    v_mov_b64 v[124:125], 0
    v_mov_b64 v[126:127], 0
    v_mov_b64 v[128:129], 0
    v_mov_b64 v[130:131], 0
    v_mov_b64 v[132:133], 0
    v_mov_b64 v[134:135], 0
    v_mov_b64 v[136:137], 0
    v_mov_b64 v[138:139], 0
    v_mov_b64 v[140:141], 0
    v_mov_b64 v[142:143], 0
    v_mov_b64 v[144:145], 0
    v_mov_b64 v[146:147], 0
    v_mov_b64 v[220:221], 0
    v_mov_b64 v[222:223], 0
    v_mov_b64 v[224:225], 0
    v_mov_b64 v[226:227], 0
    v_add_u32 v78, 56320, v77
    s_add_u32 s78, s13, 0
    s_cmp_ge_u32 s78, 10
    s_cselect_b32 s79, 10, 0
    s_sub_u32 s78, s78, s79
    s_lshl_b32 s79, s78, 13
    s_lshl_b32 s78, s78, 7
    v_add_u32 v148, s79, v76
    v_add_u32 v150, s78, v79
    v_xor_b32 v149, 64, v148
    s_add_u32 s78, s13, 1
    s_cmp_ge_u32 s78, 10
    s_cselect_b32 s79, 10, 0
    s_sub_u32 s78, s78, s79
    s_lshl_b32 s79, s78, 13
    s_lshl_b32 s78, s78, 7
    v_add_u32 v151, s79, v76
    v_add_u32 v153, s78, v79
    v_xor_b32 v152, 64, v151
    s_add_u32 s78, s13, 2
    s_cmp_ge_u32 s78, 10
    s_cselect_b32 s79, 10, 0
    s_sub_u32 s78, s78, s79
    s_lshl_b32 s79, s78, 13
    s_lshl_b32 s78, s78, 7
    v_add_u32 v154, s79, v76
    v_add_u32 v156, s78, v79
    v_xor_b32 v155, 64, v154
    s_add_u32 s78, s13, 3
    s_cmp_ge_u32 s78, 10
    s_cselect_b32 s79, 10, 0
    s_sub_u32 s78, s78, s79
    s_lshl_b32 s79, s78, 13
    s_lshl_b32 s78, s78, 7
    v_add_u32 v157, s79, v76
    v_add_u32 v159, s78, v79
    v_xor_b32 v158, 64, v157
    s_add_u32 s78, s13, 4
    s_cmp_ge_u32 s78, 10
    s_cselect_b32 s79, 10, 0
    s_sub_u32 s78, s78, s79
    s_lshl_b32 s79, s78, 13
    s_lshl_b32 s78, s78, 7
    v_add_u32 v160, s79, v76
    v_add_u32 v162, s78, v79
    v_xor_b32 v161, 64, v160
    s_add_u32 s78, s13, 5
    s_cmp_ge_u32 s78, 10
    s_cselect_b32 s79, 10, 0
    s_sub_u32 s78, s78, s79
    s_lshl_b32 s79, s78, 13
    s_lshl_b32 s78, s78, 7
    v_add_u32 v163, s79, v76
    v_add_u32 v165, s78, v79
    v_xor_b32 v164, 64, v163
    s_add_u32 s78, s13, 6
    s_cmp_ge_u32 s78, 10
    s_cselect_b32 s79, 10, 0
    s_sub_u32 s78, s78, s79
    s_lshl_b32 s79, s78, 13
    s_lshl_b32 s78, s78, 7
    v_add_u32 v166, s79, v76
    v_add_u32 v168, s78, v79
    v_xor_b32 v167, 64, v166
    s_add_u32 s78, s13, 7
    s_cmp_ge_u32 s78, 10
    s_cselect_b32 s79, 10, 0
    s_sub_u32 s78, s78, s79
    s_lshl_b32 s79, s78, 13
    s_lshl_b32 s78, s78, 7
    v_add_u32 v169, s79, v76
    v_add_u32 v171, s78, v79
    v_xor_b32 v170, 64, v169
    s_add_u32 s78, s13, 8
    s_cmp_ge_u32 s78, 10
    s_cselect_b32 s79, 10, 0
    s_sub_u32 s78, s78, s79
    s_lshl_b32 s79, s78, 13
    s_lshl_b32 s78, s78, 7
    v_add_u32 v172, s79, v76
    v_add_u32 v174, s78, v79
    v_xor_b32 v173, 64, v172
    s_add_u32 s78, s13, 9
    s_cmp_ge_u32 s78, 10
    s_cselect_b32 s79, 10, 0
    s_sub_u32 s78, s78, s79
    s_lshl_b32 s79, s78, 13
    s_lshl_b32 s78, s78, 7
    v_add_u32 v175, s79, v76
    v_add_u32 v177, s78, v79
    v_xor_b32 v176, 64, v175
    s_waitcnt lgkmcnt(0)
    s_cmp_eq_u32 s3, s14
    s_cbranch_scc1 L_m_nox1
    s_add_u32 s81, s13, 0
    s_cmp_ge_u32 s81, 10
    s_cselect_b32 s77, 10, 0
    s_sub_u32 s81, s81, s77
    s_lshl_b32 s82, s81, 7
    s_add_u32 s82, s82, s84
    s_lshl_b32 s83, s81, 13
    s_add_u32 s83, s83, s85
    s_add_u32 m0, s83, 0
    s_nop 0
    buffer_load_dwordx4 v15, s[40:43], s82 offen lds
    s_add_u32 m0, s83, 1024
    s_nop 0
    buffer_load_dwordx4 v16, s[40:43], s82 offen lds
    s_add_u32 s81, s13, 1
    s_cmp_ge_u32 s81, 10
    s_cselect_b32 s77, 10, 0
    s_sub_u32 s81, s81, s77
    s_lshl_b32 s82, s81, 7
    s_add_u32 s82, s82, s84
    s_lshl_b32 s83, s81, 13
    s_add_u32 s83, s83, s85
    s_add_u32 m0, s83, 0
    s_nop 0
    buffer_load_dwordx4 v15, s[40:43], s82 offen lds
    s_add_u32 m0, s83, 1024
    s_nop 0
    buffer_load_dwordx4 v16, s[40:43], s82 offen lds
    s_add_u32 s81, s13, 2
    s_cmp_ge_u32 s81, 10
    s_cselect_b32 s77, 10, 0
    s_sub_u32 s81, s81, s77
    s_lshl_b32 s82, s81, 7
    s_add_u32 s82, s82, s84
    s_lshl_b32 s83, s81, 13
    s_add_u32 s83, s83, s85
    s_add_u32 m0, s83, 0
    s_nop 0
    buffer_load_dwordx4 v15, s[40:43], s82 offen lds
    s_add_u32 m0, s83, 1024
    s_nop 0
    buffer_load_dwordx4 v16, s[40:43], s82 offen lds
    s_add_u32 s81, s13, 3
    s_cmp_ge_u32 s81, 10
    s_cselect_b32 s77, 10, 0
    s_sub_u32 s81, s81, s77
    s_lshl_b32 s82, s81, 7
    s_add_u32 s82, s82, s84
    s_lshl_b32 s83, s81, 13
    s_add_u32 s83, s83, s85
    s_add_u32 m0, s83, 0
    s_nop 0
    buffer_load_dwordx4 v15, s[40:43], s82 offen lds
    s_add_u32 m0, s83, 1024
    s_nop 0
    buffer_load_dwordx4 v16, s[40:43], s82 offen lds
    s_add_u32 s81, s13, 4
    s_cmp_ge_u32 s81, 10
    s_cselect_b32 s77, 10, 0
    s_sub_u32 s81, s81, s77
    s_lshl_b32 s82, s81, 7
    s_add_u32 s82, s82, s84
    s_lshl_b32 s83, s81, 13
    s_add_u32 s83, s83, s85
    s_add_u32 m0, s83, 0
    s_nop 0
    buffer_load_dwordx4 v15, s[40:43], s82 offen lds
    s_add_u32 m0, s83, 1024
    s_nop 0
    buffer_load_dwordx4 v16, s[40:43], s82 offen lds
    s_waitcnt vmcnt(10)
    s_branch L_m_nox2
L_m_nox1:
    s_waitcnt vmcnt(0)
L_m_nox2:
    s_barrier
    s_mov_b32 s7, 0x20000
Lp_21:
    ds_read_b32 v4, v2 offset:0
    s_waitcnt lgkmcnt(0)
    v_readfirstlane_b32 s76, v4
    s_nop 0
    s_cmp_ge_u32 s76, 1
    s_cbranch_scc1 Lpd_22
    s_sub_u32 s7, s7, 1
    s_cmp_lg_u32 s7, 0
    s_cbranch_scc1 Lp_21
Lpd_22:
    s_waitcnt vmcnt(8)
    ds_read_b128 v[20:23], v148
    ds_read_b128 v[44:47], v150 offset:0
    ds_read_b64_tr_b16 v[24:25], v77 offset:35840
    ds_read_b64_tr_b16 v[26:27], v77 offset:37120
    ds_read_b64_tr_b16 v[28:29], v77 offset:35872
    ds_read_b64_tr_b16 v[30:31], v77 offset:37152
    ds_read_b64_tr_b16 v[32:33], v77 offset:35904
    ds_read_b64_tr_b16 v[34:35], v77 offset:37184
    ds_read_b64_tr_b16 v[36:37], v77 offset:35936
    ds_read_b64_tr_b16 v[38:39], v77 offset:37216
    ds_read_b64_tr_b16 v[40:41], v77 offset:35968
    ds_read_b64_tr_b16 v[42:43], v77 offset:37248
    ds_read_b32 v80, v2 offset:4
    s_waitcnt lgkmcnt(10)
    v_mfma_f32_16x16x32_bf16 v[252:255], v[44:47], v[20:23], v[252:255]
    ds_read_b128 v[48:51], v149
    ds_read_b128 v[72:75], v150 offset:64
    s_waitcnt lgkmcnt(10)
    v_mfma_f32_16x16x32_bf16 v[232:235], v[24:27], v[20:23], v[232:235]
    ds_read_b64_tr_b16 v[52:53], v77 offset:40960
    ds_read_b64_tr_b16 v[54:55], v77 offset:42240
    s_waitcnt lgkmcnt(10)
    v_mfma_f32_16x16x32_bf16 v[236:239], v[28:31], v[20:23], v[236:239]
    ds_read_b64_tr_b16 v[56:57], v77 offset:40992
    ds_read_b64_tr_b16 v[58:59], v77 offset:42272
    s_waitcnt lgkmcnt(10)
    v_mfma_f32_16x16x32_bf16 v[240:243], v[32:35], v[20:23], v[240:243]
    ds_read_b64_tr_b16 v[60:61], v77 offset:41024
    ds_read_b64_tr_b16 v[62:63], v77 offset:42304
    s_waitcnt lgkmcnt(10)
    v_mfma_f32_16x16x32_bf16 v[244:247], v[36:39], v[20:23], v[244:247]
    ds_read_b64_tr_b16 v[64:65], v77 offset:41056
    ds_read_b64_tr_b16 v[66:67], v77 offset:42336
    s_waitcnt lgkmcnt(10)
    v_mfma_f32_16x16x32_bf16 v[248:251], v[40:43], v[20:23], v[248:251]
    ds_read_b64_tr_b16 v[68:69], v77 offset:41088
    ds_read_b64_tr_b16 v[70:71], v77 offset:42368
    s_waitcnt lgkmcnt(10)
    v_mfma_f32_16x16x32_bf16 v[252:255], v[72:75], v[48:51], v[252:255]
    v_readfirstlane_b32 s76, v80
    s_nop 0
    s_cmp_lt_u32 s76, 1
    s_cbranch_scc1 Lslow_23
Lback_24:
    s_waitcnt vmcnt(6)
    ds_read_b128 v[20:23], v151
    ds_read_b128 v[44:47], v153 offset:0
    s_waitcnt lgkmcnt(10)
    v_mfma_f32_16x16x32_bf16 v[232:235], v[52:55], v[48:51], v[232:235]
    ds_read_b64_tr_b16 v[24:25], v77 offset:46080
    ds_read_b64_tr_b16 v[26:27], v77 offset:47360
    s_waitcnt lgkmcnt(10)
    v_mfma_f32_16x16x32_bf16 v[236:239], v[56:59], v[48:51], v[236:239]
    ds_read_b64_tr_b16 v[28:29], v77 offset:46112
    ds_read_b64_tr_b16 v[30:31], v77 offset:47392
    s_waitcnt lgkmcnt(10)
    v_mfma_f32_16x16x32_bf16 v[240:243], v[60:63], v[48:51], v[240:243]
    ds_read_b64_tr_b16 v[32:33], v77 offset:46144
    ds_read_b64_tr_b16 v[34:35], v77 offset:47424
    s_waitcnt lgkmcnt(10)
    v_mfma_f32_16x16x32_bf16 v[244:247], v[64:67], v[48:51], v[244:247]
    ds_read_b64_tr_b16 v[36:37], v77 offset:46176
    ds_read_b64_tr_b16 v[38:39], v77 offset:47456
    s_waitcnt lgkmcnt(10)
    v_mfma_f32_16x16x32_bf16 v[248:251], v[68:71], v[48:51], v[248:251]
    ds_read_b64_tr_b16 v[40:41], v77 offset:46208
    ds_read_b64_tr_b16 v[42:43], v77 offset:47488
    ds_add_u32 v19, v3 offset:64
    ds_read_b32 v80, v2 offset:8
    s_waitcnt lgkmcnt(10)
    v_mfma_f32_16x16x32_bf16 v[252:255], v[44:47], v[20:23], v[252:255]
    ds_read_b128 v[48:51], v152
    ds_read_b128 v[72:75], v153 offset:64
    s_waitcnt lgkmcnt(10)
    v_mfma_f32_16x16x32_bf16 v[232:235], v[24:27], v[20:23], v[232:235]
    ds_read_b64_tr_b16 v[52:53], v77 offset:51200
    ds_read_b64_tr_b16 v[54:55], v77 offset:52480
    s_waitcnt lgkmcnt(10)
    v_mfma_f32_16x16x32_bf16 v[236:239], v[28:31], v[20:23], v[236:239]
    ds_read_b64_tr_b16 v[56:57], v77 offset:51232
    ds_read_b64_tr_b16 v[58:59], v77 offset:52512
    s_waitcnt lgkmcnt(10)
    v_mfma_f32_16x16x32_bf16 v[240:243], v[32:35], v[20:23], v[240:243]
    ds_read_b64_tr_b16 v[60:61], v77 offset:51264
    ds_read_b64_tr_b16 v[62:63], v77 offset:52544
    s_waitcnt lgkmcnt(10)
    v_mfma_f32_16x16x32_bf16 v[244:247], v[36:39], v[20:23], v[244:247]
    ds_read_b64_tr_b16 v[64:65], v77 offset:51296
    ds_read_b64_tr_b16 v[66:67], v77 offset:52576
    s_waitcnt lgkmcnt(10)
    v_mfma_f32_16x16x32_bf16 v[248:251], v[40:43], v[20:23], v[248:251]
    ds_read_b64_tr_b16 v[68:69], v77 offset:51328
    ds_read_b64_tr_b16 v[70:71], v77 offset:52608
    s_waitcnt lgkmcnt(10)
    v_mfma_f32_16x16x32_bf16 v[252:255], v[72:75], v[48:51], v[252:255]
    v_readfirstlane_b32 s76, v80
    s_nop 0
    s_cmp_lt_u32 s76, 1
    s_cbranch_scc1 Lslow_27
Lback_28:
    s_waitcnt vmcnt(4)
    ds_read_b128 v[20:23], v154
    ds_read_b128 v[44:47], v156 offset:0
    s_waitcnt lgkmcnt(10)
    v_mfma_f32_16x16x32_bf16 v[232:235], v[52:55], v[48:51], v[232:235]
    ds_read_b64_tr_b16 v[24:25], v78 offset:0
    ds_read_b64_tr_b16 v[26:27], v78 offset:1280
    s_waitcnt lgkmcnt(10)
    v_mfma_f32_16x16x32_bf16 v[236:239], v[56:59], v[48:51], v[236:239]
    ds_read_b64_tr_b16 v[28:29], v78 offset:32
    ds_read_b64_tr_b16 v[30:31], v78 offset:1312
    s_waitcnt lgkmcnt(10)
    v_mfma_f32_16x16x32_bf16 v[240:243], v[60:63], v[48:51], v[240:243]
    ds_read_b64_tr_b16 v[32:33], v78 offset:64
    ds_read_b64_tr_b16 v[34:35], v78 offset:1344
    s_waitcnt lgkmcnt(10)
    v_mfma_f32_16x16x32_bf16 v[244:247], v[64:67], v[48:51], v[244:247]
    ds_read_b64_tr_b16 v[36:37], v78 offset:96
    ds_read_b64_tr_b16 v[38:39], v78 offset:1376
    s_waitcnt lgkmcnt(10)
    v_mfma_f32_16x16x32_bf16 v[248:251], v[68:71], v[48:51], v[248:251]
    ds_read_b64_tr_b16 v[40:41], v78 offset:128
    ds_read_b64_tr_b16 v[42:43], v78 offset:1408
    ds_add_u32 v19, v3 offset:68
    ds_read_b32 v80, v2 offset:12
    s_waitcnt lgkmcnt(10)
    v_mfma_f32_16x16x32_bf16 v[252:255], v[44:47], v[20:23], v[252:255]
    ds_read_b128 v[48:51], v155
    ds_read_b128 v[72:75], v156 offset:64
    s_waitcnt lgkmcnt(10)
    v_mfma_f32_16x16x32_bf16 v[232:235], v[24:27], v[20:23], v[232:235]
    ds_read_b64_tr_b16 v[52:53], v78 offset:5120
    ds_read_b64_tr_b16 v[54:55], v78 offset:6400
    s_waitcnt lgkmcnt(10)
    v_mfma_f32_16x16x32_bf16 v[236:239], v[28:31], v[20:23], v[236:239]
    ds_read_b64_tr_b16 v[56:57], v78 offset:5152
    ds_read_b64_tr_b16 v[58:59], v78 offset:6432
    s_waitcnt lgkmcnt(10)
    v_mfma_f32_16x16x32_bf16 v[240:243], v[32:35], v[20:23], v[240:243]
    ds_read_b64_tr_b16 v[60:61], v78 offset:5184
    ds_read_b64_tr_b16 v[62:63], v78 offset:6464
    s_waitcnt lgkmcnt(10)
    v_mfma_f32_16x16x32_bf16 v[244:247], v[36:39], v[20:23], v[244:247]
    ds_read_b64_tr_b16 v[64:65], v78 offset:5216
    ds_read_b64_tr_b16 v[66:67], v78 offset:6496
    s_waitcnt lgkmcnt(10)
    v_mfma_f32_16x16x32_bf16 v[248:251], v[40:43], v[20:23], v[248:251]
    ds_read_b64_tr_b16 v[68:69], v78 offset:5248
    ds_read_b64_tr_b16 v[70:71], v78 offset:6528
    s_waitcnt lgkmcnt(10)
    v_mfma_f32_16x16x32_bf16 v[252:255], v[72:75], v[48:51], v[252:255]
    v_readfirstlane_b32 s76, v80
    s_nop 0
    s_cmp_lt_u32 s76, 1
    s_cbranch_scc1 Lslow_31
Lback_32:
    s_waitcnt vmcnt(2)
    ds_read_b128 v[20:23], v157
    ds_read_b128 v[44:47], v159 offset:0
    s_waitcnt lgkmcnt(10)
    v_mfma_f32_16x16x32_bf16 v[232:235], v[52:55], v[48:51], v[232:235]
    ds_read_b64_tr_b16 v[24:25], v78 offset:10240
    ds_read_b64_tr_b16 v[26:27], v78 offset:11520
    s_waitcnt lgkmcnt(10)
    v_mfma_f32_16x16x32_bf16 v[236:239], v[56:59], v[48:51], v[236:239]
    ds_read_b64_tr_b16 v[28:29], v78 offset:10272
    ds_read_b64_tr_b16 v[30:31], v78 offset:11552
    s_waitcnt lgkmcnt(10)
    v_mfma_f32_16x16x32_bf16 v[240:243], v[60:63], v[48:51], v[240:243]
    ds_read_b64_tr_b16 v[32:33], v78 offset:10304
    ds_read_b64_tr_b16 v[34:35], v78 offset:11584
    s_waitcnt lgkmcnt(10)
    v_mfma_f32_16x16x32_bf16 v[244:247], v[64:67], v[48:51], v[244:247]
    ds_read_b64_tr_b16 v[36:37], v78 offset:10336
    ds_read_b64_tr_b16 v[38:39], v78 offset:11616
    s_waitcnt lgkmcnt(10)
    v_mfma_f32_16x16x32_bf16 v[248:251], v[68:71], v[48:51], v[248:251]
    ds_read_b64_tr_b16 v[40:41], v78 offset:10368
    ds_read_b64_tr_b16 v[42:43], v78 offset:11648
    ds_add_u32 v19, v3 offset:72
    ds_read_b32 v80, v2 offset:16
    s_waitcnt lgkmcnt(10)
    v_mfma_f32_16x16x32_bf16 v[252:255], v[44:47], v[20:23], v[252:255]
    ds_read_b128 v[48:51], v158
    ds_read_b128 v[72:75], v159 offset:64
    s_waitcnt lgkmcnt(10)
    v_mfma_f32_16x16x32_bf16 v[232:235], v[24:27], v[20:23], v[232:235]
    ds_read_b64_tr_b16 v[52:53], v78 offset:15360
    ds_read_b64_tr_b16 v[54:55], v78 offset:16640
    s_waitcnt lgkmcnt(10)
    v_mfma_f32_16x16x32_bf16 v[236:239], v[28:31], v[20:23], v[236:239]
    ds_read_b64_tr_b16 v[56:57], v78 offset:15392
    ds_read_b64_tr_b16 v[58:59], v78 offset:16672
    s_waitcnt lgkmcnt(10)
    v_mfma_f32_16x16x32_bf16 v[240:243], v[32:35], v[20:23], v[240:243]
    ds_read_b64_tr_b16 v[60:61], v78 offset:15424
    ds_read_b64_tr_b16 v[62:63], v78 offset:16704
    s_waitcnt lgkmcnt(10)
    v_mfma_f32_16x16x32_bf16 v[244:247], v[36:39], v[20:23], v[244:247]
    ds_read_b64_tr_b16 v[64:65], v78 offset:15456
    ds_read_b64_tr_b16 v[66:67], v78 offset:16736
    s_waitcnt lgkmcnt(10)
    v_mfma_f32_16x16x32_bf16 v[248:251], v[40:43], v[20:23], v[248:251]
    ds_read_b64_tr_b16 v[68:69], v78 offset:15488
    ds_read_b64_tr_b16 v[70:71], v78 offset:16768
    s_waitcnt lgkmcnt(10)
    v_mfma_f32_16x16x32_bf16 v[252:255], v[72:75], v[48:51], v[252:255]
    v_readfirstlane_b32 s76, v80
    s_nop 0
    s_cmp_lt_u32 s76, 1
    s_cbranch_scc1 Lslow_35
Lback_36:
    s_waitcnt vmcnt(0)
    ds_read_b128 v[20:23], v160
    ds_read_b128 v[44:47], v162 offset:0
    s_waitcnt lgkmcnt(10)
    v_mfma_f32_16x16x32_bf16 v[232:235], v[52:55], v[48:51], v[232:235]
    ds_read_b64_tr_b16 v[24:25], v77 offset:25600
    ds_read_b64_tr_b16 v[26:27], v77 offset:26880
    s_waitcnt lgkmcnt(10)
    v_mfma_f32_16x16x32_bf16 v[236:239], v[56:59], v[48:51], v[236:239]
    ds_read_b64_tr_b16 v[28:29], v77 offset:25632
    ds_read_b64_tr_b16 v[30:31], v77 offset:26912
    s_waitcnt lgkmcnt(10)
    v_mfma_f32_16x16x32_bf16 v[240:243], v[60:63], v[48:51], v[240:243]
    ds_read_b64_tr_b16 v[32:33], v77 offset:25664
    ds_read_b64_tr_b16 v[34:35], v77 offset:26944
    s_waitcnt lgkmcnt(10)
    v_mfma_f32_16x16x32_bf16 v[244:247], v[64:67], v[48:51], v[244:247]
    ds_read_b64_tr_b16 v[36:37], v77 offset:25696
    ds_read_b64_tr_b16 v[38:39], v77 offset:26976
    s_waitcnt lgkmcnt(10)
    v_mfma_f32_16x16x32_bf16 v[248:251], v[68:71], v[48:51], v[248:251]
    ds_read_b64_tr_b16 v[40:41], v77 offset:25728
    ds_read_b64_tr_b16 v[42:43], v77 offset:27008
    ds_add_u32 v19, v3 offset:76
    ds_read_b32 v80, v2 offset:20
    s_waitcnt lgkmcnt(10)
    v_mfma_f32_16x16x32_bf16 v[252:255], v[44:47], v[20:23], v[252:255]
    ds_read_b128 v[48:51], v161
    ds_read_b128 v[72:75], v162 offset:64
    s_waitcnt lgkmcnt(10)
    v_mfma_f32_16x16x32_bf16 v[232:235], v[24:27], v[20:23], v[232:235]
    ds_read_b64_tr_b16 v[52:53], v77 offset:30720
    ds_read_b64_tr_b16 v[54:55], v77 offset:32000
    s_waitcnt lgkmcnt(10)
    v_mfma_f32_16x16x32_bf16 v[236:239], v[28:31], v[20:23], v[236:239]
    ds_read_b64_tr_b16 v[56:57], v77 offset:30752
    ds_read_b64_tr_b16 v[58:59], v77 offset:32032
    s_waitcnt lgkmcnt(10)
    v_mfma_f32_16x16x32_bf16 v[240:243], v[32:35], v[20:23], v[240:243]
    ds_read_b64_tr_b16 v[60:61], v77 offset:30784
    ds_read_b64_tr_b16 v[62:63], v77 offset:32064
    s_waitcnt lgkmcnt(10)
    v_mfma_f32_16x16x32_bf16 v[244:247], v[36:39], v[20:23], v[244:247]
    ds_read_b64_tr_b16 v[64:65], v77 offset:30816
    ds_read_b64_tr_b16 v[66:67], v77 offset:32096
    s_waitcnt lgkmcnt(10)
    v_mfma_f32_16x16x32_bf16 v[248:251], v[40:43], v[20:23], v[248:251]
    ds_read_b64_tr_b16 v[68:69], v77 offset:30848
    ds_read_b64_tr_b16 v[70:71], v77 offset:32128
    s_waitcnt lgkmcnt(10)
    v_mfma_f32_16x16x32_bf16 v[252:255], v[72:75], v[48:51], v[252:255]
    v_readfirstlane_b32 s76, v80
    s_nop 0
    s_cmp_lt_u32 s76, 1
    s_cbranch_scc1 Lslow_39
Lback_40:
    ds_read_b128 v[20:23], v163
    ds_read_b128 v[44:47], v165 offset:0
    s_waitcnt lgkmcnt(10)
    v_mfma_f32_16x16x32_bf16 v[232:235], v[52:55], v[48:51], v[232:235]
    ds_read_b64_tr_b16 v[24:25], v77 offset:0
    ds_read_b64_tr_b16 v[26:27], v77 offset:1280
    s_waitcnt lgkmcnt(10)
    v_mfma_f32_16x16x32_bf16 v[236:239], v[56:59], v[48:51], v[236:239]
    ds_read_b64_tr_b16 v[28:29], v77 offset:32
    ds_read_b64_tr_b16 v[30:31], v77 offset:1312
    s_waitcnt lgkmcnt(10)
    v_mfma_f32_16x16x32_bf16 v[240:243], v[60:63], v[48:51], v[240:243]
    ds_read_b64_tr_b16 v[32:33], v77 offset:64
    ds_read_b64_tr_b16 v[34:35], v77 offset:1344
    s_waitcnt lgkmcnt(10)
    v_mfma_f32_16x16x32_bf16 v[244:247], v[64:67], v[48:51], v[244:247]
    ds_read_b64_tr_b16 v[36:37], v77 offset:96
    ds_read_b64_tr_b16 v[38:39], v77 offset:1376
    s_waitcnt lgkmcnt(10)
    v_mfma_f32_16x16x32_bf16 v[248:251], v[68:71], v[48:51], v[248:251]
    ds_read_b64_tr_b16 v[40:41], v77 offset:128
    ds_read_b64_tr_b16 v[42:43], v77 offset:1408
    ds_add_u32 v19, v3 offset:80
    ds_read_b32 v80, v2 offset:24
    s_waitcnt lgkmcnt(10)
    v_mfma_f32_16x16x32_bf16 v[252:255], v[44:47], v[20:23], v[252:255]
    ds_read_b128 v[48:51], v164
    ds_read_b128 v[72:75], v165 offset:64
    s_waitcnt lgkmcnt(10)
    v_mfma_f32_16x16x32_bf16 v[232:235], v[24:27], v[20:23], v[232:235]
    ds_read_b64_tr_b16 v[52:53], v77 offset:5120
    ds_read_b64_tr_b16 v[54:55], v77 offset:6400
    s_waitcnt lgkmcnt(10)
    v_mfma_f32_16x16x32_bf16 v[236:239], v[28:31], v[20:23], v[236:239]
    ds_read_b64_tr_b16 v[56:57], v77 offset:5152
    ds_read_b64_tr_b16 v[58:59], v77 offset:6432
    s_waitcnt lgkmcnt(10)
    v_mfma_f32_16x16x32_bf16 v[240:243], v[32:35], v[20:23], v[240:243]
    ds_read_b64_tr_b16 v[60:61], v77 offset:5184
    ds_read_b64_tr_b16 v[62:63], v77 offset:6464
    s_waitcnt lgkmcnt(10)
    v_mfma_f32_16x16x32_bf16 v[244:247], v[36:39], v[20:23], v[244:247]
    ds_read_b64_tr_b16 v[64:65], v77 offset:5216
    ds_read_b64_tr_b16 v[66:67], v77 offset:6496
    s_waitcnt lgkmcnt(10)
    v_mfma_f32_16x16x32_bf16 v[248:251], v[40:43], v[20:23], v[248:251]
    ds_read_b64_tr_b16 v[68:69], v77 offset:5248
    ds_read_b64_tr_b16 v[70:71], v77 offset:6528
    s_waitcnt lgkmcnt(10)
    v_mfma_f32_16x16x32_bf16 v[252:255], v[72:75], v[48:51], v[252:255]
    v_readfirstlane_b32 s76, v80
    s_nop 0
    s_cmp_lt_u32 s76, 1
    s_cbranch_scc1 Lslow_43
Lback_44:
    ds_read_b128 v[20:23], v166
    ds_read_b128 v[44:47], v168 offset:0
    s_waitcnt lgkmcnt(10)
    v_mfma_f32_16x16x32_bf16 v[232:235], v[52:55], v[48:51], v[232:235]
    ds_read_b64_tr_b16 v[24:25], v77 offset:10240
    ds_read_b64_tr_b16 v[26:27], v77 offset:11520
    s_waitcnt lgkmcnt(10)
    v_mfma_f32_16x16x32_bf16 v[236:239], v[56:59], v[48:51], v[236:239]
    ds_read_b64_tr_b16 v[28:29], v77 offset:10272
    ds_read_b64_tr_b16 v[30:31], v77 offset:11552
    s_waitcnt lgkmcnt(10)
    v_mfma_f32_16x16x32_bf16 v[240:243], v[60:63], v[48:51], v[240:243]
    ds_read_b64_tr_b16 v[32:33], v77 offset:10304
    ds_read_b64_tr_b16 v[34:35], v77 offset:11584
    s_waitcnt lgkmcnt(10)
    v_mfma_f32_16x16x32_bf16 v[244:247], v[64:67], v[48:51], v[244:247]
    ds_read_b64_tr_b16 v[36:37], v77 offset:10336
    ds_read_b64_tr_b16 v[38:39], v77 offset:11616
    s_waitcnt lgkmcnt(10)
    v_mfma_f32_16x16x32_bf16 v[248:251], v[68:71], v[48:51], v[248:251]
    ds_read_b64_tr_b16 v[40:41], v77 offset:10368
    ds_read_b64_tr_b16 v[42:43], v77 offset:11648
    ds_add_u32 v19, v3 offset:84
    ds_read_b32 v80, v2 offset:28
    s_waitcnt lgkmcnt(10)
    v_mfma_f32_16x16x32_bf16 v[252:255], v[44:47], v[20:23], v[252:255]
    ds_read_b128 v[48:51], v167
    ds_read_b128 v[72:75], v168 offset:64
    s_waitcnt lgkmcnt(10)
    v_mfma_f32_16x16x32_bf16 v[232:235], v[24:27], v[20:23], v[232:235]
    ds_read_b64_tr_b16 v[52:53], v77 offset:15360
    ds_read_b64_tr_b16 v[54:55], v77 offset:16640
    s_waitcnt lgkmcnt(10)
    v_mfma_f32_16x16x32_bf16 v[236:239], v[28:31], v[20:23], v[236:239]
    ds_read_b64_tr_b16 v[56:57], v77 offset:15392
    ds_read_b64_tr_b16 v[58:59], v77 offset:16672
    s_waitcnt lgkmcnt(10)
    v_mfma_f32_16x16x32_bf16 v[240:243], v[32:35], v[20:23], v[240:243]
    ds_read_b64_tr_b16 v[60:61], v77 offset:15424
    ds_read_b64_tr_b16 v[62:63], v77 offset:16704
    s_waitcnt lgkmcnt(10)
    v_mfma_f32_16x16x32_bf16 v[244:247], v[36:39], v[20:23], v[244:247]
    ds_read_b64_tr_b16 v[64:65], v77 offset:15456
    ds_read_b64_tr_b16 v[66:67], v77 offset:16736
    s_waitcnt lgkmcnt(10)
    v_mfma_f32_16x16x32_bf16 v[248:251], v[40:43], v[20:23], v[248:251]
    ds_read_b64_tr_b16 v[68:69], v77 offset:15488
    ds_read_b64_tr_b16 v[70:71], v77 offset:16768
    s_waitcnt lgkmcnt(10)
    v_mfma_f32_16x16x32_bf16 v[252:255], v[72:75], v[48:51], v[252:255]
    v_readfirstlane_b32 s76, v80
    s_nop 0
    s_cmp_lt_u32 s76, 1
    s_cbranch_scc1 Lslow_47
Lback_48:
    ds_read_b128 v[20:23], v169
    ds_read_b128 v[44:47], v171 offset:0
    s_waitcnt lgkmcnt(10)
    v_mfma_f32_16x16x32_bf16 v[232:235], v[52:55], v[48:51], v[232:235]
    ds_read_b64_tr_b16 v[24:25], v77 offset:35840
    ds_read_b64_tr_b16 v[26:27], v77 offset:37120
    s_waitcnt lgkmcnt(10)
    v_mfma_f32_16x16x32_bf16 v[236:239], v[56:59], v[48:51], v[236:239]
    ds_read_b64_tr_b16 v[28:29], v77 offset:35872
    ds_read_b64_tr_b16 v[30:31], v77 offset:37152
    s_waitcnt lgkmcnt(10)
    v_mfma_f32_16x16x32_bf16 v[240:243], v[60:63], v[48:51], v[240:243]
    ds_read_b64_tr_b16 v[32:33], v77 offset:35904
    ds_read_b64_tr_b16 v[34:35], v77 offset:37184
    s_waitcnt lgkmcnt(10)
    v_mfma_f32_16x16x32_bf16 v[244:247], v[64:67], v[48:51], v[244:247]
    ds_read_b64_tr_b16 v[36:37], v77 offset:35936
    ds_read_b64_tr_b16 v[38:39], v77 offset:37216
    s_waitcnt lgkmcnt(10)
    v_mfma_f32_16x16x32_bf16 v[248:251], v[68:71], v[48:51], v[248:251]
    ds_read_b64_tr_b16 v[40:41], v77 offset:35968
    ds_read_b64_tr_b16 v[42:43], v77 offset:37248
    ds_read_b32 v80, v2 offset:32
    s_waitcnt lgkmcnt(10)
    v_mfma_f32_16x16x32_bf16 v[252:255], v[44:47], v[20:23], v[252:255]
    ds_read_b128 v[48:51], v170
    ds_read_b128 v[72:75], v171 offset:64
    s_waitcnt lgkmcnt(10)
    v_mfma_f32_16x16x32_bf16 v[232:235], v[24:27], v[20:23], v[232:235]
    ds_read_b64_tr_b16 v[52:53], v77 offset:40960
    ds_read_b64_tr_b16 v[54:55], v77 offset:42240
    s_waitcnt lgkmcnt(10)
    v_mfma_f32_16x16x32_bf16 v[236:239], v[28:31], v[20:23], v[236:239]
    ds_read_b64_tr_b16 v[56:57], v77 offset:40992
    ds_read_b64_tr_b16 v[58:59], v77 offset:42272
    s_waitcnt lgkmcnt(10)
    v_mfma_f32_16x16x32_bf16 v[240:243], v[32:35], v[20:23], v[240:243]
    ds_read_b64_tr_b16 v[60:61], v77 offset:41024
    ds_read_b64_tr_b16 v[62:63], v77 offset:42304
    s_waitcnt lgkmcnt(10)
    v_mfma_f32_16x16x32_bf16 v[244:247], v[36:39], v[20:23], v[244:247]
    ds_read_b64_tr_b16 v[64:65], v77 offset:41056
    ds_read_b64_tr_b16 v[66:67], v77 offset:42336
    s_waitcnt lgkmcnt(10)
    v_mfma_f32_16x16x32_bf16 v[248:251], v[40:43], v[20:23], v[248:251]
    ds_read_b64_tr_b16 v[68:69], v77 offset:41088
    ds_read_b64_tr_b16 v[70:71], v77 offset:42368
    s_waitcnt lgkmcnt(10)
    v_mfma_f32_16x16x32_bf16 v[252:255], v[72:75], v[48:51], v[252:255]
    v_readfirstlane_b32 s76, v80
    s_nop 0
    s_cmp_lt_u32 s76, 1
    s_cbranch_scc1 Lslow_51
Lback_52:
    ds_read_b128 v[20:23], v172
    ds_read_b128 v[44:47], v174 offset:0
    s_waitcnt lgkmcnt(10)
    v_mfma_f32_16x16x32_bf16 v[232:235], v[52:55], v[48:51], v[232:235]
    ds_read_b64_tr_b16 v[24:25], v77 offset:46080
    ds_read_b64_tr_b16 v[26:27], v77 offset:47360
    s_waitcnt lgkmcnt(10)
    v_mfma_f32_16x16x32_bf16 v[236:239], v[56:59], v[48:51], v[236:239]
    ds_read_b64_tr_b16 v[28:29], v77 offset:46112
    ds_read_b64_tr_b16 v[30:31], v77 offset:47392
    s_waitcnt lgkmcnt(10)
    v_mfma_f32_16x16x32_bf16 v[240:243], v[60:63], v[48:51], v[240:243]
    ds_read_b64_tr_b16 v[32:33], v77 offset:46144
    ds_read_b64_tr_b16 v[34:35], v77 offset:47424
    s_waitcnt lgkmcnt(10)
    v_mfma_f32_16x16x32_bf16 v[244:247], v[64:67], v[48:51], v[244:247]
    ds_read_b64_tr_b16 v[36:37], v77 offset:46176
    ds_read_b64_tr_b16 v[38:39], v77 offset:47456
    s_waitcnt lgkmcnt(10)
    v_mfma_f32_16x16x32_bf16 v[248:251], v[68:71], v[48:51], v[248:251]
    ds_read_b64_tr_b16 v[40:41], v77 offset:46208
    ds_read_b64_tr_b16 v[42:43], v77 offset:47488
    ds_read_b32 v80, v2 offset:36
    s_waitcnt lgkmcnt(10)
    v_mfma_f32_16x16x32_bf16 v[252:255], v[44:47], v[20:23], v[252:255]
    ds_read_b128 v[48:51], v173
    ds_read_b128 v[72:75], v174 offset:64
    s_waitcnt lgkmcnt(10)
    v_mfma_f32_16x16x32_bf16 v[232:235], v[24:27], v[20:23], v[232:235]
    ds_read_b64_tr_b16 v[52:53], v77 offset:51200
    ds_read_b64_tr_b16 v[54:55], v77 offset:52480
    s_waitcnt lgkmcnt(10)
    v_mfma_f32_16x16x32_bf16 v[236:239], v[28:31], v[20:23], v[236:239]
    ds_read_b64_tr_b16 v[56:57], v77 offset:51232
    ds_read_b64_tr_b16 v[58:59], v77 offset:52512
    s_waitcnt lgkmcnt(10)
    v_mfma_f32_16x16x32_bf16 v[240:243], v[32:35], v[20:23], v[240:243]
    ds_read_b64_tr_b16 v[60:61], v77 offset:51264
    ds_read_b64_tr_b16 v[62:63], v77 offset:52544
    s_waitcnt lgkmcnt(10)
    v_mfma_f32_16x16x32_bf16 v[244:247], v[36:39], v[20:23], v[244:247]
    ds_read_b64_tr_b16 v[64:65], v77 offset:51296
    ds_read_b64_tr_b16 v[66:67], v77 offset:52576
    s_waitcnt lgkmcnt(10)
    v_mfma_f32_16x16x32_bf16 v[248:251], v[40:43], v[20:23], v[248:251]
    ds_read_b64_tr_b16 v[68:69], v77 offset:51328
    ds_read_b64_tr_b16 v[70:71], v77 offset:52608
    s_waitcnt lgkmcnt(10)
    v_mfma_f32_16x16x32_bf16 v[252:255], v[72:75], v[48:51], v[252:255]
    v_readfirstlane_b32 s76, v80
    s_nop 0
    s_cmp_lt_u32 s76, 1
    s_cbranch_scc1 Lslow_55
Lback_56:
    ds_read_b128 v[20:23], v175
    ds_read_b128 v[44:47], v177 offset:0
    s_waitcnt lgkmcnt(10)
    v_mfma_f32_16x16x32_bf16 v[232:235], v[52:55], v[48:51], v[232:235]
    ds_read_b64_tr_b16 v[24:25], v78 offset:0
    ds_read_b64_tr_b16 v[26:27], v78 offset:1280
    s_waitcnt lgkmcnt(10)
    v_mfma_f32_16x16x32_bf16 v[236:239], v[56:59], v[48:51], v[236:239]
    ds_read_b64_tr_b16 v[28:29], v78 offset:32
    ds_read_b64_tr_b16 v[30:31], v78 offset:1312
    s_waitcnt lgkmcnt(10)
    v_mfma_f32_16x16x32_bf16 v[240:243], v[60:63], v[48:51], v[240:243]
    ds_read_b64_tr_b16 v[32:33], v78 offset:64
    ds_read_b64_tr_b16 v[34:35], v78 offset:1344
    s_waitcnt lgkmcnt(10)
    v_mfma_f32_16x16x32_bf16 v[244:247], v[64:67], v[48:51], v[244:247]
    ds_read_b64_tr_b16 v[36:37], v78 offset:96
    ds_read_b64_tr_b16 v[38:39], v78 offset:1376
    s_waitcnt lgkmcnt(10)
    v_mfma_f32_16x16x32_bf16 v[248:251], v[68:71], v[48:51], v[248:251]
    ds_read_b64_tr_b16 v[40:41], v78 offset:128
    ds_read_b64_tr_b16 v[42:43], v78 offset:1408
    ds_read_b32 v80, v2 offset:40
    ds_read_b32 v81, v2 offset:76
    s_waitcnt lgkmcnt(10)
    v_mfma_f32_16x16x32_bf16 v[252:255], v[44:47], v[20:23], v[252:255]
    ds_read_b128 v[48:51], v176
    ds_read_b128 v[72:75], v177 offset:64
    s_waitcnt lgkmcnt(10)
    v_mfma_f32_16x16x32_bf16 v[232:235], v[24:27], v[20:23], v[232:235]
    ds_read_b64_tr_b16 v[52:53], v78 offset:5120
    ds_read_b64_tr_b16 v[54:55], v78 offset:6400
    s_waitcnt lgkmcnt(10)
    v_mfma_f32_16x16x32_bf16 v[236:239], v[28:31], v[20:23], v[236:239]
    ds_read_b64_tr_b16 v[56:57], v78 offset:5152
    ds_read_b64_tr_b16 v[58:59], v78 offset:6432
    s_waitcnt lgkmcnt(10)
    v_mfma_f32_16x16x32_bf16 v[240:243], v[32:35], v[20:23], v[240:243]
    ds_read_b64_tr_b16 v[60:61], v78 offset:5184
    ds_read_b64_tr_b16 v[62:63], v78 offset:6464
    s_waitcnt lgkmcnt(10)
    v_mfma_f32_16x16x32_bf16 v[244:247], v[36:39], v[20:23], v[244:247]
    ds_read_b64_tr_b16 v[64:65], v78 offset:5216
    ds_read_b64_tr_b16 v[66:67], v78 offset:6496
    s_waitcnt lgkmcnt(10)
    v_mfma_f32_16x16x32_bf16 v[248:251], v[40:43], v[20:23], v[248:251]
    ds_read_b64_tr_b16 v[68:69], v78 offset:5248
    ds_read_b64_tr_b16 v[70:71], v78 offset:6528
    s_waitcnt lgkmcnt(10)
    v_mfma_f32_16x16x32_bf16 v[252:255], v[72:75], v[48:51], v[252:255]
    v_readfirstlane_b32 s11, v80
    s_nop 0
    s_cmp_eq_u32 s11, 0
    s_cbranch_scc1 L_m_nokv1
    buffer_load_dwordx4 v[172:175], v17, s[72:75], s8 offen sc1
    buffer_load_dwordx2 v[176:177], v230, s[72:75], s8 offen offset:1024 sc1
    s_add_u32 s8, s8, 1408
    buffer_load_dwordx4 v[196:199], v231, s[72:75], s9 offen sc1
    buffer_load_dwordx4 v[200:203], v231, s[72:75], s9 offen offset:768 sc1
    s_add_u32 s9, s9, 1536
    buffer_load_dwordx4 v[178:181], v17, s[72:75], s8 offen sc1
    buffer_load_dwordx2 v[182:183], v230, s[72:75], s8 offen offset:1024 sc1
    s_add_u32 s8, s8, 1408
    buffer_load_dwordx4 v[204:207], v231, s[72:75], s9 offen sc1
    buffer_load_dwordx4 v[208:211], v231, s[72:75], s9 offen offset:768 sc1
    s_add_u32 s9, s9, 1536
    buffer_load_dwordx4 v[184:187], v17, s[72:75], s8 offen sc1
    buffer_load_dwordx2 v[188:189], v230, s[72:75], s8 offen offset:1024 sc1
    s_add_u32 s8, s8, 1408
    buffer_load_dwordx4 v[212:215], v231, s[72:75], s9 offen sc1
    buffer_load_dwordx4 v[216:219], v231, s[72:75], s9 offen offset:768 sc1
    s_add_u32 s9, s9, 1536
    buffer_load_dwordx4 v[190:193], v17, s[72:75], s8 offen sc1
    buffer_load_dwordx2 v[194:195], v230, s[72:75], s8 offen offset:1024 sc1
    s_add_u32 s8, s8, 1408
L_m_nokv1:
    s_waitcnt lgkmcnt(8)
    v_mfma_f32_16x16x32_bf16 v[232:235], v[52:55], v[48:51], v[232:235]
    s_waitcnt lgkmcnt(6)
    v_mfma_f32_16x16x32_bf16 v[236:239], v[56:59], v[48:51], v[236:239]
    s_waitcnt lgkmcnt(4)
    v_mfma_f32_16x16x32_bf16 v[240:243], v[60:63], v[48:51], v[240:243]
    s_waitcnt lgkmcnt(2)
    v_mfma_f32_16x16x32_bf16 v[244:247], v[64:67], v[48:51], v[244:247]
    s_waitcnt lgkmcnt(0)
    v_mfma_f32_16x16x32_bf16 v[248:251], v[68:71], v[48:51], v[248:251]
    v_readfirstlane_b32 s76, v81
    s_nop 0
    s_cmp_lt_u32 s76, 4
    s_cbranch_scc1 Lslow_59
Lback_60:
    s_mov_b32 s76, 1051011932
    v_mov_b64 v[152:153], 0
    v_mov_b64 v[158:159], 0
    v_mov_b64 v[164:165], 0
    v_mov_b64 v[170:171], 0
    v_mul_f32 v252, 3216550459, v252
    v_exp_f32 v252, v252
    v_mul_f32 v232, s76, v232
    v_mul_f32 v233, s76, v233
    v_mul_f32 v234, s76, v234
    v_mul_f32 v235, s76, v235
    v_cvt_pk_bf16_f32 v232, v232, v233
    v_cvt_pk_bf16_f32 v233, v234, v235
    ds_write_b64 v13, v[232:233] offset:0
    v_mul_f32 v236, s76, v236
    v_mul_f32 v237, s76, v237
    v_mul_f32 v238, s76, v238
    v_mul_f32 v239, s76, v239
    v_cvt_pk_bf16_f32 v236, v236, v237
    v_cvt_pk_bf16_f32 v237, v238, v239
    ds_write_b64 v13, v[236:237] offset:32
    v_mul_f32 v240, s76, v240
    v_mul_f32 v241, s76, v241
    v_mul_f32 v242, s76, v242
    v_mul_f32 v243, s76, v243
    v_cvt_pk_bf16_f32 v240, v240, v241
    v_cvt_pk_bf16_f32 v241, v242, v243
    ds_write_b64 v13, v[240:241] offset:64
    v_mul_f32 v244, s76, v244
    v_mul_f32 v245, s76, v245
    v_mul_f32 v246, s76, v246
    v_mul_f32 v247, s76, v247
    v_cvt_pk_bf16_f32 v244, v244, v245
    v_cvt_pk_bf16_f32 v245, v246, v247
    ds_write_b64 v13, v[244:245] offset:96
    v_mul_f32 v248, s76, v248
    v_mul_f32 v249, s76, v249
    v_mul_f32 v250, s76, v250
    v_mul_f32 v251, s76, v251
    v_cvt_pk_bf16_f32 v248, v248, v249
    v_cvt_pk_bf16_f32 v249, v250, v251
    ds_write_b64 v13, v[248:249] offset:128
    v_add_f32 v252, 1.0, v252
    v_rcp_f32 v252, v252
    s_mov_b64 exec, 0xffff
    ds_write_b32 v14, v252 offset:256
    s_mov_b64 exec, -1
    ds_read_b32 v80, v2 offset:40
    s_waitcnt lgkmcnt(0)
    s_cmp_lg_u32 s11, 0
    s_cbranch_scc1 L_m_nokv3
    v_readfirstlane_b32 s11, v80
    s_nop 0
    s_cmp_eq_u32 s11, 0
    s_cbranch_scc1 L_m_nokv3
    buffer_load_dwordx4 v[172:175], v17, s[72:75], s8 offen sc1
    buffer_load_dwordx2 v[176:177], v230, s[72:75], s8 offen offset:1024 sc1
    s_add_u32 s8, s8, 1408
    buffer_load_dwordx4 v[196:199], v231, s[72:75], s9 offen sc1
    buffer_load_dwordx4 v[200:203], v231, s[72:75], s9 offen offset:768 sc1
    s_add_u32 s9, s9, 1536
    buffer_load_dwordx4 v[178:181], v17, s[72:75], s8 offen sc1
    buffer_load_dwordx2 v[182:183], v230, s[72:75], s8 offen offset:1024 sc1
    s_add_u32 s8, s8, 1408
    buffer_load_dwordx4 v[204:207], v231, s[72:75], s9 offen sc1
    buffer_load_dwordx4 v[208:211], v231, s[72:75], s9 offen offset:768 sc1
    s_add_u32 s9, s9, 1536
    buffer_load_dwordx4 v[184:187], v17, s[72:75], s8 offen sc1
    buffer_load_dwordx2 v[188:189], v230, s[72:75], s8 offen offset:1024 sc1
    s_add_u32 s8, s8, 1408
    buffer_load_dwordx4 v[212:215], v231, s[72:75], s9 offen sc1
    buffer_load_dwordx4 v[216:219], v231, s[72:75], s9 offen offset:768 sc1
    s_add_u32 s9, s9, 1536
    buffer_load_dwordx4 v[190:193], v17, s[72:75], s8 offen sc1
    buffer_load_dwordx2 v[194:195], v230, s[72:75], s8 offen offset:1024 sc1
    s_add_u32 s8, s8, 1408
L_m_nokv3:
    s_barrier
    ds_read_b64 v[148:149], v10 offset:0
    ds_read_b64 v[150:151], v10 offset:8
    ds_read_b64 v[154:155], v10 offset:40
    ds_read_b64 v[156:157], v10 offset:48
    ds_read_b64 v[160:161], v11 offset:0
    ds_read_b64 v[162:163], v11 offset:8
    ds_read_b64 v[166:167], v11 offset:40
    ds_read_b64 v[168:169], v11 offset:48
    s_mov_b32 exec_hi, 0
    ds_read_b64 v[152:153], v10 offset:32
    ds_read_b64 v[158:159], v10 offset:72
    ds_read_b64 v[164:165], v11 offset:32
    ds_read_b64 v[170:171], v11 offset:72
    s_mov_b32 exec_hi, -1
    ds_read_b32 v13, v2 offset:120
    s_cmp_lg_u32 s11, 0
    s_cbranch_scc1 L_m_nokv2
    buffer_load_dwordx4 v[172:175], v17, s[72:75], s8 offen sc1
    buffer_load_dwordx2 v[176:177], v230, s[72:75], s8 offen offset:1024 sc1
    s_add_u32 s8, s8, 1408
    buffer_load_dwordx4 v[196:199], v231, s[72:75], s9 offen sc1
    buffer_load_dwordx4 v[200:203], v231, s[72:75], s9 offen offset:768 sc1
    s_add_u32 s9, s9, 1536
    buffer_load_dwordx4 v[178:181], v17, s[72:75], s8 offen sc1
    buffer_load_dwordx2 v[182:183], v230, s[72:75], s8 offen offset:1024 sc1
    s_add_u32 s8, s8, 1408
    buffer_load_dwordx4 v[204:207], v231, s[72:75], s9 offen sc1
    buffer_load_dwordx4 v[208:211], v231, s[72:75], s9 offen offset:768 sc1
    s_add_u32 s9, s9, 1536
    buffer_load_dwordx4 v[184:187], v17, s[72:75], s8 offen sc1
    buffer_load_dwordx2 v[188:189], v230, s[72:75], s8 offen offset:1024 sc1
    s_add_u32 s8, s8, 1408
    buffer_load_dwordx4 v[212:215], v231, s[72:75], s9 offen sc1
    buffer_load_dwordx4 v[216:219], v231, s[72:75], s9 offen offset:768 sc1
    s_add_u32 s9, s9, 1536
    buffer_load_dwordx4 v[190:193], v17, s[72:75], s8 offen sc1
    buffer_load_dwordx2 v[194:195], v230, s[72:75], s8 offen offset:1024 sc1
    s_add_u32 s8, s8, 1408
L_m_nokv2:
    v_mov_b64 v[68:69], 0
    v_mov_b64 v[70:71], 0
    v_mov_b64 v[72:73], 0
    v_mov_b64 v[74:75], 0
    v_mov_b64 v[76:77], 0
    v_mov_b64 v[78:79], 0
    v_mov_b64 v[80:81], 0
    v_mov_b64 v[82:83], 0
    v_mov_b32 v36, 0
    v_mov_b32 v37, 0
    v_mov_b32 v38, 0
    v_mov_b32 v39, 0
    s_waitcnt lgkmcnt(0)
    ds_read_b32 v15, v2 offset:112
    ds_read_b32 v14, v2 offset:632
    ds_read_b32 v232, v12 offset:256
    v_dot2_f32_bf16 v36, v148, v148, v36
    v_dot2_f32_bf16 v37, v154, v154, v37
    v_dot2_f32_bf16 v38, v160, v160, v38
    v_dot2_f32_bf16 v39, v166, v166, v39
    v_dot2_f32_bf16 v36, v149, v149, v36
    v_dot2_f32_bf16 v37, v155, v155, v37
    v_dot2_f32_bf16 v38, v161, v161, v38
    v_dot2_f32_bf16 v39, v167, v167, v39
    v_dot2_f32_bf16 v36, v150, v150, v36
    v_dot2_f32_bf16 v37, v156, v156, v37
    v_dot2_f32_bf16 v38, v162, v162, v38
    v_dot2_f32_bf16 v39, v168, v168, v39
    v_dot2_f32_bf16 v36, v151, v151, v36
    v_dot2_f32_bf16 v37, v157, v157, v37
    v_dot2_f32_bf16 v38, v163, v163, v38
    v_dot2_f32_bf16 v39, v169, v169, v39
    v_dot2_f32_bf16 v36, v152, v152, v36
    v_dot2_f32_bf16 v37, v158, v158, v37
    v_dot2_f32_bf16 v38, v164, v164, v38
    v_dot2_f32_bf16 v39, v170, v170, v39
    v_dot2_f32_bf16 v36, v153, v153, v36
    v_dot2_f32_bf16 v37, v159, v159, v37
    v_dot2_f32_bf16 v38, v165, v165, v38
    v_dot2_f32_bf16 v39, v171, v171, v39
    v_mov_b32 v40, v36
    v_mov_b32 v41, v37
    v_mov_b32 v42, v38
    v_mov_b32 v43, v39
    v_permlane32_swap_b32 v36, v40
    v_permlane32_swap_b32 v37, v41
    v_permlane32_swap_b32 v38, v42
    v_permlane32_swap_b32 v39, v43
    v_add_f32 v36, v36, v40
    v_add_f32 v37, v37, v41
    v_add_f32 v38, v38, v42
    v_add_f32 v39, v39, v43
    v_mul_f32 v36, v36, v13
    v_mul_f32 v37, v37, v13
    v_mul_f32 v38, v38, v13
    v_mul_f32 v39, v39, v13
    v_sqrt_f32 v36, v36
    v_sqrt_f32 v37, v37
    v_sqrt_f32 v38, v38
    v_sqrt_f32 v39, v39
    s_mov_b32 exec_lo, 0
    v_mul_f32 v36, 3212967936, v36
    v_mul_f32 v37, 3212967936, v37
    v_mul_f32 v38, 3212967936, v38
    v_mul_f32 v39, 3212967936, v39
    v_lshrrev_b32 v152, 16, v36
    v_lshrrev_b32 v158, 16, v37
    v_lshrrev_b32 v164, 16, v38
    v_lshrrev_b32 v170, 16, v39
    s_mov_b32 exec_lo, -1
    s_mul_i32 s77, s3, 6144
    s_xor_b32 s78, s3, 1
    s_mul_i32 s79, s78, 6144
    s_add_u32 s77, s77, 138240
    s_add_u32 s79, s79, 138240
    v_add_u32 v234, s77, v17
    v_add_u32 v235, s79, v17
    s_lshl_b32 s77, s3, 2
    s_lshl_b32 s78, s78, 2
    v_add_u32 v236, s77, v19
    v_add_u32 v237, s78, v2
    v_add_u32 v245, s77, v2
    v_and_b32 v4, 15, v1
    v_bfe_u32 v5, v1, 4, 1
    v_mul_u32_u24 v5, 40960, v5
    v_lshl_add_u32 v4, v4, 4, v5
    v_lshrrev_b32 v5, 5, v1
    v_lshl_add_u32 v238, v5, 8, v4
    v_xor_b32 v239, 256, v238
    s_mul_i32 s64, s4, 163840
    s_mul_i32 s78, s5, 2560
    s_add_u32 s64, s64, s78
    s_lshr_b32 s78, s3, 1
    s_mul_i32 s78, s78, 1280
    s_add_u32 s64, s64, s78
    s_mul_i32 s78, s10, 81920
    s_add_u32 s64, s64, s78
    s_add_u32 s64, s64, 1069056
    s_waitcnt vmcnt(12) lgkmcnt(0)
    v_mfma_f32_32x32x16_bf16 v[20:35], v[172:175], v[148:151], 0
    v_mfma_f32_32x32x8_bf16 v[20:35], v[176:177], v[152:153], v[20:35]
    v_readfirstlane_b32 s6, v14
    v_readfirstlane_b32 s39, v15
    v_sub_f32 v232, 1.0, v232
    s_mov_b32 s7, 8
    s_nop 5
.p2align 6
L_mqa:
    v_mfma_f32_32x32x16_bf16 v[36:51], v[172:175], v[154:157], 0
    s_nop 0
    v_exp_f32 v20, v20
    v_exp_f32 v21, v21
    v_exp_f32 v22, v22
    v_exp_f32 v23, v23
    v_mfma_f32_32x32x8_bf16 v[36:51], v[176:177], v[158:159], v[36:51]
    v_exp_f32 v24, v24
    v_exp_f32 v25, v25
    v_exp_f32 v26, v26
    v_exp_f32 v27, v27
    v_smfmac_f32_32x32x32_bf16 v[132:147], v[220:223], v[68:75], v228
    v_exp_f32 v28, v28
    v_exp_f32 v29, v29
    v_exp_f32 v30, v30
    v_exp_f32 v31, v31
    v_smfmac_f32_32x32x32_bf16 v[132:147], v[224:227], v[76:83], v228
    v_exp_f32 v32, v32
    v_exp_f32 v33, v33
    v_exp_f32 v34, v34
    v_exp_f32 v35, v35
    v_mfma_f32_32x32x16_bf16 v[52:67], v[172:175], v[160:163], 0
    v_exp_f32 v36, v36
    v_exp_f32 v37, v37
    v_exp_f32 v38, v38
    v_exp_f32 v39, v39
    v_mfma_f32_32x32x8_bf16 v[52:67], v[176:177], v[164:165], v[52:67]
    v_exp_f32 v40, v40
    v_exp_f32 v41, v41
    v_exp_f32 v42, v42
    v_exp_f32 v43, v43
    s_waitcnt vmcnt(10)
    v_smfmac_f32_32x32x32_bf16 v[84:99], v[196:199], v[20:27], v228
    buffer_load_dwordx4 v[220:223], v231, s[72:75], s9 offen sc1
    v_exp_f32 v44, v44
    v_exp_f32 v45, v45
    v_exp_f32 v46, v46
    v_exp_f32 v47, v47
    v_smfmac_f32_32x32x32_bf16 v[84:99], v[200:203], v[28:35], v228
    buffer_load_dwordx4 v[224:227], v231, s[72:75], s9 offen offset:768 sc1
    s_add_u32 s9, s9, 1536
    v_exp_f32 v48, v48
    v_exp_f32 v49, v49
    v_exp_f32 v50, v50
    v_exp_f32 v51, v51
    v_mfma_f32_32x32x16_bf16 v[68:83], v[172:175], v[166:169], 0
    v_exp_f32 v52, v52
    v_exp_f32 v53, v53
    v_exp_f32 v54, v54
    v_exp_f32 v55, v55
    v_mfma_f32_32x32x8_bf16 v[68:83], v[176:177], v[170:171], v[68:83]
    v_exp_f32 v56, v56
    v_exp_f32 v57, v57
    v_exp_f32 v58, v58
    v_exp_f32 v59, v59
    v_smfmac_f32_32x32x32_bf16 v[100:115], v[196:199], v[36:43], v228
    v_exp_f32 v60, v60
    v_exp_f32 v61, v61
    v_exp_f32 v62, v62
    v_exp_f32 v63, v63
    v_smfmac_f32_32x32x32_bf16 v[100:115], v[200:203], v[44:51], v228
    v_exp_f32 v64, v64
    v_exp_f32 v65, v65
    v_exp_f32 v66, v66
    v_exp_f32 v67, v67
    s_waitcnt vmcnt(10)
    v_mfma_f32_32x32x16_bf16 v[20:35], v[178:181], v[148:151], 0
    v_exp_f32 v68, v68
    v_exp_f32 v69, v69
    v_exp_f32 v70, v70
    v_exp_f32 v71, v71
    v_mfma_f32_32x32x8_bf16 v[20:35], v[182:183], v[152:153], v[20:35]
    v_exp_f32 v72, v72
    v_exp_f32 v73, v73
    v_exp_f32 v74, v74
    v_exp_f32 v75, v75
    v_smfmac_f32_32x32x32_bf16 v[116:131], v[196:199], v[52:59], v228
    buffer_load_dwordx4 v[172:175], v17, s[72:75], s8 offen sc1
    v_exp_f32 v76, v76
    v_exp_f32 v77, v77
    v_exp_f32 v78, v78
    v_exp_f32 v79, v79
    v_smfmac_f32_32x32x32_bf16 v[116:131], v[200:203], v[60:67], v228
    buffer_load_dwordx2 v[176:177], v230, s[72:75], s8 offen offset:1024 sc1
    s_add_u32 s8, s8, 1408
    v_exp_f32 v80, v80
    v_exp_f32 v81, v81
    v_exp_f32 v82, v82
    v_exp_f32 v83, v83
    v_mfma_f32_32x32x16_bf16 v[36:51], v[178:181], v[154:157], 0
    v_exp_f32 v20, v20
    v_exp_f32 v21, v21
    v_exp_f32 v22, v22
    v_exp_f32 v23, v23
    v_mfma_f32_32x32x8_bf16 v[36:51], v[182:183], v[158:159], v[36:51]
    v_exp_f32 v24, v24
    v_exp_f32 v25, v25
    v_exp_f32 v26, v26
    v_exp_f32 v27, v27
    v_smfmac_f32_32x32x32_bf16 v[132:147], v[196:199], v[68:75], v228
    v_exp_f32 v28, v28
    v_exp_f32 v29, v29
    v_exp_f32 v30, v30
    v_exp_f32 v31, v31
    v_smfmac_f32_32x32x32_bf16 v[132:147], v[200:203], v[76:83], v228
    v_exp_f32 v32, v32
    v_exp_f32 v33, v33
    v_exp_f32 v34, v34
    v_exp_f32 v35, v35
    v_mfma_f32_32x32x16_bf16 v[52:67], v[178:181], v[160:163], 0
    v_exp_f32 v36, v36
    v_exp_f32 v37, v37
    v_exp_f32 v38, v38
    v_exp_f32 v39, v39
    v_mfma_f32_32x32x8_bf16 v[52:67], v[182:183], v[164:165], v[52:67]
    v_exp_f32 v40, v40
    v_exp_f32 v41, v41
    v_exp_f32 v42, v42
    v_exp_f32 v43, v43
    s_waitcnt vmcnt(10)
    v_smfmac_f32_32x32x32_bf16 v[84:99], v[204:207], v[20:27], v228
    buffer_load_dwordx4 v[196:199], v231, s[72:75], s9 offen sc1
    v_exp_f32 v44, v44
    v_exp_f32 v45, v45
    v_exp_f32 v46, v46
    v_exp_f32 v47, v47
    v_smfmac_f32_32x32x32_bf16 v[84:99], v[208:211], v[28:35], v228
    buffer_load_dwordx4 v[200:203], v231, s[72:75], s9 offen offset:768 sc1
    s_add_u32 s9, s9, 1536
    v_exp_f32 v48, v48
    v_exp_f32 v49, v49
    v_exp_f32 v50, v50
    v_exp_f32 v51, v51
    v_mfma_f32_32x32x16_bf16 v[68:83], v[178:181], v[166:169], 0
    v_exp_f32 v52, v52
    v_exp_f32 v53, v53
    v_exp_f32 v54, v54
    v_exp_f32 v55, v55
    v_mfma_f32_32x32x8_bf16 v[68:83], v[182:183], v[170:171], v[68:83]
    v_exp_f32 v56, v56
    v_exp_f32 v57, v57
    v_exp_f32 v58, v58
    v_exp_f32 v59, v59
    v_smfmac_f32_32x32x32_bf16 v[100:115], v[204:207], v[36:43], v228
    v_exp_f32 v60, v60
    v_exp_f32 v61, v61
    v_exp_f32 v62, v62
    v_exp_f32 v63, v63
    v_smfmac_f32_32x32x32_bf16 v[100:115], v[208:211], v[44:51], v228
    v_exp_f32 v64, v64
    v_exp_f32 v65, v65
    v_exp_f32 v66, v66
    v_exp_f32 v67, v67
    s_waitcnt vmcnt(10)
    v_mfma_f32_32x32x16_bf16 v[20:35], v[184:187], v[148:151], 0
    v_exp_f32 v68, v68
    v_exp_f32 v69, v69
    v_exp_f32 v70, v70
    v_exp_f32 v71, v71
    v_mfma_f32_32x32x8_bf16 v[20:35], v[188:189], v[152:153], v[20:35]
    v_exp_f32 v72, v72
    v_exp_f32 v73, v73
    v_exp_f32 v74, v74
    v_exp_f32 v75, v75
    v_smfmac_f32_32x32x32_bf16 v[116:131], v[204:207], v[52:59], v228
    buffer_load_dwordx4 v[178:181], v17, s[72:75], s8 offen sc1
    v_exp_f32 v76, v76
    v_exp_f32 v77, v77
    v_exp_f32 v78, v78
    v_exp_f32 v79, v79
    v_smfmac_f32_32x32x32_bf16 v[116:131], v[208:211], v[60:67], v228
    buffer_load_dwordx2 v[182:183], v230, s[72:75], s8 offen offset:1024 sc1
    s_add_u32 s8, s8, 1408
    v_exp_f32 v80, v80
    v_exp_f32 v81, v81
    v_exp_f32 v82, v82
    v_exp_f32 v83, v83
    v_mfma_f32_32x32x16_bf16 v[36:51], v[184:187], v[154:157], 0
    v_exp_f32 v20, v20
    v_exp_f32 v21, v21
    v_exp_f32 v22, v22
    v_exp_f32 v23, v23
    v_mfma_f32_32x32x8_bf16 v[36:51], v[188:189], v[158:159], v[36:51]
    v_exp_f32 v24, v24
    v_exp_f32 v25, v25
    v_exp_f32 v26, v26
    v_exp_f32 v27, v27
    v_smfmac_f32_32x32x32_bf16 v[132:147], v[204:207], v[68:75], v228
    v_exp_f32 v28, v28
    v_exp_f32 v29, v29
    v_exp_f32 v30, v30
    v_exp_f32 v31, v31
    v_smfmac_f32_32x32x32_bf16 v[132:147], v[208:211], v[76:83], v228
    v_exp_f32 v32, v32
    v_exp_f32 v33, v33
    v_exp_f32 v34, v34
    v_exp_f32 v35, v35
    v_mfma_f32_32x32x16_bf16 v[52:67], v[184:187], v[160:163], 0
    v_exp_f32 v36, v36
    v_exp_f32 v37, v37
    v_exp_f32 v38, v38
    v_exp_f32 v39, v39
    v_mfma_f32_32x32x8_bf16 v[52:67], v[188:189], v[164:165], v[52:67]
    v_exp_f32 v40, v40
    v_exp_f32 v41, v41
    v_exp_f32 v42, v42
    v_exp_f32 v43, v43
    s_waitcnt vmcnt(10)
    v_smfmac_f32_32x32x32_bf16 v[84:99], v[212:215], v[20:27], v228
    buffer_load_dwordx4 v[204:207], v231, s[72:75], s9 offen sc1
    v_exp_f32 v44, v44
    v_exp_f32 v45, v45
    v_exp_f32 v46, v46
    v_exp_f32 v47, v47
    v_smfmac_f32_32x32x32_bf16 v[84:99], v[216:219], v[28:35], v228
    buffer_load_dwordx4 v[208:211], v231, s[72:75], s9 offen offset:768 sc1
    s_add_u32 s9, s9, 1536
    v_exp_f32 v48, v48
    v_exp_f32 v49, v49
    v_exp_f32 v50, v50
    v_exp_f32 v51, v51
    v_mfma_f32_32x32x16_bf16 v[68:83], v[184:187], v[166:169], 0
    v_exp_f32 v52, v52
    v_exp_f32 v53, v53
    v_exp_f32 v54, v54
    v_exp_f32 v55, v55
    v_mfma_f32_32x32x8_bf16 v[68:83], v[188:189], v[170:171], v[68:83]
    v_exp_f32 v56, v56
    v_exp_f32 v57, v57
    v_exp_f32 v58, v58
    v_exp_f32 v59, v59
    v_smfmac_f32_32x32x32_bf16 v[100:115], v[212:215], v[36:43], v228
    v_exp_f32 v60, v60
    v_exp_f32 v61, v61
    v_exp_f32 v62, v62
    v_exp_f32 v63, v63
    v_smfmac_f32_32x32x32_bf16 v[100:115], v[216:219], v[44:51], v228
    v_exp_f32 v64, v64
    v_exp_f32 v65, v65
    v_exp_f32 v66, v66
    v_exp_f32 v67, v67
    s_waitcnt vmcnt(10)
    v_mfma_f32_32x32x16_bf16 v[20:35], v[190:193], v[148:151], 0
    v_exp_f32 v68, v68
    v_exp_f32 v69, v69
    v_exp_f32 v70, v70
    v_exp_f32 v71, v71
    v_mfma_f32_32x32x8_bf16 v[20:35], v[194:195], v[152:153], v[20:35]
    v_exp_f32 v72, v72
    v_exp_f32 v73, v73
    v_exp_f32 v74, v74
    v_exp_f32 v75, v75
    v_smfmac_f32_32x32x32_bf16 v[116:131], v[212:215], v[52:59], v228
    buffer_load_dwordx4 v[184:187], v17, s[72:75], s8 offen sc1
    v_exp_f32 v76, v76
    v_exp_f32 v77, v77
    v_exp_f32 v78, v78
    v_exp_f32 v79, v79
    v_smfmac_f32_32x32x32_bf16 v[116:131], v[216:219], v[60:67], v228
    buffer_load_dwordx2 v[188:189], v230, s[72:75], s8 offen offset:1024 sc1
    s_add_u32 s8, s8, 1408
    v_exp_f32 v80, v80
    v_exp_f32 v81, v81
    v_exp_f32 v82, v82
    v_exp_f32 v83, v83
    v_mfma_f32_32x32x16_bf16 v[36:51], v[190:193], v[154:157], 0
    v_exp_f32 v20, v20
    v_exp_f32 v21, v21
    v_exp_f32 v22, v22
    v_exp_f32 v23, v23
    v_mfma_f32_32x32x8_bf16 v[36:51], v[194:195], v[158:159], v[36:51]
    v_exp_f32 v24, v24
    v_exp_f32 v25, v25
    v_exp_f32 v26, v26
    v_exp_f32 v27, v27
    v_smfmac_f32_32x32x32_bf16 v[132:147], v[212:215], v[68:75], v228
    v_exp_f32 v28, v28
    v_exp_f32 v29, v29
    v_exp_f32 v30, v30
    v_exp_f32 v31, v31
    v_smfmac_f32_32x32x32_bf16 v[132:147], v[216:219], v[76:83], v228
    v_exp_f32 v32, v32
    v_exp_f32 v33, v33
    v_exp_f32 v34, v34
    v_exp_f32 v35, v35
    v_mfma_f32_32x32x16_bf16 v[52:67], v[190:193], v[160:163], 0
    v_exp_f32 v36, v36
    v_exp_f32 v37, v37
    v_exp_f32 v38, v38
    v_exp_f32 v39, v39
    v_mfma_f32_32x32x8_bf16 v[52:67], v[194:195], v[164:165], v[52:67]
    v_exp_f32 v40, v40
    v_exp_f32 v41, v41
    v_exp_f32 v42, v42
    v_exp_f32 v43, v43
    s_waitcnt vmcnt(10)
    v_smfmac_f32_32x32x32_bf16 v[84:99], v[220:223], v[20:27], v228
    buffer_load_dwordx4 v[212:215], v231, s[72:75], s9 offen sc1
    v_exp_f32 v44, v44
    v_exp_f32 v45, v45
    v_exp_f32 v46, v46
    v_exp_f32 v47, v47
    v_smfmac_f32_32x32x32_bf16 v[84:99], v[224:227], v[28:35], v228
    buffer_load_dwordx4 v[216:219], v231, s[72:75], s9 offen offset:768 sc1
    s_add_u32 s9, s9, 1536
    v_exp_f32 v48, v48
    v_exp_f32 v49, v49
    v_exp_f32 v50, v50
    v_exp_f32 v51, v51
    v_mfma_f32_32x32x16_bf16 v[68:83], v[190:193], v[166:169], 0
    v_exp_f32 v52, v52
    v_exp_f32 v53, v53
    v_exp_f32 v54, v54
    v_exp_f32 v55, v55
    v_mfma_f32_32x32x8_bf16 v[68:83], v[194:195], v[170:171], v[68:83]
    v_exp_f32 v56, v56
    v_exp_f32 v57, v57
    v_exp_f32 v58, v58
    v_exp_f32 v59, v59
    v_smfmac_f32_32x32x32_bf16 v[100:115], v[220:223], v[36:43], v228
    v_exp_f32 v60, v60
    v_exp_f32 v61, v61
    v_exp_f32 v62, v62
    v_exp_f32 v63, v63
    v_smfmac_f32_32x32x32_bf16 v[100:115], v[224:227], v[44:51], v228
    v_exp_f32 v64, v64
    v_exp_f32 v65, v65
    v_exp_f32 v66, v66
    v_exp_f32 v67, v67
    s_waitcnt vmcnt(10)
    v_mfma_f32_32x32x16_bf16 v[20:35], v[172:175], v[148:151], 0
    s_sub_u32 s7, s7, 1
    v_exp_f32 v68, v68
    v_exp_f32 v69, v69
    v_exp_f32 v70, v70
    v_exp_f32 v71, v71
    v_mfma_f32_32x32x8_bf16 v[20:35], v[176:177], v[152:153], v[20:35]
    v_exp_f32 v72, v72
    v_exp_f32 v73, v73
    v_exp_f32 v74, v74
    v_exp_f32 v75, v75
    v_smfmac_f32_32x32x32_bf16 v[116:131], v[220:223], v[52:59], v228
    buffer_load_dwordx4 v[190:193], v17, s[72:75], s8 offen sc1
    v_exp_f32 v76, v76
    v_exp_f32 v77, v77
    v_exp_f32 v78, v78
    v_exp_f32 v79, v79
    v_smfmac_f32_32x32x32_bf16 v[116:131], v[224:227], v[60:67], v228
    buffer_load_dwordx2 v[194:195], v230, s[72:75], s8 offen offset:1024 sc1
    s_add_u32 s8, s8, 1408
    s_cmp_lg_u32 s7, 0
    v_exp_f32 v80, v80
    v_exp_f32 v81, v81
    v_exp_f32 v82, v82
    v_exp_f32 v83, v83
    s_cbranch_scc1 L_mqa
    s_setprio 3
    ds_read_b32 v14, v2 offset:124
    v_smfmac_f32_32x32x32_bf16 v[132:147], v[220:223], v[68:75], v228
    v_smfmac_f32_32x32x32_bf16 v[132:147], v[224:227], v[76:83], v228
    s_waitcnt lgkmcnt(0)
    v_readfirstlane_b32 s76, v14
    s_nop 0
    s_cmp_lt_u32 s76, 4
    s_cbranch_scc1 Lslow_63
Lback_64:
    ds_write_b128 v234, v[116:119] offset:0
    ds_write_b128 v234, v[120:123] offset:1024
    ds_write_b128 v234, v[124:127] offset:2048
    s_nop 3
    ds_write_b128 v234, v[132:135] offset:3072
    ds_write_b128 v234, v[136:139] offset:4096
    ds_write_b128 v234, v[140:143] offset:5120
    ds_add_u32 v236, v3 offset:576
    s_mov_b32 s7, 0x20000
Lp_67:
    ds_read_b32 v4, v237 offset:576
    s_waitcnt lgkmcnt(0)
    v_readfirstlane_b32 s76, v4
    s_nop 0
    s_cmp_ge_u32 s76, 1
    s_cbranch_scc1 Lpd_68
    s_sub_u32 s7, s7, 1
    s_cmp_lg_u32 s7, 0
    s_cbranch_scc1 Lp_67
Lpd_68:
    ds_read_b128 v[20:23], v235 offset:0
    ds_read_b128 v[24:27], v235 offset:1024
    ds_read_b128 v[28:31], v235 offset:2048
    ds_read_b128 v[36:39], v235 offset:3072
    ds_read_b128 v[40:43], v235 offset:4096
    ds_read_b128 v[44:47], v235 offset:5120
    s_waitcnt lgkmcnt(3)
    v_pk_add_f32 v[84:85], v[84:85], v[20:21]
    v_pk_add_f32 v[86:87], v[86:87], v[22:23]
    v_pk_add_f32 v[88:89], v[88:89], v[24:25]
    v_pk_add_f32 v[90:91], v[90:91], v[26:27]
    v_pk_add_f32 v[92:93], v[92:93], v[28:29]
    v_pk_add_f32 v[94:95], v[94:95], v[30:31]
    s_waitcnt lgkmcnt(0)
    v_pk_add_f32 v[100:101], v[100:101], v[36:37]
    v_pk_add_f32 v[102:103], v[102:103], v[38:39]
    v_pk_add_f32 v[104:105], v[104:105], v[40:41]
    v_pk_add_f32 v[106:107], v[106:107], v[42:43]
    v_pk_add_f32 v[108:109], v[108:109], v[44:45]
    v_pk_add_f32 v[110:111], v[110:111], v[46:47]
    v_mov_b32 v52, v92
    v_mov_b32 v53, v92
    v_mov_b32 v54, v108
    v_mov_b32 v55, v108
    v_permlane32_swap_b32 v52, v53
    s_nop 0
    v_permlane32_swap_b32 v54, v55
    v_min_f32 v4, v53, v55
    v_add_f32 v5, v53, v55
    s_mov_b32 s76, 528482304
    v_cmp_nle_f32 vcc, s76, v4
    s_mov_b32 s77, 1900671690
    v_cmp_ngt_f32 s[78:79], s77, v5
    s_nop 0
    s_or_b64 vcc, vcc, s[78:79]
    s_cbranch_vccnz L_fallback
L_m_norm:
    v_rcp_f32 v53, v53
    v_rcp_f32 v55, v55
    v_mul_f32 v53, v53, v232
    v_mul_f32 v55, v55, v232
    v_pk_mul_f32 v[84:85], v[84:85], v[52:53] op_sel:[0,1] op_sel_hi:[1,1]
    v_pk_mul_f32 v[86:87], v[86:87], v[52:53] op_sel:[0,1] op_sel_hi:[1,1]
    v_pk_mul_f32 v[88:89], v[88:89], v[52:53] op_sel:[0,1] op_sel_hi:[1,1]
    v_pk_mul_f32 v[90:91], v[90:91], v[52:53] op_sel:[0,1] op_sel_hi:[1,1]
    v_pk_mul_f32 v[92:93], v[92:93], v[52:53] op_sel:[0,1] op_sel_hi:[1,1]
    v_pk_mul_f32 v[94:95], v[94:95], v[52:53] op_sel:[0,1] op_sel_hi:[1,1]
    v_pk_mul_f32 v[100:101], v[100:101], v[54:55] op_sel:[0,1] op_sel_hi:[1,1]
    v_pk_mul_f32 v[102:103], v[102:103], v[54:55] op_sel:[0,1] op_sel_hi:[1,1]
    v_pk_mul_f32 v[104:105], v[104:105], v[54:55] op_sel:[0,1] op_sel_hi:[1,1]
    v_pk_mul_f32 v[106:107], v[106:107], v[54:55] op_sel:[0,1] op_sel_hi:[1,1]
    v_pk_mul_f32 v[108:109], v[108:109], v[54:55] op_sel:[0,1] op_sel_hi:[1,1]
    v_pk_mul_f32 v[110:111], v[110:111], v[54:55] op_sel:[0,1] op_sel_hi:[1,1]
    v_cvt_pk_bf16_f32 v20, v84, v85
    v_cvt_pk_bf16_f32 v21, v86, v87
    v_cvt_pk_bf16_f32 v22, v88, v89
    v_cvt_pk_bf16_f32 v23, v90, v91
    v_cvt_pk_bf16_f32 v38, v108, v109
    v_cvt_pk_bf16_f32 v39, v110, v111
    v_cvt_pk_bf16_f32 v40, v104, v105
    v_cvt_pk_bf16_f32 v41, v106, v107
    v_cvt_pk_bf16_f32 v36, v100, v101
    v_cvt_pk_bf16_f32 v37, v102, v103
    v_cvt_pk_bf16_f32 v24, v92, v93
    v_cvt_pk_bf16_f32 v25, v94, v95
    v_cvt_pk_bf16_f32 v26, v100, v101
    v_cvt_pk_bf16_f32 v27, v102, v103
    v_permlane32_swap_b32 v20, v22
    v_permlane32_swap_b32 v21, v23
    v_permlane32_swap_b32 v38, v40
    v_permlane32_swap_b32 v39, v41
    buffer_store_dwordx4 v[20:23], v238, s[72:75], s64 offen sc1
    v_permlane32_swap_b32 v40, v36
    v_permlane32_swap_b32 v41, v37
    s_mov_b32 exec_hi, 0
    buffer_store_dwordx4 v[24:27], v238, s[72:75], s64 offen offset:512 sc1
    s_mov_b32 exec_hi, -1
    buffer_store_dwordx4 v[36:39], v239, s[72:75], s64 offen offset:768 sc1
L_m_pub:
    ds_read_b32 v14, v2 offset:596
    s_lshl2_add_u32 s84, s4, s3
    s_lshl_b32 s86, s84, 4
    s_mul_i32 s56, s84, 40960
    s_add_u32 s56, s56, 1069056
    s_add_u32 s57, s56, 4096
    s_add_u32 s58, s56, 8192
    s_add_u32 s59, s56, 12288
    s_add_u32 s60, s56, 16384
    v_lshrrev_b32 v4, 5, v1
    v_bfe_u32 v5, v1, 2, 3
    v_lshl_add_u32 v4, v4, 4, v5
    v_mul_u32_u24 v4, 160, v4
    v_and_b32 v5, 3, v1
    v_lshl_add_u32 v240, v5, 3, v4
    v_add_u32 v241, 102400, v240
    s_mov_b32 s68, s34
    s_mov_b32 s69, s35
    s_mov_b32 s70, 2621440
    s_mov_b32 s71, 0x20000
    v_and_b32 v242, 15, v1
    v_add_u32 v242, s86, v242
    v_mul_u32_u24 v242, 1280, v242
    v_lshrrev_b32 v5, 4, v1
    v_lshl_add_u32 v243, v5, 3, v242
    v_bfe_u32 v5, v1, 4, 1
    v_lshl_add_u32 v242, v5, 5, v242
    v_lshrrev_b32 v5, 5, v1
    v_lshl_add_u32 v242, v5, 4, v242
    s_mul_i32 s85, s3, 5120
    s_add_u32 s85, s85, 81920
    v_add_u32 v244, s85, v17
    s_lshl_b32 s76, s4, 3
    s_add_u32 s76, s76, s5
    s_lshl_b32 s76, s76, 7
    s_lshl2_add_u32 s76, s3, s76
    s_add_u32 s76, s76, 655360
    v_mov_b32 v4, 0
    v_mov_b32 v5, s6
    s_mov_b64 exec, 1
    s_waitcnt vmcnt(0)
    s_cmp_eq_u32 s39, 0
    s_cbranch_scc1 Lxs_69
    buffer_store_dword v5, v4, s[72:75], s76 offen
Lxb_70:
    s_mov_b64 exec, -1
    s_waitcnt lgkmcnt(0)
    v_readfirstlane_b32 s76, v14
    s_nop 0
    s_cmp_lt_u32 s76, 4
    s_cbranch_scc1 Lslow_71
Lback_72:
    ds_read_b64_tr_b16 v[152:153], v241 offset:0
    ds_read_b64_tr_b16 v[154:155], v241 offset:1280
    ds_read_b64_tr_b16 v[156:157], v241 offset:32
    ds_read_b64_tr_b16 v[158:159], v241 offset:1312
    ds_read_b64_tr_b16 v[160:161], v241 offset:64
    ds_read_b64_tr_b16 v[162:163], v241 offset:1344
    ds_read_b64_tr_b16 v[164:165], v241 offset:96
    ds_read_b64_tr_b16 v[166:167], v241 offset:1376
    ds_read_b64_tr_b16 v[168:169], v241 offset:128
    ds_read_b64_tr_b16 v[170:171], v241 offset:1408
    ds_read_b64_tr_b16 v[172:173], v241 offset:5120
    ds_read_b64_tr_b16 v[174:175], v241 offset:6400
    ds_read_b64_tr_b16 v[176:177], v241 offset:5152
    ds_read_b64_tr_b16 v[178:179], v241 offset:6432
    ds_read_b64_tr_b16 v[180:181], v241 offset:5184
    ds_read_b64_tr_b16 v[182:183], v241 offset:6464
    ds_read_b64_tr_b16 v[184:185], v241 offset:5216
    ds_read_b64_tr_b16 v[186:187], v241 offset:6496
    ds_read_b64_tr_b16 v[188:189], v241 offset:5248
    ds_read_b64_tr_b16 v[190:191], v241 offset:6528
    ds_read_b64_tr_b16 v[192:193], v241 offset:10240
    ds_read_b64_tr_b16 v[194:195], v241 offset:11520
    ds_read_b64_tr_b16 v[196:197], v241 offset:10272
    ds_read_b64_tr_b16 v[198:199], v241 offset:11552
    ds_read_b64_tr_b16 v[200:201], v241 offset:10304
    ds_read_b64_tr_b16 v[202:203], v241 offset:11584
    ds_read_b64_tr_b16 v[204:205], v241 offset:10336
    ds_read_b64_tr_b16 v[206:207], v241 offset:11616
    ds_read_b64_tr_b16 v[208:209], v241 offset:10368
    ds_read_b64_tr_b16 v[210:211], v241 offset:11648
    ds_read_b64_tr_b16 v[212:213], v241 offset:15360
    ds_read_b64_tr_b16 v[214:215], v241 offset:16640
    ds_read_b64_tr_b16 v[216:217], v241 offset:15392
    ds_read_b64_tr_b16 v[218:219], v241 offset:16672
    ds_read_b64_tr_b16 v[220:221], v241 offset:15424
    ds_read_b64_tr_b16 v[222:223], v241 offset:16704
    ds_read_b64_tr_b16 v[224:225], v241 offset:15456
    ds_read_b64_tr_b16 v[226:227], v241 offset:16736
    ds_read_b64_tr_b16 v[228:229], v241 offset:15488
    ds_read_b64_tr_b16 v[230:231], v241 offset:16768
    v_lshlrev_b32 v4, 7, v1
    s_lshl_b32 s76, s4, 10
    s_add_u32 s76, s76, 655360
    s_mov_b32 s7, 0x8000
    s_mov_b64 exec, 0xff
Lf_75:
    buffer_load_dwordx4 v[20:23], v4, s[72:75], s76 offen sc1
    s_waitcnt vmcnt(0)
    v_cmp_eq_u32 vcc, s6, v20
    v_cmp_eq_u32 s[78:79], s6, v21
    v_cmp_eq_u32 s[80:81], s6, v22
    v_cmp_eq_u32 s[82:83], s6, v23
    s_and_b32 s78, s78, vcc_lo
    s_and_b32 s80, s80, s82
    s_and_b32 s78, s78, s80
    s_cmp_eq_u32 s78, 0xff
    s_cbranch_scc1 Lfd_76
    s_sleep 2
    s_sub_u32 s7, s7, 1
    s_cmp_lg_u32 s7, 0
    s_cbranch_scc1 Lf_75
Lfd_76:
    s_mov_b64 exec, -1
    buffer_load_dwordx4 v[52:55], v17, s[72:75], s56 offen offset:0 sc1
    buffer_load_dwordx4 v[56:59], v17, s[72:75], s56 offen offset:1024 sc1
    buffer_load_dwordx4 v[60:63], v17, s[72:75], s56 offen offset:2048 sc1
    buffer_load_dwordx4 v[64:67], v17, s[72:75], s56 offen offset:3072 sc1
    buffer_load_dwordx4 v[68:71], v17, s[72:75], s57 offen offset:0 sc1
    buffer_load_dwordx4 v[72:75], v17, s[72:75], s57 offen offset:1024 sc1
    s_waitcnt vmcnt(5)
    s_waitcnt lgkmcnt(0)
    v_mfma_f32_16x16x32_bf16 v[132:135], v[152:155], v[52:55], 0
    ds_read_b64_tr_b16 v[152:153], v241 offset:20480
    ds_read_b64_tr_b16 v[154:155], v241 offset:21760
    buffer_load_dwordx4 v[76:79], v17, s[72:75], s57 offen offset:2048 sc1
    v_mfma_f32_16x16x32_bf16 v[136:139], v[156:159], v[52:55], 0
    ds_read_b64_tr_b16 v[156:157], v241 offset:20512
    ds_read_b64_tr_b16 v[158:159], v241 offset:21792
    v_mfma_f32_16x16x32_bf16 v[140:143], v[160:163], v[52:55], 0
    ds_read_b64_tr_b16 v[160:161], v241 offset:20544
    ds_read_b64_tr_b16 v[162:163], v241 offset:21824
    buffer_load_dwordx4 v[80:83], v17, s[72:75], s57 offen offset:3072 sc1
    v_mfma_f32_16x16x32_bf16 v[144:147], v[164:167], v[52:55], 0
    ds_read_b64_tr_b16 v[164:165], v241 offset:20576
    ds_read_b64_tr_b16 v[166:167], v241 offset:21856
    v_mfma_f32_16x16x32_bf16 v[148:151], v[168:171], v[52:55], 0
    ds_read_b64_tr_b16 v[168:169], v241 offset:20608
    ds_read_b64_tr_b16 v[170:171], v241 offset:21888
    ds_read_b32 v14, v2 offset:560
    s_waitcnt vmcnt(6)
    v_mfma_f32_16x16x32_bf16 v[132:135], v[172:175], v[56:59], v[132:135]
    ds_read_b64_tr_b16 v[172:173], v241 offset:25600
    ds_read_b64_tr_b16 v[174:175], v241 offset:26880
    buffer_load_dwordx4 v[84:87], v17, s[72:75], s58 offen offset:0 sc1
    v_mfma_f32_16x16x32_bf16 v[136:139], v[176:179], v[56:59], v[136:139]
    ds_read_b64_tr_b16 v[176:177], v241 offset:25632
    ds_read_b64_tr_b16 v[178:179], v241 offset:26912
    v_mfma_f32_16x16x32_bf16 v[140:143], v[180:183], v[56:59], v[140:143]
    ds_read_b64_tr_b16 v[180:181], v241 offset:25664
    ds_read_b64_tr_b16 v[182:183], v241 offset:26944
    buffer_load_dwordx4 v[88:91], v17, s[72:75], s58 offen offset:1024 sc1
    v_mfma_f32_16x16x32_bf16 v[144:147], v[184:187], v[56:59], v[144:147]
    ds_read_b64_tr_b16 v[184:185], v241 offset:25696
    ds_read_b64_tr_b16 v[186:187], v241 offset:26976
    v_mfma_f32_16x16x32_bf16 v[148:151], v[188:191], v[56:59], v[148:151]
    ds_read_b64_tr_b16 v[188:189], v241 offset:25728
    ds_read_b64_tr_b16 v[190:191], v241 offset:27008
    s_waitcnt lgkmcnt(10)
    v_readfirstlane_b32 s76, v14
    s_nop 0
    s_cmp_lt_u32 s76, 4
    s_cbranch_scc1 Lslow_77
Lback_78:
    s_waitcnt vmcnt(7)
    v_mfma_f32_16x16x32_bf16 v[132:135], v[192:195], v[60:63], v[132:135]
    ds_read_b64_tr_b16 v[192:193], v241 offset:30720
    ds_read_b64_tr_b16 v[194:195], v241 offset:32000
    buffer_load_dwordx4 v[92:95], v17, s[72:75], s58 offen offset:2048 sc1
    v_mfma_f32_16x16x32_bf16 v[136:139], v[196:199], v[60:63], v[136:139]
    ds_read_b64_tr_b16 v[196:197], v241 offset:30752
    ds_read_b64_tr_b16 v[198:199], v241 offset:32032
    v_mfma_f32_16x16x32_bf16 v[140:143], v[200:203], v[60:63], v[140:143]
    ds_read_b64_tr_b16 v[200:201], v241 offset:30784
    ds_read_b64_tr_b16 v[202:203], v241 offset:32064
    buffer_load_dwordx4 v[96:99], v17, s[72:75], s58 offen offset:3072 sc1
    v_mfma_f32_16x16x32_bf16 v[144:147], v[204:207], v[60:63], v[144:147]
    ds_read_b64_tr_b16 v[204:205], v241 offset:30816
    ds_read_b64_tr_b16 v[206:207], v241 offset:32096
    v_mfma_f32_16x16x32_bf16 v[148:151], v[208:211], v[60:63], v[148:151]
    ds_read_b64_tr_b16 v[208:209], v241 offset:30848
    ds_read_b64_tr_b16 v[210:211], v241 offset:32128
    s_waitcnt vmcnt(8)
    v_mfma_f32_16x16x32_bf16 v[132:135], v[212:215], v[64:67], v[132:135]
    ds_read_b64_tr_b16 v[212:213], v240 offset:0
    ds_read_b64_tr_b16 v[214:215], v240 offset:1280
    buffer_load_dwordx4 v[100:103], v17, s[72:75], s59 offen offset:0 sc1
    v_mfma_f32_16x16x32_bf16 v[136:139], v[216:219], v[64:67], v[136:139]
    ds_read_b64_tr_b16 v[216:217], v240 offset:32
    ds_read_b64_tr_b16 v[218:219], v240 offset:1312
    v_mfma_f32_16x16x32_bf16 v[140:143], v[220:223], v[64:67], v[140:143]
    ds_read_b64_tr_b16 v[220:221], v240 offset:64
    ds_read_b64_tr_b16 v[222:223], v240 offset:1344
    buffer_load_dwordx4 v[104:107], v17, s[72:75], s59 offen offset:1024 sc1
    v_mfma_f32_16x16x32_bf16 v[144:147], v[224:227], v[64:67], v[144:147]
    ds_read_b64_tr_b16 v[224:225], v240 offset:96
    ds_read_b64_tr_b16 v[226:227], v240 offset:1376
    v_mfma_f32_16x16x32_bf16 v[148:151], v[228:231], v[64:67], v[148:151]
    ds_read_b64_tr_b16 v[228:229], v240 offset:128
    ds_read_b64_tr_b16 v[230:231], v240 offset:1408
    s_waitcnt vmcnt(9)
    s_waitcnt lgkmcnt(10)
    v_mfma_f32_16x16x32_bf16 v[132:135], v[152:155], v[68:71], v[132:135]
    ds_read_b64_tr_b16 v[152:153], v240 offset:5120
    ds_read_b64_tr_b16 v[154:155], v240 offset:6400
    buffer_load_dwordx4 v[108:111], v17, s[72:75], s59 offen offset:2048 sc1
    v_mfma_f32_16x16x32_bf16 v[136:139], v[156:159], v[68:71], v[136:139]
    ds_read_b64_tr_b16 v[156:157], v240 offset:5152
    ds_read_b64_tr_b16 v[158:159], v240 offset:6432
    v_mfma_f32_16x16x32_bf16 v[140:143], v[160:163], v[68:71], v[140:143]
    ds_read_b64_tr_b16 v[160:161], v240 offset:5184
    ds_read_b64_tr_b16 v[162:163], v240 offset:6464
    buffer_load_dwordx4 v[112:115], v17, s[72:75], s59 offen offset:3072 sc1
    v_mfma_f32_16x16x32_bf16 v[144:147], v[164:167], v[68:71], v[144:147]
    ds_read_b64_tr_b16 v[164:165], v240 offset:5216
    ds_read_b64_tr_b16 v[166:167], v240 offset:6496
    v_mfma_f32_16x16x32_bf16 v[148:151], v[168:171], v[68:71], v[148:151]
    ds_read_b64_tr_b16 v[168:169], v240 offset:5248
    ds_read_b64_tr_b16 v[170:171], v240 offset:6528
    s_waitcnt vmcnt(10)
    s_waitcnt lgkmcnt(10)
    v_mfma_f32_16x16x32_bf16 v[132:135], v[172:175], v[72:75], v[132:135]
    ds_read_b64_tr_b16 v[172:173], v240 offset:10240
    ds_read_b64_tr_b16 v[174:175], v240 offset:11520
    buffer_load_dwordx4 v[116:119], v17, s[72:75], s60 offen offset:0 sc1
    v_mfma_f32_16x16x32_bf16 v[136:139], v[176:179], v[72:75], v[136:139]
    ds_read_b64_tr_b16 v[176:177], v240 offset:10272
    ds_read_b64_tr_b16 v[178:179], v240 offset:11552
    v_mfma_f32_16x16x32_bf16 v[140:143], v[180:183], v[72:75], v[140:143]
    ds_read_b64_tr_b16 v[180:181], v240 offset:10304
    ds_read_b64_tr_b16 v[182:183], v240 offset:11584
    buffer_load_dwordx4 v[120:123], v17, s[72:75], s60 offen offset:1024 sc1
    v_mfma_f32_16x16x32_bf16 v[144:147], v[184:187], v[72:75], v[144:147]
    ds_read_b64_tr_b16 v[184:185], v240 offset:10336
    ds_read_b64_tr_b16 v[186:187], v240 offset:11616
    v_mfma_f32_16x16x32_bf16 v[148:151], v[188:191], v[72:75], v[148:151]
    ds_read_b64_tr_b16 v[188:189], v240 offset:10368
    ds_read_b64_tr_b16 v[190:191], v240 offset:11648
    s_waitcnt vmcnt(11)
    s_waitcnt lgkmcnt(10)
    v_mfma_f32_16x16x32_bf16 v[132:135], v[192:195], v[76:79], v[132:135]
    ds_read_b64_tr_b16 v[192:193], v240 offset:15360
    ds_read_b64_tr_b16 v[194:195], v240 offset:16640
    buffer_load_dwordx4 v[124:127], v17, s[72:75], s60 offen offset:2048 sc1
    v_mfma_f32_16x16x32_bf16 v[136:139], v[196:199], v[76:79], v[136:139]
    ds_read_b64_tr_b16 v[196:197], v240 offset:15392
    ds_read_b64_tr_b16 v[198:199], v240 offset:16672
    v_mfma_f32_16x16x32_bf16 v[140:143], v[200:203], v[76:79], v[140:143]
    ds_read_b64_tr_b16 v[200:201], v240 offset:15424
    ds_read_b64_tr_b16 v[202:203], v240 offset:16704
    buffer_load_dwordx4 v[128:131], v17, s[72:75], s60 offen offset:3072 sc1
    v_mfma_f32_16x16x32_bf16 v[144:147], v[204:207], v[76:79], v[144:147]
    ds_read_b64_tr_b16 v[204:205], v240 offset:15456
    ds_read_b64_tr_b16 v[206:207], v240 offset:16736
    v_mfma_f32_16x16x32_bf16 v[148:151], v[208:211], v[76:79], v[148:151]
    ds_read_b64_tr_b16 v[208:209], v240 offset:15488
    ds_read_b64_tr_b16 v[210:211], v240 offset:16768
    ds_read_b32 v14, v2 offset:568
    s_waitcnt vmcnt(12)
    s_waitcnt lgkmcnt(10)
    v_mfma_f32_16x16x32_bf16 v[132:135], v[212:215], v[80:83], v[132:135]
    ds_read_b64_tr_b16 v[212:213], v240 offset:20480
    ds_read_b64_tr_b16 v[214:215], v240 offset:21760
    v_mfma_f32_16x16x32_bf16 v[136:139], v[216:219], v[80:83], v[136:139]
    ds_read_b64_tr_b16 v[216:217], v240 offset:20512
    ds_read_b64_tr_b16 v[218:219], v240 offset:21792
    v_mfma_f32_16x16x32_bf16 v[140:143], v[220:223], v[80:83], v[140:143]
    ds_read_b64_tr_b16 v[220:221], v240 offset:20544
    ds_read_b64_tr_b16 v[222:223], v240 offset:21824
    v_mfma_f32_16x16x32_bf16 v[144:147], v[224:227], v[80:83], v[144:147]
    ds_read_b64_tr_b16 v[224:225], v240 offset:20576
    ds_read_b64_tr_b16 v[226:227], v240 offset:21856
    v_mfma_f32_16x16x32_bf16 v[148:151], v[228:231], v[80:83], v[148:151]
    ds_read_b64_tr_b16 v[228:229], v240 offset:20608
    ds_read_b64_tr_b16 v[230:231], v240 offset:21888
    s_waitcnt vmcnt(11)
    s_waitcnt lgkmcnt(10)
    v_mfma_f32_16x16x32_bf16 v[132:135], v[152:155], v[84:87], v[132:135]
    ds_read_b64_tr_b16 v[152:153], v240 offset:25600
    ds_read_b64_tr_b16 v[154:155], v240 offset:26880
    v_mfma_f32_16x16x32_bf16 v[136:139], v[156:159], v[84:87], v[136:139]
    ds_read_b64_tr_b16 v[156:157], v240 offset:25632
    ds_read_b64_tr_b16 v[158:159], v240 offset:26912
    v_mfma_f32_16x16x32_bf16 v[140:143], v[160:163], v[84:87], v[140:143]
    ds_read_b64_tr_b16 v[160:161], v240 offset:25664
    ds_read_b64_tr_b16 v[162:163], v240 offset:26944
    v_mfma_f32_16x16x32_bf16 v[144:147], v[164:167], v[84:87], v[144:147]
    ds_read_b64_tr_b16 v[164:165], v240 offset:25696
    ds_read_b64_tr_b16 v[166:167], v240 offset:26976
    v_mfma_f32_16x16x32_bf16 v[148:151], v[168:171], v[84:87], v[148:151]
    ds_read_b64_tr_b16 v[168:169], v240 offset:25728
    ds_read_b64_tr_b16 v[170:171], v240 offset:27008
    v_readfirstlane_b32 s76, v14
    s_nop 0
    s_cmp_lt_u32 s76, 4
    s_cbranch_scc1 Lslow_81
Lback_82:
    s_waitcnt vmcnt(10)
    s_waitcnt lgkmcnt(10)
    v_mfma_f32_16x16x32_bf16 v[132:135], v[172:175], v[88:91], v[132:135]
    ds_read_b64_tr_b16 v[172:173], v240 offset:30720
    ds_read_b64_tr_b16 v[174:175], v240 offset:32000
    v_mfma_f32_16x16x32_bf16 v[136:139], v[176:179], v[88:91], v[136:139]
    ds_read_b64_tr_b16 v[176:177], v240 offset:30752
    ds_read_b64_tr_b16 v[178:179], v240 offset:32032
    v_mfma_f32_16x16x32_bf16 v[140:143], v[180:183], v[88:91], v[140:143]
    ds_read_b64_tr_b16 v[180:181], v240 offset:30784
    ds_read_b64_tr_b16 v[182:183], v240 offset:32064
    v_mfma_f32_16x16x32_bf16 v[144:147], v[184:187], v[88:91], v[144:147]
    ds_read_b64_tr_b16 v[184:185], v240 offset:30816
    ds_read_b64_tr_b16 v[186:187], v240 offset:32096
    v_mfma_f32_16x16x32_bf16 v[148:151], v[188:191], v[88:91], v[148:151]
    ds_read_b64_tr_b16 v[188:189], v240 offset:30848
    ds_read_b64_tr_b16 v[190:191], v240 offset:32128
    s_waitcnt vmcnt(9)
    s_waitcnt lgkmcnt(10)
    v_mfma_f32_16x16x32_bf16 v[132:135], v[192:195], v[92:95], v[132:135]
    ds_read_b64_tr_b16 v[192:193], v240 offset:35840
    ds_read_b64_tr_b16 v[194:195], v240 offset:37120
    v_mfma_f32_16x16x32_bf16 v[136:139], v[196:199], v[92:95], v[136:139]
    ds_read_b64_tr_b16 v[196:197], v240 offset:35872
    ds_read_b64_tr_b16 v[198:199], v240 offset:37152
    v_mfma_f32_16x16x32_bf16 v[140:143], v[200:203], v[92:95], v[140:143]
    ds_read_b64_tr_b16 v[200:201], v240 offset:35904
    ds_read_b64_tr_b16 v[202:203], v240 offset:37184
    v_mfma_f32_16x16x32_bf16 v[144:147], v[204:207], v[92:95], v[144:147]
    ds_read_b64_tr_b16 v[204:205], v240 offset:35936
    ds_read_b64_tr_b16 v[206:207], v240 offset:37216
    v_mfma_f32_16x16x32_bf16 v[148:151], v[208:211], v[92:95], v[148:151]
    ds_read_b64_tr_b16 v[208:209], v240 offset:35968
    ds_read_b64_tr_b16 v[210:211], v240 offset:37248
    s_waitcnt vmcnt(8)
    s_waitcnt lgkmcnt(10)
    v_mfma_f32_16x16x32_bf16 v[132:135], v[212:215], v[96:99], v[132:135]
    ds_read_b64_tr_b16 v[212:213], v240 offset:40960
    ds_read_b64_tr_b16 v[214:215], v240 offset:42240
    v_mfma_f32_16x16x32_bf16 v[136:139], v[216:219], v[96:99], v[136:139]
    ds_read_b64_tr_b16 v[216:217], v240 offset:40992
    ds_read_b64_tr_b16 v[218:219], v240 offset:42272
    v_mfma_f32_16x16x32_bf16 v[140:143], v[220:223], v[96:99], v[140:143]
    ds_read_b64_tr_b16 v[220:221], v240 offset:41024
    ds_read_b64_tr_b16 v[222:223], v240 offset:42304
    v_mfma_f32_16x16x32_bf16 v[144:147], v[224:227], v[96:99], v[144:147]
    ds_read_b64_tr_b16 v[224:225], v240 offset:41056
    ds_read_b64_tr_b16 v[226:227], v240 offset:42336
    v_mfma_f32_16x16x32_bf16 v[148:151], v[228:231], v[96:99], v[148:151]
    ds_read_b64_tr_b16 v[228:229], v240 offset:41088
    ds_read_b64_tr_b16 v[230:231], v240 offset:42368
    s_waitcnt vmcnt(7)
    s_waitcnt lgkmcnt(10)
    v_mfma_f32_16x16x32_bf16 v[132:135], v[152:155], v[100:103], v[132:135]
    ds_read_b64_tr_b16 v[152:153], v240 offset:46080
    ds_read_b64_tr_b16 v[154:155], v240 offset:47360
    v_mfma_f32_16x16x32_bf16 v[136:139], v[156:159], v[100:103], v[136:139]
    ds_read_b64_tr_b16 v[156:157], v240 offset:46112
    ds_read_b64_tr_b16 v[158:159], v240 offset:47392
    v_mfma_f32_16x16x32_bf16 v[140:143], v[160:163], v[100:103], v[140:143]
    ds_read_b64_tr_b16 v[160:161], v240 offset:46144
    ds_read_b64_tr_b16 v[162:163], v240 offset:47424
    v_mfma_f32_16x16x32_bf16 v[144:147], v[164:167], v[100:103], v[144:147]
    ds_read_b64_tr_b16 v[164:165], v240 offset:46176
    ds_read_b64_tr_b16 v[166:167], v240 offset:47456
    v_mfma_f32_16x16x32_bf16 v[148:151], v[168:171], v[100:103], v[148:151]
    ds_read_b64_tr_b16 v[168:169], v240 offset:46208
    ds_read_b64_tr_b16 v[170:171], v240 offset:47488
    s_waitcnt vmcnt(6)
    s_waitcnt lgkmcnt(10)
    v_mfma_f32_16x16x32_bf16 v[132:135], v[172:175], v[104:107], v[132:135]
    ds_read_b64_tr_b16 v[172:173], v240 offset:51200
    ds_read_b64_tr_b16 v[174:175], v240 offset:52480
    v_mfma_f32_16x16x32_bf16 v[136:139], v[176:179], v[104:107], v[136:139]
    ds_read_b64_tr_b16 v[176:177], v240 offset:51232
    ds_read_b64_tr_b16 v[178:179], v240 offset:52512
    v_mfma_f32_16x16x32_bf16 v[140:143], v[180:183], v[104:107], v[140:143]
    ds_read_b64_tr_b16 v[180:181], v240 offset:51264
    ds_read_b64_tr_b16 v[182:183], v240 offset:52544
    v_mfma_f32_16x16x32_bf16 v[144:147], v[184:187], v[104:107], v[144:147]
    ds_read_b64_tr_b16 v[184:185], v240 offset:51296
    ds_read_b64_tr_b16 v[186:187], v240 offset:52576
    v_mfma_f32_16x16x32_bf16 v[148:151], v[188:191], v[104:107], v[148:151]
    ds_read_b64_tr_b16 v[188:189], v240 offset:51328
    ds_read_b64_tr_b16 v[190:191], v240 offset:52608
    s_waitcnt vmcnt(5)
    s_waitcnt lgkmcnt(10)
    v_mfma_f32_16x16x32_bf16 v[132:135], v[192:195], v[108:111], v[132:135]
    ds_read_b64_tr_b16 v[192:193], v240 offset:56320
    ds_read_b64_tr_b16 v[194:195], v240 offset:57600
    v_mfma_f32_16x16x32_bf16 v[136:139], v[196:199], v[108:111], v[136:139]
    ds_read_b64_tr_b16 v[196:197], v240 offset:56352
    ds_read_b64_tr_b16 v[198:199], v240 offset:57632
    v_mfma_f32_16x16x32_bf16 v[140:143], v[200:203], v[108:111], v[140:143]
    ds_read_b64_tr_b16 v[200:201], v240 offset:56384
    ds_read_b64_tr_b16 v[202:203], v240 offset:57664
    v_mfma_f32_16x16x32_bf16 v[144:147], v[204:207], v[108:111], v[144:147]
    ds_read_b64_tr_b16 v[204:205], v240 offset:56416
    ds_read_b64_tr_b16 v[206:207], v240 offset:57696
    v_mfma_f32_16x16x32_bf16 v[148:151], v[208:211], v[108:111], v[148:151]
    ds_read_b64_tr_b16 v[208:209], v240 offset:56448
    ds_read_b64_tr_b16 v[210:211], v240 offset:57728
    s_waitcnt vmcnt(4)
    s_waitcnt lgkmcnt(10)
    v_mfma_f32_16x16x32_bf16 v[132:135], v[212:215], v[112:115], v[132:135]
    ds_read_b64_tr_b16 v[212:213], v240 offset:61440
    ds_read_b64_tr_b16 v[214:215], v240 offset:62720
    v_mfma_f32_16x16x32_bf16 v[136:139], v[216:219], v[112:115], v[136:139]
    ds_read_b64_tr_b16 v[216:217], v240 offset:61472
    ds_read_b64_tr_b16 v[218:219], v240 offset:62752
    v_mfma_f32_16x16x32_bf16 v[140:143], v[220:223], v[112:115], v[140:143]
    ds_read_b64_tr_b16 v[220:221], v240 offset:61504
    ds_read_b64_tr_b16 v[222:223], v240 offset:62784
    v_mfma_f32_16x16x32_bf16 v[144:147], v[224:227], v[112:115], v[144:147]
    ds_read_b64_tr_b16 v[224:225], v240 offset:61536
    ds_read_b64_tr_b16 v[226:227], v240 offset:62816
    v_mfma_f32_16x16x32_bf16 v[148:151], v[228:231], v[112:115], v[148:151]
    ds_read_b64_tr_b16 v[228:229], v240 offset:61568
    ds_read_b64_tr_b16 v[230:231], v240 offset:62848
    s_waitcnt vmcnt(3)
    s_waitcnt lgkmcnt(10)
    v_mfma_f32_16x16x32_bf16 v[132:135], v[152:155], v[116:119], v[132:135]
    v_mfma_f32_16x16x32_bf16 v[136:139], v[156:159], v[116:119], v[136:139]
    v_mfma_f32_16x16x32_bf16 v[140:143], v[160:163], v[116:119], v[140:143]
    v_mfma_f32_16x16x32_bf16 v[144:147], v[164:167], v[116:119], v[144:147]
    v_mfma_f32_16x16x32_bf16 v[148:151], v[168:171], v[116:119], v[148:151]
    s_waitcnt vmcnt(2)
    s_waitcnt lgkmcnt(10)
    v_mfma_f32_16x16x32_bf16 v[132:135], v[172:175], v[120:123], v[132:135]
    v_mfma_f32_16x16x32_bf16 v[136:139], v[176:179], v[120:123], v[136:139]
    v_mfma_f32_16x16x32_bf16 v[140:143], v[180:183], v[120:123], v[140:143]
    v_mfma_f32_16x16x32_bf16 v[144:147], v[184:187], v[120:123], v[144:147]
    v_mfma_f32_16x16x32_bf16 v[148:151], v[188:191], v[120:123], v[148:151]
    ds_read_b32 v14, v245 offset:608
    s_waitcnt vmcnt(1)
    s_waitcnt lgkmcnt(10)
    v_mfma_f32_16x16x32_bf16 v[132:135], v[192:195], v[124:127], v[132:135]
    v_mfma_f32_16x16x32_bf16 v[136:139], v[196:199], v[124:127], v[136:139]
    v_mfma_f32_16x16x32_bf16 v[140:143], v[200:203], v[124:127], v[140:143]
    v_mfma_f32_16x16x32_bf16 v[144:147], v[204:207], v[124:127], v[144:147]
    v_mfma_f32_16x16x32_bf16 v[148:151], v[208:211], v[124:127], v[148:151]
    s_waitcnt vmcnt(0)
    s_waitcnt lgkmcnt(0)
    v_mfma_f32_16x16x32_bf16 v[132:135], v[212:215], v[128:131], v[132:135]
    v_mfma_f32_16x16x32_bf16 v[136:139], v[216:219], v[128:131], v[136:139]
    v_mfma_f32_16x16x32_bf16 v[140:143], v[220:223], v[128:131], v[140:143]
    v_mfma_f32_16x16x32_bf16 v[144:147], v[224:227], v[128:131], v[144:147]
    v_mfma_f32_16x16x32_bf16 v[148:151], v[228:231], v[128:131], v[148:151]
    v_readfirstlane_b32 s76, v14
    s_nop 0
    s_cmp_lt_u32 s76, 1
    s_cbranch_scc1 Lslow_85
Lback_86:
    ds_read_b128 v[20:23], v244 offset:0
    ds_read_b128 v[24:27], v244 offset:1024
    ds_read_b128 v[28:31], v244 offset:2048
    ds_read_b128 v[32:35], v244 offset:3072
    ds_read_b128 v[36:39], v244 offset:4096
    s_mul_i32 s77, s5, 160
    s_waitcnt lgkmcnt(0)
    v_pk_add_f32 v[132:133], v[132:133], v[20:21]
    v_pk_add_f32 v[134:135], v[134:135], v[22:23]
    v_pk_add_f32 v[136:137], v[136:137], v[24:25]
    v_pk_add_f32 v[138:139], v[138:139], v[26:27]
    v_pk_add_f32 v[140:141], v[140:141], v[28:29]
    v_pk_add_f32 v[142:143], v[142:143], v[30:31]
    v_pk_add_f32 v[144:145], v[144:145], v[32:33]
    v_pk_add_f32 v[146:147], v[146:147], v[34:35]
    v_pk_add_f32 v[148:149], v[148:149], v[36:37]
    v_pk_add_f32 v[150:151], v[150:151], v[38:39]
    v_cvt_pk_bf16_f32 v40, v132, v133
    v_cvt_pk_bf16_f32 v41, v134, v135
    v_cvt_pk_bf16_f32 v42, v136, v137
    v_cvt_pk_bf16_f32 v43, v138, v139
    v_cvt_pk_bf16_f32 v44, v140, v141
    v_cvt_pk_bf16_f32 v45, v142, v143
    v_cvt_pk_bf16_f32 v46, v144, v145
    v_cvt_pk_bf16_f32 v47, v146, v147
    v_cvt_pk_bf16_f32 v48, v148, v149
    v_cvt_pk_bf16_f32 v49, v150, v151
    v_permlane16_swap_b32 v40, v42
    v_permlane16_swap_b32 v41, v43
    v_permlane16_swap_b32 v44, v46
    v_permlane16_swap_b32 v45, v47
    buffer_store_dwordx4 v[40:43], v242, s[68:71], s77 offen offset:0
    buffer_store_dwordx4 v[44:47], v242, s[68:71], s77 offen offset:64
    buffer_store_dwordx2 v[48:49], v243, s[68:71], s77 offen offset:128
    s_branch L_fin
L_fallback:
    s_mov_b32 exec_lo, 0
    v_mov_b32 v152, 0
    v_mov_b32 v153, 0
    v_mov_b32 v158, 0
    v_mov_b32 v159, 0
    s_mov_b32 exec_lo, -1
    v_mov_b32 v56, 0xff7fffff
    v_mov_b32 v57, 0xff7fffff
    s_mov_b32 s8, 262144
    s_mov_b32 s7, 64
    s_waitcnt vmcnt(0)
L_fb1:
    buffer_load_dwordx4 v[172:175], v17, s[72:75], s8 offen sc1
    buffer_load_dwordx2 v[176:177], v230, s[72:75], s8 offen offset:1024 sc1
    s_add_u32 s8, s8, 1408
    s_waitcnt vmcnt(0)
    v_mfma_f32_32x32x16_bf16 v[20:35], v[172:175], v[148:151], 0
    v_mfma_f32_32x32x8_bf16 v[20:35], v[176:177], v[152:153], v[20:35]
    v_mfma_f32_32x32x16_bf16 v[36:51], v[172:175], v[154:157], 0
    v_mfma_f32_32x32x8_bf16 v[36:51], v[176:177], v[158:159], v[36:51]
    s_nop 9
    v_max3_f32 v56, v20, v21, v56
    v_max3_f32 v56, v22, v23, v56
    v_max3_f32 v56, v24, v25, v56
    v_max3_f32 v56, v26, v27, v56
    v_max3_f32 v56, v28, v29, v56
    v_max3_f32 v56, v30, v31, v56
    v_max3_f32 v56, v32, v33, v56
    v_max3_f32 v56, v34, v35, v56
    v_max3_f32 v57, v36, v37, v57
    v_max3_f32 v57, v38, v39, v57
    v_max3_f32 v57, v40, v41, v57
    v_max3_f32 v57, v42, v43, v57
    v_max3_f32 v57, v44, v45, v57
    v_max3_f32 v57, v46, v47, v57
    v_max3_f32 v57, v48, v49, v57
    v_max3_f32 v57, v50, v51, v57
    s_sub_u32 s7, s7, 1
    s_cmp_lg_u32 s7, 0
    s_cbranch_scc1 L_fb1
    v_mov_b32 v58, v56
    s_nop 1
    v_permlane32_swap_b32 v56, v58
    v_max_f32 v56, v56, v58
    v_sub_f32 v56, 0, v56
    v_and_b32 v58, 0xffff0000, v56
    v_sub_f32 v56, v56, v58
    v_and_b32 v59, 0xffff0000, v56
    v_sub_f32 v56, v56, v59
    s_mov_b32 exec_lo, 0
    v_lshrrev_b32 v58, 16, v58
    v_or_b32 v152, v58, v59
    v_lshrrev_b32 v153, 16, v56
    s_mov_b32 exec_lo, -1
    v_mov_b32 v58, v57
    s_nop 1
    v_permlane32_swap_b32 v57, v58
    v_max_f32 v57, v57, v58
    v_sub_f32 v57, 0, v57
    v_and_b32 v58, 0xffff0000, v57
    v_sub_f32 v57, v57, v58
    v_and_b32 v59, 0xffff0000, v57
    v_sub_f32 v57, v57, v59
    s_mov_b32 exec_lo, 0
    v_lshrrev_b32 v58, 16, v58
    v_or_b32 v158, v58, v59
    v_lshrrev_b32 v159, 16, v57
    s_mov_b32 exec_lo, -1
    v_mov_b64 v[84:85], 0
    v_mov_b64 v[86:87], 0
    v_mov_b64 v[88:89], 0
    v_mov_b64 v[90:91], 0
    v_mov_b64 v[92:93], 0
    v_mov_b64 v[94:95], 0
    v_mov_b64 v[96:97], 0
    v_mov_b64 v[98:99], 0
    v_mov_b64 v[100:101], 0
    v_mov_b64 v[102:103], 0
    v_mov_b64 v[104:105], 0
    v_mov_b64 v[106:107], 0
    v_mov_b64 v[108:109], 0
    v_mov_b64 v[110:111], 0
    v_mov_b64 v[112:113], 0
    v_mov_b64 v[114:115], 0
    s_mov_b32 s8, 262144
    s_mov_b32 s9, 393216
    s_mov_b32 s7, 64
L_fb2:
    buffer_load_dwordx4 v[172:175], v17, s[72:75], s8 offen sc1
    buffer_load_dwordx2 v[176:177], v230, s[72:75], s8 offen offset:1024 sc1
    s_add_u32 s8, s8, 1408
    buffer_load_dwordx4 v[196:199], v231, s[72:75], s9 offen sc1
    buffer_load_dwordx4 v[200:203], v231, s[72:75], s9 offen offset:768 sc1
    s_add_u32 s9, s9, 1536
    s_waitcnt vmcnt(0)
    v_mfma_f32_32x32x16_bf16 v[20:35], v[172:175], v[148:151], 0
    v_mfma_f32_32x32x8_bf16 v[20:35], v[176:177], v[152:153], v[20:35]
    v_mfma_f32_32x32x16_bf16 v[36:51], v[172:175], v[154:157], 0
    v_mfma_f32_32x32x8_bf16 v[36:51], v[176:177], v[158:159], v[36:51]
    s_nop 9
    v_exp_f32 v20, v20
    v_exp_f32 v21, v21
    v_exp_f32 v22, v22
    v_exp_f32 v23, v23
    v_exp_f32 v24, v24
    v_exp_f32 v25, v25
    v_exp_f32 v26, v26
    v_exp_f32 v27, v27
    v_exp_f32 v28, v28
    v_exp_f32 v29, v29
    v_exp_f32 v30, v30
    v_exp_f32 v31, v31
    v_exp_f32 v32, v32
    v_exp_f32 v33, v33
    v_exp_f32 v34, v34
    v_exp_f32 v35, v35
    v_exp_f32 v36, v36
    v_exp_f32 v37, v37
    v_exp_f32 v38, v38
    v_exp_f32 v39, v39
    v_exp_f32 v40, v40
    v_exp_f32 v41, v41
    v_exp_f32 v42, v42
    v_exp_f32 v43, v43
    v_exp_f32 v44, v44
    v_exp_f32 v45, v45
    v_exp_f32 v46, v46
    v_exp_f32 v47, v47
    v_exp_f32 v48, v48
    v_exp_f32 v49, v49
    v_exp_f32 v50, v50
    v_exp_f32 v51, v51
    v_smfmac_f32_32x32x32_bf16 v[84:99], v[196:199], v[20:27], v228
    v_smfmac_f32_32x32x32_bf16 v[84:99], v[200:203], v[28:35], v228
    v_smfmac_f32_32x32x32_bf16 v[100:115], v[196:199], v[36:43], v228
    v_smfmac_f32_32x32x32_bf16 v[100:115], v[200:203], v[44:51], v228
    s_nop 15
    s_sub_u32 s7, s7, 1
    s_cmp_lg_u32 s7, 0
    s_cbranch_scc1 L_fb2
    v_mov_b32 v52, v92
    v_mov_b32 v53, v92
    v_mov_b32 v54, v108
    v_mov_b32 v55, v108
    v_permlane32_swap_b32 v52, v53
    s_nop 0
    v_permlane32_swap_b32 v54, v55
    s_nop 1
    s_branch L_m_norm
L_gmain:
    s_cmp_eq_u32 s15, 1
    s_cbranch_scc1 L_bg1
    s_cmp_eq_u32 s15, 2
    s_cbranch_scc1 L_bg2
    s_cmp_eq_u32 s15, 3
    s_cbranch_scc1 L_bg3
    ds_read_b128 v[104:107], v24 offset:0
    ds_read_b128 v[108:111], v24 offset:2048
    ds_read_b64_tr_b16 v[116:117], v28 offset:0
    ds_read_b64_tr_b16 v[118:119], v28 offset:3840
    ds_read_b64_tr_b16 v[120:121], v28 offset:32
    ds_read_b64_tr_b16 v[122:123], v28 offset:3872
    ds_read_b64_tr_b16 v[124:125], v28 offset:64
    ds_read_b64_tr_b16 v[126:127], v28 offset:3904
    ds_read_b64_tr_b16 v[128:129], v28 offset:96
    ds_read_b64_tr_b16 v[130:131], v28 offset:3936
    ds_read_b64_tr_b16 v[132:133], v28 offset:128
    ds_read_b64_tr_b16 v[134:135], v28 offset:3968
    ds_read_b64_tr_b16 v[136:137], v28 offset:160
    ds_read_b64_tr_b16 v[138:139], v28 offset:4000
    ds_read_b64_tr_b16 v[140:141], v28 offset:192
    ds_read_b64_tr_b16 v[142:143], v28 offset:4032
    ds_read_b64_tr_b16 v[144:145], v28 offset:224
    ds_read_b64_tr_b16 v[146:147], v28 offset:4064
    ds_read_b32 v9, v2 offset:632
    ds_read_b32 v7, v2 offset:112
    s_mov_b32 s48, s20
    s_mov_b32 s49, s21
    s_mov_b32 s50, 819200
    s_mov_b32 s51, 0x20000
    s_mov_b32 s60, s30
    s_mov_b32 s61, s31
    s_mov_b32 s62, 819200
    s_mov_b32 s63, 0x20000
    s_waitcnt lgkmcnt(0)
    v_mfma_f32_16x16x32_bf16 v[32:35], v[116:119], v[104:107], 0
    s_mov_b32 m0, 117760
    s_add_u32 s10, s8, 122880
    buffer_load_dwordx4 v20, s[44:47], s10 offen lds
    v_mfma_f32_16x16x32_bf16 v[36:39], v[116:119], v[108:111], 0
    s_mov_b32 m0, 121856
    s_nop 0
    buffer_load_dwordx4 v21, s[44:47], s10 offen lds
    v_mfma_f32_16x16x32_bf16 v[40:43], v[120:123], v[104:107], 0
    s_mov_b32 m0, 125952
    s_nop 0
    buffer_load_dwordx4 v22, s[44:47], s10 offen lds
    v_mfma_f32_16x16x32_bf16 v[44:47], v[120:123], v[108:111], 0
    s_mov_b32 m0, 130048
    s_nop 0
    buffer_load_dwordx4 v23, s[44:47], s10 offen lds
    v_mfma_f32_16x16x32_bf16 v[48:51], v[124:127], v[104:107], 0
    s_mov_b32 m0, 133120
    s_add_u32 s10, s8, 245760
    buffer_load_dwordx4 v20, s[44:47], s10 offen lds
    v_mfma_f32_16x16x32_bf16 v[52:55], v[124:127], v[108:111], 0
    s_mov_b32 m0, 137216
    s_nop 0
    buffer_load_dwordx4 v21, s[44:47], s10 offen lds
    v_mfma_f32_16x16x32_bf16 v[56:59], v[128:131], v[104:107], 0
    s_mov_b32 m0, 141312
    s_nop 0
    buffer_load_dwordx4 v22, s[44:47], s10 offen lds
    v_mfma_f32_16x16x32_bf16 v[60:63], v[128:131], v[108:111], 0
    s_mov_b32 m0, 145408
    s_nop 0
    buffer_load_dwordx4 v23, s[44:47], s10 offen lds
    s_setprio 2
    v_readfirstlane_b32 s6, v9
    v_readfirstlane_b32 s39, v7
    s_setprio 0
    v_mfma_f32_16x16x32_bf16 v[64:67], v[132:135], v[104:107], 0
    v_mfma_f32_16x16x32_bf16 v[68:71], v[132:135], v[108:111], 0
    s_waitcnt vmcnt(4) lgkmcnt(0)
    ds_add_u32 v19, v3 offset:144
    v_mfma_f32_16x16x32_bf16 v[72:75], v[136:139], v[104:107], 0
    ds_read_b32 v29, v2 offset:144
    v_mfma_f32_16x16x32_bf16 v[76:79], v[136:139], v[108:111], 0
    s_waitcnt lgkmcnt(0)
    s_setprio 2
    v_readfirstlane_b32 s76, v29
    s_setprio 0
    s_cmp_lt_u32 s76, 4
    s_cbranch_scc1 Lslow_89
Lback_90:
    ds_read_b128 v[148:151], v25 offset:0
    ds_read_b128 v[152:155], v25 offset:2048
    ds_read_b64_tr_b16 v[160:161], v28 offset:15360
    v_mfma_f32_16x16x32_bf16 v[80:83], v[140:143], v[104:107], 0
    ds_read_b64_tr_b16 v[162:163], v28 offset:19200
    ds_read_b64_tr_b16 v[164:165], v28 offset:15392
    ds_read_b64_tr_b16 v[166:167], v28 offset:19232
    v_mfma_f32_16x16x32_bf16 v[84:87], v[140:143], v[108:111], 0
    s_mov_b32 m0, 102400
    s_add_u32 s10, s8, 368640
    buffer_load_dwordx4 v20, s[44:47], s10 offen lds
    v_mfma_f32_16x16x32_bf16 v[88:91], v[144:147], v[104:107], 0
    ds_read_b64_tr_b16 v[168:169], v28 offset:15424
    ds_read_b64_tr_b16 v[170:171], v28 offset:19264
    ds_read_b64_tr_b16 v[172:173], v28 offset:15456
    ds_read_b64_tr_b16 v[174:175], v28 offset:19296
    ds_read_b64_tr_b16 v[176:177], v28 offset:15488
    ds_read_b64_tr_b16 v[178:179], v28 offset:19328
    s_mov_b32 m0, 106496
    s_nop 0
    buffer_load_dwordx4 v21, s[44:47], s10 offen lds
    ds_read_b64_tr_b16 v[180:181], v28 offset:15520
    ds_read_b64_tr_b16 v[182:183], v28 offset:19360
    ds_read_b64_tr_b16 v[184:185], v28 offset:15552
    ds_read_b64_tr_b16 v[186:187], v28 offset:19392
    ds_read_b64_tr_b16 v[188:189], v28 offset:15584
    ds_read_b64_tr_b16 v[190:191], v28 offset:19424
    s_mov_b32 m0, 110592
    s_nop 0
    buffer_load_dwordx4 v22, s[44:47], s10 offen lds
    s_mov_b32 m0, 114688
    s_nop 0
    buffer_load_dwordx4 v23, s[44:47], s10 offen lds
    s_waitcnt vmcnt(4) lgkmcnt(0)
    ds_add_u32 v19, v3 offset:144
    s_mul_i32 s11, s2, 3200
    s_setprio 2
    v_lshlrev_b32 v4, 7, v1
    s_setprio 0
    s_mov_b32 exec_lo, 0x1ffffff
    s_mov_b32 exec_hi, 0
    buffer_load_dword v0, v4, s[48:51], s11 offen
    s_mov_b64 exec, -1
    v_mfma_f32_16x16x32_bf16 v[32:35], v[160:163], v[148:151], v[32:35]
    ds_read_b32 v29, v2 offset:144
    v_mfma_f32_16x16x32_bf16 v[36:39], v[160:163], v[152:155], v[36:39]
    s_waitcnt lgkmcnt(0)
    s_setprio 2
    v_readfirstlane_b32 s76, v29
    s_setprio 0
    s_cmp_lt_u32 s76, 8
    s_cbranch_scc1 Lslow_93
Lback_94:
    ds_read_b128 v[104:107], v24 offset:8192
    ds_read_b128 v[108:111], v24 offset:10240
    ds_read_b64_tr_b16 v[116:117], v28 offset:30720
    v_mfma_f32_16x16x32_bf16 v[40:43], v[164:167], v[148:151], v[40:43]
    ds_read_b64_tr_b16 v[118:119], v28 offset:34560
    ds_read_b64_tr_b16 v[120:121], v28 offset:30752
    ds_read_b64_tr_b16 v[122:123], v28 offset:34592
    v_mfma_f32_16x16x32_bf16 v[44:47], v[164:167], v[152:155], v[44:47]
    s_mov_b32 m0, 117760
    s_add_u32 s10, s8, 491520
    buffer_load_dwordx4 v20, s[44:47], s10 offen lds
    v_mfma_f32_16x16x32_bf16 v[48:51], v[168:171], v[148:151], v[48:51]
    ds_read_b64_tr_b16 v[124:125], v28 offset:30784
    ds_read_b64_tr_b16 v[126:127], v28 offset:34624
    ds_read_b64_tr_b16 v[128:129], v28 offset:30816
    v_mfma_f32_16x16x32_bf16 v[52:55], v[168:171], v[152:155], v[52:55]
    ds_read_b64_tr_b16 v[130:131], v28 offset:34656
    ds_read_b64_tr_b16 v[132:133], v28 offset:30848
    ds_read_b64_tr_b16 v[134:135], v28 offset:34688
    v_mfma_f32_16x16x32_bf16 v[56:59], v[172:175], v[148:151], v[56:59]
    s_mov_b32 m0, 121856
    s_nop 0
    buffer_load_dwordx4 v21, s[44:47], s10 offen lds
    v_mfma_f32_16x16x32_bf16 v[60:63], v[172:175], v[152:155], v[60:63]
    ds_read_b64_tr_b16 v[136:137], v28 offset:30880
    ds_read_b64_tr_b16 v[138:139], v28 offset:34720
    ds_read_b64_tr_b16 v[140:141], v28 offset:30912
    v_mfma_f32_16x16x32_bf16 v[64:67], v[176:179], v[148:151], v[64:67]
    ds_read_b64_tr_b16 v[142:143], v28 offset:34752
    ds_read_b64_tr_b16 v[144:145], v28 offset:30944
    ds_read_b64_tr_b16 v[146:147], v28 offset:34784
    v_mfma_f32_16x16x32_bf16 v[68:71], v[176:179], v[152:155], v[68:71]
    s_mov_b32 m0, 125952
    s_nop 0
    buffer_load_dwordx4 v22, s[44:47], s10 offen lds
    v_mfma_f32_16x16x32_bf16 v[72:75], v[180:183], v[148:151], v[72:75]
    s_mov_b32 m0, 130048
    s_nop 0
    buffer_load_dwordx4 v23, s[44:47], s10 offen lds
    v_mfma_f32_16x16x32_bf16 v[76:79], v[180:183], v[152:155], v[76:79]
    s_waitcnt vmcnt(5) lgkmcnt(0)
    ds_add_u32 v19, v3 offset:144
    v_mfma_f32_16x16x32_bf16 v[80:83], v[184:187], v[148:151], v[80:83]
    s_mov_b32 m0, 81920
    s_mov_b32 s11, 655360
    buffer_load_dwordx4 v10, s[48:51], s11 offen lds
    v_mfma_f32_16x16x32_bf16 v[84:87], v[184:187], v[152:155], v[84:87]
    v_mfma_f32_16x16x32_bf16 v[88:91], v[188:191], v[148:151], v[88:91]
    v_mfma_f32_16x16x32_bf16 v[32:35], v[116:119], v[104:107], v[32:35]
    ds_read_b32 v29, v2 offset:144
    v_mfma_f32_16x16x32_bf16 v[36:39], v[116:119], v[108:111], v[36:39]
    s_waitcnt lgkmcnt(0)
    s_setprio 2
    v_readfirstlane_b32 s76, v29
    s_setprio 0
    s_cmp_lt_u32 s76, 12
    s_cbranch_scc1 Lslow_97
Lback_98:
    ds_read_b128 v[148:151], v25 offset:8192
    ds_read_b128 v[152:155], v25 offset:10240
    ds_read_b64_tr_b16 v[160:161], v28 offset:0
    v_mfma_f32_16x16x32_bf16 v[40:43], v[120:123], v[104:107], v[40:43]
    ds_read_b64_tr_b16 v[162:163], v28 offset:3840
    ds_read_b64_tr_b16 v[164:165], v28 offset:32
    ds_read_b64_tr_b16 v[166:167], v28 offset:3872
    v_mfma_f32_16x16x32_bf16 v[44:47], v[120:123], v[108:111], v[44:47]
    s_mov_b32 m0, 133120
    s_add_u32 s10, s8, 614400
    buffer_load_dwordx4 v20, s[44:47], s10 offen lds
    v_mfma_f32_16x16x32_bf16 v[48:51], v[124:127], v[104:107], v[48:51]
    ds_read_b64_tr_b16 v[168:169], v28 offset:64
    ds_read_b64_tr_b16 v[170:171], v28 offset:3904
    ds_read_b64_tr_b16 v[172:173], v28 offset:96
    v_mfma_f32_16x16x32_bf16 v[52:55], v[124:127], v[108:111], v[52:55]
    ds_read_b64_tr_b16 v[174:175], v28 offset:3936
    ds_read_b64_tr_b16 v[176:177], v28 offset:128
    ds_read_b64_tr_b16 v[178:179], v28 offset:3968
    v_mfma_f32_16x16x32_bf16 v[56:59], v[128:131], v[104:107], v[56:59]
    s_mov_b32 m0, 137216
    s_nop 0
    buffer_load_dwordx4 v21, s[44:47], s10 offen lds
    v_mfma_f32_16x16x32_bf16 v[60:63], v[128:131], v[108:111], v[60:63]
    ds_read_b64_tr_b16 v[180:181], v28 offset:160
    ds_read_b64_tr_b16 v[182:183], v28 offset:4000
    ds_read_b64_tr_b16 v[184:185], v28 offset:192
    v_mfma_f32_16x16x32_bf16 v[64:67], v[132:135], v[104:107], v[64:67]
    ds_read_b64_tr_b16 v[186:187], v28 offset:4032
    ds_read_b64_tr_b16 v[188:189], v28 offset:224
    ds_read_b64_tr_b16 v[190:191], v28 offset:4064
    v_mfma_f32_16x16x32_bf16 v[68:71], v[132:135], v[108:111], v[68:71]
    s_mov_b32 m0, 141312
    s_nop 0
    buffer_load_dwordx4 v22, s[44:47], s10 offen lds
    v_mfma_f32_16x16x32_bf16 v[72:75], v[136:139], v[104:107], v[72:75]
    s_mov_b32 m0, 145408
    s_nop 0
    buffer_load_dwordx4 v23, s[44:47], s10 offen lds
    v_mfma_f32_16x16x32_bf16 v[76:79], v[136:139], v[108:111], v[76:79]
    s_waitcnt vmcnt(5) lgkmcnt(0)
    ds_add_u32 v19, v3 offset:144
    v_mfma_f32_16x16x32_bf16 v[80:83], v[140:143], v[104:107], v[80:83]
    s_mov_b32 m0, 87040
    s_mov_b32 s11, 696320
    buffer_load_dwordx4 v10, s[48:51], s11 offen lds
    v_mfma_f32_16x16x32_bf16 v[84:87], v[140:143], v[108:111], v[84:87]
    v_mfma_f32_16x16x32_bf16 v[88:91], v[144:147], v[104:107], v[88:91]
    v_mfma_f32_16x16x32_bf16 v[32:35], v[160:163], v[148:151], v[32:35]
    ds_read_b32 v29, v2 offset:144
    v_mfma_f32_16x16x32_bf16 v[36:39], v[160:163], v[152:155], v[36:39]
    s_waitcnt lgkmcnt(0)
    s_setprio 2
    v_readfirstlane_b32 s76, v29
    s_setprio 0
    s_cmp_lt_u32 s76, 16
    s_cbranch_scc1 Lslow_101
Lback_102:
    ds_read_b128 v[104:107], v24 offset:16384
    ds_read_b128 v[108:111], v24 offset:18432
    ds_read_b64_tr_b16 v[116:117], v28 offset:15360
    v_mfma_f32_16x16x32_bf16 v[40:43], v[164:167], v[148:151], v[40:43]
    ds_read_b64_tr_b16 v[118:119], v28 offset:19200
    ds_read_b64_tr_b16 v[120:121], v28 offset:15392
    ds_read_b64_tr_b16 v[122:123], v28 offset:19232
    v_mfma_f32_16x16x32_bf16 v[44:47], v[164:167], v[152:155], v[44:47]
    s_mov_b32 m0, 102400
    s_add_u32 s10, s8, 737280
    buffer_load_dwordx4 v20, s[44:47], s10 offen lds
    v_mfma_f32_16x16x32_bf16 v[48:51], v[168:171], v[148:151], v[48:51]
    ds_read_b64_tr_b16 v[124:125], v28 offset:15424
    ds_read_b64_tr_b16 v[126:127], v28 offset:19264
    ds_read_b64_tr_b16 v[128:129], v28 offset:15456
    v_mfma_f32_16x16x32_bf16 v[52:55], v[168:171], v[152:155], v[52:55]
    ds_read_b64_tr_b16 v[130:131], v28 offset:19296
    ds_read_b64_tr_b16 v[132:133], v28 offset:15488
    ds_read_b64_tr_b16 v[134:135], v28 offset:19328
    v_mfma_f32_16x16x32_bf16 v[56:59], v[172:175], v[148:151], v[56:59]
    s_mov_b32 m0, 106496
    s_nop 0
    buffer_load_dwordx4 v21, s[44:47], s10 offen lds
    v_mfma_f32_16x16x32_bf16 v[60:63], v[172:175], v[152:155], v[60:63]
    ds_read_b64_tr_b16 v[136:137], v28 offset:15520
    ds_read_b64_tr_b16 v[138:139], v28 offset:19360
    ds_read_b64_tr_b16 v[140:141], v28 offset:15552
    v_mfma_f32_16x16x32_bf16 v[64:67], v[176:179], v[148:151], v[64:67]
    ds_read_b64_tr_b16 v[142:143], v28 offset:19392
    ds_read_b64_tr_b16 v[144:145], v28 offset:15584
    ds_read_b64_tr_b16 v[146:147], v28 offset:19424
    v_mfma_f32_16x16x32_bf16 v[68:71], v[176:179], v[152:155], v[68:71]
    s_mov_b32 m0, 110592
    s_nop 0
    buffer_load_dwordx4 v22, s[44:47], s10 offen lds
    v_mfma_f32_16x16x32_bf16 v[72:75], v[180:183], v[148:151], v[72:75]
    s_mov_b32 m0, 114688
    s_nop 0
    buffer_load_dwordx4 v23, s[44:47], s10 offen lds
    v_mfma_f32_16x16x32_bf16 v[76:79], v[180:183], v[152:155], v[76:79]
    s_waitcnt vmcnt(5) lgkmcnt(0)
    ds_add_u32 v19, v3 offset:144
    v_mfma_f32_16x16x32_bf16 v[80:83], v[184:187], v[148:151], v[80:83]
    s_mov_b32 m0, 92160
    s_mov_b32 s11, 737280
    buffer_load_dwordx4 v10, s[48:51], s11 offen lds
    v_mfma_f32_16x16x32_bf16 v[84:87], v[184:187], v[152:155], v[84:87]
    v_mfma_f32_16x16x32_bf16 v[88:91], v[188:191], v[148:151], v[88:91]
    v_mfma_f32_16x16x32_bf16 v[32:35], v[116:119], v[104:107], v[32:35]
    ds_read_b32 v29, v2 offset:144
    v_mfma_f32_16x16x32_bf16 v[36:39], v[116:119], v[108:111], v[36:39]
    s_waitcnt lgkmcnt(0)
    s_setprio 2
    v_readfirstlane_b32 s76, v29
    s_setprio 0
    s_cmp_lt_u32 s76, 20
    s_cbranch_scc1 Lslow_105
Lback_106:
    ds_read_b128 v[148:151], v25 offset:16384
    ds_read_b128 v[152:155], v25 offset:18432
    ds_read_b64_tr_b16 v[160:161], v28 offset:30720
    v_mfma_f32_16x16x32_bf16 v[40:43], v[120:123], v[104:107], v[40:43]
    ds_read_b64_tr_b16 v[162:163], v28 offset:34560
    ds_read_b64_tr_b16 v[164:165], v28 offset:30752
    ds_read_b64_tr_b16 v[166:167], v28 offset:34592
    v_mfma_f32_16x16x32_bf16 v[44:47], v[120:123], v[108:111], v[44:47]
    s_mov_b32 m0, 117760
    s_add_u32 s10, s8, 860160
    buffer_load_dwordx4 v20, s[44:47], s10 offen lds
    v_mfma_f32_16x16x32_bf16 v[48:51], v[124:127], v[104:107], v[48:51]
    ds_read_b64_tr_b16 v[168:169], v28 offset:30784
    ds_read_b64_tr_b16 v[170:171], v28 offset:34624
    ds_read_b64_tr_b16 v[172:173], v28 offset:30816
    v_mfma_f32_16x16x32_bf16 v[52:55], v[124:127], v[108:111], v[52:55]
    ds_read_b64_tr_b16 v[174:175], v28 offset:34656
    ds_read_b64_tr_b16 v[176:177], v28 offset:30848
    ds_read_b64_tr_b16 v[178:179], v28 offset:34688
    v_mfma_f32_16x16x32_bf16 v[56:59], v[128:131], v[104:107], v[56:59]
    s_mov_b32 m0, 121856
    s_nop 0
    buffer_load_dwordx4 v21, s[44:47], s10 offen lds
    v_mfma_f32_16x16x32_bf16 v[60:63], v[128:131], v[108:111], v[60:63]
    ds_read_b64_tr_b16 v[180:181], v28 offset:30880
    ds_read_b64_tr_b16 v[182:183], v28 offset:34720
    ds_read_b64_tr_b16 v[184:185], v28 offset:30912
    v_mfma_f32_16x16x32_bf16 v[64:67], v[132:135], v[104:107], v[64:67]
    ds_read_b64_tr_b16 v[186:187], v28 offset:34752
    ds_read_b64_tr_b16 v[188:189], v28 offset:30944
    ds_read_b64_tr_b16 v[190:191], v28 offset:34784
    v_mfma_f32_16x16x32_bf16 v[68:71], v[132:135], v[108:111], v[68:71]
    s_mov_b32 m0, 125952
    s_nop 0
    buffer_load_dwordx4 v22, s[44:47], s10 offen lds
    v_mfma_f32_16x16x32_bf16 v[72:75], v[136:139], v[104:107], v[72:75]
    s_mov_b32 m0, 130048
    s_nop 0
    buffer_load_dwordx4 v23, s[44:47], s10 offen lds
    v_mfma_f32_16x16x32_bf16 v[76:79], v[136:139], v[108:111], v[76:79]
    s_waitcnt vmcnt(5) lgkmcnt(0)
    ds_add_u32 v19, v3 offset:144
    v_mfma_f32_16x16x32_bf16 v[80:83], v[140:143], v[104:107], v[80:83]
    s_mov_b32 m0, 97280
    s_mov_b32 s11, 778240
    buffer_load_dwordx4 v10, s[48:51], s11 offen lds
    v_mfma_f32_16x16x32_bf16 v[84:87], v[140:143], v[108:111], v[84:87]
    v_mfma_f32_16x16x32_bf16 v[88:91], v[144:147], v[104:107], v[88:91]
    v_mfma_f32_16x16x32_bf16 v[32:35], v[160:163], v[148:151], v[32:35]
    ds_read_b32 v29, v2 offset:144
    v_mfma_f32_16x16x32_bf16 v[36:39], v[160:163], v[152:155], v[36:39]
    s_waitcnt lgkmcnt(0)
    s_setprio 2
    v_readfirstlane_b32 s76, v29
    s_setprio 0
    s_cmp_lt_u32 s76, 24
    s_cbranch_scc1 Lslow_109
Lback_110:
    ds_read_b128 v[104:107], v24 offset:24576
    ds_read_b128 v[108:111], v24 offset:26624
    ds_read_b64_tr_b16 v[116:117], v28 offset:0
    v_mfma_f32_16x16x32_bf16 v[40:43], v[164:167], v[148:151], v[40:43]
    ds_read_b64_tr_b16 v[118:119], v28 offset:3840
    ds_read_b64_tr_b16 v[120:121], v28 offset:32
    ds_read_b64_tr_b16 v[122:123], v28 offset:3872
    v_mfma_f32_16x16x32_bf16 v[44:47], v[164:167], v[152:155], v[44:47]
    s_mov_b32 m0, 133120
    s_add_u32 s10, s8, 983040
    buffer_load_dwordx4 v20, s[44:47], s10 offen lds
    v_mfma_f32_16x16x32_bf16 v[48:51], v[168:171], v[148:151], v[48:51]
    ds_read_b64_tr_b16 v[124:125], v28 offset:64
    ds_read_b64_tr_b16 v[126:127], v28 offset:3904
    ds_read_b64_tr_b16 v[128:129], v28 offset:96
    v_mfma_f32_16x16x32_bf16 v[52:55], v[168:171], v[152:155], v[52:55]
    ds_read_b64_tr_b16 v[130:131], v28 offset:3936
    ds_read_b64_tr_b16 v[132:133], v28 offset:128
    ds_read_b64_tr_b16 v[134:135], v28 offset:3968
    v_mfma_f32_16x16x32_bf16 v[56:59], v[172:175], v[148:151], v[56:59]
    s_mov_b32 m0, 137216
    s_nop 0
    buffer_load_dwordx4 v21, s[44:47], s10 offen lds
    v_mfma_f32_16x16x32_bf16 v[60:63], v[172:175], v[152:155], v[60:63]
    ds_read_b64_tr_b16 v[136:137], v28 offset:160
    ds_read_b64_tr_b16 v[138:139], v28 offset:4000
    ds_read_b64_tr_b16 v[140:141], v28 offset:192
    v_mfma_f32_16x16x32_bf16 v[64:67], v[176:179], v[148:151], v[64:67]
    ds_read_b64_tr_b16 v[142:143], v28 offset:4032
    ds_read_b64_tr_b16 v[144:145], v28 offset:224
    ds_read_b64_tr_b16 v[146:147], v28 offset:4064
    v_mfma_f32_16x16x32_bf16 v[68:71], v[176:179], v[152:155], v[68:71]
    s_mov_b32 m0, 141312
    s_nop 0
    buffer_load_dwordx4 v22, s[44:47], s10 offen lds
    v_mfma_f32_16x16x32_bf16 v[72:75], v[180:183], v[148:151], v[72:75]
    s_mov_b32 m0, 145408
    s_nop 0
    buffer_load_dwordx4 v23, s[44:47], s10 offen lds
    v_mfma_f32_16x16x32_bf16 v[76:79], v[180:183], v[152:155], v[76:79]
    s_waitcnt vmcnt(5) lgkmcnt(0)
    ds_add_u32 v19, v3 offset:144
    v_mfma_f32_16x16x32_bf16 v[80:83], v[184:187], v[148:151], v[80:83]
    s_add_u32 m0, s64, 0
    s_lshl3_add_u32 s11, s64, 0
    buffer_load_dwordx4 v10, s[48:51], s11 offen lds
    v_mfma_f32_16x16x32_bf16 v[84:87], v[184:187], v[152:155], v[84:87]
    v_mfma_f32_16x16x32_bf16 v[88:91], v[188:191], v[148:151], v[88:91]
    v_mfma_f32_16x16x32_bf16 v[32:35], v[116:119], v[104:107], v[32:35]
    ds_read_b32 v29, v2 offset:144
    v_mfma_f32_16x16x32_bf16 v[36:39], v[116:119], v[108:111], v[36:39]
    s_waitcnt lgkmcnt(0)
    s_setprio 2
    v_readfirstlane_b32 s76, v29
    s_setprio 0
    s_cmp_lt_u32 s76, 28
    s_cbranch_scc1 Lslow_113
Lback_114:
    ds_read_b128 v[148:151], v25 offset:24576
    ds_read_b128 v[152:155], v25 offset:26624
    ds_read_b64_tr_b16 v[160:161], v28 offset:15360
    v_mfma_f32_16x16x32_bf16 v[40:43], v[120:123], v[104:107], v[40:43]
    ds_read_b64_tr_b16 v[162:163], v28 offset:19200
    ds_read_b64_tr_b16 v[164:165], v28 offset:15392
    ds_read_b64_tr_b16 v[166:167], v28 offset:19232
    v_mfma_f32_16x16x32_bf16 v[44:47], v[120:123], v[108:111], v[44:47]
    s_mov_b32 m0, 102400
    s_add_u32 s10, s8, 1105920
    buffer_load_dwordx4 v20, s[44:47], s10 offen lds
    v_mfma_f32_16x16x32_bf16 v[48:51], v[124:127], v[104:107], v[48:51]
    ds_read_b64_tr_b16 v[168:169], v28 offset:15424
    ds_read_b64_tr_b16 v[170:171], v28 offset:19264
    ds_read_b64_tr_b16 v[172:173], v28 offset:15456
    v_mfma_f32_16x16x32_bf16 v[52:55], v[124:127], v[108:111], v[52:55]
    ds_read_b64_tr_b16 v[174:175], v28 offset:19296
    ds_read_b64_tr_b16 v[176:177], v28 offset:15488
    ds_read_b64_tr_b16 v[178:179], v28 offset:19328
    v_mfma_f32_16x16x32_bf16 v[56:59], v[128:131], v[104:107], v[56:59]
    s_mov_b32 m0, 106496
    s_nop 0
    buffer_load_dwordx4 v21, s[44:47], s10 offen lds
    v_mfma_f32_16x16x32_bf16 v[60:63], v[128:131], v[108:111], v[60:63]
    ds_read_b64_tr_b16 v[180:181], v28 offset:15520
    ds_read_b64_tr_b16 v[182:183], v28 offset:19360
    ds_read_b64_tr_b16 v[184:185], v28 offset:15552
    v_mfma_f32_16x16x32_bf16 v[64:67], v[132:135], v[104:107], v[64:67]
    ds_read_b64_tr_b16 v[186:187], v28 offset:19392
    ds_read_b64_tr_b16 v[188:189], v28 offset:15584
    ds_read_b64_tr_b16 v[190:191], v28 offset:19424
    v_mfma_f32_16x16x32_bf16 v[68:71], v[132:135], v[108:111], v[68:71]
    s_mov_b32 m0, 110592
    s_nop 0
    buffer_load_dwordx4 v22, s[44:47], s10 offen lds
    v_mfma_f32_16x16x32_bf16 v[72:75], v[136:139], v[104:107], v[72:75]
    s_mov_b32 m0, 114688
    s_nop 0
    buffer_load_dwordx4 v23, s[44:47], s10 offen lds
    v_mfma_f32_16x16x32_bf16 v[76:79], v[136:139], v[108:111], v[76:79]
    s_waitcnt vmcnt(5) lgkmcnt(0)
    ds_add_u32 v19, v3 offset:144
    v_mfma_f32_16x16x32_bf16 v[80:83], v[140:143], v[104:107], v[80:83]
    s_add_u32 m0, s64, 5120
    s_lshl3_add_u32 s11, s64, 40960
    buffer_load_dwordx4 v10, s[48:51], s11 offen lds
    v_mfma_f32_16x16x32_bf16 v[84:87], v[140:143], v[108:111], v[84:87]
    v_mfma_f32_16x16x32_bf16 v[88:91], v[144:147], v[104:107], v[88:91]
    v_mfma_f32_16x16x32_bf16 v[32:35], v[160:163], v[148:151], v[32:35]
    ds_read_b32 v29, v2 offset:144
    v_mfma_f32_16x16x32_bf16 v[36:39], v[160:163], v[152:155], v[36:39]
    s_waitcnt lgkmcnt(0)
    s_setprio 2
    v_readfirstlane_b32 s76, v29
    s_setprio 0
    s_cmp_lt_u32 s76, 32
    s_cbranch_scc1 Lslow_117
Lback_118:
    ds_read_b128 v[104:107], v24 offset:32768
    ds_read_b128 v[108:111], v24 offset:34816
    ds_read_b64_tr_b16 v[116:117], v28 offset:30720
    v_mfma_f32_16x16x32_bf16 v[40:43], v[164:167], v[148:151], v[40:43]
    ds_read_b64_tr_b16 v[118:119], v28 offset:34560
    ds_read_b64_tr_b16 v[120:121], v28 offset:30752
    ds_read_b64_tr_b16 v[122:123], v28 offset:34592
    v_mfma_f32_16x16x32_bf16 v[44:47], v[164:167], v[152:155], v[44:47]
    s_mov_b32 m0, 117760
    s_add_u32 s10, s9, 0
    buffer_load_dwordx4 v20, s[44:47], s10 offen lds
    v_mfma_f32_16x16x32_bf16 v[48:51], v[168:171], v[148:151], v[48:51]
    ds_read_b64_tr_b16 v[124:125], v28 offset:30784
    ds_read_b64_tr_b16 v[126:127], v28 offset:34624
    ds_read_b64_tr_b16 v[128:129], v28 offset:30816
    v_mfma_f32_16x16x32_bf16 v[52:55], v[168:171], v[152:155], v[52:55]
    ds_read_b64_tr_b16 v[130:131], v28 offset:34656
    ds_read_b64_tr_b16 v[132:133], v28 offset:30848
    ds_read_b64_tr_b16 v[134:135], v28 offset:34688
    v_mfma_f32_16x16x32_bf16 v[56:59], v[172:175], v[148:151], v[56:59]
    s_mov_b32 m0, 121856
    s_nop 0
    buffer_load_dwordx4 v21, s[44:47], s10 offen lds
    v_mfma_f32_16x16x32_bf16 v[60:63], v[172:175], v[152:155], v[60:63]
    ds_read_b64_tr_b16 v[136:137], v28 offset:30880
    ds_read_b64_tr_b16 v[138:139], v28 offset:34720
    ds_read_b64_tr_b16 v[140:141], v28 offset:30912
    v_mfma_f32_16x16x32_bf16 v[64:67], v[176:179], v[148:151], v[64:67]
    ds_read_b64_tr_b16 v[142:143], v28 offset:34752
    ds_read_b64_tr_b16 v[144:145], v28 offset:30944
    ds_read_b64_tr_b16 v[146:147], v28 offset:34784
    v_mfma_f32_16x16x32_bf16 v[68:71], v[176:179], v[152:155], v[68:71]
    s_mov_b32 m0, 125952
    s_nop 0
    buffer_load_dwordx4 v22, s[44:47], s10 offen lds
    v_mfma_f32_16x16x32_bf16 v[72:75], v[180:183], v[148:151], v[72:75]
    s_mov_b32 m0, 130048
    s_nop 0
    buffer_load_dwordx4 v23, s[44:47], s10 offen lds
    v_mfma_f32_16x16x32_bf16 v[76:79], v[180:183], v[152:155], v[76:79]
    s_waitcnt vmcnt(5) lgkmcnt(0)
    ds_add_u32 v19, v3 offset:144
    v_mfma_f32_16x16x32_bf16 v[80:83], v[184:187], v[148:151], v[80:83]
    s_add_u32 m0, s64, 10240
    s_lshl3_add_u32 s11, s64, 81920
    buffer_load_dwordx4 v10, s[48:51], s11 offen lds
    v_mfma_f32_16x16x32_bf16 v[84:87], v[184:187], v[152:155], v[84:87]
    v_mfma_f32_16x16x32_bf16 v[88:91], v[188:191], v[148:151], v[88:91]
    v_mfma_f32_16x16x32_bf16 v[32:35], v[116:119], v[104:107], v[32:35]
    ds_read_b32 v29, v2 offset:144
    v_mfma_f32_16x16x32_bf16 v[36:39], v[116:119], v[108:111], v[36:39]
    s_waitcnt lgkmcnt(0)
    s_setprio 2
    v_readfirstlane_b32 s76, v29
    s_setprio 0
    s_cmp_lt_u32 s76, 36
    s_cbranch_scc1 Lslow_121
Lback_122:
    ds_read_b128 v[148:151], v25 offset:32768
    ds_read_b128 v[152:155], v25 offset:34816
    ds_read_b64_tr_b16 v[160:161], v28 offset:0
    v_mfma_f32_16x16x32_bf16 v[40:43], v[120:123], v[104:107], v[40:43]
    ds_read_b64_tr_b16 v[162:163], v28 offset:3840
    ds_read_b64_tr_b16 v[164:165], v28 offset:32
    ds_read_b64_tr_b16 v[166:167], v28 offset:3872
    v_mfma_f32_16x16x32_bf16 v[44:47], v[120:123], v[108:111], v[44:47]
    s_mov_b32 m0, 133120
    s_add_u32 s10, s9, 122880
    buffer_load_dwordx4 v20, s[44:47], s10 offen lds
    v_mfma_f32_16x16x32_bf16 v[48:51], v[124:127], v[104:107], v[48:51]
    ds_read_b64_tr_b16 v[168:169], v28 offset:64
    ds_read_b64_tr_b16 v[170:171], v28 offset:3904
    ds_read_b64_tr_b16 v[172:173], v28 offset:96
    v_mfma_f32_16x16x32_bf16 v[52:55], v[124:127], v[108:111], v[52:55]
    ds_read_b64_tr_b16 v[174:175], v28 offset:3936
    ds_read_b64_tr_b16 v[176:177], v28 offset:128
    ds_read_b64_tr_b16 v[178:179], v28 offset:3968
    v_mfma_f32_16x16x32_bf16 v[56:59], v[128:131], v[104:107], v[56:59]
    s_mov_b32 m0, 137216
    s_nop 0
    buffer_load_dwordx4 v21, s[44:47], s10 offen lds
    v_mfma_f32_16x16x32_bf16 v[60:63], v[128:131], v[108:111], v[60:63]
    ds_read_b64_tr_b16 v[180:181], v28 offset:160
    ds_read_b64_tr_b16 v[182:183], v28 offset:4000
    ds_read_b64_tr_b16 v[184:185], v28 offset:192
    v_mfma_f32_16x16x32_bf16 v[64:67], v[132:135], v[104:107], v[64:67]
    ds_read_b64_tr_b16 v[186:187], v28 offset:4032
    ds_read_b64_tr_b16 v[188:189], v28 offset:224
    ds_read_b64_tr_b16 v[190:191], v28 offset:4064
    v_mfma_f32_16x16x32_bf16 v[68:71], v[132:135], v[108:111], v[68:71]
    s_mov_b32 m0, 141312
    s_nop 0
    buffer_load_dwordx4 v22, s[44:47], s10 offen lds
    v_mfma_f32_16x16x32_bf16 v[72:75], v[136:139], v[104:107], v[72:75]
    s_mov_b32 m0, 145408
    s_nop 0
    buffer_load_dwordx4 v23, s[44:47], s10 offen lds
    v_mfma_f32_16x16x32_bf16 v[76:79], v[136:139], v[108:111], v[76:79]
    s_waitcnt vmcnt(5) lgkmcnt(0)
    ds_add_u32 v19, v3 offset:144
    v_mfma_f32_16x16x32_bf16 v[80:83], v[140:143], v[104:107], v[80:83]
    s_add_u32 m0, s64, 15360
    s_lshl3_add_u32 s11, s64, 122880
    buffer_load_dwordx4 v10, s[48:51], s11 offen lds
    v_mfma_f32_16x16x32_bf16 v[84:87], v[140:143], v[108:111], v[84:87]
    v_mfma_f32_16x16x32_bf16 v[88:91], v[144:147], v[104:107], v[88:91]
    v_mfma_f32_16x16x32_bf16 v[32:35], v[160:163], v[148:151], v[32:35]
    ds_read_b32 v29, v2 offset:144
    v_mfma_f32_16x16x32_bf16 v[36:39], v[160:163], v[152:155], v[36:39]
    s_waitcnt lgkmcnt(0)
    s_setprio 2
    v_readfirstlane_b32 s76, v29
    s_setprio 0
    s_cmp_lt_u32 s76, 40
    s_cbranch_scc1 Lslow_125
Lback_126:
    ds_read_b128 v[104:107], v26 offset:0
    ds_read_b128 v[108:111], v26 offset:2048
    ds_read_b64_tr_b16 v[116:117], v28 offset:15360
    v_mfma_f32_16x16x32_bf16 v[40:43], v[164:167], v[148:151], v[40:43]
    ds_read_b64_tr_b16 v[118:119], v28 offset:19200
    ds_read_b64_tr_b16 v[120:121], v28 offset:15392
    ds_read_b64_tr_b16 v[122:123], v28 offset:19232
    v_mfma_f32_16x16x32_bf16 v[44:47], v[164:167], v[152:155], v[44:47]
    s_mov_b32 m0, 102400
    s_add_u32 s10, s9, 245760
    buffer_load_dwordx4 v20, s[44:47], s10 offen lds
    v_mfma_f32_16x16x32_bf16 v[48:51], v[168:171], v[148:151], v[48:51]
    ds_read_b64_tr_b16 v[124:125], v28 offset:15424
    ds_read_b64_tr_b16 v[126:127], v28 offset:19264
    ds_read_b64_tr_b16 v[128:129], v28 offset:15456
    v_mfma_f32_16x16x32_bf16 v[52:55], v[168:171], v[152:155], v[52:55]
    ds_read_b64_tr_b16 v[130:131], v28 offset:19296
    ds_read_b64_tr_b16 v[132:133], v28 offset:15488
    ds_read_b64_tr_b16 v[134:135], v28 offset:19328
    v_mfma_f32_16x16x32_bf16 v[56:59], v[172:175], v[148:151], v[56:59]
    s_mov_b32 m0, 106496
    s_nop 0
    buffer_load_dwordx4 v21, s[44:47], s10 offen lds
    v_mfma_f32_16x16x32_bf16 v[60:63], v[172:175], v[152:155], v[60:63]
    ds_read_b64_tr_b16 v[136:137], v28 offset:15520
    ds_read_b64_tr_b16 v[138:139], v28 offset:19360
    ds_read_b64_tr_b16 v[140:141], v28 offset:15552
    v_mfma_f32_16x16x32_bf16 v[64:67], v[176:179], v[148:151], v[64:67]
    ds_read_b64_tr_b16 v[142:143], v28 offset:19392
    ds_read_b64_tr_b16 v[144:145], v28 offset:15584
    ds_read_b64_tr_b16 v[146:147], v28 offset:19424
    v_mfma_f32_16x16x32_bf16 v[68:71], v[176:179], v[152:155], v[68:71]
    s_mov_b32 m0, 110592
    s_nop 0
    buffer_load_dwordx4 v22, s[44:47], s10 offen lds
    v_mfma_f32_16x16x32_bf16 v[72:75], v[180:183], v[148:151], v[72:75]
    s_mov_b32 m0, 114688
    s_nop 0
    buffer_load_dwordx4 v23, s[44:47], s10 offen lds
    v_mfma_f32_16x16x32_bf16 v[76:79], v[180:183], v[152:155], v[76:79]
    s_waitcnt vmcnt(5) lgkmcnt(0)
    ds_add_u32 v19, v3 offset:144
    v_mfma_f32_16x16x32_bf16 v[80:83], v[184:187], v[148:151], v[80:83]
    s_add_u32 m0, s64, 20480
    s_lshl3_add_u32 s11, s64, 163840
    buffer_load_dwordx4 v10, s[48:51], s11 offen lds
    v_mfma_f32_16x16x32_bf16 v[84:87], v[184:187], v[152:155], v[84:87]
    v_mfma_f32_16x16x32_bf16 v[88:91], v[188:191], v[148:151], v[88:91]
    v_mfma_f32_16x16x32_bf16 v[32:35], v[116:119], v[104:107], v[32:35]
    ds_read_b32 v29, v2 offset:144
    v_mfma_f32_16x16x32_bf16 v[36:39], v[116:119], v[108:111], v[36:39]
    s_waitcnt lgkmcnt(0)
    s_setprio 2
    v_readfirstlane_b32 s76, v29
    s_setprio 0
    s_cmp_lt_u32 s76, 44
    s_cbranch_scc1 Lslow_129
Lback_130:
    ds_read_b128 v[148:151], v27 offset:0
    ds_read_b128 v[152:155], v27 offset:2048
    ds_read_b64_tr_b16 v[160:161], v28 offset:30720
    v_mfma_f32_16x16x32_bf16 v[40:43], v[120:123], v[104:107], v[40:43]
    ds_read_b64_tr_b16 v[162:163], v28 offset:34560
    ds_read_b64_tr_b16 v[164:165], v28 offset:30752
    ds_read_b64_tr_b16 v[166:167], v28 offset:34592
    v_mfma_f32_16x16x32_bf16 v[44:47], v[120:123], v[108:111], v[44:47]
    s_mov_b32 m0, 117760
    s_add_u32 s10, s9, 368640
    buffer_load_dwordx4 v20, s[44:47], s10 offen lds
    v_mfma_f32_16x16x32_bf16 v[48:51], v[124:127], v[104:107], v[48:51]
    ds_read_b64_tr_b16 v[168:169], v28 offset:30784
    ds_read_b64_tr_b16 v[170:171], v28 offset:34624
    ds_read_b64_tr_b16 v[172:173], v28 offset:30816
    v_mfma_f32_16x16x32_bf16 v[52:55], v[124:127], v[108:111], v[52:55]
    ds_read_b64_tr_b16 v[174:175], v28 offset:34656
    ds_read_b64_tr_b16 v[176:177], v28 offset:30848
    ds_read_b64_tr_b16 v[178:179], v28 offset:34688
    v_mfma_f32_16x16x32_bf16 v[56:59], v[128:131], v[104:107], v[56:59]
    s_mov_b32 m0, 121856
    s_nop 0
    buffer_load_dwordx4 v21, s[44:47], s10 offen lds
    v_mfma_f32_16x16x32_bf16 v[60:63], v[128:131], v[108:111], v[60:63]
    ds_read_b64_tr_b16 v[180:181], v28 offset:30880
    ds_read_b64_tr_b16 v[182:183], v28 offset:34720
    ds_read_b64_tr_b16 v[184:185], v28 offset:30912
    v_mfma_f32_16x16x32_bf16 v[64:67], v[132:135], v[104:107], v[64:67]
    ds_read_b64_tr_b16 v[186:187], v28 offset:34752
    ds_read_b64_tr_b16 v[188:189], v28 offset:30944
    ds_read_b64_tr_b16 v[190:191], v28 offset:34784
    v_mfma_f32_16x16x32_bf16 v[68:71], v[132:135], v[108:111], v[68:71]
    s_mov_b32 m0, 125952
    s_nop 0
    buffer_load_dwordx4 v22, s[44:47], s10 offen lds
    v_mfma_f32_16x16x32_bf16 v[72:75], v[136:139], v[104:107], v[72:75]
    s_mov_b32 m0, 130048
    s_nop 0
    buffer_load_dwordx4 v23, s[44:47], s10 offen lds
    v_mfma_f32_16x16x32_bf16 v[76:79], v[136:139], v[108:111], v[76:79]
    s_waitcnt vmcnt(5) lgkmcnt(0)
    ds_add_u32 v19, v3 offset:144
    v_mfma_f32_16x16x32_bf16 v[80:83], v[140:143], v[104:107], v[80:83]
    s_add_u32 m0, s64, 25600
    s_lshl3_add_u32 s11, s64, 204800
    buffer_load_dwordx4 v10, s[48:51], s11 offen lds
    v_mfma_f32_16x16x32_bf16 v[84:87], v[140:143], v[108:111], v[84:87]
    v_mfma_f32_16x16x32_bf16 v[88:91], v[144:147], v[104:107], v[88:91]
    v_mfma_f32_16x16x32_bf16 v[32:35], v[160:163], v[148:151], v[32:35]
    ds_read_b32 v29, v2 offset:144
    v_mfma_f32_16x16x32_bf16 v[36:39], v[160:163], v[152:155], v[36:39]
    s_waitcnt lgkmcnt(0)
    s_setprio 2
    v_readfirstlane_b32 s76, v29
    s_setprio 0
    s_cmp_lt_u32 s76, 48
    s_cbranch_scc1 Lslow_133
Lback_134:
    ds_read_b128 v[104:107], v26 offset:8192
    ds_read_b128 v[108:111], v26 offset:10240
    ds_read_b64_tr_b16 v[116:117], v28 offset:0
    v_mfma_f32_16x16x32_bf16 v[40:43], v[164:167], v[148:151], v[40:43]
    ds_read_b64_tr_b16 v[118:119], v28 offset:3840
    ds_read_b64_tr_b16 v[120:121], v28 offset:32
    ds_read_b64_tr_b16 v[122:123], v28 offset:3872
    v_mfma_f32_16x16x32_bf16 v[44:47], v[164:167], v[152:155], v[44:47]
    s_mov_b32 m0, 133120
    s_add_u32 s10, s9, 491520
    buffer_load_dwordx4 v20, s[44:47], s10 offen lds
    v_mfma_f32_16x16x32_bf16 v[48:51], v[168:171], v[148:151], v[48:51]
    ds_read_b64_tr_b16 v[124:125], v28 offset:64
    ds_read_b64_tr_b16 v[126:127], v28 offset:3904
    ds_read_b64_tr_b16 v[128:129], v28 offset:96
    v_mfma_f32_16x16x32_bf16 v[52:55], v[168:171], v[152:155], v[52:55]
    ds_read_b64_tr_b16 v[130:131], v28 offset:3936
    ds_read_b64_tr_b16 v[132:133], v28 offset:128
    ds_read_b64_tr_b16 v[134:135], v28 offset:3968
    v_mfma_f32_16x16x32_bf16 v[56:59], v[172:175], v[148:151], v[56:59]
    s_mov_b32 m0, 137216
    s_nop 0
    buffer_load_dwordx4 v21, s[44:47], s10 offen lds
    v_mfma_f32_16x16x32_bf16 v[60:63], v[172:175], v[152:155], v[60:63]
    ds_read_b64_tr_b16 v[136:137], v28 offset:160
    ds_read_b64_tr_b16 v[138:139], v28 offset:4000
    ds_read_b64_tr_b16 v[140:141], v28 offset:192
    v_mfma_f32_16x16x32_bf16 v[64:67], v[176:179], v[148:151], v[64:67]
    ds_read_b64_tr_b16 v[142:143], v28 offset:4032
    ds_read_b64_tr_b16 v[144:145], v28 offset:224
    ds_read_b64_tr_b16 v[146:147], v28 offset:4064
    v_mfma_f32_16x16x32_bf16 v[68:71], v[176:179], v[152:155], v[68:71]
    s_mov_b32 m0, 141312
    s_nop 0
    buffer_load_dwordx4 v22, s[44:47], s10 offen lds
    v_mfma_f32_16x16x32_bf16 v[72:75], v[180:183], v[148:151], v[72:75]
    s_mov_b32 m0, 145408
    s_nop 0
    buffer_load_dwordx4 v23, s[44:47], s10 offen lds
    v_mfma_f32_16x16x32_bf16 v[76:79], v[180:183], v[152:155], v[76:79]
    s_waitcnt vmcnt(5) lgkmcnt(0)
    ds_add_u32 v19, v3 offset:144
    v_mfma_f32_16x16x32_bf16 v[80:83], v[184:187], v[148:151], v[80:83]
    s_add_u32 m0, s64, 30720
    s_lshl3_add_u32 s11, s64, 245760
    buffer_load_dwordx4 v10, s[48:51], s11 offen lds
    v_mfma_f32_16x16x32_bf16 v[84:87], v[184:187], v[152:155], v[84:87]
    v_mfma_f32_16x16x32_bf16 v[88:91], v[188:191], v[148:151], v[88:91]
    v_mfma_f32_16x16x32_bf16 v[32:35], v[116:119], v[104:107], v[32:35]
    ds_read_b32 v29, v2 offset:144
    v_mfma_f32_16x16x32_bf16 v[36:39], v[116:119], v[108:111], v[36:39]
    s_waitcnt lgkmcnt(0)
    s_setprio 2
    v_readfirstlane_b32 s76, v29
    s_setprio 0
    s_cmp_lt_u32 s76, 52
    s_cbranch_scc1 Lslow_137
Lback_138:
    ds_read_b128 v[148:151], v27 offset:8192
    ds_read_b128 v[152:155], v27 offset:10240
    ds_read_b64_tr_b16 v[160:161], v28 offset:15360
    v_mfma_f32_16x16x32_bf16 v[40:43], v[120:123], v[104:107], v[40:43]
    ds_read_b64_tr_b16 v[162:163], v28 offset:19200
    ds_read_b64_tr_b16 v[164:165], v28 offset:15392
    ds_read_b64_tr_b16 v[166:167], v28 offset:19232
    v_mfma_f32_16x16x32_bf16 v[44:47], v[120:123], v[108:111], v[44:47]
    s_mov_b32 m0, 102400
    s_add_u32 s10, s9, 614400
    buffer_load_dwordx4 v20, s[44:47], s10 offen lds
    v_mfma_f32_16x16x32_bf16 v[48:51], v[124:127], v[104:107], v[48:51]
    ds_read_b64_tr_b16 v[168:169], v28 offset:15424
    ds_read_b64_tr_b16 v[170:171], v28 offset:19264
    ds_read_b64_tr_b16 v[172:173], v28 offset:15456
    v_mfma_f32_16x16x32_bf16 v[52:55], v[124:127], v[108:111], v[52:55]
    ds_read_b64_tr_b16 v[174:175], v28 offset:19296
    ds_read_b64_tr_b16 v[176:177], v28 offset:15488
    ds_read_b64_tr_b16 v[178:179], v28 offset:19328
    v_mfma_f32_16x16x32_bf16 v[56:59], v[128:131], v[104:107], v[56:59]
    s_mov_b32 m0, 106496
    s_nop 0
    buffer_load_dwordx4 v21, s[44:47], s10 offen lds
    v_mfma_f32_16x16x32_bf16 v[60:63], v[128:131], v[108:111], v[60:63]
    ds_read_b64_tr_b16 v[180:181], v28 offset:15520
    ds_read_b64_tr_b16 v[182:183], v28 offset:19360
    ds_read_b64_tr_b16 v[184:185], v28 offset:15552
    v_mfma_f32_16x16x32_bf16 v[64:67], v[132:135], v[104:107], v[64:67]
    ds_read_b64_tr_b16 v[186:187], v28 offset:19392
    ds_read_b64_tr_b16 v[188:189], v28 offset:15584
    ds_read_b64_tr_b16 v[190:191], v28 offset:19424
    v_mfma_f32_16x16x32_bf16 v[68:71], v[132:135], v[108:111], v[68:71]
    s_mov_b32 m0, 110592
    s_nop 0
    buffer_load_dwordx4 v22, s[44:47], s10 offen lds
    v_mfma_f32_16x16x32_bf16 v[72:75], v[136:139], v[104:107], v[72:75]
    s_mov_b32 m0, 114688
    s_nop 0
    buffer_load_dwordx4 v23, s[44:47], s10 offen lds
    v_mfma_f32_16x16x32_bf16 v[76:79], v[136:139], v[108:111], v[76:79]
    s_waitcnt vmcnt(5) lgkmcnt(0)
    ds_add_u32 v19, v3 offset:144
    v_mfma_f32_16x16x32_bf16 v[80:83], v[140:143], v[104:107], v[80:83]
    s_add_u32 m0, s64, 35840
    s_lshl3_add_u32 s11, s64, 286720
    buffer_load_dwordx4 v10, s[48:51], s11 offen lds
    v_mfma_f32_16x16x32_bf16 v[84:87], v[140:143], v[108:111], v[84:87]
    v_mfma_f32_16x16x32_bf16 v[88:91], v[144:147], v[104:107], v[88:91]
    v_mfma_f32_16x16x32_bf16 v[32:35], v[160:163], v[148:151], v[32:35]
    ds_read_b32 v29, v2 offset:144
    v_mfma_f32_16x16x32_bf16 v[36:39], v[160:163], v[152:155], v[36:39]
    s_waitcnt lgkmcnt(0)
    s_setprio 2
    v_readfirstlane_b32 s76, v29
    s_setprio 0
    s_cmp_lt_u32 s76, 56
    s_cbranch_scc1 Lslow_141
Lback_142:
    ds_read_b128 v[104:107], v26 offset:16384
    ds_read_b128 v[108:111], v26 offset:18432
    ds_read_b64_tr_b16 v[116:117], v28 offset:30720
    v_mfma_f32_16x16x32_bf16 v[40:43], v[164:167], v[148:151], v[40:43]
    ds_read_b64_tr_b16 v[118:119], v28 offset:34560
    ds_read_b64_tr_b16 v[120:121], v28 offset:30752
    ds_read_b64_tr_b16 v[122:123], v28 offset:34592
    v_mfma_f32_16x16x32_bf16 v[44:47], v[164:167], v[152:155], v[44:47]
    s_mov_b32 m0, 117760
    s_add_u32 s10, s9, 737280
    buffer_load_dwordx4 v20, s[44:47], s10 offen lds
    v_mfma_f32_16x16x32_bf16 v[48:51], v[168:171], v[148:151], v[48:51]
    ds_read_b64_tr_b16 v[124:125], v28 offset:30784
    ds_read_b64_tr_b16 v[126:127], v28 offset:34624
    ds_read_b64_tr_b16 v[128:129], v28 offset:30816
    v_mfma_f32_16x16x32_bf16 v[52:55], v[168:171], v[152:155], v[52:55]
    ds_read_b64_tr_b16 v[130:131], v28 offset:34656
    ds_read_b64_tr_b16 v[132:133], v28 offset:30848
    ds_read_b64_tr_b16 v[134:135], v28 offset:34688
    v_mfma_f32_16x16x32_bf16 v[56:59], v[172:175], v[148:151], v[56:59]
    s_mov_b32 m0, 121856
    s_nop 0
    buffer_load_dwordx4 v21, s[44:47], s10 offen lds
    v_mfma_f32_16x16x32_bf16 v[60:63], v[172:175], v[152:155], v[60:63]
    ds_read_b64_tr_b16 v[136:137], v28 offset:30880
    ds_read_b64_tr_b16 v[138:139], v28 offset:34720
    ds_read_b64_tr_b16 v[140:141], v28 offset:30912
    v_mfma_f32_16x16x32_bf16 v[64:67], v[176:179], v[148:151], v[64:67]
    ds_read_b64_tr_b16 v[142:143], v28 offset:34752
    ds_read_b64_tr_b16 v[144:145], v28 offset:30944
    ds_read_b64_tr_b16 v[146:147], v28 offset:34784
    v_mfma_f32_16x16x32_bf16 v[68:71], v[176:179], v[152:155], v[68:71]
    s_mov_b32 m0, 125952
    s_nop 0
    buffer_load_dwordx4 v22, s[44:47], s10 offen lds
    v_mfma_f32_16x16x32_bf16 v[72:75], v[180:183], v[148:151], v[72:75]
    s_mov_b32 m0, 130048
    s_nop 0
    buffer_load_dwordx4 v23, s[44:47], s10 offen lds
    v_mfma_f32_16x16x32_bf16 v[76:79], v[180:183], v[152:155], v[76:79]
    s_waitcnt vmcnt(5) lgkmcnt(0)
    ds_add_u32 v19, v3 offset:144
    v_mfma_f32_16x16x32_bf16 v[80:83], v[184:187], v[148:151], v[80:83]
    s_add_u32 m0, s65, 0
    s_lshl3_add_u32 s11, s65, 0
    buffer_load_dwordx4 v10, s[48:51], s11 offen lds
    v_mfma_f32_16x16x32_bf16 v[84:87], v[184:187], v[152:155], v[84:87]
    v_mfma_f32_16x16x32_bf16 v[88:91], v[188:191], v[148:151], v[88:91]
    v_mfma_f32_16x16x32_bf16 v[32:35], v[116:119], v[104:107], v[32:35]
    ds_read_b32 v29, v2 offset:144
    v_mfma_f32_16x16x32_bf16 v[36:39], v[116:119], v[108:111], v[36:39]
    s_waitcnt lgkmcnt(0)
    s_setprio 2
    v_readfirstlane_b32 s76, v29
    s_setprio 0
    s_cmp_lt_u32 s76, 60
    s_cbranch_scc1 Lslow_145
Lback_146:
    ds_read_b128 v[148:151], v27 offset:16384
    ds_read_b128 v[152:155], v27 offset:18432
    ds_read_b64_tr_b16 v[160:161], v28 offset:0
    v_mfma_f32_16x16x32_bf16 v[40:43], v[120:123], v[104:107], v[40:43]
    ds_read_b64_tr_b16 v[162:163], v28 offset:3840
    ds_read_b64_tr_b16 v[164:165], v28 offset:32
    ds_read_b64_tr_b16 v[166:167], v28 offset:3872
    v_mfma_f32_16x16x32_bf16 v[44:47], v[120:123], v[108:111], v[44:47]
    s_mov_b32 m0, 133120
    s_add_u32 s10, s9, 860160
    buffer_load_dwordx4 v20, s[44:47], s10 offen lds
    v_mfma_f32_16x16x32_bf16 v[48:51], v[124:127], v[104:107], v[48:51]
    ds_read_b64_tr_b16 v[168:169], v28 offset:64
    ds_read_b64_tr_b16 v[170:171], v28 offset:3904
    ds_read_b64_tr_b16 v[172:173], v28 offset:96
    v_mfma_f32_16x16x32_bf16 v[52:55], v[124:127], v[108:111], v[52:55]
    ds_read_b64_tr_b16 v[174:175], v28 offset:3936
    ds_read_b64_tr_b16 v[176:177], v28 offset:128
    ds_read_b64_tr_b16 v[178:179], v28 offset:3968
    v_mfma_f32_16x16x32_bf16 v[56:59], v[128:131], v[104:107], v[56:59]
    s_mov_b32 m0, 137216
    s_nop 0
    buffer_load_dwordx4 v21, s[44:47], s10 offen lds
    v_mfma_f32_16x16x32_bf16 v[60:63], v[128:131], v[108:111], v[60:63]
    ds_read_b64_tr_b16 v[180:181], v28 offset:160
    ds_read_b64_tr_b16 v[182:183], v28 offset:4000
    ds_read_b64_tr_b16 v[184:185], v28 offset:192
    v_mfma_f32_16x16x32_bf16 v[64:67], v[132:135], v[104:107], v[64:67]
    ds_read_b64_tr_b16 v[186:187], v28 offset:4032
    ds_read_b64_tr_b16 v[188:189], v28 offset:224
    ds_read_b64_tr_b16 v[190:191], v28 offset:4064
    v_mfma_f32_16x16x32_bf16 v[68:71], v[132:135], v[108:111], v[68:71]
    s_mov_b32 m0, 141312
    s_nop 0
    buffer_load_dwordx4 v22, s[44:47], s10 offen lds
    v_mfma_f32_16x16x32_bf16 v[72:75], v[136:139], v[104:107], v[72:75]
    s_mov_b32 m0, 145408
    s_nop 0
    buffer_load_dwordx4 v23, s[44:47], s10 offen lds
    v_mfma_f32_16x16x32_bf16 v[76:79], v[136:139], v[108:111], v[76:79]
    s_waitcnt vmcnt(5) lgkmcnt(0)
    ds_add_u32 v19, v3 offset:144
    v_mfma_f32_16x16x32_bf16 v[80:83], v[140:143], v[104:107], v[80:83]
    s_add_u32 m0, s65, 5120
    s_lshl3_add_u32 s11, s65, 40960
    buffer_load_dwordx4 v10, s[48:51], s11 offen lds
    v_mfma_f32_16x16x32_bf16 v[84:87], v[140:143], v[108:111], v[84:87]
    v_mfma_f32_16x16x32_bf16 v[88:91], v[144:147], v[104:107], v[88:91]
    v_mfma_f32_16x16x32_bf16 v[32:35], v[160:163], v[148:151], v[32:35]
    ds_read_b32 v29, v2 offset:144
    v_mfma_f32_16x16x32_bf16 v[36:39], v[160:163], v[152:155], v[36:39]
    s_waitcnt lgkmcnt(0)
    s_setprio 2
    v_readfirstlane_b32 s76, v29
    s_setprio 0
    s_cmp_lt_u32 s76, 64
    s_cbranch_scc1 Lslow_149
Lback_150:
    ds_read_b128 v[104:107], v26 offset:24576
    ds_read_b128 v[108:111], v26 offset:26624
    ds_read_b64_tr_b16 v[116:117], v28 offset:15360
    v_mfma_f32_16x16x32_bf16 v[40:43], v[164:167], v[148:151], v[40:43]
    ds_read_b64_tr_b16 v[118:119], v28 offset:19200
    ds_read_b64_tr_b16 v[120:121], v28 offset:15392
    ds_read_b64_tr_b16 v[122:123], v28 offset:19232
    v_mfma_f32_16x16x32_bf16 v[44:47], v[164:167], v[152:155], v[44:47]
    s_mov_b32 m0, 102400
    s_add_u32 s10, s9, 983040
    buffer_load_dwordx4 v20, s[44:47], s10 offen lds
    v_mfma_f32_16x16x32_bf16 v[48:51], v[168:171], v[148:151], v[48:51]
    ds_read_b64_tr_b16 v[124:125], v28 offset:15424
    ds_read_b64_tr_b16 v[126:127], v28 offset:19264
    ds_read_b64_tr_b16 v[128:129], v28 offset:15456
    v_mfma_f32_16x16x32_bf16 v[52:55], v[168:171], v[152:155], v[52:55]
    ds_read_b64_tr_b16 v[130:131], v28 offset:19296
    ds_read_b64_tr_b16 v[132:133], v28 offset:15488
    ds_read_b64_tr_b16 v[134:135], v28 offset:19328
    v_mfma_f32_16x16x32_bf16 v[56:59], v[172:175], v[148:151], v[56:59]
    s_mov_b32 m0, 106496
    s_nop 0
    buffer_load_dwordx4 v21, s[44:47], s10 offen lds
    v_mfma_f32_16x16x32_bf16 v[60:63], v[172:175], v[152:155], v[60:63]
    ds_read_b64_tr_b16 v[136:137], v28 offset:15520
    ds_read_b64_tr_b16 v[138:139], v28 offset:19360
    ds_read_b64_tr_b16 v[140:141], v28 offset:15552
    v_mfma_f32_16x16x32_bf16 v[64:67], v[176:179], v[148:151], v[64:67]
    ds_read_b64_tr_b16 v[142:143], v28 offset:19392
    ds_read_b64_tr_b16 v[144:145], v28 offset:15584
    ds_read_b64_tr_b16 v[146:147], v28 offset:19424
    v_mfma_f32_16x16x32_bf16 v[68:71], v[176:179], v[152:155], v[68:71]
    s_mov_b32 m0, 110592
    s_nop 0
    buffer_load_dwordx4 v22, s[44:47], s10 offen lds
    v_mfma_f32_16x16x32_bf16 v[72:75], v[180:183], v[148:151], v[72:75]
    s_mov_b32 m0, 114688
    s_nop 0
    buffer_load_dwordx4 v23, s[44:47], s10 offen lds
    v_mfma_f32_16x16x32_bf16 v[76:79], v[180:183], v[152:155], v[76:79]
    s_waitcnt vmcnt(5) lgkmcnt(0)
    ds_add_u32 v19, v3 offset:144
    v_mfma_f32_16x16x32_bf16 v[80:83], v[184:187], v[148:151], v[80:83]
    s_add_u32 m0, s65, 10240
    s_lshl3_add_u32 s11, s65, 81920
    buffer_load_dwordx4 v10, s[48:51], s11 offen lds
    v_mfma_f32_16x16x32_bf16 v[84:87], v[184:187], v[152:155], v[84:87]
    v_mfma_f32_16x16x32_bf16 v[88:91], v[188:191], v[148:151], v[88:91]
    v_mfma_f32_16x16x32_bf16 v[32:35], v[116:119], v[104:107], v[32:35]
    ds_read_b32 v29, v2 offset:144
    v_mfma_f32_16x16x32_bf16 v[36:39], v[116:119], v[108:111], v[36:39]
    s_waitcnt lgkmcnt(0)
    s_setprio 2
    v_readfirstlane_b32 s76, v29
    s_setprio 0
    s_cmp_lt_u32 s76, 68
    s_cbranch_scc1 Lslow_153
Lback_154:
    ds_read_b128 v[148:151], v27 offset:24576
    ds_read_b128 v[152:155], v27 offset:26624
    ds_read_b64_tr_b16 v[160:161], v28 offset:30720
    v_mfma_f32_16x16x32_bf16 v[40:43], v[120:123], v[104:107], v[40:43]
    ds_read_b64_tr_b16 v[162:163], v28 offset:34560
    ds_read_b64_tr_b16 v[164:165], v28 offset:30752
    ds_read_b64_tr_b16 v[166:167], v28 offset:34592
    v_mfma_f32_16x16x32_bf16 v[44:47], v[120:123], v[108:111], v[44:47]
    s_mov_b32 m0, 117760
    s_add_u32 s10, s9, 1105920
    buffer_load_dwordx4 v20, s[44:47], s10 offen lds
    v_mfma_f32_16x16x32_bf16 v[48:51], v[124:127], v[104:107], v[48:51]
    ds_read_b64_tr_b16 v[168:169], v28 offset:30784
    ds_read_b64_tr_b16 v[170:171], v28 offset:34624
    ds_read_b64_tr_b16 v[172:173], v28 offset:30816
    v_mfma_f32_16x16x32_bf16 v[52:55], v[124:127], v[108:111], v[52:55]
    ds_read_b64_tr_b16 v[174:175], v28 offset:34656
    ds_read_b64_tr_b16 v[176:177], v28 offset:30848
    ds_read_b64_tr_b16 v[178:179], v28 offset:34688
    v_mfma_f32_16x16x32_bf16 v[56:59], v[128:131], v[104:107], v[56:59]
    s_mov_b32 m0, 121856
    s_nop 0
    buffer_load_dwordx4 v21, s[44:47], s10 offen lds
    v_mfma_f32_16x16x32_bf16 v[60:63], v[128:131], v[108:111], v[60:63]
    ds_read_b64_tr_b16 v[180:181], v28 offset:30880
    ds_read_b64_tr_b16 v[182:183], v28 offset:34720
    ds_read_b64_tr_b16 v[184:185], v28 offset:30912
    v_mfma_f32_16x16x32_bf16 v[64:67], v[132:135], v[104:107], v[64:67]
    ds_read_b64_tr_b16 v[186:187], v28 offset:34752
    ds_read_b64_tr_b16 v[188:189], v28 offset:30944
    ds_read_b64_tr_b16 v[190:191], v28 offset:34784
    v_mfma_f32_16x16x32_bf16 v[68:71], v[132:135], v[108:111], v[68:71]
    s_mov_b32 m0, 125952
    s_nop 0
    buffer_load_dwordx4 v22, s[44:47], s10 offen lds
    v_mfma_f32_16x16x32_bf16 v[72:75], v[136:139], v[104:107], v[72:75]
    s_mov_b32 m0, 130048
    s_nop 0
    buffer_load_dwordx4 v23, s[44:47], s10 offen lds
    v_mfma_f32_16x16x32_bf16 v[76:79], v[136:139], v[108:111], v[76:79]
    s_waitcnt vmcnt(5) lgkmcnt(0)
    ds_add_u32 v19, v3 offset:144
    v_mfma_f32_16x16x32_bf16 v[80:83], v[140:143], v[104:107], v[80:83]
    s_add_u32 m0, s65, 15360
    s_lshl3_add_u32 s11, s65, 122880
    buffer_load_dwordx4 v10, s[48:51], s11 offen lds
    v_mfma_f32_16x16x32_bf16 v[84:87], v[140:143], v[108:111], v[84:87]
    v_mfma_f32_16x16x32_bf16 v[88:91], v[144:147], v[104:107], v[88:91]
    v_mfma_f32_16x16x32_bf16 v[32:35], v[160:163], v[148:151], v[32:35]
    ds_read_b32 v29, v2 offset:144
    v_mfma_f32_16x16x32_bf16 v[36:39], v[160:163], v[152:155], v[36:39]
    s_waitcnt lgkmcnt(0)
    s_setprio 2
    v_readfirstlane_b32 s76, v29
    s_setprio 0
    s_cmp_lt_u32 s76, 72
    s_cbranch_scc1 Lslow_157
Lback_158:
    ds_read_b128 v[104:107], v26 offset:32768
    ds_read_b128 v[108:111], v26 offset:34816
    ds_read_b64_tr_b16 v[116:117], v28 offset:0
    v_mfma_f32_16x16x32_bf16 v[40:43], v[164:167], v[148:151], v[40:43]
    ds_read_b64_tr_b16 v[118:119], v28 offset:3840
    ds_read_b64_tr_b16 v[120:121], v28 offset:32
    ds_read_b64_tr_b16 v[122:123], v28 offset:3872
    v_mfma_f32_16x16x32_bf16 v[44:47], v[164:167], v[152:155], v[44:47]
    ds_read_b64_tr_b16 v[124:125], v28 offset:64
    ds_read_b64_tr_b16 v[126:127], v28 offset:3904
    ds_read_b64_tr_b16 v[128:129], v28 offset:96
    v_mfma_f32_16x16x32_bf16 v[48:51], v[168:171], v[148:151], v[48:51]
    ds_read_b64_tr_b16 v[130:131], v28 offset:3936
    ds_read_b64_tr_b16 v[132:133], v28 offset:128
    ds_read_b64_tr_b16 v[134:135], v28 offset:3968
    v_mfma_f32_16x16x32_bf16 v[52:55], v[168:171], v[152:155], v[52:55]
    ds_read_b64_tr_b16 v[136:137], v28 offset:160
    ds_read_b64_tr_b16 v[138:139], v28 offset:4000
    ds_read_b64_tr_b16 v[140:141], v28 offset:192
    v_mfma_f32_16x16x32_bf16 v[56:59], v[172:175], v[148:151], v[56:59]
    ds_read_b64_tr_b16 v[142:143], v28 offset:4032
    ds_read_b64_tr_b16 v[144:145], v28 offset:224
    ds_read_b64_tr_b16 v[146:147], v28 offset:4064
    v_mfma_f32_16x16x32_bf16 v[60:63], v[172:175], v[152:155], v[60:63]
    s_waitcnt vmcnt(1) lgkmcnt(0)
    ds_add_u32 v19, v3 offset:144
    v_mfma_f32_16x16x32_bf16 v[64:67], v[176:179], v[148:151], v[64:67]
    s_add_u32 m0, s65, 20480
    s_lshl3_add_u32 s11, s65, 163840
    buffer_load_dwordx4 v10, s[48:51], s11 offen lds
    v_mfma_f32_16x16x32_bf16 v[68:71], v[176:179], v[152:155], v[68:71]
    v_mfma_f32_16x16x32_bf16 v[72:75], v[180:183], v[148:151], v[72:75]
    v_mfma_f32_16x16x32_bf16 v[76:79], v[180:183], v[152:155], v[76:79]
    v_mfma_f32_16x16x32_bf16 v[80:83], v[184:187], v[148:151], v[80:83]
    v_mfma_f32_16x16x32_bf16 v[84:87], v[184:187], v[152:155], v[84:87]
    v_mfma_f32_16x16x32_bf16 v[88:91], v[188:191], v[148:151], v[88:91]
    v_mfma_f32_16x16x32_bf16 v[32:35], v[116:119], v[104:107], v[32:35]
    ds_read_b32 v29, v2 offset:144
    v_mfma_f32_16x16x32_bf16 v[36:39], v[116:119], v[108:111], v[36:39]
    s_waitcnt lgkmcnt(0)
    s_setprio 2
    v_readfirstlane_b32 s76, v29
    s_setprio 0
    s_cmp_lt_u32 s76, 76
    s_cbranch_scc1 Lslow_161
Lback_162:
    ds_read_b128 v[148:151], v27 offset:32768
    ds_read_b128 v[152:155], v27 offset:34816
    ds_read_b64_tr_b16 v[160:161], v28 offset:15360
    v_mfma_f32_16x16x32_bf16 v[40:43], v[120:123], v[104:107], v[40:43]
    ds_read_b64_tr_b16 v[162:163], v28 offset:19200
    ds_read_b64_tr_b16 v[164:165], v28 offset:15392
    ds_read_b64_tr_b16 v[166:167], v28 offset:19232
    v_mfma_f32_16x16x32_bf16 v[44:47], v[120:123], v[108:111], v[44:47]
    ds_read_b64_tr_b16 v[168:169], v28 offset:15424
    ds_read_b64_tr_b16 v[170:171], v28 offset:19264
    ds_read_b64_tr_b16 v[172:173], v28 offset:15456
    v_mfma_f32_16x16x32_bf16 v[48:51], v[124:127], v[104:107], v[48:51]
    ds_read_b64_tr_b16 v[174:175], v28 offset:19296
    ds_read_b64_tr_b16 v[176:177], v28 offset:15488
    ds_read_b64_tr_b16 v[178:179], v28 offset:19328
    v_mfma_f32_16x16x32_bf16 v[52:55], v[124:127], v[108:111], v[52:55]
    ds_read_b64_tr_b16 v[180:181], v28 offset:15520
    ds_read_b64_tr_b16 v[182:183], v28 offset:19360
    ds_read_b64_tr_b16 v[184:185], v28 offset:15552
    v_mfma_f32_16x16x32_bf16 v[56:59], v[128:131], v[104:107], v[56:59]
    ds_read_b64_tr_b16 v[186:187], v28 offset:19392
    ds_read_b64_tr_b16 v[188:189], v28 offset:15584
    ds_read_b64_tr_b16 v[190:191], v28 offset:19424
    v_mfma_f32_16x16x32_bf16 v[60:63], v[128:131], v[108:111], v[60:63]
    s_waitcnt lgkmcnt(0)
    ds_add_u32 v19, v3 offset:124
    v_mfma_f32_16x16x32_bf16 v[64:67], v[132:135], v[104:107], v[64:67]
    s_add_u32 m0, s65, 25600
    s_lshl3_add_u32 s11, s65, 204800
    buffer_load_dwordx4 v10, s[48:51], s11 offen lds
    v_mfma_f32_16x16x32_bf16 v[68:71], v[132:135], v[108:111], v[68:71]
    v_mfma_f32_16x16x32_bf16 v[72:75], v[136:139], v[104:107], v[72:75]
    v_mfma_f32_16x16x32_bf16 v[76:79], v[136:139], v[108:111], v[76:79]
    v_mfma_f32_16x16x32_bf16 v[80:83], v[140:143], v[104:107], v[80:83]
    v_mfma_f32_16x16x32_bf16 v[84:87], v[140:143], v[108:111], v[84:87]
    v_mfma_f32_16x16x32_bf16 v[88:91], v[144:147], v[104:107], v[88:91]
    s_lshl3_add_u32 s84, s4, s5
    s_mul_i32 s85, s84, 5120
    s_add_u32 s85, s85, 16777216
    s_add_u32 s83, s85, 4096
    s_lshl_b32 s84, s84, 7
    s_add_u32 s84, s84, 786432
    s_mov_b32 s86, s39
    s_and_b32 s87, s4, 3
    s_cmp_eq_u32 s87, 3
    s_cselect_b32 s39, 0, s39
    v_mfma_f32_16x16x32_bf16 v[32:35], v[160:163], v[148:151], v[32:35]
    v_mfma_f32_16x16x32_bf16 v[36:39], v[160:163], v[152:155], v[36:39]
    ds_read_b32 v29, v2 offset:124
    v_mfma_f32_16x16x32_bf16 v[40:43], v[164:167], v[148:151], v[40:43]
    s_waitcnt lgkmcnt(0)
    s_setprio 2
    v_readfirstlane_b32 s76, v29
    s_setprio 0
    s_cmp_lt_u32 s76, 4
    s_cbranch_scc1 Lslow_165
Lback_166:
    v_mfma_f32_16x16x32_bf16 v[44:47], v[164:167], v[152:155], v[44:47]
    s_setprio 2
    v_cvt_pk_bf16_f32 v32, v32, v33
    v_cvt_pk_bf16_f32 v33, v34, v35
    s_setprio 0
    ds_write_b64 v205, v[32:33] offset:0
    v_mfma_f32_16x16x32_bf16 v[48:51], v[168:171], v[148:151], v[48:51]
    s_setprio 2
    v_cvt_pk_bf16_f32 v36, v36, v37
    v_cvt_pk_bf16_f32 v37, v38, v39
    s_setprio 0
    ds_write_b64 v205, v[36:37] offset:2560
    v_mfma_f32_16x16x32_bf16 v[52:55], v[168:171], v[152:155], v[52:55]
    s_setprio 2
    v_cvt_pk_bf16_f32 v40, v40, v41
    v_cvt_pk_bf16_f32 v41, v42, v43
    s_setprio 0
    ds_write_b64 v205, v[40:41] offset:32
    v_mfma_f32_16x16x32_bf16 v[56:59], v[172:175], v[148:151], v[56:59]
    s_setprio 2
    v_cvt_pk_bf16_f32 v44, v44, v45
    v_cvt_pk_bf16_f32 v45, v46, v47
    s_setprio 0
    ds_write_b64 v205, v[44:45] offset:2592
    v_mfma_f32_16x16x32_bf16 v[60:63], v[172:175], v[152:155], v[60:63]
    s_setprio 2
    v_cvt_pk_bf16_f32 v48, v48, v49
    v_cvt_pk_bf16_f32 v49, v50, v51
    s_setprio 0
    ds_write_b64 v205, v[48:49] offset:64
    v_mfma_f32_16x16x32_bf16 v[64:67], v[176:179], v[148:151], v[64:67]
    s_setprio 2
    v_cvt_pk_bf16_f32 v52, v52, v53
    v_cvt_pk_bf16_f32 v53, v54, v55
    s_setprio 0
    ds_write_b64 v205, v[52:53] offset:2624
    v_mfma_f32_16x16x32_bf16 v[68:71], v[176:179], v[152:155], v[68:71]
    s_setprio 2
    v_cvt_pk_bf16_f32 v56, v56, v57
    v_cvt_pk_bf16_f32 v57, v58, v59
    s_setprio 0
    ds_write_b64 v205, v[56:57] offset:96
    v_mfma_f32_16x16x32_bf16 v[72:75], v[180:183], v[148:151], v[72:75]
    s_setprio 2
    v_cvt_pk_bf16_f32 v60, v60, v61
    v_cvt_pk_bf16_f32 v61, v62, v63
    s_setprio 0
    ds_write_b64 v205, v[60:61] offset:2656
    v_mfma_f32_16x16x32_bf16 v[76:79], v[180:183], v[152:155], v[76:79]
    s_setprio 2
    v_cvt_pk_bf16_f32 v64, v64, v65
    v_cvt_pk_bf16_f32 v65, v66, v67
    s_setprio 0
    ds_write_b64 v205, v[64:65] offset:128
    v_mfma_f32_16x16x32_bf16 v[80:83], v[184:187], v[148:151], v[80:83]
    s_setprio 2
    v_cvt_pk_bf16_f32 v68, v68, v69
    v_cvt_pk_bf16_f32 v69, v70, v71
    s_setprio 0
    ds_write_b64 v205, v[68:69] offset:2688
    v_mfma_f32_16x16x32_bf16 v[84:87], v[184:187], v[152:155], v[84:87]
    s_setprio 2
    v_cvt_pk_bf16_f32 v72, v72, v73
    v_cvt_pk_bf16_f32 v73, v74, v75
    s_setprio 0
    ds_write_b64 v205, v[72:73] offset:12800
    v_mfma_f32_16x16x32_bf16 v[88:91], v[188:191], v[148:151], v[88:91]
    s_setprio 2
    v_cvt_pk_bf16_f32 v76, v76, v77
    v_cvt_pk_bf16_f32 v77, v78, v79
    s_setprio 0
    ds_write_b64 v205, v[76:77] offset:15360
    s_setprio 2
    v_cvt_pk_bf16_f32 v80, v80, v81
    v_cvt_pk_bf16_f32 v81, v82, v83
    s_setprio 0
    ds_write_b64 v205, v[80:81] offset:12832
    s_setprio 2
    v_cvt_pk_bf16_f32 v84, v84, v85
    v_cvt_pk_bf16_f32 v85, v86, v87
    s_setprio 0
    ds_write_b64 v205, v[84:85] offset:15392
    s_setprio 2
    v_cvt_pk_bf16_f32 v88, v88, v89
    v_cvt_pk_bf16_f32 v89, v90, v91
    s_setprio 0
    ds_write_b64 v205, v[88:89] offset:12864
    ds_add_u32 v19, v3 offset:564
    s_setprio 2
    v_mov_b64 v[104:105], 0
    v_mov_b64 v[106:107], 0
    v_mov_b64 v[108:109], 0
    v_mov_b64 v[110:111], 0
    v_mov_b64 v[112:113], 0
    v_mov_b64 v[114:115], 0
    v_add_u32 v6, 112640, v225
    v_mov_b32 v4, 0
    s_cmp_eq_u32 s4, 0
    s_cbranch_scc1 Lhz_171
    s_sub_u32 s84, s84, 1024
    s_sub_u32 s85, s85, 40960
    s_mov_b32 s7, 0x8000
    s_mov_b64 exec, 1
Lh_169:
    buffer_load_dwordx2 v[8:9], v4, s[72:75], s84 offen sc1
    s_waitcnt vmcnt(0)
    v_readfirstlane_b32 s76, v8
    v_readfirstlane_b32 s77, v9
    s_xor_b32 s76, s76, s6
    s_xor_b32 s77, s77, s6
    s_or_b32 s76, s76, s77
    s_cbranch_scc0 Lhd_170
    s_sub_u32 s7, s7, 1
    s_cmp_lg_u32 s7, 0
    s_cbranch_scc1 Lh_169
Lhd_170:
    s_mov_b64 exec, -1
    buffer_load_dwordx4 v[104:107], v17, s[72:75], s85 offen sc1
    buffer_load_dwordx4 v[108:111], v17, s[72:75], s85 offen offset:1024 sc1
    s_mov_b32 exec_hi, 0
    buffer_load_dwordx4 v[112:115], v17, s[72:75], s85 offen offset:2048 sc1
    s_mov_b32 exec_hi, -1
    s_waitcnt vmcnt(0)
Lhz_171:
    ds_write_b128 v6, v[104:107]
    ds_write_b128 v6, v[108:111] offset:64
    s_mov_b32 exec_hi, 0
    ds_write_b128 v6, v[112:115] offset:128
    s_mov_b32 exec_hi, -1
    ds_add_u32 v19, v3 offset:604
    s_mov_b32 s39, s86
    s_waitcnt lgkmcnt(0)
    s_add_u32 m0, s65, 30720
    s_lshl3_add_u32 s11, s65, 245760
    buffer_load_dwordx4 v10, s[48:51], s11 offen lds
    s_add_u32 m0, s65, 35840
    s_lshl3_add_u32 s11, s65, 286720
    buffer_load_dwordx4 v10, s[48:51], s11 offen lds
    s_branch L_bg_done
L_bg1:
    ds_read_b128 v[104:107], v24 offset:0
    ds_read_b128 v[108:111], v24 offset:2048
    ds_read_b64_tr_b16 v[116:117], v28 offset:0
    ds_read_b64_tr_b16 v[118:119], v28 offset:3840
    ds_read_b64_tr_b16 v[120:121], v28 offset:32
    ds_read_b64_tr_b16 v[122:123], v28 offset:3872
    ds_read_b64_tr_b16 v[124:125], v28 offset:64
    ds_read_b64_tr_b16 v[126:127], v28 offset:3904
    ds_read_b64_tr_b16 v[128:129], v28 offset:96
    ds_read_b64_tr_b16 v[130:131], v28 offset:3936
    ds_read_b64_tr_b16 v[132:133], v28 offset:128
    ds_read_b64_tr_b16 v[134:135], v28 offset:3968
    ds_read_b64_tr_b16 v[136:137], v28 offset:160
    ds_read_b64_tr_b16 v[138:139], v28 offset:4000
    ds_read_b64_tr_b16 v[140:141], v28 offset:192
    ds_read_b64_tr_b16 v[142:143], v28 offset:4032
    ds_read_b64_tr_b16 v[144:145], v28 offset:224
    ds_read_b64_tr_b16 v[146:147], v28 offset:4064
    ds_read_b32 v9, v2 offset:632
    ds_read_b32 v7, v2 offset:112
    s_mov_b32 s48, s20
    s_mov_b32 s49, s21
    s_mov_b32 s50, 819200
    s_mov_b32 s51, 0x20000
    s_mov_b32 s60, s30
    s_mov_b32 s61, s31
    s_mov_b32 s62, 819200
    s_mov_b32 s63, 0x20000
    s_waitcnt lgkmcnt(0)
    v_mfma_f32_16x16x32_bf16 v[32:35], v[136:139], v[108:111], 0
    s_mov_b32 m0, 118784
    s_add_u32 s10, s8, 122880
    buffer_load_dwordx4 v20, s[44:47], s10 offen lds
    v_mfma_f32_16x16x32_bf16 v[36:39], v[140:143], v[108:111], 0
    s_mov_b32 m0, 122880
    s_nop 0
    buffer_load_dwordx4 v21, s[44:47], s10 offen lds
    v_mfma_f32_16x16x32_bf16 v[40:43], v[116:119], v[104:107], 0
    s_mov_b32 m0, 126976
    s_nop 0
    buffer_load_dwordx4 v22, s[44:47], s10 offen lds
    v_mfma_f32_16x16x32_bf16 v[44:47], v[116:119], v[108:111], 0
    s_mov_b32 m0, 131072
    s_nop 0
    buffer_load_dwordx4 v23, s[44:47], s10 offen lds
    v_mfma_f32_16x16x32_bf16 v[48:51], v[120:123], v[104:107], 0
    s_mov_b32 m0, 134144
    s_add_u32 s10, s8, 245760
    buffer_load_dwordx4 v20, s[44:47], s10 offen lds
    v_mfma_f32_16x16x32_bf16 v[52:55], v[120:123], v[108:111], 0
    s_mov_b32 m0, 138240
    s_nop 0
    buffer_load_dwordx4 v21, s[44:47], s10 offen lds
    v_mfma_f32_16x16x32_bf16 v[56:59], v[124:127], v[104:107], 0
    s_mov_b32 m0, 142336
    s_nop 0
    buffer_load_dwordx4 v22, s[44:47], s10 offen lds
    v_mfma_f32_16x16x32_bf16 v[60:63], v[124:127], v[108:111], 0
    s_mov_b32 m0, 146432
    s_nop 0
    buffer_load_dwordx4 v23, s[44:47], s10 offen lds
    s_setprio 2
    v_readfirstlane_b32 s6, v9
    v_readfirstlane_b32 s39, v7
    s_setprio 0
    v_mfma_f32_16x16x32_bf16 v[64:67], v[128:131], v[104:107], 0
    v_mfma_f32_16x16x32_bf16 v[68:71], v[128:131], v[108:111], 0
    s_waitcnt vmcnt(4) lgkmcnt(0)
    ds_add_u32 v19, v3 offset:144
    v_mfma_f32_16x16x32_bf16 v[72:75], v[132:135], v[104:107], 0
    ds_read_b32 v29, v2 offset:144
    v_mfma_f32_16x16x32_bf16 v[76:79], v[132:135], v[108:111], 0
    s_waitcnt lgkmcnt(0)
    s_setprio 2
    v_readfirstlane_b32 s76, v29
    s_setprio 0
    s_cmp_lt_u32 s76, 4
    s_cbranch_scc1 Lslow_172
Lback_173:
    ds_read_b128 v[148:151], v25 offset:0
    ds_read_b128 v[152:155], v25 offset:2048
    ds_read_b64_tr_b16 v[160:161], v28 offset:15360
    v_mfma_f32_16x16x32_bf16 v[80:83], v[136:139], v[104:107], 0
    ds_read_b64_tr_b16 v[162:163], v28 offset:19200
    ds_read_b64_tr_b16 v[164:165], v28 offset:15392
    ds_read_b64_tr_b16 v[166:167], v28 offset:19232
    v_mfma_f32_16x16x32_bf16 v[84:87], v[140:143], v[104:107], 0
    s_mov_b32 m0, 103424
    s_add_u32 s10, s8, 368640
    buffer_load_dwordx4 v20, s[44:47], s10 offen lds
    v_mfma_f32_16x16x32_bf16 v[88:91], v[144:147], v[104:107], 0
    ds_read_b64_tr_b16 v[168:169], v28 offset:15424
    ds_read_b64_tr_b16 v[170:171], v28 offset:19264
    ds_read_b64_tr_b16 v[172:173], v28 offset:15456
    ds_read_b64_tr_b16 v[174:175], v28 offset:19296
    ds_read_b64_tr_b16 v[176:177], v28 offset:15488
    ds_read_b64_tr_b16 v[178:179], v28 offset:19328
    s_mov_b32 m0, 107520
    s_nop 0
    buffer_load_dwordx4 v21, s[44:47], s10 offen lds
    ds_read_b64_tr_b16 v[180:181], v28 offset:15520
    ds_read_b64_tr_b16 v[182:183], v28 offset:19360
    ds_read_b64_tr_b16 v[184:185], v28 offset:15552
    ds_read_b64_tr_b16 v[186:187], v28 offset:19392
    ds_read_b64_tr_b16 v[188:189], v28 offset:15584
    ds_read_b64_tr_b16 v[190:191], v28 offset:19424
    s_mov_b32 m0, 111616
    s_nop 0
    buffer_load_dwordx4 v22, s[44:47], s10 offen lds
    s_mov_b32 m0, 115712
    s_nop 0
    buffer_load_dwordx4 v23, s[44:47], s10 offen lds
    s_waitcnt vmcnt(4) lgkmcnt(0)
    ds_add_u32 v19, v3 offset:144
    s_mul_i32 s11, s2, 3200
    s_setprio 2
    v_lshlrev_b32 v4, 7, v1
    s_setprio 0
    s_mov_b32 exec_lo, 0x1ffffff
    s_mov_b32 exec_hi, 0
    buffer_load_dword v0, v4, s[60:63], s11 offen
    s_mov_b64 exec, -1
    v_mfma_f32_16x16x32_bf16 v[32:35], v[180:183], v[152:155], v[32:35]
    ds_read_b32 v29, v2 offset:144
    v_mfma_f32_16x16x32_bf16 v[36:39], v[184:187], v[152:155], v[36:39]
    s_waitcnt lgkmcnt(0)
    s_setprio 2
    v_readfirstlane_b32 s76, v29
    s_setprio 0
    s_cmp_lt_u32 s76, 8
    s_cbranch_scc1 Lslow_176
Lback_177:
    ds_read_b128 v[104:107], v24 offset:8192
    ds_read_b128 v[108:111], v24 offset:10240
    ds_read_b64_tr_b16 v[116:117], v28 offset:30720
    v_mfma_f32_16x16x32_bf16 v[40:43], v[160:163], v[148:151], v[40:43]
    ds_read_b64_tr_b16 v[118:119], v28 offset:34560
    ds_read_b64_tr_b16 v[120:121], v28 offset:30752
    ds_read_b64_tr_b16 v[122:123], v28 offset:34592
    v_mfma_f32_16x16x32_bf16 v[44:47], v[160:163], v[152:155], v[44:47]
    s_mov_b32 m0, 118784
    s_add_u32 s10, s8, 491520
    buffer_load_dwordx4 v20, s[44:47], s10 offen lds
    v_mfma_f32_16x16x32_bf16 v[48:51], v[164:167], v[148:151], v[48:51]
    ds_read_b64_tr_b16 v[124:125], v28 offset:30784
    ds_read_b64_tr_b16 v[126:127], v28 offset:34624
    ds_read_b64_tr_b16 v[128:129], v28 offset:30816
    v_mfma_f32_16x16x32_bf16 v[52:55], v[164:167], v[152:155], v[52:55]
    ds_read_b64_tr_b16 v[130:131], v28 offset:34656
    ds_read_b64_tr_b16 v[132:133], v28 offset:30848
    ds_read_b64_tr_b16 v[134:135], v28 offset:34688
    v_mfma_f32_16x16x32_bf16 v[56:59], v[168:171], v[148:151], v[56:59]
    s_mov_b32 m0, 122880
    s_nop 0
    buffer_load_dwordx4 v21, s[44:47], s10 offen lds
    v_mfma_f32_16x16x32_bf16 v[60:63], v[168:171], v[152:155], v[60:63]
    ds_read_b64_tr_b16 v[136:137], v28 offset:30880
    ds_read_b64_tr_b16 v[138:139], v28 offset:34720
    ds_read_b64_tr_b16 v[140:141], v28 offset:30912
    v_mfma_f32_16x16x32_bf16 v[64:67], v[172:175], v[148:151], v[64:67]
    ds_read_b64_tr_b16 v[142:143], v28 offset:34752
    ds_read_b64_tr_b16 v[144:145], v28 offset:30944
    ds_read_b64_tr_b16 v[146:147], v28 offset:34784
    v_mfma_f32_16x16x32_bf16 v[68:71], v[172:175], v[152:155], v[68:71]
    s_mov_b32 m0, 126976
    s_nop 0
    buffer_load_dwordx4 v22, s[44:47], s10 offen lds
    v_mfma_f32_16x16x32_bf16 v[72:75], v[176:179], v[148:151], v[72:75]
    s_mov_b32 m0, 131072
    s_nop 0
    buffer_load_dwordx4 v23, s[44:47], s10 offen lds
    v_mfma_f32_16x16x32_bf16 v[76:79], v[176:179], v[152:155], v[76:79]
    s_waitcnt vmcnt(5) lgkmcnt(0)
    ds_add_u32 v19, v3 offset:144
    v_mfma_f32_16x16x32_bf16 v[80:83], v[180:183], v[148:151], v[80:83]
    s_mov_b32 m0, 82944
    s_mov_b32 s11, 655360
    buffer_load_dwordx4 v11, s[48:51], s11 offen lds
    v_mfma_f32_16x16x32_bf16 v[84:87], v[184:187], v[148:151], v[84:87]
    v_mfma_f32_16x16x32_bf16 v[88:91], v[188:191], v[148:151], v[88:91]
    v_mfma_f32_16x16x32_bf16 v[32:35], v[136:139], v[108:111], v[32:35]
    ds_read_b32 v29, v2 offset:144
    v_mfma_f32_16x16x32_bf16 v[36:39], v[140:143], v[108:111], v[36:39]
    s_waitcnt lgkmcnt(0)
    s_setprio 2
    v_readfirstlane_b32 s76, v29
    s_setprio 0
    s_cmp_lt_u32 s76, 12
    s_cbranch_scc1 Lslow_180
Lback_181:
    ds_read_b128 v[148:151], v25 offset:8192
    ds_read_b128 v[152:155], v25 offset:10240
    ds_read_b64_tr_b16 v[160:161], v28 offset:0
    v_mfma_f32_16x16x32_bf16 v[40:43], v[116:119], v[104:107], v[40:43]
    ds_read_b64_tr_b16 v[162:163], v28 offset:3840
    ds_read_b64_tr_b16 v[164:165], v28 offset:32
    ds_read_b64_tr_b16 v[166:167], v28 offset:3872
    v_mfma_f32_16x16x32_bf16 v[44:47], v[116:119], v[108:111], v[44:47]
    s_mov_b32 m0, 134144
    s_add_u32 s10, s8, 614400
    buffer_load_dwordx4 v20, s[44:47], s10 offen lds
    v_mfma_f32_16x16x32_bf16 v[48:51], v[120:123], v[104:107], v[48:51]
    ds_read_b64_tr_b16 v[168:169], v28 offset:64
    ds_read_b64_tr_b16 v[170:171], v28 offset:3904
    ds_read_b64_tr_b16 v[172:173], v28 offset:96
    v_mfma_f32_16x16x32_bf16 v[52:55], v[120:123], v[108:111], v[52:55]
    ds_read_b64_tr_b16 v[174:175], v28 offset:3936
    ds_read_b64_tr_b16 v[176:177], v28 offset:128
    ds_read_b64_tr_b16 v[178:179], v28 offset:3968
    v_mfma_f32_16x16x32_bf16 v[56:59], v[124:127], v[104:107], v[56:59]
    s_mov_b32 m0, 138240
    s_nop 0
    buffer_load_dwordx4 v21, s[44:47], s10 offen lds
    v_mfma_f32_16x16x32_bf16 v[60:63], v[124:127], v[108:111], v[60:63]
    ds_read_b64_tr_b16 v[180:181], v28 offset:160
    ds_read_b64_tr_b16 v[182:183], v28 offset:4000
    ds_read_b64_tr_b16 v[184:185], v28 offset:192
    v_mfma_f32_16x16x32_bf16 v[64:67], v[128:131], v[104:107], v[64:67]
    ds_read_b64_tr_b16 v[186:187], v28 offset:4032
    ds_read_b64_tr_b16 v[188:189], v28 offset:224
    ds_read_b64_tr_b16 v[190:191], v28 offset:4064
    v_mfma_f32_16x16x32_bf16 v[68:71], v[128:131], v[108:111], v[68:71]
    s_mov_b32 m0, 142336
    s_nop 0
    buffer_load_dwordx4 v22, s[44:47], s10 offen lds
    v_mfma_f32_16x16x32_bf16 v[72:75], v[132:135], v[104:107], v[72:75]
    s_mov_b32 m0, 146432
    s_nop 0
    buffer_load_dwordx4 v23, s[44:47], s10 offen lds
    v_mfma_f32_16x16x32_bf16 v[76:79], v[132:135], v[108:111], v[76:79]
    s_waitcnt vmcnt(5) lgkmcnt(0)
    ds_add_u32 v19, v3 offset:144
    v_mfma_f32_16x16x32_bf16 v[80:83], v[136:139], v[104:107], v[80:83]
    s_mov_b32 m0, 88064
    s_mov_b32 s11, 696320
    buffer_load_dwordx4 v11, s[48:51], s11 offen lds
    v_mfma_f32_16x16x32_bf16 v[84:87], v[140:143], v[104:107], v[84:87]
    v_mfma_f32_16x16x32_bf16 v[88:91], v[144:147], v[104:107], v[88:91]
    v_mfma_f32_16x16x32_bf16 v[32:35], v[180:183], v[152:155], v[32:35]
    ds_read_b32 v29, v2 offset:144
    v_mfma_f32_16x16x32_bf16 v[36:39], v[184:187], v[152:155], v[36:39]
    s_waitcnt lgkmcnt(0)
    s_setprio 2
    v_readfirstlane_b32 s76, v29
    s_setprio 0
    s_cmp_lt_u32 s76, 16
    s_cbranch_scc1 Lslow_184
Lback_185:
    ds_read_b128 v[104:107], v24 offset:16384
    ds_read_b128 v[108:111], v24 offset:18432
    ds_read_b64_tr_b16 v[116:117], v28 offset:15360
    v_mfma_f32_16x16x32_bf16 v[40:43], v[160:163], v[148:151], v[40:43]
    ds_read_b64_tr_b16 v[118:119], v28 offset:19200
    ds_read_b64_tr_b16 v[120:121], v28 offset:15392
    ds_read_b64_tr_b16 v[122:123], v28 offset:19232
    v_mfma_f32_16x16x32_bf16 v[44:47], v[160:163], v[152:155], v[44:47]
    s_mov_b32 m0, 103424
    s_add_u32 s10, s8, 737280
    buffer_load_dwordx4 v20, s[44:47], s10 offen lds
    v_mfma_f32_16x16x32_bf16 v[48:51], v[164:167], v[148:151], v[48:51]
    ds_read_b64_tr_b16 v[124:125], v28 offset:15424
    ds_read_b64_tr_b16 v[126:127], v28 offset:19264
    ds_read_b64_tr_b16 v[128:129], v28 offset:15456
    v_mfma_f32_16x16x32_bf16 v[52:55], v[164:167], v[152:155], v[52:55]
    ds_read_b64_tr_b16 v[130:131], v28 offset:19296
    ds_read_b64_tr_b16 v[132:133], v28 offset:15488
    ds_read_b64_tr_b16 v[134:135], v28 offset:19328
    v_mfma_f32_16x16x32_bf16 v[56:59], v[168:171], v[148:151], v[56:59]
    s_mov_b32 m0, 107520
    s_nop 0
    buffer_load_dwordx4 v21, s[44:47], s10 offen lds
    v_mfma_f32_16x16x32_bf16 v[60:63], v[168:171], v[152:155], v[60:63]
    ds_read_b64_tr_b16 v[136:137], v28 offset:15520
    ds_read_b64_tr_b16 v[138:139], v28 offset:19360
    ds_read_b64_tr_b16 v[140:141], v28 offset:15552
    v_mfma_f32_16x16x32_bf16 v[64:67], v[172:175], v[148:151], v[64:67]
    ds_read_b64_tr_b16 v[142:143], v28 offset:19392
    ds_read_b64_tr_b16 v[144:145], v28 offset:15584
    ds_read_b64_tr_b16 v[146:147], v28 offset:19424
    v_mfma_f32_16x16x32_bf16 v[68:71], v[172:175], v[152:155], v[68:71]
    s_mov_b32 m0, 111616
    s_nop 0
    buffer_load_dwordx4 v22, s[44:47], s10 offen lds
    v_mfma_f32_16x16x32_bf16 v[72:75], v[176:179], v[148:151], v[72:75]
    s_mov_b32 m0, 115712
    s_nop 0
    buffer_load_dwordx4 v23, s[44:47], s10 offen lds
    v_mfma_f32_16x16x32_bf16 v[76:79], v[176:179], v[152:155], v[76:79]
    s_waitcnt vmcnt(5) lgkmcnt(0)
    ds_add_u32 v19, v3 offset:144
    v_mfma_f32_16x16x32_bf16 v[80:83], v[180:183], v[148:151], v[80:83]
    s_mov_b32 m0, 93184
    s_mov_b32 s11, 737280
    buffer_load_dwordx4 v11, s[48:51], s11 offen lds
    v_mfma_f32_16x16x32_bf16 v[84:87], v[184:187], v[148:151], v[84:87]
    v_mfma_f32_16x16x32_bf16 v[88:91], v[188:191], v[148:151], v[88:91]
    v_mfma_f32_16x16x32_bf16 v[32:35], v[136:139], v[108:111], v[32:35]
    ds_read_b32 v29, v2 offset:144
    v_mfma_f32_16x16x32_bf16 v[36:39], v[140:143], v[108:111], v[36:39]
    s_waitcnt lgkmcnt(0)
    s_setprio 2
    v_readfirstlane_b32 s76, v29
    s_setprio 0
    s_cmp_lt_u32 s76, 20
    s_cbranch_scc1 Lslow_188
Lback_189:
    ds_read_b128 v[148:151], v25 offset:16384
    ds_read_b128 v[152:155], v25 offset:18432
    ds_read_b64_tr_b16 v[160:161], v28 offset:30720
    v_mfma_f32_16x16x32_bf16 v[40:43], v[116:119], v[104:107], v[40:43]
    ds_read_b64_tr_b16 v[162:163], v28 offset:34560
    ds_read_b64_tr_b16 v[164:165], v28 offset:30752
    ds_read_b64_tr_b16 v[166:167], v28 offset:34592
    v_mfma_f32_16x16x32_bf16 v[44:47], v[116:119], v[108:111], v[44:47]
    s_mov_b32 m0, 118784
    s_add_u32 s10, s8, 860160
    buffer_load_dwordx4 v20, s[44:47], s10 offen lds
    v_mfma_f32_16x16x32_bf16 v[48:51], v[120:123], v[104:107], v[48:51]
    ds_read_b64_tr_b16 v[168:169], v28 offset:30784
    ds_read_b64_tr_b16 v[170:171], v28 offset:34624
    ds_read_b64_tr_b16 v[172:173], v28 offset:30816
    v_mfma_f32_16x16x32_bf16 v[52:55], v[120:123], v[108:111], v[52:55]
    ds_read_b64_tr_b16 v[174:175], v28 offset:34656
    ds_read_b64_tr_b16 v[176:177], v28 offset:30848
    ds_read_b64_tr_b16 v[178:179], v28 offset:34688
    v_mfma_f32_16x16x32_bf16 v[56:59], v[124:127], v[104:107], v[56:59]
    s_mov_b32 m0, 122880
    s_nop 0
    buffer_load_dwordx4 v21, s[44:47], s10 offen lds
    v_mfma_f32_16x16x32_bf16 v[60:63], v[124:127], v[108:111], v[60:63]
    ds_read_b64_tr_b16 v[180:181], v28 offset:30880
    ds_read_b64_tr_b16 v[182:183], v28 offset:34720
    ds_read_b64_tr_b16 v[184:185], v28 offset:30912
    v_mfma_f32_16x16x32_bf16 v[64:67], v[128:131], v[104:107], v[64:67]
    ds_read_b64_tr_b16 v[186:187], v28 offset:34752
    ds_read_b64_tr_b16 v[188:189], v28 offset:30944
    ds_read_b64_tr_b16 v[190:191], v28 offset:34784
    v_mfma_f32_16x16x32_bf16 v[68:71], v[128:131], v[108:111], v[68:71]
    s_mov_b32 m0, 126976
    s_nop 0
    buffer_load_dwordx4 v22, s[44:47], s10 offen lds
    v_mfma_f32_16x16x32_bf16 v[72:75], v[132:135], v[104:107], v[72:75]
    s_mov_b32 m0, 131072
    s_nop 0
    buffer_load_dwordx4 v23, s[44:47], s10 offen lds
    v_mfma_f32_16x16x32_bf16 v[76:79], v[132:135], v[108:111], v[76:79]
    s_waitcnt vmcnt(5) lgkmcnt(0)
    ds_add_u32 v19, v3 offset:144
    v_mfma_f32_16x16x32_bf16 v[80:83], v[136:139], v[104:107], v[80:83]
    s_mov_b32 m0, 98304
    s_mov_b32 s11, 778240
    buffer_load_dwordx4 v11, s[48:51], s11 offen lds
    v_mfma_f32_16x16x32_bf16 v[84:87], v[140:143], v[104:107], v[84:87]
    v_mfma_f32_16x16x32_bf16 v[88:91], v[144:147], v[104:107], v[88:91]
    v_mfma_f32_16x16x32_bf16 v[32:35], v[180:183], v[152:155], v[32:35]
    ds_read_b32 v29, v2 offset:144
    v_mfma_f32_16x16x32_bf16 v[36:39], v[184:187], v[152:155], v[36:39]
    s_waitcnt lgkmcnt(0)
    s_setprio 2
    v_readfirstlane_b32 s76, v29
    s_setprio 0
    s_cmp_lt_u32 s76, 24
    s_cbranch_scc1 Lslow_192
Lback_193:
    ds_read_b128 v[104:107], v24 offset:24576
    ds_read_b128 v[108:111], v24 offset:26624
    ds_read_b64_tr_b16 v[116:117], v28 offset:0
    v_mfma_f32_16x16x32_bf16 v[40:43], v[160:163], v[148:151], v[40:43]
    ds_read_b64_tr_b16 v[118:119], v28 offset:3840
    ds_read_b64_tr_b16 v[120:121], v28 offset:32
    ds_read_b64_tr_b16 v[122:123], v28 offset:3872
    v_mfma_f32_16x16x32_bf16 v[44:47], v[160:163], v[152:155], v[44:47]
    s_mov_b32 m0, 134144
    s_add_u32 s10, s8, 983040
    buffer_load_dwordx4 v20, s[44:47], s10 offen lds
    v_mfma_f32_16x16x32_bf16 v[48:51], v[164:167], v[148:151], v[48:51]
    ds_read_b64_tr_b16 v[124:125], v28 offset:64
    ds_read_b64_tr_b16 v[126:127], v28 offset:3904
    ds_read_b64_tr_b16 v[128:129], v28 offset:96
    v_mfma_f32_16x16x32_bf16 v[52:55], v[164:167], v[152:155], v[52:55]
    ds_read_b64_tr_b16 v[130:131], v28 offset:3936
    ds_read_b64_tr_b16 v[132:133], v28 offset:128
    ds_read_b64_tr_b16 v[134:135], v28 offset:3968
    v_mfma_f32_16x16x32_bf16 v[56:59], v[168:171], v[148:151], v[56:59]
    s_mov_b32 m0, 138240
    s_nop 0
    buffer_load_dwordx4 v21, s[44:47], s10 offen lds
    v_mfma_f32_16x16x32_bf16 v[60:63], v[168:171], v[152:155], v[60:63]
    ds_read_b64_tr_b16 v[136:137], v28 offset:160
    ds_read_b64_tr_b16 v[138:139], v28 offset:4000
    ds_read_b64_tr_b16 v[140:141], v28 offset:192
    v_mfma_f32_16x16x32_bf16 v[64:67], v[172:175], v[148:151], v[64:67]
    ds_read_b64_tr_b16 v[142:143], v28 offset:4032
    ds_read_b64_tr_b16 v[144:145], v28 offset:224
    ds_read_b64_tr_b16 v[146:147], v28 offset:4064
    v_mfma_f32_16x16x32_bf16 v[68:71], v[172:175], v[152:155], v[68:71]
    s_mov_b32 m0, 142336
    s_nop 0
    buffer_load_dwordx4 v22, s[44:47], s10 offen lds
    v_mfma_f32_16x16x32_bf16 v[72:75], v[176:179], v[148:151], v[72:75]
    s_mov_b32 m0, 146432
    s_nop 0
    buffer_load_dwordx4 v23, s[44:47], s10 offen lds
    v_mfma_f32_16x16x32_bf16 v[76:79], v[176:179], v[152:155], v[76:79]
    s_waitcnt vmcnt(5) lgkmcnt(0)
    ds_add_u32 v19, v3 offset:144
    v_mfma_f32_16x16x32_bf16 v[80:83], v[180:183], v[148:151], v[80:83]
    s_add_u32 m0, s64, 1024
    s_lshl3_add_u32 s11, s64, 0
    buffer_load_dwordx4 v11, s[48:51], s11 offen lds
    v_mfma_f32_16x16x32_bf16 v[84:87], v[184:187], v[148:151], v[84:87]
    v_mfma_f32_16x16x32_bf16 v[88:91], v[188:191], v[148:151], v[88:91]
    v_mfma_f32_16x16x32_bf16 v[32:35], v[136:139], v[108:111], v[32:35]
    ds_read_b32 v29, v2 offset:144
    v_mfma_f32_16x16x32_bf16 v[36:39], v[140:143], v[108:111], v[36:39]
    s_waitcnt lgkmcnt(0)
    s_setprio 2
    v_readfirstlane_b32 s76, v29
    s_setprio 0
    s_cmp_lt_u32 s76, 28
    s_cbranch_scc1 Lslow_196
Lback_197:
    ds_read_b128 v[148:151], v25 offset:24576
    ds_read_b128 v[152:155], v25 offset:26624
    ds_read_b64_tr_b16 v[160:161], v28 offset:15360
    v_mfma_f32_16x16x32_bf16 v[40:43], v[116:119], v[104:107], v[40:43]
    ds_read_b64_tr_b16 v[162:163], v28 offset:19200
    ds_read_b64_tr_b16 v[164:165], v28 offset:15392
    ds_read_b64_tr_b16 v[166:167], v28 offset:19232
    v_mfma_f32_16x16x32_bf16 v[44:47], v[116:119], v[108:111], v[44:47]
    s_mov_b32 m0, 103424
    s_add_u32 s10, s8, 1105920
    buffer_load_dwordx4 v20, s[44:47], s10 offen lds
    v_mfma_f32_16x16x32_bf16 v[48:51], v[120:123], v[104:107], v[48:51]
    ds_read_b64_tr_b16 v[168:169], v28 offset:15424
    ds_read_b64_tr_b16 v[170:171], v28 offset:19264
    ds_read_b64_tr_b16 v[172:173], v28 offset:15456
    v_mfma_f32_16x16x32_bf16 v[52:55], v[120:123], v[108:111], v[52:55]
    ds_read_b64_tr_b16 v[174:175], v28 offset:19296
    ds_read_b64_tr_b16 v[176:177], v28 offset:15488
    ds_read_b64_tr_b16 v[178:179], v28 offset:19328
    v_mfma_f32_16x16x32_bf16 v[56:59], v[124:127], v[104:107], v[56:59]
    s_mov_b32 m0, 107520
    s_nop 0
    buffer_load_dwordx4 v21, s[44:47], s10 offen lds
    v_mfma_f32_16x16x32_bf16 v[60:63], v[124:127], v[108:111], v[60:63]
    ds_read_b64_tr_b16 v[180:181], v28 offset:15520
    ds_read_b64_tr_b16 v[182:183], v28 offset:19360
    ds_read_b64_tr_b16 v[184:185], v28 offset:15552
    v_mfma_f32_16x16x32_bf16 v[64:67], v[128:131], v[104:107], v[64:67]
    ds_read_b64_tr_b16 v[186:187], v28 offset:19392
    ds_read_b64_tr_b16 v[188:189], v28 offset:15584
    ds_read_b64_tr_b16 v[190:191], v28 offset:19424
    v_mfma_f32_16x16x32_bf16 v[68:71], v[128:131], v[108:111], v[68:71]
    s_mov_b32 m0, 111616
    s_nop 0
    buffer_load_dwordx4 v22, s[44:47], s10 offen lds
    v_mfma_f32_16x16x32_bf16 v[72:75], v[132:135], v[104:107], v[72:75]
    s_mov_b32 m0, 115712
    s_nop 0
    buffer_load_dwordx4 v23, s[44:47], s10 offen lds
    v_mfma_f32_16x16x32_bf16 v[76:79], v[132:135], v[108:111], v[76:79]
    s_waitcnt vmcnt(5) lgkmcnt(0)
    ds_add_u32 v19, v3 offset:144
    v_mfma_f32_16x16x32_bf16 v[80:83], v[136:139], v[104:107], v[80:83]
    s_add_u32 m0, s64, 6144
    s_lshl3_add_u32 s11, s64, 40960
    buffer_load_dwordx4 v11, s[48:51], s11 offen lds
    v_mfma_f32_16x16x32_bf16 v[84:87], v[140:143], v[104:107], v[84:87]
    v_mfma_f32_16x16x32_bf16 v[88:91], v[144:147], v[104:107], v[88:91]
    v_mfma_f32_16x16x32_bf16 v[32:35], v[180:183], v[152:155], v[32:35]
    ds_read_b32 v29, v2 offset:144
    v_mfma_f32_16x16x32_bf16 v[36:39], v[184:187], v[152:155], v[36:39]
    s_waitcnt lgkmcnt(0)
    s_setprio 2
    v_readfirstlane_b32 s76, v29
    s_setprio 0
    s_cmp_lt_u32 s76, 32
    s_cbranch_scc1 Lslow_200
Lback_201:
    ds_read_b128 v[104:107], v24 offset:32768
    ds_read_b128 v[108:111], v24 offset:34816
    ds_read_b64_tr_b16 v[116:117], v28 offset:30720
    v_mfma_f32_16x16x32_bf16 v[40:43], v[160:163], v[148:151], v[40:43]
    ds_read_b64_tr_b16 v[118:119], v28 offset:34560
    ds_read_b64_tr_b16 v[120:121], v28 offset:30752
    ds_read_b64_tr_b16 v[122:123], v28 offset:34592
    v_mfma_f32_16x16x32_bf16 v[44:47], v[160:163], v[152:155], v[44:47]
    s_mov_b32 m0, 118784
    s_add_u32 s10, s9, 0
    buffer_load_dwordx4 v20, s[44:47], s10 offen lds
    v_mfma_f32_16x16x32_bf16 v[48:51], v[164:167], v[148:151], v[48:51]
    ds_read_b64_tr_b16 v[124:125], v28 offset:30784
    ds_read_b64_tr_b16 v[126:127], v28 offset:34624
    ds_read_b64_tr_b16 v[128:129], v28 offset:30816
    v_mfma_f32_16x16x32_bf16 v[52:55], v[164:167], v[152:155], v[52:55]
    ds_read_b64_tr_b16 v[130:131], v28 offset:34656
    ds_read_b64_tr_b16 v[132:133], v28 offset:30848
    ds_read_b64_tr_b16 v[134:135], v28 offset:34688
    v_mfma_f32_16x16x32_bf16 v[56:59], v[168:171], v[148:151], v[56:59]
    s_mov_b32 m0, 122880
    s_nop 0
    buffer_load_dwordx4 v21, s[44:47], s10 offen lds
    v_mfma_f32_16x16x32_bf16 v[60:63], v[168:171], v[152:155], v[60:63]
    ds_read_b64_tr_b16 v[136:137], v28 offset:30880
    ds_read_b64_tr_b16 v[138:139], v28 offset:34720
    ds_read_b64_tr_b16 v[140:141], v28 offset:30912
    v_mfma_f32_16x16x32_bf16 v[64:67], v[172:175], v[148:151], v[64:67]
    ds_read_b64_tr_b16 v[142:143], v28 offset:34752
    ds_read_b64_tr_b16 v[144:145], v28 offset:30944
    ds_read_b64_tr_b16 v[146:147], v28 offset:34784
    v_mfma_f32_16x16x32_bf16 v[68:71], v[172:175], v[152:155], v[68:71]
    s_mov_b32 m0, 126976
    s_nop 0
    buffer_load_dwordx4 v22, s[44:47], s10 offen lds
    v_mfma_f32_16x16x32_bf16 v[72:75], v[176:179], v[148:151], v[72:75]
    s_mov_b32 m0, 131072
    s_nop 0
    buffer_load_dwordx4 v23, s[44:47], s10 offen lds
    v_mfma_f32_16x16x32_bf16 v[76:79], v[176:179], v[152:155], v[76:79]
    s_waitcnt vmcnt(5) lgkmcnt(0)
    ds_add_u32 v19, v3 offset:144
    v_mfma_f32_16x16x32_bf16 v[80:83], v[180:183], v[148:151], v[80:83]
    s_add_u32 m0, s64, 11264
    s_lshl3_add_u32 s11, s64, 81920
    buffer_load_dwordx4 v11, s[48:51], s11 offen lds
    v_mfma_f32_16x16x32_bf16 v[84:87], v[184:187], v[148:151], v[84:87]
    v_mfma_f32_16x16x32_bf16 v[88:91], v[188:191], v[148:151], v[88:91]
    v_mfma_f32_16x16x32_bf16 v[32:35], v[136:139], v[108:111], v[32:35]
    ds_read_b32 v29, v2 offset:144
    v_mfma_f32_16x16x32_bf16 v[36:39], v[140:143], v[108:111], v[36:39]
    s_waitcnt lgkmcnt(0)
    s_setprio 2
    v_readfirstlane_b32 s76, v29
    s_setprio 0
    s_cmp_lt_u32 s76, 36
    s_cbranch_scc1 Lslow_204
Lback_205:
    ds_read_b128 v[148:151], v25 offset:32768
    ds_read_b128 v[152:155], v25 offset:34816
    ds_read_b64_tr_b16 v[160:161], v28 offset:0
    v_mfma_f32_16x16x32_bf16 v[40:43], v[116:119], v[104:107], v[40:43]
    ds_read_b64_tr_b16 v[162:163], v28 offset:3840
    ds_read_b64_tr_b16 v[164:165], v28 offset:32
    ds_read_b64_tr_b16 v[166:167], v28 offset:3872
    v_mfma_f32_16x16x32_bf16 v[44:47], v[116:119], v[108:111], v[44:47]
    s_mov_b32 m0, 134144
    s_add_u32 s10, s9, 122880
    buffer_load_dwordx4 v20, s[44:47], s10 offen lds
    v_mfma_f32_16x16x32_bf16 v[48:51], v[120:123], v[104:107], v[48:51]
    ds_read_b64_tr_b16 v[168:169], v28 offset:64
    ds_read_b64_tr_b16 v[170:171], v28 offset:3904
    ds_read_b64_tr_b16 v[172:173], v28 offset:96
    v_mfma_f32_16x16x32_bf16 v[52:55], v[120:123], v[108:111], v[52:55]
    ds_read_b64_tr_b16 v[174:175], v28 offset:3936
    ds_read_b64_tr_b16 v[176:177], v28 offset:128
    ds_read_b64_tr_b16 v[178:179], v28 offset:3968
    v_mfma_f32_16x16x32_bf16 v[56:59], v[124:127], v[104:107], v[56:59]
    s_mov_b32 m0, 138240
    s_nop 0
    buffer_load_dwordx4 v21, s[44:47], s10 offen lds
    v_mfma_f32_16x16x32_bf16 v[60:63], v[124:127], v[108:111], v[60:63]
    ds_read_b64_tr_b16 v[180:181], v28 offset:160
    ds_read_b64_tr_b16 v[182:183], v28 offset:4000
    ds_read_b64_tr_b16 v[184:185], v28 offset:192
    v_mfma_f32_16x16x32_bf16 v[64:67], v[128:131], v[104:107], v[64:67]
    ds_read_b64_tr_b16 v[186:187], v28 offset:4032
    ds_read_b64_tr_b16 v[188:189], v28 offset:224
    ds_read_b64_tr_b16 v[190:191], v28 offset:4064
    v_mfma_f32_16x16x32_bf16 v[68:71], v[128:131], v[108:111], v[68:71]
    s_mov_b32 m0, 142336
    s_nop 0
    buffer_load_dwordx4 v22, s[44:47], s10 offen lds
    v_mfma_f32_16x16x32_bf16 v[72:75], v[132:135], v[104:107], v[72:75]
    s_mov_b32 m0, 146432
    s_nop 0
    buffer_load_dwordx4 v23, s[44:47], s10 offen lds
    v_mfma_f32_16x16x32_bf16 v[76:79], v[132:135], v[108:111], v[76:79]
    s_waitcnt vmcnt(5) lgkmcnt(0)
    ds_add_u32 v19, v3 offset:144
    v_mfma_f32_16x16x32_bf16 v[80:83], v[136:139], v[104:107], v[80:83]
    s_add_u32 m0, s64, 16384
    s_lshl3_add_u32 s11, s64, 122880
    buffer_load_dwordx4 v11, s[48:51], s11 offen lds
    v_mfma_f32_16x16x32_bf16 v[84:87], v[140:143], v[104:107], v[84:87]
    v_mfma_f32_16x16x32_bf16 v[88:91], v[144:147], v[104:107], v[88:91]
    v_mfma_f32_16x16x32_bf16 v[32:35], v[180:183], v[152:155], v[32:35]
    ds_read_b32 v29, v2 offset:144
    v_mfma_f32_16x16x32_bf16 v[36:39], v[184:187], v[152:155], v[36:39]
    s_waitcnt lgkmcnt(0)
    s_setprio 2
    v_readfirstlane_b32 s76, v29
    s_setprio 0
    s_cmp_lt_u32 s76, 40
    s_cbranch_scc1 Lslow_208
Lback_209:
    ds_read_b128 v[104:107], v26 offset:0
    ds_read_b128 v[108:111], v26 offset:2048
    ds_read_b64_tr_b16 v[116:117], v28 offset:15360
    v_mfma_f32_16x16x32_bf16 v[40:43], v[160:163], v[148:151], v[40:43]
    ds_read_b64_tr_b16 v[118:119], v28 offset:19200
    ds_read_b64_tr_b16 v[120:121], v28 offset:15392
    ds_read_b64_tr_b16 v[122:123], v28 offset:19232
    v_mfma_f32_16x16x32_bf16 v[44:47], v[160:163], v[152:155], v[44:47]
    s_mov_b32 m0, 103424
    s_add_u32 s10, s9, 245760
    buffer_load_dwordx4 v20, s[44:47], s10 offen lds
    v_mfma_f32_16x16x32_bf16 v[48:51], v[164:167], v[148:151], v[48:51]
    ds_read_b64_tr_b16 v[124:125], v28 offset:15424
    ds_read_b64_tr_b16 v[126:127], v28 offset:19264
    ds_read_b64_tr_b16 v[128:129], v28 offset:15456
    v_mfma_f32_16x16x32_bf16 v[52:55], v[164:167], v[152:155], v[52:55]
    ds_read_b64_tr_b16 v[130:131], v28 offset:19296
    ds_read_b64_tr_b16 v[132:133], v28 offset:15488
    ds_read_b64_tr_b16 v[134:135], v28 offset:19328
    v_mfma_f32_16x16x32_bf16 v[56:59], v[168:171], v[148:151], v[56:59]
    s_mov_b32 m0, 107520
    s_nop 0
    buffer_load_dwordx4 v21, s[44:47], s10 offen lds
    v_mfma_f32_16x16x32_bf16 v[60:63], v[168:171], v[152:155], v[60:63]
    ds_read_b64_tr_b16 v[136:137], v28 offset:15520
    ds_read_b64_tr_b16 v[138:139], v28 offset:19360
    ds_read_b64_tr_b16 v[140:141], v28 offset:15552
    v_mfma_f32_16x16x32_bf16 v[64:67], v[172:175], v[148:151], v[64:67]
    ds_read_b64_tr_b16 v[142:143], v28 offset:19392
    ds_read_b64_tr_b16 v[144:145], v28 offset:15584
    ds_read_b64_tr_b16 v[146:147], v28 offset:19424
    v_mfma_f32_16x16x32_bf16 v[68:71], v[172:175], v[152:155], v[68:71]
    s_mov_b32 m0, 111616
    s_nop 0
    buffer_load_dwordx4 v22, s[44:47], s10 offen lds
    v_mfma_f32_16x16x32_bf16 v[72:75], v[176:179], v[148:151], v[72:75]
    s_mov_b32 m0, 115712
    s_nop 0
    buffer_load_dwordx4 v23, s[44:47], s10 offen lds
    v_mfma_f32_16x16x32_bf16 v[76:79], v[176:179], v[152:155], v[76:79]
    s_waitcnt vmcnt(5) lgkmcnt(0)
    ds_add_u32 v19, v3 offset:144
    v_mfma_f32_16x16x32_bf16 v[80:83], v[180:183], v[148:151], v[80:83]
    s_add_u32 m0, s64, 21504
    s_lshl3_add_u32 s11, s64, 163840
    buffer_load_dwordx4 v11, s[48:51], s11 offen lds
    v_mfma_f32_16x16x32_bf16 v[84:87], v[184:187], v[148:151], v[84:87]
    v_mfma_f32_16x16x32_bf16 v[88:91], v[188:191], v[148:151], v[88:91]
    v_mfma_f32_16x16x32_bf16 v[32:35], v[136:139], v[108:111], v[32:35]
    ds_read_b32 v29, v2 offset:144
    v_mfma_f32_16x16x32_bf16 v[36:39], v[140:143], v[108:111], v[36:39]
    s_waitcnt lgkmcnt(0)
    s_setprio 2
    v_readfirstlane_b32 s76, v29
    s_setprio 0
    s_cmp_lt_u32 s76, 44
    s_cbranch_scc1 Lslow_212
Lback_213:
    ds_read_b128 v[148:151], v27 offset:0
    ds_read_b128 v[152:155], v27 offset:2048
    ds_read_b64_tr_b16 v[160:161], v28 offset:30720
    v_mfma_f32_16x16x32_bf16 v[40:43], v[116:119], v[104:107], v[40:43]
    ds_read_b64_tr_b16 v[162:163], v28 offset:34560
    ds_read_b64_tr_b16 v[164:165], v28 offset:30752
    ds_read_b64_tr_b16 v[166:167], v28 offset:34592
    v_mfma_f32_16x16x32_bf16 v[44:47], v[116:119], v[108:111], v[44:47]
    s_mov_b32 m0, 118784
    s_add_u32 s10, s9, 368640
    buffer_load_dwordx4 v20, s[44:47], s10 offen lds
    v_mfma_f32_16x16x32_bf16 v[48:51], v[120:123], v[104:107], v[48:51]
    ds_read_b64_tr_b16 v[168:169], v28 offset:30784
    ds_read_b64_tr_b16 v[170:171], v28 offset:34624
    ds_read_b64_tr_b16 v[172:173], v28 offset:30816
    v_mfma_f32_16x16x32_bf16 v[52:55], v[120:123], v[108:111], v[52:55]
    ds_read_b64_tr_b16 v[174:175], v28 offset:34656
    ds_read_b64_tr_b16 v[176:177], v28 offset:30848
    ds_read_b64_tr_b16 v[178:179], v28 offset:34688
    v_mfma_f32_16x16x32_bf16 v[56:59], v[124:127], v[104:107], v[56:59]
    s_mov_b32 m0, 122880
    s_nop 0
    buffer_load_dwordx4 v21, s[44:47], s10 offen lds
    v_mfma_f32_16x16x32_bf16 v[60:63], v[124:127], v[108:111], v[60:63]
    ds_read_b64_tr_b16 v[180:181], v28 offset:30880
    ds_read_b64_tr_b16 v[182:183], v28 offset:34720
    ds_read_b64_tr_b16 v[184:185], v28 offset:30912
    v_mfma_f32_16x16x32_bf16 v[64:67], v[128:131], v[104:107], v[64:67]
    ds_read_b64_tr_b16 v[186:187], v28 offset:34752
    ds_read_b64_tr_b16 v[188:189], v28 offset:30944
    ds_read_b64_tr_b16 v[190:191], v28 offset:34784
    v_mfma_f32_16x16x32_bf16 v[68:71], v[128:131], v[108:111], v[68:71]
    s_mov_b32 m0, 126976
    s_nop 0
    buffer_load_dwordx4 v22, s[44:47], s10 offen lds
    v_mfma_f32_16x16x32_bf16 v[72:75], v[132:135], v[104:107], v[72:75]
    s_mov_b32 m0, 131072
    s_nop 0
    buffer_load_dwordx4 v23, s[44:47], s10 offen lds
    v_mfma_f32_16x16x32_bf16 v[76:79], v[132:135], v[108:111], v[76:79]
    s_waitcnt vmcnt(5) lgkmcnt(0)
    ds_add_u32 v19, v3 offset:144
    v_mfma_f32_16x16x32_bf16 v[80:83], v[136:139], v[104:107], v[80:83]
    s_add_u32 m0, s64, 26624
    s_lshl3_add_u32 s11, s64, 204800
    buffer_load_dwordx4 v11, s[48:51], s11 offen lds
    v_mfma_f32_16x16x32_bf16 v[84:87], v[140:143], v[104:107], v[84:87]
    v_mfma_f32_16x16x32_bf16 v[88:91], v[144:147], v[104:107], v[88:91]
    v_mfma_f32_16x16x32_bf16 v[32:35], v[180:183], v[152:155], v[32:35]
    ds_read_b32 v29, v2 offset:144
    v_mfma_f32_16x16x32_bf16 v[36:39], v[184:187], v[152:155], v[36:39]
    s_waitcnt lgkmcnt(0)
    s_setprio 2
    v_readfirstlane_b32 s76, v29
    s_setprio 0
    s_cmp_lt_u32 s76, 48
    s_cbranch_scc1 Lslow_216
Lback_217:
    ds_read_b128 v[104:107], v26 offset:8192
    ds_read_b128 v[108:111], v26 offset:10240
    ds_read_b64_tr_b16 v[116:117], v28 offset:0
    v_mfma_f32_16x16x32_bf16 v[40:43], v[160:163], v[148:151], v[40:43]
    ds_read_b64_tr_b16 v[118:119], v28 offset:3840
    ds_read_b64_tr_b16 v[120:121], v28 offset:32
    ds_read_b64_tr_b16 v[122:123], v28 offset:3872
    v_mfma_f32_16x16x32_bf16 v[44:47], v[160:163], v[152:155], v[44:47]
    s_mov_b32 m0, 134144
    s_add_u32 s10, s9, 491520
    buffer_load_dwordx4 v20, s[44:47], s10 offen lds
    v_mfma_f32_16x16x32_bf16 v[48:51], v[164:167], v[148:151], v[48:51]
    ds_read_b64_tr_b16 v[124:125], v28 offset:64
    ds_read_b64_tr_b16 v[126:127], v28 offset:3904
    ds_read_b64_tr_b16 v[128:129], v28 offset:96
    v_mfma_f32_16x16x32_bf16 v[52:55], v[164:167], v[152:155], v[52:55]
    ds_read_b64_tr_b16 v[130:131], v28 offset:3936
    ds_read_b64_tr_b16 v[132:133], v28 offset:128
    ds_read_b64_tr_b16 v[134:135], v28 offset:3968
    v_mfma_f32_16x16x32_bf16 v[56:59], v[168:171], v[148:151], v[56:59]
    s_mov_b32 m0, 138240
    s_nop 0
    buffer_load_dwordx4 v21, s[44:47], s10 offen lds
    v_mfma_f32_16x16x32_bf16 v[60:63], v[168:171], v[152:155], v[60:63]
    ds_read_b64_tr_b16 v[136:137], v28 offset:160
    ds_read_b64_tr_b16 v[138:139], v28 offset:4000
    ds_read_b64_tr_b16 v[140:141], v28 offset:192
    v_mfma_f32_16x16x32_bf16 v[64:67], v[172:175], v[148:151], v[64:67]
    ds_read_b64_tr_b16 v[142:143], v28 offset:4032
    ds_read_b64_tr_b16 v[144:145], v28 offset:224
    ds_read_b64_tr_b16 v[146:147], v28 offset:4064
    v_mfma_f32_16x16x32_bf16 v[68:71], v[172:175], v[152:155], v[68:71]
    s_mov_b32 m0, 142336
    s_nop 0
    buffer_load_dwordx4 v22, s[44:47], s10 offen lds
    v_mfma_f32_16x16x32_bf16 v[72:75], v[176:179], v[148:151], v[72:75]
    s_mov_b32 m0, 146432
    s_nop 0
    buffer_load_dwordx4 v23, s[44:47], s10 offen lds
    v_mfma_f32_16x16x32_bf16 v[76:79], v[176:179], v[152:155], v[76:79]
    s_waitcnt vmcnt(5) lgkmcnt(0)
    ds_add_u32 v19, v3 offset:144
    v_mfma_f32_16x16x32_bf16 v[80:83], v[180:183], v[148:151], v[80:83]
    s_add_u32 m0, s64, 31744
    s_lshl3_add_u32 s11, s64, 245760
    buffer_load_dwordx4 v11, s[48:51], s11 offen lds
    v_mfma_f32_16x16x32_bf16 v[84:87], v[184:187], v[148:151], v[84:87]
    v_mfma_f32_16x16x32_bf16 v[88:91], v[188:191], v[148:151], v[88:91]
    v_mfma_f32_16x16x32_bf16 v[32:35], v[136:139], v[108:111], v[32:35]
    ds_read_b32 v29, v2 offset:144
    v_mfma_f32_16x16x32_bf16 v[36:39], v[140:143], v[108:111], v[36:39]
    s_waitcnt lgkmcnt(0)
    s_setprio 2
    v_readfirstlane_b32 s76, v29
    s_setprio 0
    s_cmp_lt_u32 s76, 52
    s_cbranch_scc1 Lslow_220
Lback_221:
    ds_read_b128 v[148:151], v27 offset:8192
    ds_read_b128 v[152:155], v27 offset:10240
    ds_read_b64_tr_b16 v[160:161], v28 offset:15360
    v_mfma_f32_16x16x32_bf16 v[40:43], v[116:119], v[104:107], v[40:43]
    ds_read_b64_tr_b16 v[162:163], v28 offset:19200
    ds_read_b64_tr_b16 v[164:165], v28 offset:15392
    ds_read_b64_tr_b16 v[166:167], v28 offset:19232
    v_mfma_f32_16x16x32_bf16 v[44:47], v[116:119], v[108:111], v[44:47]
    s_mov_b32 m0, 103424
    s_add_u32 s10, s9, 614400
    buffer_load_dwordx4 v20, s[44:47], s10 offen lds
    v_mfma_f32_16x16x32_bf16 v[48:51], v[120:123], v[104:107], v[48:51]
    ds_read_b64_tr_b16 v[168:169], v28 offset:15424
    ds_read_b64_tr_b16 v[170:171], v28 offset:19264
    ds_read_b64_tr_b16 v[172:173], v28 offset:15456
    v_mfma_f32_16x16x32_bf16 v[52:55], v[120:123], v[108:111], v[52:55]
    ds_read_b64_tr_b16 v[174:175], v28 offset:19296
    ds_read_b64_tr_b16 v[176:177], v28 offset:15488
    ds_read_b64_tr_b16 v[178:179], v28 offset:19328
    v_mfma_f32_16x16x32_bf16 v[56:59], v[124:127], v[104:107], v[56:59]
    s_mov_b32 m0, 107520
    s_nop 0
    buffer_load_dwordx4 v21, s[44:47], s10 offen lds
    v_mfma_f32_16x16x32_bf16 v[60:63], v[124:127], v[108:111], v[60:63]
    ds_read_b64_tr_b16 v[180:181], v28 offset:15520
    ds_read_b64_tr_b16 v[182:183], v28 offset:19360
    ds_read_b64_tr_b16 v[184:185], v28 offset:15552
    v_mfma_f32_16x16x32_bf16 v[64:67], v[128:131], v[104:107], v[64:67]
    ds_read_b64_tr_b16 v[186:187], v28 offset:19392
    ds_read_b64_tr_b16 v[188:189], v28 offset:15584
    ds_read_b64_tr_b16 v[190:191], v28 offset:19424
    v_mfma_f32_16x16x32_bf16 v[68:71], v[128:131], v[108:111], v[68:71]
    s_mov_b32 m0, 111616
    s_nop 0
    buffer_load_dwordx4 v22, s[44:47], s10 offen lds
    v_mfma_f32_16x16x32_bf16 v[72:75], v[132:135], v[104:107], v[72:75]
    s_mov_b32 m0, 115712
    s_nop 0
    buffer_load_dwordx4 v23, s[44:47], s10 offen lds
    v_mfma_f32_16x16x32_bf16 v[76:79], v[132:135], v[108:111], v[76:79]
    s_waitcnt vmcnt(5) lgkmcnt(0)
    ds_add_u32 v19, v3 offset:144
    v_mfma_f32_16x16x32_bf16 v[80:83], v[136:139], v[104:107], v[80:83]
    s_add_u32 m0, s64, 36864
    s_lshl3_add_u32 s11, s64, 286720
    buffer_load_dwordx4 v11, s[48:51], s11 offen lds
    v_mfma_f32_16x16x32_bf16 v[84:87], v[140:143], v[104:107], v[84:87]
    v_mfma_f32_16x16x32_bf16 v[88:91], v[144:147], v[104:107], v[88:91]
    v_mfma_f32_16x16x32_bf16 v[32:35], v[180:183], v[152:155], v[32:35]
    ds_read_b32 v29, v2 offset:144
    v_mfma_f32_16x16x32_bf16 v[36:39], v[184:187], v[152:155], v[36:39]
    s_waitcnt lgkmcnt(0)
    s_setprio 2
    v_readfirstlane_b32 s76, v29
    s_setprio 0
    s_cmp_lt_u32 s76, 56
    s_cbranch_scc1 Lslow_224
Lback_225:
    ds_read_b128 v[104:107], v26 offset:16384
    ds_read_b128 v[108:111], v26 offset:18432
    ds_read_b64_tr_b16 v[116:117], v28 offset:30720
    v_mfma_f32_16x16x32_bf16 v[40:43], v[160:163], v[148:151], v[40:43]
    ds_read_b64_tr_b16 v[118:119], v28 offset:34560
    ds_read_b64_tr_b16 v[120:121], v28 offset:30752
    ds_read_b64_tr_b16 v[122:123], v28 offset:34592
    v_mfma_f32_16x16x32_bf16 v[44:47], v[160:163], v[152:155], v[44:47]
    s_mov_b32 m0, 118784
    s_add_u32 s10, s9, 737280
    buffer_load_dwordx4 v20, s[44:47], s10 offen lds
    v_mfma_f32_16x16x32_bf16 v[48:51], v[164:167], v[148:151], v[48:51]
    ds_read_b64_tr_b16 v[124:125], v28 offset:30784
    ds_read_b64_tr_b16 v[126:127], v28 offset:34624
    ds_read_b64_tr_b16 v[128:129], v28 offset:30816
    v_mfma_f32_16x16x32_bf16 v[52:55], v[164:167], v[152:155], v[52:55]
    ds_read_b64_tr_b16 v[130:131], v28 offset:34656
    ds_read_b64_tr_b16 v[132:133], v28 offset:30848
    ds_read_b64_tr_b16 v[134:135], v28 offset:34688
    v_mfma_f32_16x16x32_bf16 v[56:59], v[168:171], v[148:151], v[56:59]
    s_mov_b32 m0, 122880
    s_nop 0
    buffer_load_dwordx4 v21, s[44:47], s10 offen lds
    v_mfma_f32_16x16x32_bf16 v[60:63], v[168:171], v[152:155], v[60:63]
    ds_read_b64_tr_b16 v[136:137], v28 offset:30880
    ds_read_b64_tr_b16 v[138:139], v28 offset:34720
    ds_read_b64_tr_b16 v[140:141], v28 offset:30912
    v_mfma_f32_16x16x32_bf16 v[64:67], v[172:175], v[148:151], v[64:67]
    ds_read_b64_tr_b16 v[142:143], v28 offset:34752
    ds_read_b64_tr_b16 v[144:145], v28 offset:30944
    ds_read_b64_tr_b16 v[146:147], v28 offset:34784
    v_mfma_f32_16x16x32_bf16 v[68:71], v[172:175], v[152:155], v[68:71]
    s_mov_b32 m0, 126976
    s_nop 0
    buffer_load_dwordx4 v22, s[44:47], s10 offen lds
    v_mfma_f32_16x16x32_bf16 v[72:75], v[176:179], v[148:151], v[72:75]
    s_mov_b32 m0, 131072
    s_nop 0
    buffer_load_dwordx4 v23, s[44:47], s10 offen lds
    v_mfma_f32_16x16x32_bf16 v[76:79], v[176:179], v[152:155], v[76:79]
    s_waitcnt vmcnt(5) lgkmcnt(0)
    ds_add_u32 v19, v3 offset:144
    v_mfma_f32_16x16x32_bf16 v[80:83], v[180:183], v[148:151], v[80:83]
    s_add_u32 m0, s65, 1024
    s_lshl3_add_u32 s11, s65, 0
    buffer_load_dwordx4 v11, s[48:51], s11 offen lds
    v_mfma_f32_16x16x32_bf16 v[84:87], v[184:187], v[148:151], v[84:87]
    v_mfma_f32_16x16x32_bf16 v[88:91], v[188:191], v[148:151], v[88:91]
    v_mfma_f32_16x16x32_bf16 v[32:35], v[136:139], v[108:111], v[32:35]
    ds_read_b32 v29, v2 offset:144
    v_mfma_f32_16x16x32_bf16 v[36:39], v[140:143], v[108:111], v[36:39]
    s_waitcnt lgkmcnt(0)
    s_setprio 2
    v_readfirstlane_b32 s76, v29
    s_setprio 0
    s_cmp_lt_u32 s76, 60
    s_cbranch_scc1 Lslow_228
Lback_229:
    ds_read_b128 v[148:151], v27 offset:16384
    ds_read_b128 v[152:155], v27 offset:18432
    ds_read_b64_tr_b16 v[160:161], v28 offset:0
    v_mfma_f32_16x16x32_bf16 v[40:43], v[116:119], v[104:107], v[40:43]
    ds_read_b64_tr_b16 v[162:163], v28 offset:3840
    ds_read_b64_tr_b16 v[164:165], v28 offset:32
    ds_read_b64_tr_b16 v[166:167], v28 offset:3872
    v_mfma_f32_16x16x32_bf16 v[44:47], v[116:119], v[108:111], v[44:47]
    s_mov_b32 m0, 134144
    s_add_u32 s10, s9, 860160
    buffer_load_dwordx4 v20, s[44:47], s10 offen lds
    v_mfma_f32_16x16x32_bf16 v[48:51], v[120:123], v[104:107], v[48:51]
    ds_read_b64_tr_b16 v[168:169], v28 offset:64
    ds_read_b64_tr_b16 v[170:171], v28 offset:3904
    ds_read_b64_tr_b16 v[172:173], v28 offset:96
    v_mfma_f32_16x16x32_bf16 v[52:55], v[120:123], v[108:111], v[52:55]
    ds_read_b64_tr_b16 v[174:175], v28 offset:3936
    ds_read_b64_tr_b16 v[176:177], v28 offset:128
    ds_read_b64_tr_b16 v[178:179], v28 offset:3968
    v_mfma_f32_16x16x32_bf16 v[56:59], v[124:127], v[104:107], v[56:59]
    s_mov_b32 m0, 138240
    s_nop 0
    buffer_load_dwordx4 v21, s[44:47], s10 offen lds
    v_mfma_f32_16x16x32_bf16 v[60:63], v[124:127], v[108:111], v[60:63]
    ds_read_b64_tr_b16 v[180:181], v28 offset:160
    ds_read_b64_tr_b16 v[182:183], v28 offset:4000
    ds_read_b64_tr_b16 v[184:185], v28 offset:192
    v_mfma_f32_16x16x32_bf16 v[64:67], v[128:131], v[104:107], v[64:67]
    ds_read_b64_tr_b16 v[186:187], v28 offset:4032
    ds_read_b64_tr_b16 v[188:189], v28 offset:224
    ds_read_b64_tr_b16 v[190:191], v28 offset:4064
    v_mfma_f32_16x16x32_bf16 v[68:71], v[128:131], v[108:111], v[68:71]
    s_mov_b32 m0, 142336
    s_nop 0
    buffer_load_dwordx4 v22, s[44:47], s10 offen lds
    v_mfma_f32_16x16x32_bf16 v[72:75], v[132:135], v[104:107], v[72:75]
    s_mov_b32 m0, 146432
    s_nop 0
    buffer_load_dwordx4 v23, s[44:47], s10 offen lds
    v_mfma_f32_16x16x32_bf16 v[76:79], v[132:135], v[108:111], v[76:79]
    s_waitcnt vmcnt(5) lgkmcnt(0)
    ds_add_u32 v19, v3 offset:144
    v_mfma_f32_16x16x32_bf16 v[80:83], v[136:139], v[104:107], v[80:83]
    s_add_u32 m0, s65, 6144
    s_lshl3_add_u32 s11, s65, 40960
    buffer_load_dwordx4 v11, s[48:51], s11 offen lds
    v_mfma_f32_16x16x32_bf16 v[84:87], v[140:143], v[104:107], v[84:87]
    v_mfma_f32_16x16x32_bf16 v[88:91], v[144:147], v[104:107], v[88:91]
    v_mfma_f32_16x16x32_bf16 v[32:35], v[180:183], v[152:155], v[32:35]
    ds_read_b32 v29, v2 offset:144
    v_mfma_f32_16x16x32_bf16 v[36:39], v[184:187], v[152:155], v[36:39]
    s_waitcnt lgkmcnt(0)
    s_setprio 2
    v_readfirstlane_b32 s76, v29
    s_setprio 0
    s_cmp_lt_u32 s76, 64
    s_cbranch_scc1 Lslow_232
Lback_233:
    ds_read_b128 v[104:107], v26 offset:24576
    ds_read_b128 v[108:111], v26 offset:26624
    ds_read_b64_tr_b16 v[116:117], v28 offset:15360
    v_mfma_f32_16x16x32_bf16 v[40:43], v[160:163], v[148:151], v[40:43]
    ds_read_b64_tr_b16 v[118:119], v28 offset:19200
    ds_read_b64_tr_b16 v[120:121], v28 offset:15392
    ds_read_b64_tr_b16 v[122:123], v28 offset:19232
    v_mfma_f32_16x16x32_bf16 v[44:47], v[160:163], v[152:155], v[44:47]
    s_mov_b32 m0, 103424
    s_add_u32 s10, s9, 983040
    buffer_load_dwordx4 v20, s[44:47], s10 offen lds
    v_mfma_f32_16x16x32_bf16 v[48:51], v[164:167], v[148:151], v[48:51]
    ds_read_b64_tr_b16 v[124:125], v28 offset:15424
    ds_read_b64_tr_b16 v[126:127], v28 offset:19264
    ds_read_b64_tr_b16 v[128:129], v28 offset:15456
    v_mfma_f32_16x16x32_bf16 v[52:55], v[164:167], v[152:155], v[52:55]
    ds_read_b64_tr_b16 v[130:131], v28 offset:19296
    ds_read_b64_tr_b16 v[132:133], v28 offset:15488
    ds_read_b64_tr_b16 v[134:135], v28 offset:19328
    v_mfma_f32_16x16x32_bf16 v[56:59], v[168:171], v[148:151], v[56:59]
    s_mov_b32 m0, 107520
    s_nop 0
    buffer_load_dwordx4 v21, s[44:47], s10 offen lds
    v_mfma_f32_16x16x32_bf16 v[60:63], v[168:171], v[152:155], v[60:63]
    ds_read_b64_tr_b16 v[136:137], v28 offset:15520
    ds_read_b64_tr_b16 v[138:139], v28 offset:19360
    ds_read_b64_tr_b16 v[140:141], v28 offset:15552
    v_mfma_f32_16x16x32_bf16 v[64:67], v[172:175], v[148:151], v[64:67]
    ds_read_b64_tr_b16 v[142:143], v28 offset:19392
    ds_read_b64_tr_b16 v[144:145], v28 offset:15584
    ds_read_b64_tr_b16 v[146:147], v28 offset:19424
    v_mfma_f32_16x16x32_bf16 v[68:71], v[172:175], v[152:155], v[68:71]
    s_mov_b32 m0, 111616
    s_nop 0
    buffer_load_dwordx4 v22, s[44:47], s10 offen lds
    v_mfma_f32_16x16x32_bf16 v[72:75], v[176:179], v[148:151], v[72:75]
    s_mov_b32 m0, 115712
    s_nop 0
    buffer_load_dwordx4 v23, s[44:47], s10 offen lds
    v_mfma_f32_16x16x32_bf16 v[76:79], v[176:179], v[152:155], v[76:79]
    s_waitcnt vmcnt(5) lgkmcnt(0)
    ds_add_u32 v19, v3 offset:144
    v_mfma_f32_16x16x32_bf16 v[80:83], v[180:183], v[148:151], v[80:83]
    s_add_u32 m0, s65, 11264
    s_lshl3_add_u32 s11, s65, 81920
    buffer_load_dwordx4 v11, s[48:51], s11 offen lds
    v_mfma_f32_16x16x32_bf16 v[84:87], v[184:187], v[148:151], v[84:87]
    v_mfma_f32_16x16x32_bf16 v[88:91], v[188:191], v[148:151], v[88:91]
    v_mfma_f32_16x16x32_bf16 v[32:35], v[136:139], v[108:111], v[32:35]
    ds_read_b32 v29, v2 offset:144
    v_mfma_f32_16x16x32_bf16 v[36:39], v[140:143], v[108:111], v[36:39]
    s_waitcnt lgkmcnt(0)
    s_setprio 2
    v_readfirstlane_b32 s76, v29
    s_setprio 0
    s_cmp_lt_u32 s76, 68
    s_cbranch_scc1 Lslow_236
Lback_237:
    ds_read_b128 v[148:151], v27 offset:24576
    ds_read_b128 v[152:155], v27 offset:26624
    ds_read_b64_tr_b16 v[160:161], v28 offset:30720
    v_mfma_f32_16x16x32_bf16 v[40:43], v[116:119], v[104:107], v[40:43]
    ds_read_b64_tr_b16 v[162:163], v28 offset:34560
    ds_read_b64_tr_b16 v[164:165], v28 offset:30752
    ds_read_b64_tr_b16 v[166:167], v28 offset:34592
    v_mfma_f32_16x16x32_bf16 v[44:47], v[116:119], v[108:111], v[44:47]
    s_mov_b32 m0, 118784
    s_add_u32 s10, s9, 1105920
    buffer_load_dwordx4 v20, s[44:47], s10 offen lds
    v_mfma_f32_16x16x32_bf16 v[48:51], v[120:123], v[104:107], v[48:51]
    ds_read_b64_tr_b16 v[168:169], v28 offset:30784
    ds_read_b64_tr_b16 v[170:171], v28 offset:34624
    ds_read_b64_tr_b16 v[172:173], v28 offset:30816
    v_mfma_f32_16x16x32_bf16 v[52:55], v[120:123], v[108:111], v[52:55]
    ds_read_b64_tr_b16 v[174:175], v28 offset:34656
    ds_read_b64_tr_b16 v[176:177], v28 offset:30848
    ds_read_b64_tr_b16 v[178:179], v28 offset:34688
    v_mfma_f32_16x16x32_bf16 v[56:59], v[124:127], v[104:107], v[56:59]
    s_mov_b32 m0, 122880
    s_nop 0
    buffer_load_dwordx4 v21, s[44:47], s10 offen lds
    v_mfma_f32_16x16x32_bf16 v[60:63], v[124:127], v[108:111], v[60:63]
    ds_read_b64_tr_b16 v[180:181], v28 offset:30880
    ds_read_b64_tr_b16 v[182:183], v28 offset:34720
    ds_read_b64_tr_b16 v[184:185], v28 offset:30912
    v_mfma_f32_16x16x32_bf16 v[64:67], v[128:131], v[104:107], v[64:67]
    ds_read_b64_tr_b16 v[186:187], v28 offset:34752
    ds_read_b64_tr_b16 v[188:189], v28 offset:30944
    ds_read_b64_tr_b16 v[190:191], v28 offset:34784
    v_mfma_f32_16x16x32_bf16 v[68:71], v[128:131], v[108:111], v[68:71]
    s_mov_b32 m0, 126976
    s_nop 0
    buffer_load_dwordx4 v22, s[44:47], s10 offen lds
    v_mfma_f32_16x16x32_bf16 v[72:75], v[132:135], v[104:107], v[72:75]
    s_mov_b32 m0, 131072
    s_nop 0
    buffer_load_dwordx4 v23, s[44:47], s10 offen lds
    v_mfma_f32_16x16x32_bf16 v[76:79], v[132:135], v[108:111], v[76:79]
    s_waitcnt vmcnt(5) lgkmcnt(0)
    ds_add_u32 v19, v3 offset:144
    v_mfma_f32_16x16x32_bf16 v[80:83], v[136:139], v[104:107], v[80:83]
    s_add_u32 m0, s65, 16384
    s_lshl3_add_u32 s11, s65, 122880
    buffer_load_dwordx4 v11, s[48:51], s11 offen lds
    v_mfma_f32_16x16x32_bf16 v[84:87], v[140:143], v[104:107], v[84:87]
    v_mfma_f32_16x16x32_bf16 v[88:91], v[144:147], v[104:107], v[88:91]
    v_mfma_f32_16x16x32_bf16 v[32:35], v[180:183], v[152:155], v[32:35]
    ds_read_b32 v29, v2 offset:144
    v_mfma_f32_16x16x32_bf16 v[36:39], v[184:187], v[152:155], v[36:39]
    s_waitcnt lgkmcnt(0)
    s_setprio 2
    v_readfirstlane_b32 s76, v29
    s_setprio 0
    s_cmp_lt_u32 s76, 72
    s_cbranch_scc1 Lslow_240
Lback_241:
    ds_read_b128 v[104:107], v26 offset:32768
    ds_read_b128 v[108:111], v26 offset:34816
    ds_read_b64_tr_b16 v[116:117], v28 offset:0
    v_mfma_f32_16x16x32_bf16 v[40:43], v[160:163], v[148:151], v[40:43]
    ds_read_b64_tr_b16 v[118:119], v28 offset:3840
    ds_read_b64_tr_b16 v[120:121], v28 offset:32
    ds_read_b64_tr_b16 v[122:123], v28 offset:3872
    v_mfma_f32_16x16x32_bf16 v[44:47], v[160:163], v[152:155], v[44:47]
    ds_read_b64_tr_b16 v[124:125], v28 offset:64
    ds_read_b64_tr_b16 v[126:127], v28 offset:3904
    ds_read_b64_tr_b16 v[128:129], v28 offset:96
    v_mfma_f32_16x16x32_bf16 v[48:51], v[164:167], v[148:151], v[48:51]
    ds_read_b64_tr_b16 v[130:131], v28 offset:3936
    ds_read_b64_tr_b16 v[132:133], v28 offset:128
    ds_read_b64_tr_b16 v[134:135], v28 offset:3968
    v_mfma_f32_16x16x32_bf16 v[52:55], v[164:167], v[152:155], v[52:55]
    ds_read_b64_tr_b16 v[136:137], v28 offset:160
    ds_read_b64_tr_b16 v[138:139], v28 offset:4000
    ds_read_b64_tr_b16 v[140:141], v28 offset:192
    v_mfma_f32_16x16x32_bf16 v[56:59], v[168:171], v[148:151], v[56:59]
    ds_read_b64_tr_b16 v[142:143], v28 offset:4032
    ds_read_b64_tr_b16 v[144:145], v28 offset:224
    ds_read_b64_tr_b16 v[146:147], v28 offset:4064
    v_mfma_f32_16x16x32_bf16 v[60:63], v[168:171], v[152:155], v[60:63]
    s_waitcnt vmcnt(1) lgkmcnt(0)
    ds_add_u32 v19, v3 offset:144
    v_mfma_f32_16x16x32_bf16 v[64:67], v[172:175], v[148:151], v[64:67]
    s_add_u32 m0, s65, 21504
    s_lshl3_add_u32 s11, s65, 163840
    buffer_load_dwordx4 v11, s[48:51], s11 offen lds
    v_mfma_f32_16x16x32_bf16 v[68:71], v[172:175], v[152:155], v[68:71]
    v_mfma_f32_16x16x32_bf16 v[72:75], v[176:179], v[148:151], v[72:75]
    v_mfma_f32_16x16x32_bf16 v[76:79], v[176:179], v[152:155], v[76:79]
    v_mfma_f32_16x16x32_bf16 v[80:83], v[180:183], v[148:151], v[80:83]
    v_mfma_f32_16x16x32_bf16 v[84:87], v[184:187], v[148:151], v[84:87]
    v_mfma_f32_16x16x32_bf16 v[88:91], v[188:191], v[148:151], v[88:91]
    v_mfma_f32_16x16x32_bf16 v[32:35], v[136:139], v[108:111], v[32:35]
    ds_read_b32 v29, v2 offset:144
    v_mfma_f32_16x16x32_bf16 v[36:39], v[140:143], v[108:111], v[36:39]
    s_waitcnt lgkmcnt(0)
    s_setprio 2
    v_readfirstlane_b32 s76, v29
    s_setprio 0
    s_cmp_lt_u32 s76, 76
    s_cbranch_scc1 Lslow_244
Lback_245:
    ds_read_b128 v[148:151], v27 offset:32768
    ds_read_b128 v[152:155], v27 offset:34816
    ds_read_b64_tr_b16 v[160:161], v28 offset:15360
    v_mfma_f32_16x16x32_bf16 v[40:43], v[116:119], v[104:107], v[40:43]
    ds_read_b64_tr_b16 v[162:163], v28 offset:19200
    ds_read_b64_tr_b16 v[164:165], v28 offset:15392
    ds_read_b64_tr_b16 v[166:167], v28 offset:19232
    v_mfma_f32_16x16x32_bf16 v[44:47], v[116:119], v[108:111], v[44:47]
    ds_read_b64_tr_b16 v[168:169], v28 offset:15424
    ds_read_b64_tr_b16 v[170:171], v28 offset:19264
    ds_read_b64_tr_b16 v[172:173], v28 offset:15456
    v_mfma_f32_16x16x32_bf16 v[48:51], v[120:123], v[104:107], v[48:51]
    ds_read_b64_tr_b16 v[174:175], v28 offset:19296
    ds_read_b64_tr_b16 v[176:177], v28 offset:15488
    ds_read_b64_tr_b16 v[178:179], v28 offset:19328
    v_mfma_f32_16x16x32_bf16 v[52:55], v[120:123], v[108:111], v[52:55]
    ds_read_b64_tr_b16 v[180:181], v28 offset:15520
    ds_read_b64_tr_b16 v[182:183], v28 offset:19360
    ds_read_b64_tr_b16 v[184:185], v28 offset:15552
    v_mfma_f32_16x16x32_bf16 v[56:59], v[124:127], v[104:107], v[56:59]
    ds_read_b64_tr_b16 v[186:187], v28 offset:19392
    ds_read_b64_tr_b16 v[188:189], v28 offset:15584
    ds_read_b64_tr_b16 v[190:191], v28 offset:19424
    v_mfma_f32_16x16x32_bf16 v[60:63], v[124:127], v[108:111], v[60:63]
    s_waitcnt lgkmcnt(0)
    ds_add_u32 v19, v3 offset:124
    v_mfma_f32_16x16x32_bf16 v[64:67], v[128:131], v[104:107], v[64:67]
    s_add_u32 m0, s65, 26624
    s_lshl3_add_u32 s11, s65, 204800
    buffer_load_dwordx4 v11, s[48:51], s11 offen lds
    v_mfma_f32_16x16x32_bf16 v[68:71], v[128:131], v[108:111], v[68:71]
    v_mfma_f32_16x16x32_bf16 v[72:75], v[132:135], v[104:107], v[72:75]
    v_mfma_f32_16x16x32_bf16 v[76:79], v[132:135], v[108:111], v[76:79]
    v_mfma_f32_16x16x32_bf16 v[80:83], v[136:139], v[104:107], v[80:83]
    v_mfma_f32_16x16x32_bf16 v[84:87], v[140:143], v[104:107], v[84:87]
    v_mfma_f32_16x16x32_bf16 v[88:91], v[144:147], v[104:107], v[88:91]
    s_lshl3_add_u32 s84, s4, s5
    s_mul_i32 s85, s84, 5120
    s_add_u32 s85, s85, 16777216
    s_add_u32 s83, s85, 4096
    s_lshl_b32 s84, s84, 7
    s_add_u32 s84, s84, 786432
    s_mov_b32 s86, s39
    s_and_b32 s87, s4, 3
    s_cmp_eq_u32 s87, 3
    s_cselect_b32 s39, 0, s39
    v_mfma_f32_16x16x32_bf16 v[32:35], v[180:183], v[152:155], v[32:35]
    v_mfma_f32_16x16x32_bf16 v[36:39], v[184:187], v[152:155], v[36:39]
    ds_read_b32 v29, v2 offset:124
    v_mfma_f32_16x16x32_bf16 v[40:43], v[160:163], v[148:151], v[40:43]
    s_waitcnt lgkmcnt(0)
    s_setprio 2
    v_readfirstlane_b32 s76, v29
    s_setprio 0
    s_cmp_lt_u32 s76, 4
    s_cbranch_scc1 Lslow_248
Lback_249:
    v_mfma_f32_16x16x32_bf16 v[44:47], v[160:163], v[152:155], v[44:47]
    s_setprio 2
    v_cvt_pk_bf16_f32 v32, v32, v33
    v_cvt_pk_bf16_f32 v33, v34, v35
    s_setprio 0
    ds_write_b64 v205, v[32:33] offset:20480
    buffer_store_dwordx2 v[32:33], v224, s[72:75], s85 offen offset:0 sc1
    v_mfma_f32_16x16x32_bf16 v[48:51], v[164:167], v[148:151], v[48:51]
    s_setprio 2
    v_cvt_pk_bf16_f32 v36, v36, v37
    v_cvt_pk_bf16_f32 v37, v38, v39
    s_setprio 0
    ds_write_b64 v205, v[36:37] offset:20512
    buffer_store_dwordx2 v[36:37], v224, s[72:75], s85 offen offset:512 sc1
    v_mfma_f32_16x16x32_bf16 v[52:55], v[164:167], v[152:155], v[52:55]
    s_setprio 2
    v_cvt_pk_bf16_f32 v40, v40, v41
    v_cvt_pk_bf16_f32 v41, v42, v43
    s_setprio 0
    ds_write_b64 v205, v[40:41] offset:5120
    v_mfma_f32_16x16x32_bf16 v[56:59], v[168:171], v[148:151], v[56:59]
    s_setprio 2
    v_cvt_pk_bf16_f32 v44, v44, v45
    v_cvt_pk_bf16_f32 v45, v46, v47
    s_setprio 0
    ds_write_b64 v205, v[44:45] offset:7680
    v_mfma_f32_16x16x32_bf16 v[60:63], v[168:171], v[152:155], v[60:63]
    s_setprio 2
    v_cvt_pk_bf16_f32 v48, v48, v49
    v_cvt_pk_bf16_f32 v49, v50, v51
    s_setprio 0
    ds_write_b64 v205, v[48:49] offset:5152
    s_setprio 2
    v_mov_b32 v4, 0
    v_mov_b32 v5, s6
    s_setprio 0
    s_mov_b64 exec, 1
    s_waitcnt vmcnt(0)
    s_cmp_eq_u32 s39, 0
    s_cbranch_scc1 Lxs_252
    buffer_store_dword v5, v4, s[72:75], s84 offen offset:0
Lxb_253:
    s_mov_b64 exec, -1
    v_mfma_f32_16x16x32_bf16 v[64:67], v[172:175], v[148:151], v[64:67]
    s_setprio 2
    v_cvt_pk_bf16_f32 v52, v52, v53
    v_cvt_pk_bf16_f32 v53, v54, v55
    s_setprio 0
    ds_write_b64 v205, v[52:53] offset:7712
    v_mfma_f32_16x16x32_bf16 v[68:71], v[172:175], v[152:155], v[68:71]
    s_setprio 2
    v_cvt_pk_bf16_f32 v56, v56, v57
    v_cvt_pk_bf16_f32 v57, v58, v59
    s_setprio 0
    ds_write_b64 v205, v[56:57] offset:5184
    v_mfma_f32_16x16x32_bf16 v[72:75], v[176:179], v[148:151], v[72:75]
    s_setprio 2
    v_cvt_pk_bf16_f32 v60, v60, v61
    v_cvt_pk_bf16_f32 v61, v62, v63
    s_setprio 0
    ds_write_b64 v205, v[60:61] offset:7744
    v_mfma_f32_16x16x32_bf16 v[76:79], v[176:179], v[152:155], v[76:79]
    s_setprio 2
    v_cvt_pk_bf16_f32 v64, v64, v65
    v_cvt_pk_bf16_f32 v65, v66, v67
    s_setprio 0
    ds_write_b64 v205, v[64:65] offset:5216
    v_mfma_f32_16x16x32_bf16 v[80:83], v[180:183], v[148:151], v[80:83]
    s_setprio 2
    v_cvt_pk_bf16_f32 v68, v68, v69
    v_cvt_pk_bf16_f32 v69, v70, v71
    s_setprio 0
    ds_write_b64 v205, v[68:69] offset:7776
    v_mfma_f32_16x16x32_bf16 v[84:87], v[184:187], v[148:151], v[84:87]
    s_setprio 2
    v_cvt_pk_bf16_f32 v72, v72, v73
    v_cvt_pk_bf16_f32 v73, v74, v75
    s_setprio 0
    ds_write_b64 v205, v[72:73] offset:5248
    v_mfma_f32_16x16x32_bf16 v[88:91], v[188:191], v[148:151], v[88:91]
    s_setprio 2
    v_cvt_pk_bf16_f32 v76, v76, v77
    v_cvt_pk_bf16_f32 v77, v78, v79
    s_setprio 0
    ds_write_b64 v205, v[76:77] offset:7808
    s_setprio 2
    v_cvt_pk_bf16_f32 v80, v80, v81
    v_cvt_pk_bf16_f32 v81, v82, v83
    s_setprio 0
    ds_write_b64 v205, v[80:81] offset:17920
    s_setprio 2
    v_cvt_pk_bf16_f32 v84, v84, v85
    v_cvt_pk_bf16_f32 v85, v86, v87
    s_setprio 0
    ds_write_b64 v205, v[84:85] offset:17952
    s_setprio 2
    v_cvt_pk_bf16_f32 v88, v88, v89
    v_cvt_pk_bf16_f32 v89, v90, v91
    s_setprio 0
    ds_write_b64 v205, v[88:89] offset:17984
    ds_add_u32 v19, v3 offset:564
    s_mov_b32 s39, s86
    s_waitcnt lgkmcnt(0)
    s_add_u32 m0, s65, 31744
    s_lshl3_add_u32 s11, s65, 245760
    buffer_load_dwordx4 v11, s[48:51], s11 offen lds
    s_add_u32 m0, s65, 36864
    s_lshl3_add_u32 s11, s65, 286720
    buffer_load_dwordx4 v11, s[48:51], s11 offen lds
    s_branch L_bg_done
L_bg2:
    ds_read_b128 v[104:107], v24 offset:0
    ds_read_b128 v[108:111], v24 offset:2048
    ds_read_b64_tr_b16 v[116:117], v28 offset:224
    ds_read_b64_tr_b16 v[118:119], v28 offset:4064
    ds_read_b64_tr_b16 v[120:121], v28 offset:256
    ds_read_b64_tr_b16 v[122:123], v28 offset:4096
    ds_read_b64_tr_b16 v[124:125], v28 offset:288
    ds_read_b64_tr_b16 v[126:127], v28 offset:4128
    ds_read_b64_tr_b16 v[128:129], v28 offset:320
    ds_read_b64_tr_b16 v[130:131], v28 offset:4160
    ds_read_b64_tr_b16 v[132:133], v28 offset:352
    ds_read_b64_tr_b16 v[134:135], v28 offset:4192
    ds_read_b64_tr_b16 v[136:137], v28 offset:384
    ds_read_b64_tr_b16 v[138:139], v28 offset:4224
    ds_read_b64_tr_b16 v[140:141], v28 offset:416
    ds_read_b64_tr_b16 v[142:143], v28 offset:4256
    ds_read_b64_tr_b16 v[144:145], v28 offset:448
    ds_read_b64_tr_b16 v[146:147], v28 offset:4288
    ds_read_b32 v9, v2 offset:632
    ds_read_b32 v7, v2 offset:112
    s_mov_b32 s48, s20
    s_mov_b32 s49, s21
    s_mov_b32 s50, 819200
    s_mov_b32 s51, 0x20000
    s_mov_b32 s60, s30
    s_mov_b32 s61, s31
    s_mov_b32 s62, 819200
    s_mov_b32 s63, 0x20000
    s_waitcnt lgkmcnt(0)
    v_mfma_f32_16x16x32_bf16 v[32:35], v[116:119], v[108:111], 0
    s_mov_b32 m0, 119808
    s_add_u32 s10, s8, 122880
    buffer_load_dwordx4 v20, s[44:47], s10 offen lds
    v_mfma_f32_16x16x32_bf16 v[36:39], v[120:123], v[104:107], 0
    s_mov_b32 m0, 123904
    s_nop 0
    buffer_load_dwordx4 v21, s[44:47], s10 offen lds
    v_mfma_f32_16x16x32_bf16 v[40:43], v[120:123], v[108:111], 0
    s_mov_b32 m0, 128000
    s_nop 0
    buffer_load_dwordx4 v22, s[44:47], s10 offen lds
    v_mfma_f32_16x16x32_bf16 v[44:47], v[124:127], v[104:107], 0
    s_mov_b32 m0, 132096
    s_nop 0
    buffer_load_dwordx4 v23, s[44:47], s10 offen lds
    v_mfma_f32_16x16x32_bf16 v[48:51], v[124:127], v[108:111], 0
    s_mov_b32 m0, 135168
    s_add_u32 s10, s8, 245760
    buffer_load_dwordx4 v20, s[44:47], s10 offen lds
    v_mfma_f32_16x16x32_bf16 v[52:55], v[128:131], v[104:107], 0
    s_mov_b32 m0, 139264
    s_nop 0
    buffer_load_dwordx4 v21, s[44:47], s10 offen lds
    v_mfma_f32_16x16x32_bf16 v[56:59], v[128:131], v[108:111], 0
    s_mov_b32 m0, 143360
    s_nop 0
    buffer_load_dwordx4 v22, s[44:47], s10 offen lds
    v_mfma_f32_16x16x32_bf16 v[60:63], v[132:135], v[104:107], 0
    s_mov_b32 m0, 147456
    s_nop 0
    buffer_load_dwordx4 v23, s[44:47], s10 offen lds
    s_setprio 2
    v_readfirstlane_b32 s6, v9
    v_readfirstlane_b32 s39, v7
    s_setprio 0
    v_mfma_f32_16x16x32_bf16 v[64:67], v[132:135], v[108:111], 0
    v_mfma_f32_16x16x32_bf16 v[68:71], v[136:139], v[104:107], 0
    s_waitcnt vmcnt(4) lgkmcnt(0)
    ds_add_u32 v19, v3 offset:144
    v_mfma_f32_16x16x32_bf16 v[72:75], v[136:139], v[108:111], 0
    ds_read_b32 v29, v2 offset:144
    v_mfma_f32_16x16x32_bf16 v[76:79], v[140:143], v[104:107], 0
    s_waitcnt lgkmcnt(0)
    s_setprio 2
    v_readfirstlane_b32 s76, v29
    s_setprio 0
    s_cmp_lt_u32 s76, 4
    s_cbranch_scc1 Lslow_254
Lback_255:
    ds_read_b128 v[148:151], v25 offset:0
    ds_read_b128 v[152:155], v25 offset:2048
    ds_read_b64_tr_b16 v[160:161], v28 offset:15584
    v_mfma_f32_16x16x32_bf16 v[80:83], v[140:143], v[108:111], 0
    ds_read_b64_tr_b16 v[162:163], v28 offset:19424
    ds_read_b64_tr_b16 v[164:165], v28 offset:15616
    ds_read_b64_tr_b16 v[166:167], v28 offset:19456
    v_mfma_f32_16x16x32_bf16 v[84:87], v[144:147], v[104:107], 0
    s_mov_b32 m0, 104448
    s_add_u32 s10, s8, 368640
    buffer_load_dwordx4 v20, s[44:47], s10 offen lds
    v_mfma_f32_16x16x32_bf16 v[88:91], v[144:147], v[108:111], 0
    ds_read_b64_tr_b16 v[168:169], v28 offset:15648
    ds_read_b64_tr_b16 v[170:171], v28 offset:19488
    ds_read_b64_tr_b16 v[172:173], v28 offset:15680
    ds_read_b64_tr_b16 v[174:175], v28 offset:19520
    ds_read_b64_tr_b16 v[176:177], v28 offset:15712
    ds_read_b64_tr_b16 v[178:179], v28 offset:19552
    s_mov_b32 m0, 108544
    s_nop 0
    buffer_load_dwordx4 v21, s[44:47], s10 offen lds
    ds_read_b64_tr_b16 v[180:181], v28 offset:15744
    ds_read_b64_tr_b16 v[182:183], v28 offset:19584
    ds_read_b64_tr_b16 v[184:185], v28 offset:15776
    ds_read_b64_tr_b16 v[186:187], v28 offset:19616
    ds_read_b64_tr_b16 v[188:189], v28 offset:15808
    ds_read_b64_tr_b16 v[190:191], v28 offset:19648
    s_mov_b32 m0, 112640
    s_nop 0
    buffer_load_dwordx4 v22, s[44:47], s10 offen lds
    s_mov_b32 m0, 116736
    s_nop 0
    buffer_load_dwordx4 v23, s[44:47], s10 offen lds
    s_waitcnt vmcnt(4) lgkmcnt(0)
    ds_add_u32 v19, v3 offset:144
    v_mfma_f32_16x16x32_bf16 v[32:35], v[160:163], v[152:155], v[32:35]
    ds_read_b32 v29, v2 offset:144
    v_mfma_f32_16x16x32_bf16 v[36:39], v[164:167], v[148:151], v[36:39]
    s_waitcnt lgkmcnt(0)
    s_setprio 2
    v_readfirstlane_b32 s76, v29
    s_setprio 0
    s_cmp_lt_u32 s76, 8
    s_cbranch_scc1 Lslow_258
Lback_259:
    ds_read_b128 v[104:107], v24 offset:8192
    ds_read_b128 v[108:111], v24 offset:10240
    ds_read_b64_tr_b16 v[116:117], v28 offset:30944
    v_mfma_f32_16x16x32_bf16 v[40:43], v[164:167], v[152:155], v[40:43]
    ds_read_b64_tr_b16 v[118:119], v28 offset:34784
    ds_read_b64_tr_b16 v[120:121], v28 offset:30976
    ds_read_b64_tr_b16 v[122:123], v28 offset:34816
    v_mfma_f32_16x16x32_bf16 v[44:47], v[168:171], v[148:151], v[44:47]
    s_mov_b32 m0, 119808
    s_add_u32 s10, s8, 491520
    buffer_load_dwordx4 v20, s[44:47], s10 offen lds
    v_mfma_f32_16x16x32_bf16 v[48:51], v[168:171], v[152:155], v[48:51]
    ds_read_b64_tr_b16 v[124:125], v28 offset:31008
    ds_read_b64_tr_b16 v[126:127], v28 offset:34848
    ds_read_b64_tr_b16 v[128:129], v28 offset:31040
    v_mfma_f32_16x16x32_bf16 v[52:55], v[172:175], v[148:151], v[52:55]
    ds_read_b64_tr_b16 v[130:131], v28 offset:34880
    ds_read_b64_tr_b16 v[132:133], v28 offset:31072
    ds_read_b64_tr_b16 v[134:135], v28 offset:34912
    v_mfma_f32_16x16x32_bf16 v[56:59], v[172:175], v[152:155], v[56:59]
    s_mov_b32 m0, 123904
    s_nop 0
    buffer_load_dwordx4 v21, s[44:47], s10 offen lds
    v_mfma_f32_16x16x32_bf16 v[60:63], v[176:179], v[148:151], v[60:63]
    ds_read_b64_tr_b16 v[136:137], v28 offset:31104
    ds_read_b64_tr_b16 v[138:139], v28 offset:34944
    ds_read_b64_tr_b16 v[140:141], v28 offset:31136
    v_mfma_f32_16x16x32_bf16 v[64:67], v[176:179], v[152:155], v[64:67]
    ds_read_b64_tr_b16 v[142:143], v28 offset:34976
    ds_read_b64_tr_b16 v[144:145], v28 offset:31168
    ds_read_b64_tr_b16 v[146:147], v28 offset:35008
    v_mfma_f32_16x16x32_bf16 v[68:71], v[180:183], v[148:151], v[68:71]
    s_mov_b32 m0, 128000
    s_nop 0
    buffer_load_dwordx4 v22, s[44:47], s10 offen lds
    v_mfma_f32_16x16x32_bf16 v[72:75], v[180:183], v[152:155], v[72:75]
    s_mov_b32 m0, 132096
    s_nop 0
    buffer_load_dwordx4 v23, s[44:47], s10 offen lds
    v_mfma_f32_16x16x32_bf16 v[76:79], v[184:187], v[148:151], v[76:79]
    s_waitcnt vmcnt(4) lgkmcnt(0)
    ds_add_u32 v19, v3 offset:144
    v_mfma_f32_16x16x32_bf16 v[80:83], v[184:187], v[152:155], v[80:83]
    s_mov_b32 m0, 83968
    s_mov_b32 s11, 655360
    buffer_load_dwordx4 v12, s[48:51], s11 offen lds
    v_mfma_f32_16x16x32_bf16 v[84:87], v[188:191], v[148:151], v[84:87]
    v_mfma_f32_16x16x32_bf16 v[88:91], v[188:191], v[152:155], v[88:91]
    v_mfma_f32_16x16x32_bf16 v[32:35], v[116:119], v[108:111], v[32:35]
    ds_read_b32 v29, v2 offset:144
    v_mfma_f32_16x16x32_bf16 v[36:39], v[120:123], v[104:107], v[36:39]
    s_waitcnt lgkmcnt(0)
    s_setprio 2
    v_readfirstlane_b32 s76, v29
    s_setprio 0
    s_cmp_lt_u32 s76, 12
    s_cbranch_scc1 Lslow_262
Lback_263:
    ds_read_b128 v[148:151], v25 offset:8192
    ds_read_b128 v[152:155], v25 offset:10240
    ds_read_b64_tr_b16 v[160:161], v28 offset:224
    v_mfma_f32_16x16x32_bf16 v[40:43], v[120:123], v[108:111], v[40:43]
    ds_read_b64_tr_b16 v[162:163], v28 offset:4064
    ds_read_b64_tr_b16 v[164:165], v28 offset:256
    ds_read_b64_tr_b16 v[166:167], v28 offset:4096
    v_mfma_f32_16x16x32_bf16 v[44:47], v[124:127], v[104:107], v[44:47]
    s_mov_b32 m0, 135168
    s_add_u32 s10, s8, 614400
    buffer_load_dwordx4 v20, s[44:47], s10 offen lds
    v_mfma_f32_16x16x32_bf16 v[48:51], v[124:127], v[108:111], v[48:51]
    ds_read_b64_tr_b16 v[168:169], v28 offset:288
    ds_read_b64_tr_b16 v[170:171], v28 offset:4128
    ds_read_b64_tr_b16 v[172:173], v28 offset:320
    v_mfma_f32_16x16x32_bf16 v[52:55], v[128:131], v[104:107], v[52:55]
    ds_read_b64_tr_b16 v[174:175], v28 offset:4160
    ds_read_b64_tr_b16 v[176:177], v28 offset:352
    ds_read_b64_tr_b16 v[178:179], v28 offset:4192
    v_mfma_f32_16x16x32_bf16 v[56:59], v[128:131], v[108:111], v[56:59]
    s_mov_b32 m0, 139264
    s_nop 0
    buffer_load_dwordx4 v21, s[44:47], s10 offen lds
    v_mfma_f32_16x16x32_bf16 v[60:63], v[132:135], v[104:107], v[60:63]
    ds_read_b64_tr_b16 v[180:181], v28 offset:384
    ds_read_b64_tr_b16 v[182:183], v28 offset:4224
    ds_read_b64_tr_b16 v[184:185], v28 offset:416
    v_mfma_f32_16x16x32_bf16 v[64:67], v[132:135], v[108:111], v[64:67]
    ds_read_b64_tr_b16 v[186:187], v28 offset:4256
    ds_read_b64_tr_b16 v[188:189], v28 offset:448
    ds_read_b64_tr_b16 v[190:191], v28 offset:4288
    v_mfma_f32_16x16x32_bf16 v[68:71], v[136:139], v[104:107], v[68:71]
    s_mov_b32 m0, 143360
    s_nop 0
    buffer_load_dwordx4 v22, s[44:47], s10 offen lds
    v_mfma_f32_16x16x32_bf16 v[72:75], v[136:139], v[108:111], v[72:75]
    s_mov_b32 m0, 147456
    s_nop 0
    buffer_load_dwordx4 v23, s[44:47], s10 offen lds
    v_mfma_f32_16x16x32_bf16 v[76:79], v[140:143], v[104:107], v[76:79]
    s_waitcnt vmcnt(5) lgkmcnt(0)
    ds_add_u32 v19, v3 offset:144
    v_mfma_f32_16x16x32_bf16 v[80:83], v[140:143], v[108:111], v[80:83]
    s_mov_b32 m0, 89088
    s_mov_b32 s11, 696320
    buffer_load_dwordx4 v12, s[48:51], s11 offen lds
    v_mfma_f32_16x16x32_bf16 v[84:87], v[144:147], v[104:107], v[84:87]
    v_mfma_f32_16x16x32_bf16 v[88:91], v[144:147], v[108:111], v[88:91]
    v_mfma_f32_16x16x32_bf16 v[32:35], v[160:163], v[152:155], v[32:35]
    ds_read_b32 v29, v2 offset:144
    v_mfma_f32_16x16x32_bf16 v[36:39], v[164:167], v[148:151], v[36:39]
    s_waitcnt lgkmcnt(0)
    s_setprio 2
    v_readfirstlane_b32 s76, v29
    s_setprio 0
    s_cmp_lt_u32 s76, 16
    s_cbranch_scc1 Lslow_266
Lback_267:
    ds_read_b128 v[104:107], v24 offset:16384
    ds_read_b128 v[108:111], v24 offset:18432
    ds_read_b64_tr_b16 v[116:117], v28 offset:15584
    v_mfma_f32_16x16x32_bf16 v[40:43], v[164:167], v[152:155], v[40:43]
    ds_read_b64_tr_b16 v[118:119], v28 offset:19424
    ds_read_b64_tr_b16 v[120:121], v28 offset:15616
    ds_read_b64_tr_b16 v[122:123], v28 offset:19456
    v_mfma_f32_16x16x32_bf16 v[44:47], v[168:171], v[148:151], v[44:47]
    s_mov_b32 m0, 104448
    s_add_u32 s10, s8, 737280
    buffer_load_dwordx4 v20, s[44:47], s10 offen lds
    v_mfma_f32_16x16x32_bf16 v[48:51], v[168:171], v[152:155], v[48:51]
    ds_read_b64_tr_b16 v[124:125], v28 offset:15648
    ds_read_b64_tr_b16 v[126:127], v28 offset:19488
    ds_read_b64_tr_b16 v[128:129], v28 offset:15680
    v_mfma_f32_16x16x32_bf16 v[52:55], v[172:175], v[148:151], v[52:55]
    ds_read_b64_tr_b16 v[130:131], v28 offset:19520
    ds_read_b64_tr_b16 v[132:133], v28 offset:15712
    ds_read_b64_tr_b16 v[134:135], v28 offset:19552
    v_mfma_f32_16x16x32_bf16 v[56:59], v[172:175], v[152:155], v[56:59]
    s_mov_b32 m0, 108544
    s_nop 0
    buffer_load_dwordx4 v21, s[44:47], s10 offen lds
    v_mfma_f32_16x16x32_bf16 v[60:63], v[176:179], v[148:151], v[60:63]
    ds_read_b64_tr_b16 v[136:137], v28 offset:15744
    ds_read_b64_tr_b16 v[138:139], v28 offset:19584
    ds_read_b64_tr_b16 v[140:141], v28 offset:15776
    v_mfma_f32_16x16x32_bf16 v[64:67], v[176:179], v[152:155], v[64:67]
    ds_read_b64_tr_b16 v[142:143], v28 offset:19616
    ds_read_b64_tr_b16 v[144:145], v28 offset:15808
    ds_read_b64_tr_b16 v[146:147], v28 offset:19648
    v_mfma_f32_16x16x32_bf16 v[68:71], v[180:183], v[148:151], v[68:71]
    s_mov_b32 m0, 112640
    s_nop 0
    buffer_load_dwordx4 v22, s[44:47], s10 offen lds
    v_mfma_f32_16x16x32_bf16 v[72:75], v[180:183], v[152:155], v[72:75]
    s_mov_b32 m0, 116736
    s_nop 0
    buffer_load_dwordx4 v23, s[44:47], s10 offen lds
    v_mfma_f32_16x16x32_bf16 v[76:79], v[184:187], v[148:151], v[76:79]
    s_waitcnt vmcnt(5) lgkmcnt(0)
    ds_add_u32 v19, v3 offset:144
    v_mfma_f32_16x16x32_bf16 v[80:83], v[184:187], v[152:155], v[80:83]
    s_mov_b32 m0, 94208
    s_mov_b32 s11, 737280
    buffer_load_dwordx4 v12, s[48:51], s11 offen lds
    v_mfma_f32_16x16x32_bf16 v[84:87], v[188:191], v[148:151], v[84:87]
    v_mfma_f32_16x16x32_bf16 v[88:91], v[188:191], v[152:155], v[88:91]
    v_mfma_f32_16x16x32_bf16 v[32:35], v[116:119], v[108:111], v[32:35]
    ds_read_b32 v29, v2 offset:144
    v_mfma_f32_16x16x32_bf16 v[36:39], v[120:123], v[104:107], v[36:39]
    s_waitcnt lgkmcnt(0)
    s_setprio 2
    v_readfirstlane_b32 s76, v29
    s_setprio 0
    s_cmp_lt_u32 s76, 20
    s_cbranch_scc1 Lslow_270
Lback_271:
    ds_read_b128 v[148:151], v25 offset:16384
    ds_read_b128 v[152:155], v25 offset:18432
    ds_read_b64_tr_b16 v[160:161], v28 offset:30944
    v_mfma_f32_16x16x32_bf16 v[40:43], v[120:123], v[108:111], v[40:43]
    ds_read_b64_tr_b16 v[162:163], v28 offset:34784
    ds_read_b64_tr_b16 v[164:165], v28 offset:30976
    ds_read_b64_tr_b16 v[166:167], v28 offset:34816
    v_mfma_f32_16x16x32_bf16 v[44:47], v[124:127], v[104:107], v[44:47]
    s_mov_b32 m0, 119808
    s_add_u32 s10, s8, 860160
    buffer_load_dwordx4 v20, s[44:47], s10 offen lds
    v_mfma_f32_16x16x32_bf16 v[48:51], v[124:127], v[108:111], v[48:51]
    ds_read_b64_tr_b16 v[168:169], v28 offset:31008
    ds_read_b64_tr_b16 v[170:171], v28 offset:34848
    ds_read_b64_tr_b16 v[172:173], v28 offset:31040
    v_mfma_f32_16x16x32_bf16 v[52:55], v[128:131], v[104:107], v[52:55]
    ds_read_b64_tr_b16 v[174:175], v28 offset:34880
    ds_read_b64_tr_b16 v[176:177], v28 offset:31072
    ds_read_b64_tr_b16 v[178:179], v28 offset:34912
    v_mfma_f32_16x16x32_bf16 v[56:59], v[128:131], v[108:111], v[56:59]
    s_mov_b32 m0, 123904
    s_nop 0
    buffer_load_dwordx4 v21, s[44:47], s10 offen lds
    v_mfma_f32_16x16x32_bf16 v[60:63], v[132:135], v[104:107], v[60:63]
    ds_read_b64_tr_b16 v[180:181], v28 offset:31104
    ds_read_b64_tr_b16 v[182:183], v28 offset:34944
    ds_read_b64_tr_b16 v[184:185], v28 offset:31136
    v_mfma_f32_16x16x32_bf16 v[64:67], v[132:135], v[108:111], v[64:67]
    ds_read_b64_tr_b16 v[186:187], v28 offset:34976
    ds_read_b64_tr_b16 v[188:189], v28 offset:31168
    ds_read_b64_tr_b16 v[190:191], v28 offset:35008
    v_mfma_f32_16x16x32_bf16 v[68:71], v[136:139], v[104:107], v[68:71]
    s_mov_b32 m0, 128000
    s_nop 0
    buffer_load_dwordx4 v22, s[44:47], s10 offen lds
    v_mfma_f32_16x16x32_bf16 v[72:75], v[136:139], v[108:111], v[72:75]
    s_mov_b32 m0, 132096
    s_nop 0
    buffer_load_dwordx4 v23, s[44:47], s10 offen lds
    v_mfma_f32_16x16x32_bf16 v[76:79], v[140:143], v[104:107], v[76:79]
    s_waitcnt vmcnt(5) lgkmcnt(0)
    ds_add_u32 v19, v3 offset:144
    v_mfma_f32_16x16x32_bf16 v[80:83], v[140:143], v[108:111], v[80:83]
    s_mov_b32 m0, 99328
    s_mov_b32 s11, 778240
    buffer_load_dwordx4 v12, s[48:51], s11 offen lds
    v_mfma_f32_16x16x32_bf16 v[84:87], v[144:147], v[104:107], v[84:87]
    v_mfma_f32_16x16x32_bf16 v[88:91], v[144:147], v[108:111], v[88:91]
    v_mfma_f32_16x16x32_bf16 v[32:35], v[160:163], v[152:155], v[32:35]
    ds_read_b32 v29, v2 offset:144
    v_mfma_f32_16x16x32_bf16 v[36:39], v[164:167], v[148:151], v[36:39]
    s_waitcnt lgkmcnt(0)
    s_setprio 2
    v_readfirstlane_b32 s76, v29
    s_setprio 0
    s_cmp_lt_u32 s76, 24
    s_cbranch_scc1 Lslow_274
Lback_275:
    ds_read_b128 v[104:107], v24 offset:24576
    ds_read_b128 v[108:111], v24 offset:26624
    ds_read_b64_tr_b16 v[116:117], v28 offset:224
    v_mfma_f32_16x16x32_bf16 v[40:43], v[164:167], v[152:155], v[40:43]
    ds_read_b64_tr_b16 v[118:119], v28 offset:4064
    ds_read_b64_tr_b16 v[120:121], v28 offset:256
    ds_read_b64_tr_b16 v[122:123], v28 offset:4096
    v_mfma_f32_16x16x32_bf16 v[44:47], v[168:171], v[148:151], v[44:47]
    s_mov_b32 m0, 135168
    s_add_u32 s10, s8, 983040
    buffer_load_dwordx4 v20, s[44:47], s10 offen lds
    v_mfma_f32_16x16x32_bf16 v[48:51], v[168:171], v[152:155], v[48:51]
    ds_read_b64_tr_b16 v[124:125], v28 offset:288
    ds_read_b64_tr_b16 v[126:127], v28 offset:4128
    ds_read_b64_tr_b16 v[128:129], v28 offset:320
    v_mfma_f32_16x16x32_bf16 v[52:55], v[172:175], v[148:151], v[52:55]
    ds_read_b64_tr_b16 v[130:131], v28 offset:4160
    ds_read_b64_tr_b16 v[132:133], v28 offset:352
    ds_read_b64_tr_b16 v[134:135], v28 offset:4192
    v_mfma_f32_16x16x32_bf16 v[56:59], v[172:175], v[152:155], v[56:59]
    s_mov_b32 m0, 139264
    s_nop 0
    buffer_load_dwordx4 v21, s[44:47], s10 offen lds
    v_mfma_f32_16x16x32_bf16 v[60:63], v[176:179], v[148:151], v[60:63]
    ds_read_b64_tr_b16 v[136:137], v28 offset:384
    ds_read_b64_tr_b16 v[138:139], v28 offset:4224
    ds_read_b64_tr_b16 v[140:141], v28 offset:416
    v_mfma_f32_16x16x32_bf16 v[64:67], v[176:179], v[152:155], v[64:67]
    ds_read_b64_tr_b16 v[142:143], v28 offset:4256
    ds_read_b64_tr_b16 v[144:145], v28 offset:448
    ds_read_b64_tr_b16 v[146:147], v28 offset:4288
    v_mfma_f32_16x16x32_bf16 v[68:71], v[180:183], v[148:151], v[68:71]
    s_mov_b32 m0, 143360
    s_nop 0
    buffer_load_dwordx4 v22, s[44:47], s10 offen lds
    v_mfma_f32_16x16x32_bf16 v[72:75], v[180:183], v[152:155], v[72:75]
    s_mov_b32 m0, 147456
    s_nop 0
    buffer_load_dwordx4 v23, s[44:47], s10 offen lds
    v_mfma_f32_16x16x32_bf16 v[76:79], v[184:187], v[148:151], v[76:79]
    s_waitcnt vmcnt(5) lgkmcnt(0)
    ds_add_u32 v19, v3 offset:144
    v_mfma_f32_16x16x32_bf16 v[80:83], v[184:187], v[152:155], v[80:83]
    s_add_u32 m0, s64, 2048
    s_lshl3_add_u32 s11, s64, 0
    buffer_load_dwordx4 v12, s[48:51], s11 offen lds
    v_mfma_f32_16x16x32_bf16 v[84:87], v[188:191], v[148:151], v[84:87]
    v_mfma_f32_16x16x32_bf16 v[88:91], v[188:191], v[152:155], v[88:91]
    v_mfma_f32_16x16x32_bf16 v[32:35], v[116:119], v[108:111], v[32:35]
    ds_read_b32 v29, v2 offset:144
    v_mfma_f32_16x16x32_bf16 v[36:39], v[120:123], v[104:107], v[36:39]
    s_waitcnt lgkmcnt(0)
    s_setprio 2
    v_readfirstlane_b32 s76, v29
    s_setprio 0
    s_cmp_lt_u32 s76, 28
    s_cbranch_scc1 Lslow_278
Lback_279:
    ds_read_b128 v[148:151], v25 offset:24576
    ds_read_b128 v[152:155], v25 offset:26624
    ds_read_b64_tr_b16 v[160:161], v28 offset:15584
    v_mfma_f32_16x16x32_bf16 v[40:43], v[120:123], v[108:111], v[40:43]
    ds_read_b64_tr_b16 v[162:163], v28 offset:19424
    ds_read_b64_tr_b16 v[164:165], v28 offset:15616
    ds_read_b64_tr_b16 v[166:167], v28 offset:19456
    v_mfma_f32_16x16x32_bf16 v[44:47], v[124:127], v[104:107], v[44:47]
    s_mov_b32 m0, 104448
    s_add_u32 s10, s8, 1105920
    buffer_load_dwordx4 v20, s[44:47], s10 offen lds
    v_mfma_f32_16x16x32_bf16 v[48:51], v[124:127], v[108:111], v[48:51]
    ds_read_b64_tr_b16 v[168:169], v28 offset:15648
    ds_read_b64_tr_b16 v[170:171], v28 offset:19488
    ds_read_b64_tr_b16 v[172:173], v28 offset:15680
    v_mfma_f32_16x16x32_bf16 v[52:55], v[128:131], v[104:107], v[52:55]
    ds_read_b64_tr_b16 v[174:175], v28 offset:19520
    ds_read_b64_tr_b16 v[176:177], v28 offset:15712
    ds_read_b64_tr_b16 v[178:179], v28 offset:19552
    v_mfma_f32_16x16x32_bf16 v[56:59], v[128:131], v[108:111], v[56:59]
    s_mov_b32 m0, 108544
    s_nop 0
    buffer_load_dwordx4 v21, s[44:47], s10 offen lds
    v_mfma_f32_16x16x32_bf16 v[60:63], v[132:135], v[104:107], v[60:63]
    ds_read_b64_tr_b16 v[180:181], v28 offset:15744
    ds_read_b64_tr_b16 v[182:183], v28 offset:19584
    ds_read_b64_tr_b16 v[184:185], v28 offset:15776
    v_mfma_f32_16x16x32_bf16 v[64:67], v[132:135], v[108:111], v[64:67]
    ds_read_b64_tr_b16 v[186:187], v28 offset:19616
    ds_read_b64_tr_b16 v[188:189], v28 offset:15808
    ds_read_b64_tr_b16 v[190:191], v28 offset:19648
    v_mfma_f32_16x16x32_bf16 v[68:71], v[136:139], v[104:107], v[68:71]
    s_mov_b32 m0, 112640
    s_nop 0
    buffer_load_dwordx4 v22, s[44:47], s10 offen lds
    v_mfma_f32_16x16x32_bf16 v[72:75], v[136:139], v[108:111], v[72:75]
    s_mov_b32 m0, 116736
    s_nop 0
    buffer_load_dwordx4 v23, s[44:47], s10 offen lds
    v_mfma_f32_16x16x32_bf16 v[76:79], v[140:143], v[104:107], v[76:79]
    s_waitcnt vmcnt(5) lgkmcnt(0)
    ds_add_u32 v19, v3 offset:144
    v_mfma_f32_16x16x32_bf16 v[80:83], v[140:143], v[108:111], v[80:83]
    s_add_u32 m0, s64, 7168
    s_lshl3_add_u32 s11, s64, 40960
    buffer_load_dwordx4 v12, s[48:51], s11 offen lds
    v_mfma_f32_16x16x32_bf16 v[84:87], v[144:147], v[104:107], v[84:87]
    v_mfma_f32_16x16x32_bf16 v[88:91], v[144:147], v[108:111], v[88:91]
    v_mfma_f32_16x16x32_bf16 v[32:35], v[160:163], v[152:155], v[32:35]
    ds_read_b32 v29, v2 offset:144
    v_mfma_f32_16x16x32_bf16 v[36:39], v[164:167], v[148:151], v[36:39]
    s_waitcnt lgkmcnt(0)
    s_setprio 2
    v_readfirstlane_b32 s76, v29
    s_setprio 0
    s_cmp_lt_u32 s76, 32
    s_cbranch_scc1 Lslow_282
Lback_283:
    ds_read_b128 v[104:107], v24 offset:32768
    ds_read_b128 v[108:111], v24 offset:34816
    ds_read_b64_tr_b16 v[116:117], v28 offset:30944
    v_mfma_f32_16x16x32_bf16 v[40:43], v[164:167], v[152:155], v[40:43]
    ds_read_b64_tr_b16 v[118:119], v28 offset:34784
    ds_read_b64_tr_b16 v[120:121], v28 offset:30976
    ds_read_b64_tr_b16 v[122:123], v28 offset:34816
    v_mfma_f32_16x16x32_bf16 v[44:47], v[168:171], v[148:151], v[44:47]
    s_mov_b32 m0, 119808
    s_add_u32 s10, s9, 0
    buffer_load_dwordx4 v20, s[44:47], s10 offen lds
    v_mfma_f32_16x16x32_bf16 v[48:51], v[168:171], v[152:155], v[48:51]
    ds_read_b64_tr_b16 v[124:125], v28 offset:31008
    ds_read_b64_tr_b16 v[126:127], v28 offset:34848
    ds_read_b64_tr_b16 v[128:129], v28 offset:31040
    v_mfma_f32_16x16x32_bf16 v[52:55], v[172:175], v[148:151], v[52:55]
    ds_read_b64_tr_b16 v[130:131], v28 offset:34880
    ds_read_b64_tr_b16 v[132:133], v28 offset:31072
    ds_read_b64_tr_b16 v[134:135], v28 offset:34912
    v_mfma_f32_16x16x32_bf16 v[56:59], v[172:175], v[152:155], v[56:59]
    s_mov_b32 m0, 123904
    s_nop 0
    buffer_load_dwordx4 v21, s[44:47], s10 offen lds
    v_mfma_f32_16x16x32_bf16 v[60:63], v[176:179], v[148:151], v[60:63]
    ds_read_b64_tr_b16 v[136:137], v28 offset:31104
    ds_read_b64_tr_b16 v[138:139], v28 offset:34944
    ds_read_b64_tr_b16 v[140:141], v28 offset:31136
    v_mfma_f32_16x16x32_bf16 v[64:67], v[176:179], v[152:155], v[64:67]
    ds_read_b64_tr_b16 v[142:143], v28 offset:34976
    ds_read_b64_tr_b16 v[144:145], v28 offset:31168
    ds_read_b64_tr_b16 v[146:147], v28 offset:35008
    v_mfma_f32_16x16x32_bf16 v[68:71], v[180:183], v[148:151], v[68:71]
    s_mov_b32 m0, 128000
    s_nop 0
    buffer_load_dwordx4 v22, s[44:47], s10 offen lds
    v_mfma_f32_16x16x32_bf16 v[72:75], v[180:183], v[152:155], v[72:75]
    s_mov_b32 m0, 132096
    s_nop 0
    buffer_load_dwordx4 v23, s[44:47], s10 offen lds
    v_mfma_f32_16x16x32_bf16 v[76:79], v[184:187], v[148:151], v[76:79]
    s_waitcnt vmcnt(5) lgkmcnt(0)
    ds_add_u32 v19, v3 offset:144
    v_mfma_f32_16x16x32_bf16 v[80:83], v[184:187], v[152:155], v[80:83]
    s_add_u32 m0, s64, 12288
    s_lshl3_add_u32 s11, s64, 81920
    buffer_load_dwordx4 v12, s[48:51], s11 offen lds
    v_mfma_f32_16x16x32_bf16 v[84:87], v[188:191], v[148:151], v[84:87]
    v_mfma_f32_16x16x32_bf16 v[88:91], v[188:191], v[152:155], v[88:91]
    v_mfma_f32_16x16x32_bf16 v[32:35], v[116:119], v[108:111], v[32:35]
    ds_read_b32 v29, v2 offset:144
    v_mfma_f32_16x16x32_bf16 v[36:39], v[120:123], v[104:107], v[36:39]
    s_waitcnt lgkmcnt(0)
    s_setprio 2
    v_readfirstlane_b32 s76, v29
    s_setprio 0
    s_cmp_lt_u32 s76, 36
    s_cbranch_scc1 Lslow_286
Lback_287:
    ds_read_b128 v[148:151], v25 offset:32768
    ds_read_b128 v[152:155], v25 offset:34816
    ds_read_b64_tr_b16 v[160:161], v28 offset:224
    v_mfma_f32_16x16x32_bf16 v[40:43], v[120:123], v[108:111], v[40:43]
    ds_read_b64_tr_b16 v[162:163], v28 offset:4064
    ds_read_b64_tr_b16 v[164:165], v28 offset:256
    ds_read_b64_tr_b16 v[166:167], v28 offset:4096
    v_mfma_f32_16x16x32_bf16 v[44:47], v[124:127], v[104:107], v[44:47]
    s_mov_b32 m0, 135168
    s_add_u32 s10, s9, 122880
    buffer_load_dwordx4 v20, s[44:47], s10 offen lds
    v_mfma_f32_16x16x32_bf16 v[48:51], v[124:127], v[108:111], v[48:51]
    ds_read_b64_tr_b16 v[168:169], v28 offset:288
    ds_read_b64_tr_b16 v[170:171], v28 offset:4128
    ds_read_b64_tr_b16 v[172:173], v28 offset:320
    v_mfma_f32_16x16x32_bf16 v[52:55], v[128:131], v[104:107], v[52:55]
    ds_read_b64_tr_b16 v[174:175], v28 offset:4160
    ds_read_b64_tr_b16 v[176:177], v28 offset:352
    ds_read_b64_tr_b16 v[178:179], v28 offset:4192
    v_mfma_f32_16x16x32_bf16 v[56:59], v[128:131], v[108:111], v[56:59]
    s_mov_b32 m0, 139264
    s_nop 0
    buffer_load_dwordx4 v21, s[44:47], s10 offen lds
    v_mfma_f32_16x16x32_bf16 v[60:63], v[132:135], v[104:107], v[60:63]
    ds_read_b64_tr_b16 v[180:181], v28 offset:384
    ds_read_b64_tr_b16 v[182:183], v28 offset:4224
    ds_read_b64_tr_b16 v[184:185], v28 offset:416
    v_mfma_f32_16x16x32_bf16 v[64:67], v[132:135], v[108:111], v[64:67]
    ds_read_b64_tr_b16 v[186:187], v28 offset:4256
    ds_read_b64_tr_b16 v[188:189], v28 offset:448
    ds_read_b64_tr_b16 v[190:191], v28 offset:4288
    v_mfma_f32_16x16x32_bf16 v[68:71], v[136:139], v[104:107], v[68:71]
    s_mov_b32 m0, 143360
    s_nop 0
    buffer_load_dwordx4 v22, s[44:47], s10 offen lds
    v_mfma_f32_16x16x32_bf16 v[72:75], v[136:139], v[108:111], v[72:75]
    s_mov_b32 m0, 147456
    s_nop 0
    buffer_load_dwordx4 v23, s[44:47], s10 offen lds
    v_mfma_f32_16x16x32_bf16 v[76:79], v[140:143], v[104:107], v[76:79]
    s_waitcnt vmcnt(5) lgkmcnt(0)
    ds_add_u32 v19, v3 offset:144
    v_mfma_f32_16x16x32_bf16 v[80:83], v[140:143], v[108:111], v[80:83]
    s_add_u32 m0, s64, 17408
    s_lshl3_add_u32 s11, s64, 122880
    buffer_load_dwordx4 v12, s[48:51], s11 offen lds
    v_mfma_f32_16x16x32_bf16 v[84:87], v[144:147], v[104:107], v[84:87]
    v_mfma_f32_16x16x32_bf16 v[88:91], v[144:147], v[108:111], v[88:91]
    v_mfma_f32_16x16x32_bf16 v[32:35], v[160:163], v[152:155], v[32:35]
    ds_read_b32 v29, v2 offset:144
    v_mfma_f32_16x16x32_bf16 v[36:39], v[164:167], v[148:151], v[36:39]
    s_waitcnt lgkmcnt(0)
    s_setprio 2
    v_readfirstlane_b32 s76, v29
    s_setprio 0
    s_cmp_lt_u32 s76, 40
    s_cbranch_scc1 Lslow_290
Lback_291:
    ds_read_b128 v[104:107], v26 offset:0
    ds_read_b128 v[108:111], v26 offset:2048
    ds_read_b64_tr_b16 v[116:117], v28 offset:15584
    v_mfma_f32_16x16x32_bf16 v[40:43], v[164:167], v[152:155], v[40:43]
    ds_read_b64_tr_b16 v[118:119], v28 offset:19424
    ds_read_b64_tr_b16 v[120:121], v28 offset:15616
    ds_read_b64_tr_b16 v[122:123], v28 offset:19456
    v_mfma_f32_16x16x32_bf16 v[44:47], v[168:171], v[148:151], v[44:47]
    s_mov_b32 m0, 104448
    s_add_u32 s10, s9, 245760
    buffer_load_dwordx4 v20, s[44:47], s10 offen lds
    v_mfma_f32_16x16x32_bf16 v[48:51], v[168:171], v[152:155], v[48:51]
    ds_read_b64_tr_b16 v[124:125], v28 offset:15648
    ds_read_b64_tr_b16 v[126:127], v28 offset:19488
    ds_read_b64_tr_b16 v[128:129], v28 offset:15680
    v_mfma_f32_16x16x32_bf16 v[52:55], v[172:175], v[148:151], v[52:55]
    ds_read_b64_tr_b16 v[130:131], v28 offset:19520
    ds_read_b64_tr_b16 v[132:133], v28 offset:15712
    ds_read_b64_tr_b16 v[134:135], v28 offset:19552
    v_mfma_f32_16x16x32_bf16 v[56:59], v[172:175], v[152:155], v[56:59]
    s_mov_b32 m0, 108544
    s_nop 0
    buffer_load_dwordx4 v21, s[44:47], s10 offen lds
    v_mfma_f32_16x16x32_bf16 v[60:63], v[176:179], v[148:151], v[60:63]
    ds_read_b64_tr_b16 v[136:137], v28 offset:15744
    ds_read_b64_tr_b16 v[138:139], v28 offset:19584
    ds_read_b64_tr_b16 v[140:141], v28 offset:15776
    v_mfma_f32_16x16x32_bf16 v[64:67], v[176:179], v[152:155], v[64:67]
    ds_read_b64_tr_b16 v[142:143], v28 offset:19616
    ds_read_b64_tr_b16 v[144:145], v28 offset:15808
    ds_read_b64_tr_b16 v[146:147], v28 offset:19648
    v_mfma_f32_16x16x32_bf16 v[68:71], v[180:183], v[148:151], v[68:71]
    s_mov_b32 m0, 112640
    s_nop 0
    buffer_load_dwordx4 v22, s[44:47], s10 offen lds
    v_mfma_f32_16x16x32_bf16 v[72:75], v[180:183], v[152:155], v[72:75]
    s_mov_b32 m0, 116736
    s_nop 0
    buffer_load_dwordx4 v23, s[44:47], s10 offen lds
    v_mfma_f32_16x16x32_bf16 v[76:79], v[184:187], v[148:151], v[76:79]
    s_waitcnt vmcnt(5) lgkmcnt(0)
    ds_add_u32 v19, v3 offset:144
    v_mfma_f32_16x16x32_bf16 v[80:83], v[184:187], v[152:155], v[80:83]
    s_add_u32 m0, s64, 22528
    s_lshl3_add_u32 s11, s64, 163840
    buffer_load_dwordx4 v12, s[48:51], s11 offen lds
    v_mfma_f32_16x16x32_bf16 v[84:87], v[188:191], v[148:151], v[84:87]
    v_mfma_f32_16x16x32_bf16 v[88:91], v[188:191], v[152:155], v[88:91]
    v_mfma_f32_16x16x32_bf16 v[32:35], v[116:119], v[108:111], v[32:35]
    ds_read_b32 v29, v2 offset:144
    v_mfma_f32_16x16x32_bf16 v[36:39], v[120:123], v[104:107], v[36:39]
    s_waitcnt lgkmcnt(0)
    s_setprio 2
    v_readfirstlane_b32 s76, v29
    s_setprio 0
    s_cmp_lt_u32 s76, 44
    s_cbranch_scc1 Lslow_294
Lback_295:
    ds_read_b128 v[148:151], v27 offset:0
    ds_read_b128 v[152:155], v27 offset:2048
    ds_read_b64_tr_b16 v[160:161], v28 offset:30944
    v_mfma_f32_16x16x32_bf16 v[40:43], v[120:123], v[108:111], v[40:43]
    ds_read_b64_tr_b16 v[162:163], v28 offset:34784
    ds_read_b64_tr_b16 v[164:165], v28 offset:30976
    ds_read_b64_tr_b16 v[166:167], v28 offset:34816
    v_mfma_f32_16x16x32_bf16 v[44:47], v[124:127], v[104:107], v[44:47]
    s_mov_b32 m0, 119808
    s_add_u32 s10, s9, 368640
    buffer_load_dwordx4 v20, s[44:47], s10 offen lds
    v_mfma_f32_16x16x32_bf16 v[48:51], v[124:127], v[108:111], v[48:51]
    ds_read_b64_tr_b16 v[168:169], v28 offset:31008
    ds_read_b64_tr_b16 v[170:171], v28 offset:34848
    ds_read_b64_tr_b16 v[172:173], v28 offset:31040
    v_mfma_f32_16x16x32_bf16 v[52:55], v[128:131], v[104:107], v[52:55]
    ds_read_b64_tr_b16 v[174:175], v28 offset:34880
    ds_read_b64_tr_b16 v[176:177], v28 offset:31072
    ds_read_b64_tr_b16 v[178:179], v28 offset:34912
    v_mfma_f32_16x16x32_bf16 v[56:59], v[128:131], v[108:111], v[56:59]
    s_mov_b32 m0, 123904
    s_nop 0
    buffer_load_dwordx4 v21, s[44:47], s10 offen lds
    v_mfma_f32_16x16x32_bf16 v[60:63], v[132:135], v[104:107], v[60:63]
    ds_read_b64_tr_b16 v[180:181], v28 offset:31104
    ds_read_b64_tr_b16 v[182:183], v28 offset:34944
    ds_read_b64_tr_b16 v[184:185], v28 offset:31136
    v_mfma_f32_16x16x32_bf16 v[64:67], v[132:135], v[108:111], v[64:67]
    ds_read_b64_tr_b16 v[186:187], v28 offset:34976
    ds_read_b64_tr_b16 v[188:189], v28 offset:31168
    ds_read_b64_tr_b16 v[190:191], v28 offset:35008
    v_mfma_f32_16x16x32_bf16 v[68:71], v[136:139], v[104:107], v[68:71]
    s_mov_b32 m0, 128000
    s_nop 0
    buffer_load_dwordx4 v22, s[44:47], s10 offen lds
    v_mfma_f32_16x16x32_bf16 v[72:75], v[136:139], v[108:111], v[72:75]
    s_mov_b32 m0, 132096
    s_nop 0
    buffer_load_dwordx4 v23, s[44:47], s10 offen lds
    v_mfma_f32_16x16x32_bf16 v[76:79], v[140:143], v[104:107], v[76:79]
    s_waitcnt vmcnt(5) lgkmcnt(0)
    ds_add_u32 v19, v3 offset:144
    v_mfma_f32_16x16x32_bf16 v[80:83], v[140:143], v[108:111], v[80:83]
    s_add_u32 m0, s64, 27648
    s_lshl3_add_u32 s11, s64, 204800
    buffer_load_dwordx4 v12, s[48:51], s11 offen lds
    v_mfma_f32_16x16x32_bf16 v[84:87], v[144:147], v[104:107], v[84:87]
    v_mfma_f32_16x16x32_bf16 v[88:91], v[144:147], v[108:111], v[88:91]
    v_mfma_f32_16x16x32_bf16 v[32:35], v[160:163], v[152:155], v[32:35]
    ds_read_b32 v29, v2 offset:144
    v_mfma_f32_16x16x32_bf16 v[36:39], v[164:167], v[148:151], v[36:39]
    s_waitcnt lgkmcnt(0)
    s_setprio 2
    v_readfirstlane_b32 s76, v29
    s_setprio 0
    s_cmp_lt_u32 s76, 48
    s_cbranch_scc1 Lslow_298
Lback_299:
    ds_read_b128 v[104:107], v26 offset:8192
    ds_read_b128 v[108:111], v26 offset:10240
    ds_read_b64_tr_b16 v[116:117], v28 offset:224
    v_mfma_f32_16x16x32_bf16 v[40:43], v[164:167], v[152:155], v[40:43]
    ds_read_b64_tr_b16 v[118:119], v28 offset:4064
    ds_read_b64_tr_b16 v[120:121], v28 offset:256
    ds_read_b64_tr_b16 v[122:123], v28 offset:4096
    v_mfma_f32_16x16x32_bf16 v[44:47], v[168:171], v[148:151], v[44:47]
    s_mov_b32 m0, 135168
    s_add_u32 s10, s9, 491520
    buffer_load_dwordx4 v20, s[44:47], s10 offen lds
    v_mfma_f32_16x16x32_bf16 v[48:51], v[168:171], v[152:155], v[48:51]
    ds_read_b64_tr_b16 v[124:125], v28 offset:288
    ds_read_b64_tr_b16 v[126:127], v28 offset:4128
    ds_read_b64_tr_b16 v[128:129], v28 offset:320
    v_mfma_f32_16x16x32_bf16 v[52:55], v[172:175], v[148:151], v[52:55]
    ds_read_b64_tr_b16 v[130:131], v28 offset:4160
    ds_read_b64_tr_b16 v[132:133], v28 offset:352
    ds_read_b64_tr_b16 v[134:135], v28 offset:4192
    v_mfma_f32_16x16x32_bf16 v[56:59], v[172:175], v[152:155], v[56:59]
    s_mov_b32 m0, 139264
    s_nop 0
    buffer_load_dwordx4 v21, s[44:47], s10 offen lds
    v_mfma_f32_16x16x32_bf16 v[60:63], v[176:179], v[148:151], v[60:63]
    ds_read_b64_tr_b16 v[136:137], v28 offset:384
    ds_read_b64_tr_b16 v[138:139], v28 offset:4224
    ds_read_b64_tr_b16 v[140:141], v28 offset:416
    v_mfma_f32_16x16x32_bf16 v[64:67], v[176:179], v[152:155], v[64:67]
    ds_read_b64_tr_b16 v[142:143], v28 offset:4256
    ds_read_b64_tr_b16 v[144:145], v28 offset:448
    ds_read_b64_tr_b16 v[146:147], v28 offset:4288
    v_mfma_f32_16x16x32_bf16 v[68:71], v[180:183], v[148:151], v[68:71]
    s_mov_b32 m0, 143360
    s_nop 0
    buffer_load_dwordx4 v22, s[44:47], s10 offen lds
    v_mfma_f32_16x16x32_bf16 v[72:75], v[180:183], v[152:155], v[72:75]
    s_mov_b32 m0, 147456
    s_nop 0
    buffer_load_dwordx4 v23, s[44:47], s10 offen lds
    v_mfma_f32_16x16x32_bf16 v[76:79], v[184:187], v[148:151], v[76:79]
    s_waitcnt vmcnt(5) lgkmcnt(0)
    ds_add_u32 v19, v3 offset:144
    v_mfma_f32_16x16x32_bf16 v[80:83], v[184:187], v[152:155], v[80:83]
    s_add_u32 m0, s64, 32768
    s_lshl3_add_u32 s11, s64, 245760
    buffer_load_dwordx4 v12, s[48:51], s11 offen lds
    v_mfma_f32_16x16x32_bf16 v[84:87], v[188:191], v[148:151], v[84:87]
    v_mfma_f32_16x16x32_bf16 v[88:91], v[188:191], v[152:155], v[88:91]
    v_mfma_f32_16x16x32_bf16 v[32:35], v[116:119], v[108:111], v[32:35]
    ds_read_b32 v29, v2 offset:144
    v_mfma_f32_16x16x32_bf16 v[36:39], v[120:123], v[104:107], v[36:39]
    s_waitcnt lgkmcnt(0)
    s_setprio 2
    v_readfirstlane_b32 s76, v29
    s_setprio 0
    s_cmp_lt_u32 s76, 52
    s_cbranch_scc1 Lslow_302
Lback_303:
    ds_read_b128 v[148:151], v27 offset:8192
    ds_read_b128 v[152:155], v27 offset:10240
    ds_read_b64_tr_b16 v[160:161], v28 offset:15584
    v_mfma_f32_16x16x32_bf16 v[40:43], v[120:123], v[108:111], v[40:43]
    ds_read_b64_tr_b16 v[162:163], v28 offset:19424
    ds_read_b64_tr_b16 v[164:165], v28 offset:15616
    ds_read_b64_tr_b16 v[166:167], v28 offset:19456
    v_mfma_f32_16x16x32_bf16 v[44:47], v[124:127], v[104:107], v[44:47]
    s_mov_b32 m0, 104448
    s_add_u32 s10, s9, 614400
    buffer_load_dwordx4 v20, s[44:47], s10 offen lds
    v_mfma_f32_16x16x32_bf16 v[48:51], v[124:127], v[108:111], v[48:51]
    ds_read_b64_tr_b16 v[168:169], v28 offset:15648
    ds_read_b64_tr_b16 v[170:171], v28 offset:19488
    ds_read_b64_tr_b16 v[172:173], v28 offset:15680
    v_mfma_f32_16x16x32_bf16 v[52:55], v[128:131], v[104:107], v[52:55]
    ds_read_b64_tr_b16 v[174:175], v28 offset:19520
    ds_read_b64_tr_b16 v[176:177], v28 offset:15712
    ds_read_b64_tr_b16 v[178:179], v28 offset:19552
    v_mfma_f32_16x16x32_bf16 v[56:59], v[128:131], v[108:111], v[56:59]
    s_mov_b32 m0, 108544
    s_nop 0
    buffer_load_dwordx4 v21, s[44:47], s10 offen lds
    v_mfma_f32_16x16x32_bf16 v[60:63], v[132:135], v[104:107], v[60:63]
    ds_read_b64_tr_b16 v[180:181], v28 offset:15744
    ds_read_b64_tr_b16 v[182:183], v28 offset:19584
    ds_read_b64_tr_b16 v[184:185], v28 offset:15776
    v_mfma_f32_16x16x32_bf16 v[64:67], v[132:135], v[108:111], v[64:67]
    ds_read_b64_tr_b16 v[186:187], v28 offset:19616
    ds_read_b64_tr_b16 v[188:189], v28 offset:15808
    ds_read_b64_tr_b16 v[190:191], v28 offset:19648
    v_mfma_f32_16x16x32_bf16 v[68:71], v[136:139], v[104:107], v[68:71]
    s_mov_b32 m0, 112640
    s_nop 0
    buffer_load_dwordx4 v22, s[44:47], s10 offen lds
    v_mfma_f32_16x16x32_bf16 v[72:75], v[136:139], v[108:111], v[72:75]
    s_mov_b32 m0, 116736
    s_nop 0
    buffer_load_dwordx4 v23, s[44:47], s10 offen lds
    v_mfma_f32_16x16x32_bf16 v[76:79], v[140:143], v[104:107], v[76:79]
    s_waitcnt vmcnt(5) lgkmcnt(0)
    ds_add_u32 v19, v3 offset:144
    v_mfma_f32_16x16x32_bf16 v[80:83], v[140:143], v[108:111], v[80:83]
    s_add_u32 m0, s64, 37888
    s_lshl3_add_u32 s11, s64, 286720
    buffer_load_dwordx4 v12, s[48:51], s11 offen lds
    v_mfma_f32_16x16x32_bf16 v[84:87], v[144:147], v[104:107], v[84:87]
    v_mfma_f32_16x16x32_bf16 v[88:91], v[144:147], v[108:111], v[88:91]
    v_mfma_f32_16x16x32_bf16 v[32:35], v[160:163], v[152:155], v[32:35]
    ds_read_b32 v29, v2 offset:144
    v_mfma_f32_16x16x32_bf16 v[36:39], v[164:167], v[148:151], v[36:39]
    s_waitcnt lgkmcnt(0)
    s_setprio 2
    v_readfirstlane_b32 s76, v29
    s_setprio 0
    s_cmp_lt_u32 s76, 56
    s_cbranch_scc1 Lslow_306
Lback_307:
    ds_read_b128 v[104:107], v26 offset:16384
    ds_read_b128 v[108:111], v26 offset:18432
    ds_read_b64_tr_b16 v[116:117], v28 offset:30944
    v_mfma_f32_16x16x32_bf16 v[40:43], v[164:167], v[152:155], v[40:43]
    ds_read_b64_tr_b16 v[118:119], v28 offset:34784
    ds_read_b64_tr_b16 v[120:121], v28 offset:30976
    ds_read_b64_tr_b16 v[122:123], v28 offset:34816
    v_mfma_f32_16x16x32_bf16 v[44:47], v[168:171], v[148:151], v[44:47]
    s_mov_b32 m0, 119808
    s_add_u32 s10, s9, 737280
    buffer_load_dwordx4 v20, s[44:47], s10 offen lds
    v_mfma_f32_16x16x32_bf16 v[48:51], v[168:171], v[152:155], v[48:51]
    ds_read_b64_tr_b16 v[124:125], v28 offset:31008
    ds_read_b64_tr_b16 v[126:127], v28 offset:34848
    ds_read_b64_tr_b16 v[128:129], v28 offset:31040
    v_mfma_f32_16x16x32_bf16 v[52:55], v[172:175], v[148:151], v[52:55]
    ds_read_b64_tr_b16 v[130:131], v28 offset:34880
    ds_read_b64_tr_b16 v[132:133], v28 offset:31072
    ds_read_b64_tr_b16 v[134:135], v28 offset:34912
    v_mfma_f32_16x16x32_bf16 v[56:59], v[172:175], v[152:155], v[56:59]
    s_mov_b32 m0, 123904
    s_nop 0
    buffer_load_dwordx4 v21, s[44:47], s10 offen lds
    v_mfma_f32_16x16x32_bf16 v[60:63], v[176:179], v[148:151], v[60:63]
    ds_read_b64_tr_b16 v[136:137], v28 offset:31104
    ds_read_b64_tr_b16 v[138:139], v28 offset:34944
    ds_read_b64_tr_b16 v[140:141], v28 offset:31136
    v_mfma_f32_16x16x32_bf16 v[64:67], v[176:179], v[152:155], v[64:67]
    ds_read_b64_tr_b16 v[142:143], v28 offset:34976
    ds_read_b64_tr_b16 v[144:145], v28 offset:31168
    ds_read_b64_tr_b16 v[146:147], v28 offset:35008
    v_mfma_f32_16x16x32_bf16 v[68:71], v[180:183], v[148:151], v[68:71]
    s_mov_b32 m0, 128000
    s_nop 0
    buffer_load_dwordx4 v22, s[44:47], s10 offen lds
    v_mfma_f32_16x16x32_bf16 v[72:75], v[180:183], v[152:155], v[72:75]
    s_mov_b32 m0, 132096
    s_nop 0
    buffer_load_dwordx4 v23, s[44:47], s10 offen lds
    v_mfma_f32_16x16x32_bf16 v[76:79], v[184:187], v[148:151], v[76:79]
    s_waitcnt vmcnt(5) lgkmcnt(0)
    ds_add_u32 v19, v3 offset:144
    v_mfma_f32_16x16x32_bf16 v[80:83], v[184:187], v[152:155], v[80:83]
    s_add_u32 m0, s65, 2048
    s_lshl3_add_u32 s11, s65, 0
    buffer_load_dwordx4 v12, s[48:51], s11 offen lds
    v_mfma_f32_16x16x32_bf16 v[84:87], v[188:191], v[148:151], v[84:87]
    v_mfma_f32_16x16x32_bf16 v[88:91], v[188:191], v[152:155], v[88:91]
    v_mfma_f32_16x16x32_bf16 v[32:35], v[116:119], v[108:111], v[32:35]
    ds_read_b32 v29, v2 offset:144
    v_mfma_f32_16x16x32_bf16 v[36:39], v[120:123], v[104:107], v[36:39]
    s_waitcnt lgkmcnt(0)
    s_setprio 2
    v_readfirstlane_b32 s76, v29
    s_setprio 0
    s_cmp_lt_u32 s76, 60
    s_cbranch_scc1 Lslow_310
Lback_311:
    ds_read_b128 v[148:151], v27 offset:16384
    ds_read_b128 v[152:155], v27 offset:18432
    ds_read_b64_tr_b16 v[160:161], v28 offset:224
    v_mfma_f32_16x16x32_bf16 v[40:43], v[120:123], v[108:111], v[40:43]
    ds_read_b64_tr_b16 v[162:163], v28 offset:4064
    ds_read_b64_tr_b16 v[164:165], v28 offset:256
    ds_read_b64_tr_b16 v[166:167], v28 offset:4096
    v_mfma_f32_16x16x32_bf16 v[44:47], v[124:127], v[104:107], v[44:47]
    s_mov_b32 m0, 135168
    s_add_u32 s10, s9, 860160
    buffer_load_dwordx4 v20, s[44:47], s10 offen lds
    v_mfma_f32_16x16x32_bf16 v[48:51], v[124:127], v[108:111], v[48:51]
    ds_read_b64_tr_b16 v[168:169], v28 offset:288
    ds_read_b64_tr_b16 v[170:171], v28 offset:4128
    ds_read_b64_tr_b16 v[172:173], v28 offset:320
    v_mfma_f32_16x16x32_bf16 v[52:55], v[128:131], v[104:107], v[52:55]
    ds_read_b64_tr_b16 v[174:175], v28 offset:4160
    ds_read_b64_tr_b16 v[176:177], v28 offset:352
    ds_read_b64_tr_b16 v[178:179], v28 offset:4192
    v_mfma_f32_16x16x32_bf16 v[56:59], v[128:131], v[108:111], v[56:59]
    s_mov_b32 m0, 139264
    s_nop 0
    buffer_load_dwordx4 v21, s[44:47], s10 offen lds
    v_mfma_f32_16x16x32_bf16 v[60:63], v[132:135], v[104:107], v[60:63]
    ds_read_b64_tr_b16 v[180:181], v28 offset:384
    ds_read_b64_tr_b16 v[182:183], v28 offset:4224
    ds_read_b64_tr_b16 v[184:185], v28 offset:416
    v_mfma_f32_16x16x32_bf16 v[64:67], v[132:135], v[108:111], v[64:67]
    ds_read_b64_tr_b16 v[186:187], v28 offset:4256
    ds_read_b64_tr_b16 v[188:189], v28 offset:448
    ds_read_b64_tr_b16 v[190:191], v28 offset:4288
    v_mfma_f32_16x16x32_bf16 v[68:71], v[136:139], v[104:107], v[68:71]
    s_mov_b32 m0, 143360
    s_nop 0
    buffer_load_dwordx4 v22, s[44:47], s10 offen lds
    v_mfma_f32_16x16x32_bf16 v[72:75], v[136:139], v[108:111], v[72:75]
    s_mov_b32 m0, 147456
    s_nop 0
    buffer_load_dwordx4 v23, s[44:47], s10 offen lds
    v_mfma_f32_16x16x32_bf16 v[76:79], v[140:143], v[104:107], v[76:79]
    s_waitcnt vmcnt(5) lgkmcnt(0)
    ds_add_u32 v19, v3 offset:144
    v_mfma_f32_16x16x32_bf16 v[80:83], v[140:143], v[108:111], v[80:83]
    s_add_u32 m0, s65, 7168
    s_lshl3_add_u32 s11, s65, 40960
    buffer_load_dwordx4 v12, s[48:51], s11 offen lds
    v_mfma_f32_16x16x32_bf16 v[84:87], v[144:147], v[104:107], v[84:87]
    v_mfma_f32_16x16x32_bf16 v[88:91], v[144:147], v[108:111], v[88:91]
    v_mfma_f32_16x16x32_bf16 v[32:35], v[160:163], v[152:155], v[32:35]
    ds_read_b32 v29, v2 offset:144
    v_mfma_f32_16x16x32_bf16 v[36:39], v[164:167], v[148:151], v[36:39]
    s_waitcnt lgkmcnt(0)
    s_setprio 2
    v_readfirstlane_b32 s76, v29
    s_setprio 0
    s_cmp_lt_u32 s76, 64
    s_cbranch_scc1 Lslow_314
Lback_315:
    ds_read_b128 v[104:107], v26 offset:24576
    ds_read_b128 v[108:111], v26 offset:26624
    ds_read_b64_tr_b16 v[116:117], v28 offset:15584
    v_mfma_f32_16x16x32_bf16 v[40:43], v[164:167], v[152:155], v[40:43]
    ds_read_b64_tr_b16 v[118:119], v28 offset:19424
    ds_read_b64_tr_b16 v[120:121], v28 offset:15616
    ds_read_b64_tr_b16 v[122:123], v28 offset:19456
    v_mfma_f32_16x16x32_bf16 v[44:47], v[168:171], v[148:151], v[44:47]
    s_mov_b32 m0, 104448
    s_add_u32 s10, s9, 983040
    buffer_load_dwordx4 v20, s[44:47], s10 offen lds
    v_mfma_f32_16x16x32_bf16 v[48:51], v[168:171], v[152:155], v[48:51]
    ds_read_b64_tr_b16 v[124:125], v28 offset:15648
    ds_read_b64_tr_b16 v[126:127], v28 offset:19488
    ds_read_b64_tr_b16 v[128:129], v28 offset:15680
    v_mfma_f32_16x16x32_bf16 v[52:55], v[172:175], v[148:151], v[52:55]
    ds_read_b64_tr_b16 v[130:131], v28 offset:19520
    ds_read_b64_tr_b16 v[132:133], v28 offset:15712
    ds_read_b64_tr_b16 v[134:135], v28 offset:19552
    v_mfma_f32_16x16x32_bf16 v[56:59], v[172:175], v[152:155], v[56:59]
    s_mov_b32 m0, 108544
    s_nop 0
    buffer_load_dwordx4 v21, s[44:47], s10 offen lds
    v_mfma_f32_16x16x32_bf16 v[60:63], v[176:179], v[148:151], v[60:63]
    ds_read_b64_tr_b16 v[136:137], v28 offset:15744
    ds_read_b64_tr_b16 v[138:139], v28 offset:19584
    ds_read_b64_tr_b16 v[140:141], v28 offset:15776
    v_mfma_f32_16x16x32_bf16 v[64:67], v[176:179], v[152:155], v[64:67]
    ds_read_b64_tr_b16 v[142:143], v28 offset:19616
    ds_read_b64_tr_b16 v[144:145], v28 offset:15808
    ds_read_b64_tr_b16 v[146:147], v28 offset:19648
    v_mfma_f32_16x16x32_bf16 v[68:71], v[180:183], v[148:151], v[68:71]
    s_mov_b32 m0, 112640
    s_nop 0
    buffer_load_dwordx4 v22, s[44:47], s10 offen lds
    v_mfma_f32_16x16x32_bf16 v[72:75], v[180:183], v[152:155], v[72:75]
    s_mov_b32 m0, 116736
    s_nop 0
    buffer_load_dwordx4 v23, s[44:47], s10 offen lds
    v_mfma_f32_16x16x32_bf16 v[76:79], v[184:187], v[148:151], v[76:79]
    s_waitcnt vmcnt(5) lgkmcnt(0)
    ds_add_u32 v19, v3 offset:144
    v_mfma_f32_16x16x32_bf16 v[80:83], v[184:187], v[152:155], v[80:83]
    s_add_u32 m0, s65, 12288
    s_lshl3_add_u32 s11, s65, 81920
    buffer_load_dwordx4 v12, s[48:51], s11 offen lds
    v_mfma_f32_16x16x32_bf16 v[84:87], v[188:191], v[148:151], v[84:87]
    v_mfma_f32_16x16x32_bf16 v[88:91], v[188:191], v[152:155], v[88:91]
    v_mfma_f32_16x16x32_bf16 v[32:35], v[116:119], v[108:111], v[32:35]
    ds_read_b32 v29, v2 offset:144
    v_mfma_f32_16x16x32_bf16 v[36:39], v[120:123], v[104:107], v[36:39]
    s_waitcnt lgkmcnt(0)
    s_setprio 2
    v_readfirstlane_b32 s76, v29
    s_setprio 0
    s_cmp_lt_u32 s76, 68
    s_cbranch_scc1 Lslow_318
Lback_319:
    ds_read_b128 v[148:151], v27 offset:24576
    ds_read_b128 v[152:155], v27 offset:26624
    ds_read_b64_tr_b16 v[160:161], v28 offset:30944
    v_mfma_f32_16x16x32_bf16 v[40:43], v[120:123], v[108:111], v[40:43]
    ds_read_b64_tr_b16 v[162:163], v28 offset:34784
    ds_read_b64_tr_b16 v[164:165], v28 offset:30976
    ds_read_b64_tr_b16 v[166:167], v28 offset:34816
    v_mfma_f32_16x16x32_bf16 v[44:47], v[124:127], v[104:107], v[44:47]
    s_mov_b32 m0, 119808
    s_add_u32 s10, s9, 1105920
    buffer_load_dwordx4 v20, s[44:47], s10 offen lds
    v_mfma_f32_16x16x32_bf16 v[48:51], v[124:127], v[108:111], v[48:51]
    ds_read_b64_tr_b16 v[168:169], v28 offset:31008
    ds_read_b64_tr_b16 v[170:171], v28 offset:34848
    ds_read_b64_tr_b16 v[172:173], v28 offset:31040
    v_mfma_f32_16x16x32_bf16 v[52:55], v[128:131], v[104:107], v[52:55]
    ds_read_b64_tr_b16 v[174:175], v28 offset:34880
    ds_read_b64_tr_b16 v[176:177], v28 offset:31072
    ds_read_b64_tr_b16 v[178:179], v28 offset:34912
    v_mfma_f32_16x16x32_bf16 v[56:59], v[128:131], v[108:111], v[56:59]
    s_mov_b32 m0, 123904
    s_nop 0
    buffer_load_dwordx4 v21, s[44:47], s10 offen lds
    v_mfma_f32_16x16x32_bf16 v[60:63], v[132:135], v[104:107], v[60:63]
    ds_read_b64_tr_b16 v[180:181], v28 offset:31104
    ds_read_b64_tr_b16 v[182:183], v28 offset:34944
    ds_read_b64_tr_b16 v[184:185], v28 offset:31136
    v_mfma_f32_16x16x32_bf16 v[64:67], v[132:135], v[108:111], v[64:67]
    ds_read_b64_tr_b16 v[186:187], v28 offset:34976
    ds_read_b64_tr_b16 v[188:189], v28 offset:31168
    ds_read_b64_tr_b16 v[190:191], v28 offset:35008
    v_mfma_f32_16x16x32_bf16 v[68:71], v[136:139], v[104:107], v[68:71]
    s_mov_b32 m0, 128000
    s_nop 0
    buffer_load_dwordx4 v22, s[44:47], s10 offen lds
    v_mfma_f32_16x16x32_bf16 v[72:75], v[136:139], v[108:111], v[72:75]
    s_mov_b32 m0, 132096
    s_nop 0
    buffer_load_dwordx4 v23, s[44:47], s10 offen lds
    v_mfma_f32_16x16x32_bf16 v[76:79], v[140:143], v[104:107], v[76:79]
    s_waitcnt vmcnt(5) lgkmcnt(0)
    ds_add_u32 v19, v3 offset:144
    v_mfma_f32_16x16x32_bf16 v[80:83], v[140:143], v[108:111], v[80:83]
    s_add_u32 m0, s65, 17408
    s_lshl3_add_u32 s11, s65, 122880
    buffer_load_dwordx4 v12, s[48:51], s11 offen lds
    v_mfma_f32_16x16x32_bf16 v[84:87], v[144:147], v[104:107], v[84:87]
    v_mfma_f32_16x16x32_bf16 v[88:91], v[144:147], v[108:111], v[88:91]
    v_mfma_f32_16x16x32_bf16 v[32:35], v[160:163], v[152:155], v[32:35]
    ds_read_b32 v29, v2 offset:144
    v_mfma_f32_16x16x32_bf16 v[36:39], v[164:167], v[148:151], v[36:39]
    s_waitcnt lgkmcnt(0)
    s_setprio 2
    v_readfirstlane_b32 s76, v29
    s_setprio 0
    s_cmp_lt_u32 s76, 72
    s_cbranch_scc1 Lslow_322
Lback_323:
    ds_read_b128 v[104:107], v26 offset:32768
    ds_read_b128 v[108:111], v26 offset:34816
    ds_read_b64_tr_b16 v[116:117], v28 offset:224
    v_mfma_f32_16x16x32_bf16 v[40:43], v[164:167], v[152:155], v[40:43]
    ds_read_b64_tr_b16 v[118:119], v28 offset:4064
    ds_read_b64_tr_b16 v[120:121], v28 offset:256
    ds_read_b64_tr_b16 v[122:123], v28 offset:4096
    v_mfma_f32_16x16x32_bf16 v[44:47], v[168:171], v[148:151], v[44:47]
    ds_read_b64_tr_b16 v[124:125], v28 offset:288
    ds_read_b64_tr_b16 v[126:127], v28 offset:4128
    ds_read_b64_tr_b16 v[128:129], v28 offset:320
    v_mfma_f32_16x16x32_bf16 v[48:51], v[168:171], v[152:155], v[48:51]
    ds_read_b64_tr_b16 v[130:131], v28 offset:4160
    ds_read_b64_tr_b16 v[132:133], v28 offset:352
    ds_read_b64_tr_b16 v[134:135], v28 offset:4192
    v_mfma_f32_16x16x32_bf16 v[52:55], v[172:175], v[148:151], v[52:55]
    ds_read_b64_tr_b16 v[136:137], v28 offset:384
    ds_read_b64_tr_b16 v[138:139], v28 offset:4224
    ds_read_b64_tr_b16 v[140:141], v28 offset:416
    v_mfma_f32_16x16x32_bf16 v[56:59], v[172:175], v[152:155], v[56:59]
    ds_read_b64_tr_b16 v[142:143], v28 offset:4256
    ds_read_b64_tr_b16 v[144:145], v28 offset:448
    ds_read_b64_tr_b16 v[146:147], v28 offset:4288
    v_mfma_f32_16x16x32_bf16 v[60:63], v[176:179], v[148:151], v[60:63]
    s_waitcnt vmcnt(1) lgkmcnt(0)
    ds_add_u32 v19, v3 offset:144
    v_mfma_f32_16x16x32_bf16 v[64:67], v[176:179], v[152:155], v[64:67]
    s_add_u32 m0, s65, 22528
    s_lshl3_add_u32 s11, s65, 163840
    buffer_load_dwordx4 v12, s[48:51], s11 offen lds
    v_mfma_f32_16x16x32_bf16 v[68:71], v[180:183], v[148:151], v[68:71]
    v_mfma_f32_16x16x32_bf16 v[72:75], v[180:183], v[152:155], v[72:75]
    v_mfma_f32_16x16x32_bf16 v[76:79], v[184:187], v[148:151], v[76:79]
    v_mfma_f32_16x16x32_bf16 v[80:83], v[184:187], v[152:155], v[80:83]
    v_mfma_f32_16x16x32_bf16 v[84:87], v[188:191], v[148:151], v[84:87]
    v_mfma_f32_16x16x32_bf16 v[88:91], v[188:191], v[152:155], v[88:91]
    v_mfma_f32_16x16x32_bf16 v[32:35], v[116:119], v[108:111], v[32:35]
    ds_read_b32 v29, v2 offset:144
    v_mfma_f32_16x16x32_bf16 v[36:39], v[120:123], v[104:107], v[36:39]
    s_waitcnt lgkmcnt(0)
    s_setprio 2
    v_readfirstlane_b32 s76, v29
    s_setprio 0
    s_cmp_lt_u32 s76, 76
    s_cbranch_scc1 Lslow_326
Lback_327:
    ds_read_b128 v[148:151], v27 offset:32768
    ds_read_b128 v[152:155], v27 offset:34816
    ds_read_b64_tr_b16 v[160:161], v28 offset:15584
    v_mfma_f32_16x16x32_bf16 v[40:43], v[120:123], v[108:111], v[40:43]
    ds_read_b64_tr_b16 v[162:163], v28 offset:19424
    ds_read_b64_tr_b16 v[164:165], v28 offset:15616
    ds_read_b64_tr_b16 v[166:167], v28 offset:19456
    v_mfma_f32_16x16x32_bf16 v[44:47], v[124:127], v[104:107], v[44:47]
    ds_read_b64_tr_b16 v[168:169], v28 offset:15648
    ds_read_b64_tr_b16 v[170:171], v28 offset:19488
    ds_read_b64_tr_b16 v[172:173], v28 offset:15680
    v_mfma_f32_16x16x32_bf16 v[48:51], v[124:127], v[108:111], v[48:51]
    ds_read_b64_tr_b16 v[174:175], v28 offset:19520
    ds_read_b64_tr_b16 v[176:177], v28 offset:15712
    ds_read_b64_tr_b16 v[178:179], v28 offset:19552
    v_mfma_f32_16x16x32_bf16 v[52:55], v[128:131], v[104:107], v[52:55]
    ds_read_b64_tr_b16 v[180:181], v28 offset:15744
    ds_read_b64_tr_b16 v[182:183], v28 offset:19584
    ds_read_b64_tr_b16 v[184:185], v28 offset:15776
    v_mfma_f32_16x16x32_bf16 v[56:59], v[128:131], v[108:111], v[56:59]
    ds_read_b64_tr_b16 v[186:187], v28 offset:19616
    ds_read_b64_tr_b16 v[188:189], v28 offset:15808
    ds_read_b64_tr_b16 v[190:191], v28 offset:19648
    v_mfma_f32_16x16x32_bf16 v[60:63], v[132:135], v[104:107], v[60:63]
    s_waitcnt lgkmcnt(0)
    ds_add_u32 v19, v3 offset:124
    v_mfma_f32_16x16x32_bf16 v[64:67], v[132:135], v[108:111], v[64:67]
    s_add_u32 m0, s65, 27648
    s_lshl3_add_u32 s11, s65, 204800
    buffer_load_dwordx4 v12, s[48:51], s11 offen lds
    v_mfma_f32_16x16x32_bf16 v[68:71], v[136:139], v[104:107], v[68:71]
    v_mfma_f32_16x16x32_bf16 v[72:75], v[136:139], v[108:111], v[72:75]
    v_mfma_f32_16x16x32_bf16 v[76:79], v[140:143], v[104:107], v[76:79]
    v_mfma_f32_16x16x32_bf16 v[80:83], v[140:143], v[108:111], v[80:83]
    v_mfma_f32_16x16x32_bf16 v[84:87], v[144:147], v[104:107], v[84:87]
    v_mfma_f32_16x16x32_bf16 v[88:91], v[144:147], v[108:111], v[88:91]
    s_lshl3_add_u32 s84, s4, s5
    s_mul_i32 s85, s84, 5120
    s_add_u32 s85, s85, 16777216
    s_add_u32 s83, s85, 4096
    s_lshl_b32 s84, s84, 7
    s_add_u32 s84, s84, 786432
    s_mov_b32 s86, s39
    s_and_b32 s87, s4, 3
    s_cmp_eq_u32 s87, 3
    s_cselect_b32 s39, 0, s39
    v_mfma_f32_16x16x32_bf16 v[32:35], v[160:163], v[152:155], v[32:35]
    v_mfma_f32_16x16x32_bf16 v[36:39], v[164:167], v[148:151], v[36:39]
    ds_read_b32 v29, v2 offset:124
    v_mfma_f32_16x16x32_bf16 v[40:43], v[164:167], v[152:155], v[40:43]
    s_waitcnt lgkmcnt(0)
    s_setprio 2
    v_readfirstlane_b32 s76, v29
    s_setprio 0
    s_cmp_lt_u32 s76, 4
    s_cbranch_scc1 Lslow_330
Lback_331:
    v_mfma_f32_16x16x32_bf16 v[44:47], v[168:171], v[148:151], v[44:47]
    s_setprio 2
    v_cvt_pk_bf16_f32 v32, v32, v33
    v_cvt_pk_bf16_f32 v33, v34, v35
    s_setprio 0
    ds_write_b64 v205, v[32:33] offset:15424
    v_mfma_f32_16x16x32_bf16 v[48:51], v[168:171], v[152:155], v[48:51]
    s_setprio 2
    v_cvt_pk_bf16_f32 v36, v36, v37
    v_cvt_pk_bf16_f32 v37, v38, v39
    s_setprio 0
    ds_write_b64 v205, v[36:37] offset:12896
    v_mfma_f32_16x16x32_bf16 v[52:55], v[172:175], v[148:151], v[52:55]
    s_setprio 2
    v_cvt_pk_bf16_f32 v40, v40, v41
    v_cvt_pk_bf16_f32 v41, v42, v43
    s_setprio 0
    ds_write_b64 v205, v[40:41] offset:15456
    v_mfma_f32_16x16x32_bf16 v[56:59], v[172:175], v[152:155], v[56:59]
    s_setprio 2
    v_cvt_pk_bf16_f32 v44, v44, v45
    v_cvt_pk_bf16_f32 v45, v46, v47
    s_setprio 0
    ds_write_b64 v205, v[44:45] offset:12928
    v_mfma_f32_16x16x32_bf16 v[60:63], v[176:179], v[148:151], v[60:63]
    s_setprio 2
    v_cvt_pk_bf16_f32 v48, v48, v49
    v_cvt_pk_bf16_f32 v49, v50, v51
    s_setprio 0
    ds_write_b64 v205, v[48:49] offset:15488
    v_mfma_f32_16x16x32_bf16 v[64:67], v[176:179], v[152:155], v[64:67]
    s_setprio 2
    v_cvt_pk_bf16_f32 v52, v52, v53
    v_cvt_pk_bf16_f32 v53, v54, v55
    s_setprio 0
    ds_write_b64 v205, v[52:53] offset:25600
    v_mfma_f32_16x16x32_bf16 v[68:71], v[180:183], v[148:151], v[68:71]
    s_setprio 2
    v_cvt_pk_bf16_f32 v56, v56, v57
    v_cvt_pk_bf16_f32 v57, v58, v59
    s_setprio 0
    ds_write_b64 v205, v[56:57] offset:28160
    v_mfma_f32_16x16x32_bf16 v[72:75], v[180:183], v[152:155], v[72:75]
    s_setprio 2
    v_cvt_pk_bf16_f32 v60, v60, v61
    v_cvt_pk_bf16_f32 v61, v62, v63
    s_setprio 0
    ds_write_b64 v205, v[60:61] offset:25632
    v_mfma_f32_16x16x32_bf16 v[76:79], v[184:187], v[148:151], v[76:79]
    s_setprio 2
    v_cvt_pk_bf16_f32 v64, v64, v65
    v_cvt_pk_bf16_f32 v65, v66, v67
    s_setprio 0
    ds_write_b64 v205, v[64:65] offset:28192
    v_mfma_f32_16x16x32_bf16 v[80:83], v[184:187], v[152:155], v[80:83]
    s_setprio 2
    v_cvt_pk_bf16_f32 v68, v68, v69
    v_cvt_pk_bf16_f32 v69, v70, v71
    s_setprio 0
    ds_write_b64 v205, v[68:69] offset:25664
    v_mfma_f32_16x16x32_bf16 v[84:87], v[188:191], v[148:151], v[84:87]
    s_setprio 2
    v_cvt_pk_bf16_f32 v72, v72, v73
    v_cvt_pk_bf16_f32 v73, v74, v75
    s_setprio 0
    ds_write_b64 v205, v[72:73] offset:28224
    v_mfma_f32_16x16x32_bf16 v[88:91], v[188:191], v[152:155], v[88:91]
    s_setprio 2
    v_cvt_pk_bf16_f32 v76, v76, v77
    v_cvt_pk_bf16_f32 v77, v78, v79
    s_setprio 0
    ds_write_b64 v205, v[76:77] offset:25696
    s_setprio 2
    v_cvt_pk_bf16_f32 v80, v80, v81
    v_cvt_pk_bf16_f32 v81, v82, v83
    s_setprio 0
    ds_write_b64 v205, v[80:81] offset:28256
    s_setprio 2
    v_cvt_pk_bf16_f32 v84, v84, v85
    v_cvt_pk_bf16_f32 v85, v86, v87
    s_setprio 0
    ds_write_b64 v205, v[84:85] offset:25728
    s_setprio 2
    v_cvt_pk_bf16_f32 v88, v88, v89
    v_cvt_pk_bf16_f32 v89, v90, v91
    s_setprio 0
    ds_write_b64 v205, v[88:89] offset:28288
    ds_add_u32 v19, v3 offset:564
    s_setprio 2
    v_mov_b64 v[104:105], 0
    v_mov_b64 v[106:107], 0
    v_mov_b64 v[108:109], 0
    v_mov_b64 v[110:111], 0
    v_mov_b64 v[112:113], 0
    v_mov_b64 v[114:115], 0
    v_add_u32 v6, 125440, v225
    v_mov_b32 v4, 0
    s_cmp_eq_u32 s4, 0
    s_cbranch_scc1 Lhz_336
    s_sub_u32 s84, s84, 1024
    s_sub_u32 s85, s85, 38400
    s_mov_b32 s7, 0x8000
    s_mov_b64 exec, 1
Lh_334:
    buffer_load_dwordx2 v[8:9], v4, s[72:75], s84 offen sc1
    s_waitcnt vmcnt(0)
    v_readfirstlane_b32 s76, v8
    v_readfirstlane_b32 s77, v9
    s_xor_b32 s76, s76, s6
    s_xor_b32 s77, s77, s6
    s_or_b32 s76, s76, s77
    s_cbranch_scc0 Lhd_335
    s_sub_u32 s7, s7, 1
    s_cmp_lg_u32 s7, 0
    s_cbranch_scc1 Lh_334
Lhd_335:
    s_mov_b64 exec, -1
    buffer_load_dwordx4 v[104:107], v17, s[72:75], s85 offen sc1
    buffer_load_dwordx4 v[108:111], v17, s[72:75], s85 offen offset:1024 sc1
    s_mov_b32 exec_hi, 0
    buffer_load_dwordx4 v[112:115], v17, s[72:75], s85 offen offset:2048 sc1
    s_mov_b32 exec_hi, -1
    s_waitcnt vmcnt(0)
Lhz_336:
    ds_write_b128 v6, v[104:107]
    ds_write_b128 v6, v[108:111] offset:64
    s_mov_b32 exec_hi, 0
    ds_write_b128 v6, v[112:115] offset:128
    s_mov_b32 exec_hi, -1
    ds_add_u32 v19, v3 offset:604
    s_mov_b32 s39, s86
    s_waitcnt lgkmcnt(0)
    s_add_u32 m0, s65, 32768
    s_lshl3_add_u32 s11, s65, 245760
    buffer_load_dwordx4 v12, s[48:51], s11 offen lds
    s_add_u32 m0, s65, 37888
    s_lshl3_add_u32 s11, s65, 286720
    buffer_load_dwordx4 v12, s[48:51], s11 offen lds
    s_branch L_bg_done
L_bg3:
    ds_read_b128 v[104:107], v24 offset:0
    ds_read_b128 v[108:111], v24 offset:2048
    ds_read_b64_tr_b16 v[116:117], v28 offset:224
    ds_read_b64_tr_b16 v[118:119], v28 offset:4064
    ds_read_b64_tr_b16 v[120:121], v28 offset:256
    ds_read_b64_tr_b16 v[122:123], v28 offset:4096
    ds_read_b64_tr_b16 v[124:125], v28 offset:288
    ds_read_b64_tr_b16 v[126:127], v28 offset:4128
    ds_read_b64_tr_b16 v[128:129], v28 offset:320
    ds_read_b64_tr_b16 v[130:131], v28 offset:4160
    ds_read_b64_tr_b16 v[132:133], v28 offset:352
    ds_read_b64_tr_b16 v[134:135], v28 offset:4192
    ds_read_b64_tr_b16 v[136:137], v28 offset:384
    ds_read_b64_tr_b16 v[138:139], v28 offset:4224
    ds_read_b64_tr_b16 v[140:141], v28 offset:416
    ds_read_b64_tr_b16 v[142:143], v28 offset:4256
    ds_read_b64_tr_b16 v[144:145], v28 offset:448
    ds_read_b64_tr_b16 v[146:147], v28 offset:4288
    ds_read_b32 v9, v2 offset:632
    ds_read_b32 v7, v2 offset:112
    s_mov_b32 s48, s20
    s_mov_b32 s49, s21
    s_mov_b32 s50, 819200
    s_mov_b32 s51, 0x20000
    s_mov_b32 s60, s30
    s_mov_b32 s61, s31
    s_mov_b32 s62, 819200
    s_mov_b32 s63, 0x20000
    s_waitcnt lgkmcnt(0)
    v_mfma_f32_16x16x32_bf16 v[32:35], v[116:119], v[108:111], 0
    s_mov_b32 m0, 120832
    s_add_u32 s10, s8, 122880
    buffer_load_dwordx4 v20, s[44:47], s10 offen lds
    v_mfma_f32_16x16x32_bf16 v[36:39], v[120:123], v[108:111], 0
    s_mov_b32 m0, 124928
    s_nop 0
    buffer_load_dwordx4 v21, s[44:47], s10 offen lds
    v_mfma_f32_16x16x32_bf16 v[40:43], v[124:127], v[108:111], 0
    s_mov_b32 m0, 129024
    s_nop 0
    buffer_load_dwordx4 v22, s[44:47], s10 offen lds
    v_mfma_f32_16x16x32_bf16 v[44:47], v[128:131], v[108:111], 0
    s_mov_b32 m0, 136192
    s_add_u32 s10, s8, 245760
    buffer_load_dwordx4 v20, s[44:47], s10 offen lds
    v_mfma_f32_16x16x32_bf16 v[48:51], v[132:135], v[108:111], 0
    s_mov_b32 m0, 140288
    s_nop 0
    buffer_load_dwordx4 v21, s[44:47], s10 offen lds
    v_mfma_f32_16x16x32_bf16 v[52:55], v[136:139], v[108:111], 0
    s_mov_b32 m0, 144384
    s_nop 0
    buffer_load_dwordx4 v22, s[44:47], s10 offen lds
    s_setprio 2
    v_readfirstlane_b32 s6, v9
    v_readfirstlane_b32 s39, v7
    s_setprio 0
    v_mfma_f32_16x16x32_bf16 v[56:59], v[140:143], v[108:111], 0
    v_mfma_f32_16x16x32_bf16 v[60:63], v[144:147], v[108:111], 0
    v_mfma_f32_16x16x32_bf16 v[64:67], v[120:123], v[104:107], 0
    v_mfma_f32_16x16x32_bf16 v[68:71], v[124:127], v[104:107], 0
    s_waitcnt vmcnt(3) lgkmcnt(0)
    ds_add_u32 v19, v3 offset:144
    v_mfma_f32_16x16x32_bf16 v[72:75], v[128:131], v[104:107], 0
    ds_read_b32 v29, v2 offset:144
    v_mfma_f32_16x16x32_bf16 v[76:79], v[132:135], v[104:107], 0
    s_waitcnt lgkmcnt(0)
    s_setprio 2
    v_readfirstlane_b32 s76, v29
    s_setprio 0
    s_cmp_lt_u32 s76, 4
    s_cbranch_scc1 Lslow_337
Lback_338:
    ds_read_b128 v[148:151], v25 offset:0
    ds_read_b128 v[152:155], v25 offset:2048
    ds_read_b64_tr_b16 v[160:161], v28 offset:15584
    v_mfma_f32_16x16x32_bf16 v[80:83], v[136:139], v[104:107], 0
    ds_read_b64_tr_b16 v[162:163], v28 offset:19424
    ds_read_b64_tr_b16 v[164:165], v28 offset:15616
    ds_read_b64_tr_b16 v[166:167], v28 offset:19456
    v_mfma_f32_16x16x32_bf16 v[84:87], v[140:143], v[104:107], 0
    s_mov_b32 m0, 105472
    s_add_u32 s10, s8, 368640
    buffer_load_dwordx4 v20, s[44:47], s10 offen lds
    v_mfma_f32_16x16x32_bf16 v[88:91], v[144:147], v[104:107], 0
    ds_read_b64_tr_b16 v[168:169], v28 offset:15648
    ds_read_b64_tr_b16 v[170:171], v28 offset:19488
    ds_read_b64_tr_b16 v[172:173], v28 offset:15680
    ds_read_b64_tr_b16 v[174:175], v28 offset:19520
    ds_read_b64_tr_b16 v[176:177], v28 offset:15712
    ds_read_b64_tr_b16 v[178:179], v28 offset:19552
    s_mov_b32 m0, 109568
    s_nop 0
    buffer_load_dwordx4 v21, s[44:47], s10 offen lds
    ds_read_b64_tr_b16 v[180:181], v28 offset:15744
    ds_read_b64_tr_b16 v[182:183], v28 offset:19584
    ds_read_b64_tr_b16 v[184:185], v28 offset:15776
    ds_read_b64_tr_b16 v[186:187], v28 offset:19616
    ds_read_b64_tr_b16 v[188:189], v28 offset:15808
    ds_read_b64_tr_b16 v[190:191], v28 offset:19648
    s_mov_b32 m0, 113664
    s_nop 0
    buffer_load_dwordx4 v22, s[44:47], s10 offen lds
    s_waitcnt vmcnt(3) lgkmcnt(0)
    ds_add_u32 v19, v3 offset:144
    v_mfma_f32_16x16x32_bf16 v[32:35], v[160:163], v[152:155], v[32:35]
    ds_read_b32 v29, v2 offset:144
    v_mfma_f32_16x16x32_bf16 v[36:39], v[164:167], v[152:155], v[36:39]
    s_waitcnt lgkmcnt(0)
    s_setprio 2
    v_readfirstlane_b32 s76, v29
    s_setprio 0
    s_cmp_lt_u32 s76, 8
    s_cbranch_scc1 Lslow_341
Lback_342:
    ds_read_b128 v[104:107], v24 offset:8192
    ds_read_b128 v[108:111], v24 offset:10240
    ds_read_b64_tr_b16 v[116:117], v28 offset:30944
    v_mfma_f32_16x16x32_bf16 v[40:43], v[168:171], v[152:155], v[40:43]
    ds_read_b64_tr_b16 v[118:119], v28 offset:34784
    ds_read_b64_tr_b16 v[120:121], v28 offset:30976
    ds_read_b64_tr_b16 v[122:123], v28 offset:34816
    v_mfma_f32_16x16x32_bf16 v[44:47], v[172:175], v[152:155], v[44:47]
    s_mov_b32 m0, 120832
    s_add_u32 s10, s8, 491520
    buffer_load_dwordx4 v20, s[44:47], s10 offen lds
    v_mfma_f32_16x16x32_bf16 v[48:51], v[176:179], v[152:155], v[48:51]
    ds_read_b64_tr_b16 v[124:125], v28 offset:31008
    ds_read_b64_tr_b16 v[126:127], v28 offset:34848
    ds_read_b64_tr_b16 v[128:129], v28 offset:31040
    v_mfma_f32_16x16x32_bf16 v[52:55], v[180:183], v[152:155], v[52:55]
    ds_read_b64_tr_b16 v[130:131], v28 offset:34880
    ds_read_b64_tr_b16 v[132:133], v28 offset:31072
    ds_read_b64_tr_b16 v[134:135], v28 offset:34912
    v_mfma_f32_16x16x32_bf16 v[56:59], v[184:187], v[152:155], v[56:59]
    s_mov_b32 m0, 124928
    s_nop 0
    buffer_load_dwordx4 v21, s[44:47], s10 offen lds
    v_mfma_f32_16x16x32_bf16 v[60:63], v[188:191], v[152:155], v[60:63]
    ds_read_b64_tr_b16 v[136:137], v28 offset:31104
    ds_read_b64_tr_b16 v[138:139], v28 offset:34944
    ds_read_b64_tr_b16 v[140:141], v28 offset:31136
    v_mfma_f32_16x16x32_bf16 v[64:67], v[164:167], v[148:151], v[64:67]
    ds_read_b64_tr_b16 v[142:143], v28 offset:34976
    ds_read_b64_tr_b16 v[144:145], v28 offset:31168
    ds_read_b64_tr_b16 v[146:147], v28 offset:35008
    v_mfma_f32_16x16x32_bf16 v[68:71], v[168:171], v[148:151], v[68:71]
    s_mov_b32 m0, 129024
    s_nop 0
    buffer_load_dwordx4 v22, s[44:47], s10 offen lds
    v_mfma_f32_16x16x32_bf16 v[72:75], v[172:175], v[148:151], v[72:75]
    s_waitcnt vmcnt(3) lgkmcnt(0)
    ds_add_u32 v19, v3 offset:144
    ds_add_u32 v19, v3 offset:600
    v_mfma_f32_16x16x32_bf16 v[76:79], v[176:179], v[148:151], v[76:79]
    s_mov_b32 m0, 84992
    s_mov_b32 s11, 655360
    buffer_load_dwordx4 v13, s[48:51], s11 offen lds
    v_mfma_f32_16x16x32_bf16 v[80:83], v[180:183], v[148:151], v[80:83]
    s_mov_b32 m0, 86016
    s_nop 0
    buffer_load_dwordx4 v14, s[48:51], s11 offen lds
    v_mfma_f32_16x16x32_bf16 v[84:87], v[184:187], v[148:151], v[84:87]
    v_mfma_f32_16x16x32_bf16 v[88:91], v[188:191], v[148:151], v[88:91]
    v_mfma_f32_16x16x32_bf16 v[32:35], v[116:119], v[108:111], v[32:35]
    ds_read_b32 v29, v2 offset:144
    v_mfma_f32_16x16x32_bf16 v[36:39], v[120:123], v[108:111], v[36:39]
    s_waitcnt lgkmcnt(0)
    s_setprio 2
    v_readfirstlane_b32 s76, v29
    s_setprio 0
    s_cmp_lt_u32 s76, 12
    s_cbranch_scc1 Lslow_345
Lback_346:
    ds_read_b128 v[148:151], v25 offset:8192
    ds_read_b128 v[152:155], v25 offset:10240
    ds_read_b64_tr_b16 v[160:161], v28 offset:224
    v_mfma_f32_16x16x32_bf16 v[40:43], v[124:127], v[108:111], v[40:43]
    ds_read_b64_tr_b16 v[162:163], v28 offset:4064
    ds_read_b64_tr_b16 v[164:165], v28 offset:256
    ds_read_b64_tr_b16 v[166:167], v28 offset:4096
    v_mfma_f32_16x16x32_bf16 v[44:47], v[128:131], v[108:111], v[44:47]
    s_mov_b32 m0, 136192
    s_add_u32 s10, s8, 614400
    buffer_load_dwordx4 v20, s[44:47], s10 offen lds
    v_mfma_f32_16x16x32_bf16 v[48:51], v[132:135], v[108:111], v[48:51]
    ds_read_b64_tr_b16 v[168:169], v28 offset:288
    ds_read_b64_tr_b16 v[170:171], v28 offset:4128
    ds_read_b64_tr_b16 v[172:173], v28 offset:320
    v_mfma_f32_16x16x32_bf16 v[52:55], v[136:139], v[108:111], v[52:55]
    ds_read_b64_tr_b16 v[174:175], v28 offset:4160
    ds_read_b64_tr_b16 v[176:177], v28 offset:352
    ds_read_b64_tr_b16 v[178:179], v28 offset:4192
    v_mfma_f32_16x16x32_bf16 v[56:59], v[140:143], v[108:111], v[56:59]
    s_mov_b32 m0, 140288
    s_nop 0
    buffer_load_dwordx4 v21, s[44:47], s10 offen lds
    v_mfma_f32_16x16x32_bf16 v[60:63], v[144:147], v[108:111], v[60:63]
    ds_read_b64_tr_b16 v[180:181], v28 offset:384
    ds_read_b64_tr_b16 v[182:183], v28 offset:4224
    ds_read_b64_tr_b16 v[184:185], v28 offset:416
    v_mfma_f32_16x16x32_bf16 v[64:67], v[120:123], v[104:107], v[64:67]
    ds_read_b64_tr_b16 v[186:187], v28 offset:4256
    ds_read_b64_tr_b16 v[188:189], v28 offset:448
    ds_read_b64_tr_b16 v[190:191], v28 offset:4288
    v_mfma_f32_16x16x32_bf16 v[68:71], v[124:127], v[104:107], v[68:71]
    s_mov_b32 m0, 144384
    s_nop 0
    buffer_load_dwordx4 v22, s[44:47], s10 offen lds
    v_mfma_f32_16x16x32_bf16 v[72:75], v[128:131], v[104:107], v[72:75]
    s_waitcnt vmcnt(5) lgkmcnt(0)
    ds_add_u32 v19, v3 offset:144
    v_mfma_f32_16x16x32_bf16 v[76:79], v[132:135], v[104:107], v[76:79]
    s_mov_b32 m0, 90112
    s_mov_b32 s11, 696320
    buffer_load_dwordx4 v13, s[48:51], s11 offen lds
    v_mfma_f32_16x16x32_bf16 v[80:83], v[136:139], v[104:107], v[80:83]
    s_mov_b32 m0, 91136
    s_nop 0
    buffer_load_dwordx4 v14, s[48:51], s11 offen lds
    v_mfma_f32_16x16x32_bf16 v[84:87], v[140:143], v[104:107], v[84:87]
    v_mfma_f32_16x16x32_bf16 v[88:91], v[144:147], v[104:107], v[88:91]
    v_mfma_f32_16x16x32_bf16 v[32:35], v[160:163], v[152:155], v[32:35]
    ds_read_b32 v29, v2 offset:144
    v_mfma_f32_16x16x32_bf16 v[36:39], v[164:167], v[152:155], v[36:39]
    s_waitcnt lgkmcnt(0)
    s_setprio 2
    v_readfirstlane_b32 s76, v29
    s_setprio 0
    s_cmp_lt_u32 s76, 16
    s_cbranch_scc1 Lslow_349
Lback_350:
    ds_read_b128 v[104:107], v24 offset:16384
    ds_read_b128 v[108:111], v24 offset:18432
    ds_read_b64_tr_b16 v[116:117], v28 offset:15584
    v_mfma_f32_16x16x32_bf16 v[40:43], v[168:171], v[152:155], v[40:43]
    ds_read_b64_tr_b16 v[118:119], v28 offset:19424
    ds_read_b64_tr_b16 v[120:121], v28 offset:15616
    ds_read_b64_tr_b16 v[122:123], v28 offset:19456
    v_mfma_f32_16x16x32_bf16 v[44:47], v[172:175], v[152:155], v[44:47]
    s_mov_b32 m0, 105472
    s_add_u32 s10, s8, 737280
    buffer_load_dwordx4 v20, s[44:47], s10 offen lds
    v_mfma_f32_16x16x32_bf16 v[48:51], v[176:179], v[152:155], v[48:51]
    ds_read_b64_tr_b16 v[124:125], v28 offset:15648
    ds_read_b64_tr_b16 v[126:127], v28 offset:19488
    ds_read_b64_tr_b16 v[128:129], v28 offset:15680
    v_mfma_f32_16x16x32_bf16 v[52:55], v[180:183], v[152:155], v[52:55]
    ds_read_b64_tr_b16 v[130:131], v28 offset:19520
    ds_read_b64_tr_b16 v[132:133], v28 offset:15712
    ds_read_b64_tr_b16 v[134:135], v28 offset:19552
    v_mfma_f32_16x16x32_bf16 v[56:59], v[184:187], v[152:155], v[56:59]
    s_mov_b32 m0, 109568
    s_nop 0
    buffer_load_dwordx4 v21, s[44:47], s10 offen lds
    v_mfma_f32_16x16x32_bf16 v[60:63], v[188:191], v[152:155], v[60:63]
    ds_read_b64_tr_b16 v[136:137], v28 offset:15744
    ds_read_b64_tr_b16 v[138:139], v28 offset:19584
    ds_read_b64_tr_b16 v[140:141], v28 offset:15776
    v_mfma_f32_16x16x32_bf16 v[64:67], v[164:167], v[148:151], v[64:67]
    ds_read_b64_tr_b16 v[142:143], v28 offset:19616
    ds_read_b64_tr_b16 v[144:145], v28 offset:15808
    ds_read_b64_tr_b16 v[146:147], v28 offset:19648
    v_mfma_f32_16x16x32_bf16 v[68:71], v[168:171], v[148:151], v[68:71]
    s_mov_b32 m0, 113664
    s_nop 0
    buffer_load_dwordx4 v22, s[44:47], s10 offen lds
    v_mfma_f32_16x16x32_bf16 v[72:75], v[172:175], v[148:151], v[72:75]
    s_waitcnt vmcnt(5) lgkmcnt(0)
    ds_add_u32 v19, v3 offset:144
    v_mfma_f32_16x16x32_bf16 v[76:79], v[176:179], v[148:151], v[76:79]
    s_mov_b32 m0, 95232
    s_mov_b32 s11, 737280
    buffer_load_dwordx4 v13, s[48:51], s11 offen lds
    v_mfma_f32_16x16x32_bf16 v[80:83], v[180:183], v[148:151], v[80:83]
    s_mov_b32 m0, 96256
    s_nop 0
    buffer_load_dwordx4 v14, s[48:51], s11 offen lds
    v_mfma_f32_16x16x32_bf16 v[84:87], v[184:187], v[148:151], v[84:87]
    v_mfma_f32_16x16x32_bf16 v[88:91], v[188:191], v[148:151], v[88:91]
    v_mfma_f32_16x16x32_bf16 v[32:35], v[116:119], v[108:111], v[32:35]
    ds_read_b32 v29, v2 offset:144
    v_mfma_f32_16x16x32_bf16 v[36:39], v[120:123], v[108:111], v[36:39]
    s_waitcnt lgkmcnt(0)
    s_setprio 2
    v_readfirstlane_b32 s76, v29
    s_setprio 0
    s_cmp_lt_u32 s76, 20
    s_cbranch_scc1 Lslow_353
Lback_354:
    ds_read_b128 v[148:151], v25 offset:16384
    ds_read_b128 v[152:155], v25 offset:18432
    ds_read_b64_tr_b16 v[160:161], v28 offset:30944
    v_mfma_f32_16x16x32_bf16 v[40:43], v[124:127], v[108:111], v[40:43]
    ds_read_b64_tr_b16 v[162:163], v28 offset:34784
    ds_read_b64_tr_b16 v[164:165], v28 offset:30976
    ds_read_b64_tr_b16 v[166:167], v28 offset:34816
    v_mfma_f32_16x16x32_bf16 v[44:47], v[128:131], v[108:111], v[44:47]
    s_mov_b32 m0, 120832
    s_add_u32 s10, s8, 860160
    buffer_load_dwordx4 v20, s[44:47], s10 offen lds
    v_mfma_f32_16x16x32_bf16 v[48:51], v[132:135], v[108:111], v[48:51]
    ds_read_b64_tr_b16 v[168:169], v28 offset:31008
    ds_read_b64_tr_b16 v[170:171], v28 offset:34848
    ds_read_b64_tr_b16 v[172:173], v28 offset:31040
    v_mfma_f32_16x16x32_bf16 v[52:55], v[136:139], v[108:111], v[52:55]
    ds_read_b64_tr_b16 v[174:175], v28 offset:34880
    ds_read_b64_tr_b16 v[176:177], v28 offset:31072
    ds_read_b64_tr_b16 v[178:179], v28 offset:34912
    v_mfma_f32_16x16x32_bf16 v[56:59], v[140:143], v[108:111], v[56:59]
    s_mov_b32 m0, 124928
    s_nop 0
    buffer_load_dwordx4 v21, s[44:47], s10 offen lds
    v_mfma_f32_16x16x32_bf16 v[60:63], v[144:147], v[108:111], v[60:63]
    ds_read_b64_tr_b16 v[180:181], v28 offset:31104
    ds_read_b64_tr_b16 v[182:183], v28 offset:34944
    ds_read_b64_tr_b16 v[184:185], v28 offset:31136
    v_mfma_f32_16x16x32_bf16 v[64:67], v[120:123], v[104:107], v[64:67]
    ds_read_b64_tr_b16 v[186:187], v28 offset:34976
    ds_read_b64_tr_b16 v[188:189], v28 offset:31168
    ds_read_b64_tr_b16 v[190:191], v28 offset:35008
    v_mfma_f32_16x16x32_bf16 v[68:71], v[124:127], v[104:107], v[68:71]
    s_mov_b32 m0, 129024
    s_nop 0
    buffer_load_dwordx4 v22, s[44:47], s10 offen lds
    v_mfma_f32_16x16x32_bf16 v[72:75], v[128:131], v[104:107], v[72:75]
    s_waitcnt vmcnt(5) lgkmcnt(0)
    ds_add_u32 v19, v3 offset:144
    v_mfma_f32_16x16x32_bf16 v[76:79], v[132:135], v[104:107], v[76:79]
    s_mov_b32 m0, 100352
    s_mov_b32 s11, 778240
    buffer_load_dwordx4 v13, s[48:51], s11 offen lds
    v_mfma_f32_16x16x32_bf16 v[80:83], v[136:139], v[104:107], v[80:83]
    s_mov_b32 m0, 101376
    s_nop 0
    buffer_load_dwordx4 v14, s[48:51], s11 offen lds
    v_mfma_f32_16x16x32_bf16 v[84:87], v[140:143], v[104:107], v[84:87]
    v_mfma_f32_16x16x32_bf16 v[88:91], v[144:147], v[104:107], v[88:91]
    v_mfma_f32_16x16x32_bf16 v[32:35], v[160:163], v[152:155], v[32:35]
    ds_read_b32 v29, v2 offset:144
    v_mfma_f32_16x16x32_bf16 v[36:39], v[164:167], v[152:155], v[36:39]
    s_waitcnt lgkmcnt(0)
    s_setprio 2
    v_readfirstlane_b32 s76, v29
    s_setprio 0
    s_cmp_lt_u32 s76, 24
    s_cbranch_scc1 Lslow_357
Lback_358:
    ds_read_b128 v[104:107], v24 offset:24576
    ds_read_b128 v[108:111], v24 offset:26624
    ds_read_b64_tr_b16 v[116:117], v28 offset:224
    v_mfma_f32_16x16x32_bf16 v[40:43], v[168:171], v[152:155], v[40:43]
    ds_read_b64_tr_b16 v[118:119], v28 offset:4064
    ds_read_b64_tr_b16 v[120:121], v28 offset:256
    ds_read_b64_tr_b16 v[122:123], v28 offset:4096
    v_mfma_f32_16x16x32_bf16 v[44:47], v[172:175], v[152:155], v[44:47]
    s_mov_b32 m0, 136192
    s_add_u32 s10, s8, 983040
    buffer_load_dwordx4 v20, s[44:47], s10 offen lds
    v_mfma_f32_16x16x32_bf16 v[48:51], v[176:179], v[152:155], v[48:51]
    ds_read_b64_tr_b16 v[124:125], v28 offset:288
    ds_read_b64_tr_b16 v[126:127], v28 offset:4128
    ds_read_b64_tr_b16 v[128:129], v28 offset:320
    v_mfma_f32_16x16x32_bf16 v[52:55], v[180:183], v[152:155], v[52:55]
    ds_read_b64_tr_b16 v[130:131], v28 offset:4160
    ds_read_b64_tr_b16 v[132:133], v28 offset:352
    ds_read_b64_tr_b16 v[134:135], v28 offset:4192
    v_mfma_f32_16x16x32_bf16 v[56:59], v[184:187], v[152:155], v[56:59]
    s_mov_b32 m0, 140288
    s_nop 0
    buffer_load_dwordx4 v21, s[44:47], s10 offen lds
    v_mfma_f32_16x16x32_bf16 v[60:63], v[188:191], v[152:155], v[60:63]
    ds_read_b64_tr_b16 v[136:137], v28 offset:384
    ds_read_b64_tr_b16 v[138:139], v28 offset:4224
    ds_read_b64_tr_b16 v[140:141], v28 offset:416
    v_mfma_f32_16x16x32_bf16 v[64:67], v[164:167], v[148:151], v[64:67]
    ds_read_b64_tr_b16 v[142:143], v28 offset:4256
    ds_read_b64_tr_b16 v[144:145], v28 offset:448
    ds_read_b64_tr_b16 v[146:147], v28 offset:4288
    v_mfma_f32_16x16x32_bf16 v[68:71], v[168:171], v[148:151], v[68:71]
    s_mov_b32 m0, 144384
    s_nop 0
    buffer_load_dwordx4 v22, s[44:47], s10 offen lds
    v_mfma_f32_16x16x32_bf16 v[72:75], v[172:175], v[148:151], v[72:75]
    s_waitcnt vmcnt(5) lgkmcnt(0)
    ds_add_u32 v19, v3 offset:144
    v_mfma_f32_16x16x32_bf16 v[76:79], v[176:179], v[148:151], v[76:79]
    s_add_u32 m0, s64, 3072
    s_lshl3_add_u32 s11, s64, 0
    buffer_load_dwordx4 v13, s[48:51], s11 offen lds
    v_mfma_f32_16x16x32_bf16 v[80:83], v[180:183], v[148:151], v[80:83]
    s_add_u32 m0, s64, 4096
    s_nop 0
    buffer_load_dwordx4 v14, s[48:51], s11 offen lds
    v_mfma_f32_16x16x32_bf16 v[84:87], v[184:187], v[148:151], v[84:87]
    v_mfma_f32_16x16x32_bf16 v[88:91], v[188:191], v[148:151], v[88:91]
    v_mfma_f32_16x16x32_bf16 v[32:35], v[116:119], v[108:111], v[32:35]
    ds_read_b32 v29, v2 offset:144
    v_mfma_f32_16x16x32_bf16 v[36:39], v[120:123], v[108:111], v[36:39]
    s_waitcnt lgkmcnt(0)
    s_setprio 2
    v_readfirstlane_b32 s76, v29
    s_setprio 0
    s_cmp_lt_u32 s76, 28
    s_cbranch_scc1 Lslow_361
Lback_362:
    ds_read_b128 v[148:151], v25 offset:24576
    ds_read_b128 v[152:155], v25 offset:26624
    ds_read_b64_tr_b16 v[160:161], v28 offset:15584
    v_mfma_f32_16x16x32_bf16 v[40:43], v[124:127], v[108:111], v[40:43]
    ds_read_b64_tr_b16 v[162:163], v28 offset:19424
    ds_read_b64_tr_b16 v[164:165], v28 offset:15616
    ds_read_b64_tr_b16 v[166:167], v28 offset:19456
    v_mfma_f32_16x16x32_bf16 v[44:47], v[128:131], v[108:111], v[44:47]
    s_mov_b32 m0, 105472
    s_add_u32 s10, s8, 1105920
    buffer_load_dwordx4 v20, s[44:47], s10 offen lds
    v_mfma_f32_16x16x32_bf16 v[48:51], v[132:135], v[108:111], v[48:51]
    ds_read_b64_tr_b16 v[168:169], v28 offset:15648
    ds_read_b64_tr_b16 v[170:171], v28 offset:19488
    ds_read_b64_tr_b16 v[172:173], v28 offset:15680
    v_mfma_f32_16x16x32_bf16 v[52:55], v[136:139], v[108:111], v[52:55]
    ds_read_b64_tr_b16 v[174:175], v28 offset:19520
    ds_read_b64_tr_b16 v[176:177], v28 offset:15712
    ds_read_b64_tr_b16 v[178:179], v28 offset:19552
    v_mfma_f32_16x16x32_bf16 v[56:59], v[140:143], v[108:111], v[56:59]
    s_mov_b32 m0, 109568
    s_nop 0
    buffer_load_dwordx4 v21, s[44:47], s10 offen lds
    v_mfma_f32_16x16x32_bf16 v[60:63], v[144:147], v[108:111], v[60:63]
    ds_read_b64_tr_b16 v[180:181], v28 offset:15744
    ds_read_b64_tr_b16 v[182:183], v28 offset:19584
    ds_read_b64_tr_b16 v[184:185], v28 offset:15776
    v_mfma_f32_16x16x32_bf16 v[64:67], v[120:123], v[104:107], v[64:67]
    ds_read_b64_tr_b16 v[186:187], v28 offset:19616
    ds_read_b64_tr_b16 v[188:189], v28 offset:15808
    ds_read_b64_tr_b16 v[190:191], v28 offset:19648
    v_mfma_f32_16x16x32_bf16 v[68:71], v[124:127], v[104:107], v[68:71]
    s_mov_b32 m0, 113664
    s_nop 0
    buffer_load_dwordx4 v22, s[44:47], s10 offen lds
    v_mfma_f32_16x16x32_bf16 v[72:75], v[128:131], v[104:107], v[72:75]
    s_waitcnt vmcnt(5) lgkmcnt(0)
    ds_add_u32 v19, v3 offset:144
    v_mfma_f32_16x16x32_bf16 v[76:79], v[132:135], v[104:107], v[76:79]
    s_add_u32 m0, s64, 8192
    s_lshl3_add_u32 s11, s64, 40960
    buffer_load_dwordx4 v13, s[48:51], s11 offen lds
    v_mfma_f32_16x16x32_bf16 v[80:83], v[136:139], v[104:107], v[80:83]
    s_add_u32 m0, s64, 9216
    s_nop 0
    buffer_load_dwordx4 v14, s[48:51], s11 offen lds
    v_mfma_f32_16x16x32_bf16 v[84:87], v[140:143], v[104:107], v[84:87]
    v_mfma_f32_16x16x32_bf16 v[88:91], v[144:147], v[104:107], v[88:91]
    v_mfma_f32_16x16x32_bf16 v[32:35], v[160:163], v[152:155], v[32:35]
    ds_read_b32 v29, v2 offset:144
    v_mfma_f32_16x16x32_bf16 v[36:39], v[164:167], v[152:155], v[36:39]
    s_waitcnt lgkmcnt(0)
    s_setprio 2
    v_readfirstlane_b32 s76, v29
    s_setprio 0
    s_cmp_lt_u32 s76, 32
    s_cbranch_scc1 Lslow_365
Lback_366:
    ds_read_b128 v[104:107], v24 offset:32768
    ds_read_b128 v[108:111], v24 offset:34816
    ds_read_b64_tr_b16 v[116:117], v28 offset:30944
    v_mfma_f32_16x16x32_bf16 v[40:43], v[168:171], v[152:155], v[40:43]
    ds_read_b64_tr_b16 v[118:119], v28 offset:34784
    ds_read_b64_tr_b16 v[120:121], v28 offset:30976
    ds_read_b64_tr_b16 v[122:123], v28 offset:34816
    v_mfma_f32_16x16x32_bf16 v[44:47], v[172:175], v[152:155], v[44:47]
    s_mov_b32 m0, 120832
    s_add_u32 s10, s9, 0
    buffer_load_dwordx4 v20, s[44:47], s10 offen lds
    v_mfma_f32_16x16x32_bf16 v[48:51], v[176:179], v[152:155], v[48:51]
    ds_read_b64_tr_b16 v[124:125], v28 offset:31008
    ds_read_b64_tr_b16 v[126:127], v28 offset:34848
    ds_read_b64_tr_b16 v[128:129], v28 offset:31040
    v_mfma_f32_16x16x32_bf16 v[52:55], v[180:183], v[152:155], v[52:55]
    ds_read_b64_tr_b16 v[130:131], v28 offset:34880
    ds_read_b64_tr_b16 v[132:133], v28 offset:31072
    ds_read_b64_tr_b16 v[134:135], v28 offset:34912
    v_mfma_f32_16x16x32_bf16 v[56:59], v[184:187], v[152:155], v[56:59]
    s_mov_b32 m0, 124928
    s_nop 0
    buffer_load_dwordx4 v21, s[44:47], s10 offen lds
    v_mfma_f32_16x16x32_bf16 v[60:63], v[188:191], v[152:155], v[60:63]
    ds_read_b64_tr_b16 v[136:137], v28 offset:31104
    ds_read_b64_tr_b16 v[138:139], v28 offset:34944
    ds_read_b64_tr_b16 v[140:141], v28 offset:31136
    v_mfma_f32_16x16x32_bf16 v[64:67], v[164:167], v[148:151], v[64:67]
    ds_read_b64_tr_b16 v[142:143], v28 offset:34976
    ds_read_b64_tr_b16 v[144:145], v28 offset:31168
    ds_read_b64_tr_b16 v[146:147], v28 offset:35008
    v_mfma_f32_16x16x32_bf16 v[68:71], v[168:171], v[148:151], v[68:71]
    s_mov_b32 m0, 129024
    s_nop 0
    buffer_load_dwordx4 v22, s[44:47], s10 offen lds
    v_mfma_f32_16x16x32_bf16 v[72:75], v[172:175], v[148:151], v[72:75]
    s_waitcnt vmcnt(5) lgkmcnt(0)
    ds_add_u32 v19, v3 offset:144
    v_mfma_f32_16x16x32_bf16 v[76:79], v[176:179], v[148:151], v[76:79]
    s_add_u32 m0, s64, 13312
    s_lshl3_add_u32 s11, s64, 81920
    buffer_load_dwordx4 v13, s[48:51], s11 offen lds
    v_mfma_f32_16x16x32_bf16 v[80:83], v[180:183], v[148:151], v[80:83]
    s_add_u32 m0, s64, 14336
    s_nop 0
    buffer_load_dwordx4 v14, s[48:51], s11 offen lds
    v_mfma_f32_16x16x32_bf16 v[84:87], v[184:187], v[148:151], v[84:87]
    v_mfma_f32_16x16x32_bf16 v[88:91], v[188:191], v[148:151], v[88:91]
    v_mfma_f32_16x16x32_bf16 v[32:35], v[116:119], v[108:111], v[32:35]
    ds_read_b32 v29, v2 offset:144
    v_mfma_f32_16x16x32_bf16 v[36:39], v[120:123], v[108:111], v[36:39]
    s_waitcnt lgkmcnt(0)
    s_setprio 2
    v_readfirstlane_b32 s76, v29
    s_setprio 0
    s_cmp_lt_u32 s76, 36
    s_cbranch_scc1 Lslow_369
Lback_370:
    ds_read_b128 v[148:151], v25 offset:32768
    ds_read_b128 v[152:155], v25 offset:34816
    ds_read_b64_tr_b16 v[160:161], v28 offset:224
    v_mfma_f32_16x16x32_bf16 v[40:43], v[124:127], v[108:111], v[40:43]
    ds_read_b64_tr_b16 v[162:163], v28 offset:4064
    ds_read_b64_tr_b16 v[164:165], v28 offset:256
    ds_read_b64_tr_b16 v[166:167], v28 offset:4096
    v_mfma_f32_16x16x32_bf16 v[44:47], v[128:131], v[108:111], v[44:47]
    s_mov_b32 m0, 136192
    s_add_u32 s10, s9, 122880
    buffer_load_dwordx4 v20, s[44:47], s10 offen lds
    v_mfma_f32_16x16x32_bf16 v[48:51], v[132:135], v[108:111], v[48:51]
    ds_read_b64_tr_b16 v[168:169], v28 offset:288
    ds_read_b64_tr_b16 v[170:171], v28 offset:4128
    ds_read_b64_tr_b16 v[172:173], v28 offset:320
    v_mfma_f32_16x16x32_bf16 v[52:55], v[136:139], v[108:111], v[52:55]
    ds_read_b64_tr_b16 v[174:175], v28 offset:4160
    ds_read_b64_tr_b16 v[176:177], v28 offset:352
    ds_read_b64_tr_b16 v[178:179], v28 offset:4192
    v_mfma_f32_16x16x32_bf16 v[56:59], v[140:143], v[108:111], v[56:59]
    s_mov_b32 m0, 140288
    s_nop 0
    buffer_load_dwordx4 v21, s[44:47], s10 offen lds
    v_mfma_f32_16x16x32_bf16 v[60:63], v[144:147], v[108:111], v[60:63]
    ds_read_b64_tr_b16 v[180:181], v28 offset:384
    ds_read_b64_tr_b16 v[182:183], v28 offset:4224
    ds_read_b64_tr_b16 v[184:185], v28 offset:416
    v_mfma_f32_16x16x32_bf16 v[64:67], v[120:123], v[104:107], v[64:67]
    ds_read_b64_tr_b16 v[186:187], v28 offset:4256
    ds_read_b64_tr_b16 v[188:189], v28 offset:448
    ds_read_b64_tr_b16 v[190:191], v28 offset:4288
    v_mfma_f32_16x16x32_bf16 v[68:71], v[124:127], v[104:107], v[68:71]
    s_mov_b32 m0, 144384
    s_nop 0
    buffer_load_dwordx4 v22, s[44:47], s10 offen lds
    v_mfma_f32_16x16x32_bf16 v[72:75], v[128:131], v[104:107], v[72:75]
    s_waitcnt vmcnt(5) lgkmcnt(0)
    ds_add_u32 v19, v3 offset:144
    v_mfma_f32_16x16x32_bf16 v[76:79], v[132:135], v[104:107], v[76:79]
    s_add_u32 m0, s64, 18432
    s_lshl3_add_u32 s11, s64, 122880
    buffer_load_dwordx4 v13, s[48:51], s11 offen lds
    v_mfma_f32_16x16x32_bf16 v[80:83], v[136:139], v[104:107], v[80:83]
    s_add_u32 m0, s64, 19456
    s_nop 0
    buffer_load_dwordx4 v14, s[48:51], s11 offen lds
    v_mfma_f32_16x16x32_bf16 v[84:87], v[140:143], v[104:107], v[84:87]
    v_mfma_f32_16x16x32_bf16 v[88:91], v[144:147], v[104:107], v[88:91]
    v_mfma_f32_16x16x32_bf16 v[32:35], v[160:163], v[152:155], v[32:35]
    ds_read_b32 v29, v2 offset:144
    v_mfma_f32_16x16x32_bf16 v[36:39], v[164:167], v[152:155], v[36:39]
    s_waitcnt lgkmcnt(0)
    s_setprio 2
    v_readfirstlane_b32 s76, v29
    s_setprio 0
    s_cmp_lt_u32 s76, 40
    s_cbranch_scc1 Lslow_373
Lback_374:
    ds_read_b128 v[104:107], v26 offset:0
    ds_read_b128 v[108:111], v26 offset:2048
    ds_read_b64_tr_b16 v[116:117], v28 offset:15584
    v_mfma_f32_16x16x32_bf16 v[40:43], v[168:171], v[152:155], v[40:43]
    ds_read_b64_tr_b16 v[118:119], v28 offset:19424
    ds_read_b64_tr_b16 v[120:121], v28 offset:15616
    ds_read_b64_tr_b16 v[122:123], v28 offset:19456
    v_mfma_f32_16x16x32_bf16 v[44:47], v[172:175], v[152:155], v[44:47]
    s_mov_b32 m0, 105472
    s_add_u32 s10, s9, 245760
    buffer_load_dwordx4 v20, s[44:47], s10 offen lds
    v_mfma_f32_16x16x32_bf16 v[48:51], v[176:179], v[152:155], v[48:51]
    ds_read_b64_tr_b16 v[124:125], v28 offset:15648
    ds_read_b64_tr_b16 v[126:127], v28 offset:19488
    ds_read_b64_tr_b16 v[128:129], v28 offset:15680
    v_mfma_f32_16x16x32_bf16 v[52:55], v[180:183], v[152:155], v[52:55]
    ds_read_b64_tr_b16 v[130:131], v28 offset:19520
    ds_read_b64_tr_b16 v[132:133], v28 offset:15712
    ds_read_b64_tr_b16 v[134:135], v28 offset:19552
    v_mfma_f32_16x16x32_bf16 v[56:59], v[184:187], v[152:155], v[56:59]
    s_mov_b32 m0, 109568
    s_nop 0
    buffer_load_dwordx4 v21, s[44:47], s10 offen lds
    v_mfma_f32_16x16x32_bf16 v[60:63], v[188:191], v[152:155], v[60:63]
    ds_read_b64_tr_b16 v[136:137], v28 offset:15744
    ds_read_b64_tr_b16 v[138:139], v28 offset:19584
    ds_read_b64_tr_b16 v[140:141], v28 offset:15776
    v_mfma_f32_16x16x32_bf16 v[64:67], v[164:167], v[148:151], v[64:67]
    ds_read_b64_tr_b16 v[142:143], v28 offset:19616
    ds_read_b64_tr_b16 v[144:145], v28 offset:15808
    ds_read_b64_tr_b16 v[146:147], v28 offset:19648
    v_mfma_f32_16x16x32_bf16 v[68:71], v[168:171], v[148:151], v[68:71]
    s_mov_b32 m0, 113664
    s_nop 0
    buffer_load_dwordx4 v22, s[44:47], s10 offen lds
    v_mfma_f32_16x16x32_bf16 v[72:75], v[172:175], v[148:151], v[72:75]
    s_waitcnt vmcnt(5) lgkmcnt(0)
    ds_add_u32 v19, v3 offset:144
    v_mfma_f32_16x16x32_bf16 v[76:79], v[176:179], v[148:151], v[76:79]
    s_add_u32 m0, s64, 23552
    s_lshl3_add_u32 s11, s64, 163840
    buffer_load_dwordx4 v13, s[48:51], s11 offen lds
    v_mfma_f32_16x16x32_bf16 v[80:83], v[180:183], v[148:151], v[80:83]
    s_add_u32 m0, s64, 24576
    s_nop 0
    buffer_load_dwordx4 v14, s[48:51], s11 offen lds
    v_mfma_f32_16x16x32_bf16 v[84:87], v[184:187], v[148:151], v[84:87]
    v_mfma_f32_16x16x32_bf16 v[88:91], v[188:191], v[148:151], v[88:91]
    v_mfma_f32_16x16x32_bf16 v[32:35], v[116:119], v[108:111], v[32:35]
    ds_read_b32 v29, v2 offset:144
    v_mfma_f32_16x16x32_bf16 v[36:39], v[120:123], v[108:111], v[36:39]
    s_waitcnt lgkmcnt(0)
    s_setprio 2
    v_readfirstlane_b32 s76, v29
    s_setprio 0
    s_cmp_lt_u32 s76, 44
    s_cbranch_scc1 Lslow_377
Lback_378:
    ds_read_b128 v[148:151], v27 offset:0
    ds_read_b128 v[152:155], v27 offset:2048
    ds_read_b64_tr_b16 v[160:161], v28 offset:30944
    v_mfma_f32_16x16x32_bf16 v[40:43], v[124:127], v[108:111], v[40:43]
    ds_read_b64_tr_b16 v[162:163], v28 offset:34784
    ds_read_b64_tr_b16 v[164:165], v28 offset:30976
    ds_read_b64_tr_b16 v[166:167], v28 offset:34816
    v_mfma_f32_16x16x32_bf16 v[44:47], v[128:131], v[108:111], v[44:47]
    s_mov_b32 m0, 120832
    s_add_u32 s10, s9, 368640
    buffer_load_dwordx4 v20, s[44:47], s10 offen lds
    v_mfma_f32_16x16x32_bf16 v[48:51], v[132:135], v[108:111], v[48:51]
    ds_read_b64_tr_b16 v[168:169], v28 offset:31008
    ds_read_b64_tr_b16 v[170:171], v28 offset:34848
    ds_read_b64_tr_b16 v[172:173], v28 offset:31040
    v_mfma_f32_16x16x32_bf16 v[52:55], v[136:139], v[108:111], v[52:55]
    ds_read_b64_tr_b16 v[174:175], v28 offset:34880
    ds_read_b64_tr_b16 v[176:177], v28 offset:31072
    ds_read_b64_tr_b16 v[178:179], v28 offset:34912
    v_mfma_f32_16x16x32_bf16 v[56:59], v[140:143], v[108:111], v[56:59]
    s_mov_b32 m0, 124928
    s_nop 0
    buffer_load_dwordx4 v21, s[44:47], s10 offen lds
    v_mfma_f32_16x16x32_bf16 v[60:63], v[144:147], v[108:111], v[60:63]
    ds_read_b64_tr_b16 v[180:181], v28 offset:31104
    ds_read_b64_tr_b16 v[182:183], v28 offset:34944
    ds_read_b64_tr_b16 v[184:185], v28 offset:31136
    v_mfma_f32_16x16x32_bf16 v[64:67], v[120:123], v[104:107], v[64:67]
    ds_read_b64_tr_b16 v[186:187], v28 offset:34976
    ds_read_b64_tr_b16 v[188:189], v28 offset:31168
    ds_read_b64_tr_b16 v[190:191], v28 offset:35008
    v_mfma_f32_16x16x32_bf16 v[68:71], v[124:127], v[104:107], v[68:71]
    s_mov_b32 m0, 129024
    s_nop 0
    buffer_load_dwordx4 v22, s[44:47], s10 offen lds
    v_mfma_f32_16x16x32_bf16 v[72:75], v[128:131], v[104:107], v[72:75]
    s_waitcnt vmcnt(5) lgkmcnt(0)
    ds_add_u32 v19, v3 offset:144
    v_mfma_f32_16x16x32_bf16 v[76:79], v[132:135], v[104:107], v[76:79]
    s_add_u32 m0, s64, 28672
    s_lshl3_add_u32 s11, s64, 204800
    buffer_load_dwordx4 v13, s[48:51], s11 offen lds
    v_mfma_f32_16x16x32_bf16 v[80:83], v[136:139], v[104:107], v[80:83]
    s_add_u32 m0, s64, 29696
    s_nop 0
    buffer_load_dwordx4 v14, s[48:51], s11 offen lds
    v_mfma_f32_16x16x32_bf16 v[84:87], v[140:143], v[104:107], v[84:87]
    v_mfma_f32_16x16x32_bf16 v[88:91], v[144:147], v[104:107], v[88:91]
    v_mfma_f32_16x16x32_bf16 v[32:35], v[160:163], v[152:155], v[32:35]
    ds_read_b32 v29, v2 offset:144
    v_mfma_f32_16x16x32_bf16 v[36:39], v[164:167], v[152:155], v[36:39]
    s_waitcnt lgkmcnt(0)
    s_setprio 2
    v_readfirstlane_b32 s76, v29
    s_setprio 0
    s_cmp_lt_u32 s76, 48
    s_cbranch_scc1 Lslow_381
Lback_382:
    ds_read_b128 v[104:107], v26 offset:8192
    ds_read_b128 v[108:111], v26 offset:10240
    ds_read_b64_tr_b16 v[116:117], v28 offset:224
    v_mfma_f32_16x16x32_bf16 v[40:43], v[168:171], v[152:155], v[40:43]
    ds_read_b64_tr_b16 v[118:119], v28 offset:4064
    ds_read_b64_tr_b16 v[120:121], v28 offset:256
    ds_read_b64_tr_b16 v[122:123], v28 offset:4096
    v_mfma_f32_16x16x32_bf16 v[44:47], v[172:175], v[152:155], v[44:47]
    s_mov_b32 m0, 136192
    s_add_u32 s10, s9, 491520
    buffer_load_dwordx4 v20, s[44:47], s10 offen lds
    v_mfma_f32_16x16x32_bf16 v[48:51], v[176:179], v[152:155], v[48:51]
    ds_read_b64_tr_b16 v[124:125], v28 offset:288
    ds_read_b64_tr_b16 v[126:127], v28 offset:4128
    ds_read_b64_tr_b16 v[128:129], v28 offset:320
    v_mfma_f32_16x16x32_bf16 v[52:55], v[180:183], v[152:155], v[52:55]
    ds_read_b64_tr_b16 v[130:131], v28 offset:4160
    ds_read_b64_tr_b16 v[132:133], v28 offset:352
    ds_read_b64_tr_b16 v[134:135], v28 offset:4192
    v_mfma_f32_16x16x32_bf16 v[56:59], v[184:187], v[152:155], v[56:59]
    s_mov_b32 m0, 140288
    s_nop 0
    buffer_load_dwordx4 v21, s[44:47], s10 offen lds
    v_mfma_f32_16x16x32_bf16 v[60:63], v[188:191], v[152:155], v[60:63]
    ds_read_b64_tr_b16 v[136:137], v28 offset:384
    ds_read_b64_tr_b16 v[138:139], v28 offset:4224
    ds_read_b64_tr_b16 v[140:141], v28 offset:416
    v_mfma_f32_16x16x32_bf16 v[64:67], v[164:167], v[148:151], v[64:67]
    ds_read_b64_tr_b16 v[142:143], v28 offset:4256
    ds_read_b64_tr_b16 v[144:145], v28 offset:448
    ds_read_b64_tr_b16 v[146:147], v28 offset:4288
    v_mfma_f32_16x16x32_bf16 v[68:71], v[168:171], v[148:151], v[68:71]
    s_mov_b32 m0, 144384
    s_nop 0
    buffer_load_dwordx4 v22, s[44:47], s10 offen lds
    v_mfma_f32_16x16x32_bf16 v[72:75], v[172:175], v[148:151], v[72:75]
    s_waitcnt vmcnt(5) lgkmcnt(0)
    ds_add_u32 v19, v3 offset:144
    v_mfma_f32_16x16x32_bf16 v[76:79], v[176:179], v[148:151], v[76:79]
    s_add_u32 m0, s64, 33792
    s_lshl3_add_u32 s11, s64, 245760
    buffer_load_dwordx4 v13, s[48:51], s11 offen lds
    v_mfma_f32_16x16x32_bf16 v[80:83], v[180:183], v[148:151], v[80:83]
    s_add_u32 m0, s64, 34816
    s_nop 0
    buffer_load_dwordx4 v14, s[48:51], s11 offen lds
    v_mfma_f32_16x16x32_bf16 v[84:87], v[184:187], v[148:151], v[84:87]
    v_mfma_f32_16x16x32_bf16 v[88:91], v[188:191], v[148:151], v[88:91]
    v_mfma_f32_16x16x32_bf16 v[32:35], v[116:119], v[108:111], v[32:35]
    ds_read_b32 v29, v2 offset:144
    v_mfma_f32_16x16x32_bf16 v[36:39], v[120:123], v[108:111], v[36:39]
    s_waitcnt lgkmcnt(0)
    s_setprio 2
    v_readfirstlane_b32 s76, v29
    s_setprio 0
    s_cmp_lt_u32 s76, 52
    s_cbranch_scc1 Lslow_385
Lback_386:
    ds_read_b128 v[148:151], v27 offset:8192
    ds_read_b128 v[152:155], v27 offset:10240
    ds_read_b64_tr_b16 v[160:161], v28 offset:15584
    v_mfma_f32_16x16x32_bf16 v[40:43], v[124:127], v[108:111], v[40:43]
    ds_read_b64_tr_b16 v[162:163], v28 offset:19424
    ds_read_b64_tr_b16 v[164:165], v28 offset:15616
    ds_read_b64_tr_b16 v[166:167], v28 offset:19456
    v_mfma_f32_16x16x32_bf16 v[44:47], v[128:131], v[108:111], v[44:47]
    s_mov_b32 m0, 105472
    s_add_u32 s10, s9, 614400
    buffer_load_dwordx4 v20, s[44:47], s10 offen lds
    v_mfma_f32_16x16x32_bf16 v[48:51], v[132:135], v[108:111], v[48:51]
    ds_read_b64_tr_b16 v[168:169], v28 offset:15648
    ds_read_b64_tr_b16 v[170:171], v28 offset:19488
    ds_read_b64_tr_b16 v[172:173], v28 offset:15680
    v_mfma_f32_16x16x32_bf16 v[52:55], v[136:139], v[108:111], v[52:55]
    ds_read_b64_tr_b16 v[174:175], v28 offset:19520
    ds_read_b64_tr_b16 v[176:177], v28 offset:15712
    ds_read_b64_tr_b16 v[178:179], v28 offset:19552
    v_mfma_f32_16x16x32_bf16 v[56:59], v[140:143], v[108:111], v[56:59]
    s_mov_b32 m0, 109568
    s_nop 0
    buffer_load_dwordx4 v21, s[44:47], s10 offen lds
    v_mfma_f32_16x16x32_bf16 v[60:63], v[144:147], v[108:111], v[60:63]
    ds_read_b64_tr_b16 v[180:181], v28 offset:15744
    ds_read_b64_tr_b16 v[182:183], v28 offset:19584
    ds_read_b64_tr_b16 v[184:185], v28 offset:15776
    v_mfma_f32_16x16x32_bf16 v[64:67], v[120:123], v[104:107], v[64:67]
    ds_read_b64_tr_b16 v[186:187], v28 offset:19616
    ds_read_b64_tr_b16 v[188:189], v28 offset:15808
    ds_read_b64_tr_b16 v[190:191], v28 offset:19648
    v_mfma_f32_16x16x32_bf16 v[68:71], v[124:127], v[104:107], v[68:71]
    s_mov_b32 m0, 113664
    s_nop 0
    buffer_load_dwordx4 v22, s[44:47], s10 offen lds
    v_mfma_f32_16x16x32_bf16 v[72:75], v[128:131], v[104:107], v[72:75]
    s_waitcnt vmcnt(5) lgkmcnt(0)
    ds_add_u32 v19, v3 offset:144
    v_mfma_f32_16x16x32_bf16 v[76:79], v[132:135], v[104:107], v[76:79]
    s_add_u32 m0, s64, 38912
    s_lshl3_add_u32 s11, s64, 286720
    buffer_load_dwordx4 v13, s[48:51], s11 offen lds
    v_mfma_f32_16x16x32_bf16 v[80:83], v[136:139], v[104:107], v[80:83]
    s_add_u32 m0, s64, 39936
    s_nop 0
    buffer_load_dwordx4 v14, s[48:51], s11 offen lds
    v_mfma_f32_16x16x32_bf16 v[84:87], v[140:143], v[104:107], v[84:87]
    v_mfma_f32_16x16x32_bf16 v[88:91], v[144:147], v[104:107], v[88:91]
    v_mfma_f32_16x16x32_bf16 v[32:35], v[160:163], v[152:155], v[32:35]
    ds_read_b32 v29, v2 offset:144
    v_mfma_f32_16x16x32_bf16 v[36:39], v[164:167], v[152:155], v[36:39]
    s_waitcnt lgkmcnt(0)
    s_setprio 2
    v_readfirstlane_b32 s76, v29
    s_setprio 0
    s_cmp_lt_u32 s76, 56
    s_cbranch_scc1 Lslow_389
Lback_390:
    ds_read_b128 v[104:107], v26 offset:16384
    ds_read_b128 v[108:111], v26 offset:18432
    ds_read_b64_tr_b16 v[116:117], v28 offset:30944
    v_mfma_f32_16x16x32_bf16 v[40:43], v[168:171], v[152:155], v[40:43]
    ds_read_b64_tr_b16 v[118:119], v28 offset:34784
    ds_read_b64_tr_b16 v[120:121], v28 offset:30976
    ds_read_b64_tr_b16 v[122:123], v28 offset:34816
    v_mfma_f32_16x16x32_bf16 v[44:47], v[172:175], v[152:155], v[44:47]
    s_mov_b32 m0, 120832
    s_add_u32 s10, s9, 737280
    buffer_load_dwordx4 v20, s[44:47], s10 offen lds
    v_mfma_f32_16x16x32_bf16 v[48:51], v[176:179], v[152:155], v[48:51]
    ds_read_b64_tr_b16 v[124:125], v28 offset:31008
    ds_read_b64_tr_b16 v[126:127], v28 offset:34848
    ds_read_b64_tr_b16 v[128:129], v28 offset:31040
    v_mfma_f32_16x16x32_bf16 v[52:55], v[180:183], v[152:155], v[52:55]
    ds_read_b64_tr_b16 v[130:131], v28 offset:34880
    ds_read_b64_tr_b16 v[132:133], v28 offset:31072
    ds_read_b64_tr_b16 v[134:135], v28 offset:34912
    v_mfma_f32_16x16x32_bf16 v[56:59], v[184:187], v[152:155], v[56:59]
    s_mov_b32 m0, 124928
    s_nop 0
    buffer_load_dwordx4 v21, s[44:47], s10 offen lds
    v_mfma_f32_16x16x32_bf16 v[60:63], v[188:191], v[152:155], v[60:63]
    ds_read_b64_tr_b16 v[136:137], v28 offset:31104
    ds_read_b64_tr_b16 v[138:139], v28 offset:34944
    ds_read_b64_tr_b16 v[140:141], v28 offset:31136
    v_mfma_f32_16x16x32_bf16 v[64:67], v[164:167], v[148:151], v[64:67]
    ds_read_b64_tr_b16 v[142:143], v28 offset:34976
    ds_read_b64_tr_b16 v[144:145], v28 offset:31168
    ds_read_b64_tr_b16 v[146:147], v28 offset:35008
    v_mfma_f32_16x16x32_bf16 v[68:71], v[168:171], v[148:151], v[68:71]
    s_mov_b32 m0, 129024
    s_nop 0
    buffer_load_dwordx4 v22, s[44:47], s10 offen lds
    v_mfma_f32_16x16x32_bf16 v[72:75], v[172:175], v[148:151], v[72:75]
    s_waitcnt vmcnt(5) lgkmcnt(0)
    ds_add_u32 v19, v3 offset:144
    v_mfma_f32_16x16x32_bf16 v[76:79], v[176:179], v[148:151], v[76:79]
    s_add_u32 m0, s65, 3072
    s_lshl3_add_u32 s11, s65, 0
    buffer_load_dwordx4 v13, s[48:51], s11 offen lds
    v_mfma_f32_16x16x32_bf16 v[80:83], v[180:183], v[148:151], v[80:83]
    s_add_u32 m0, s65, 4096
    s_nop 0
    buffer_load_dwordx4 v14, s[48:51], s11 offen lds
    v_mfma_f32_16x16x32_bf16 v[84:87], v[184:187], v[148:151], v[84:87]
    v_mfma_f32_16x16x32_bf16 v[88:91], v[188:191], v[148:151], v[88:91]
    v_mfma_f32_16x16x32_bf16 v[32:35], v[116:119], v[108:111], v[32:35]
    ds_read_b32 v29, v2 offset:144
    v_mfma_f32_16x16x32_bf16 v[36:39], v[120:123], v[108:111], v[36:39]
    s_waitcnt lgkmcnt(0)
    s_setprio 2
    v_readfirstlane_b32 s76, v29
    s_setprio 0
    s_cmp_lt_u32 s76, 60
    s_cbranch_scc1 Lslow_393
Lback_394:
    ds_read_b128 v[148:151], v27 offset:16384
    ds_read_b128 v[152:155], v27 offset:18432
    ds_read_b64_tr_b16 v[160:161], v28 offset:224
    v_mfma_f32_16x16x32_bf16 v[40:43], v[124:127], v[108:111], v[40:43]
    ds_read_b64_tr_b16 v[162:163], v28 offset:4064
    ds_read_b64_tr_b16 v[164:165], v28 offset:256
    ds_read_b64_tr_b16 v[166:167], v28 offset:4096
    v_mfma_f32_16x16x32_bf16 v[44:47], v[128:131], v[108:111], v[44:47]
    s_mov_b32 m0, 136192
    s_add_u32 s10, s9, 860160
    buffer_load_dwordx4 v20, s[44:47], s10 offen lds
    v_mfma_f32_16x16x32_bf16 v[48:51], v[132:135], v[108:111], v[48:51]
    ds_read_b64_tr_b16 v[168:169], v28 offset:288
    ds_read_b64_tr_b16 v[170:171], v28 offset:4128
    ds_read_b64_tr_b16 v[172:173], v28 offset:320
    v_mfma_f32_16x16x32_bf16 v[52:55], v[136:139], v[108:111], v[52:55]
    ds_read_b64_tr_b16 v[174:175], v28 offset:4160
    ds_read_b64_tr_b16 v[176:177], v28 offset:352
    ds_read_b64_tr_b16 v[178:179], v28 offset:4192
    v_mfma_f32_16x16x32_bf16 v[56:59], v[140:143], v[108:111], v[56:59]
    s_mov_b32 m0, 140288
    s_nop 0
    buffer_load_dwordx4 v21, s[44:47], s10 offen lds
    v_mfma_f32_16x16x32_bf16 v[60:63], v[144:147], v[108:111], v[60:63]
    ds_read_b64_tr_b16 v[180:181], v28 offset:384
    ds_read_b64_tr_b16 v[182:183], v28 offset:4224
    ds_read_b64_tr_b16 v[184:185], v28 offset:416
    v_mfma_f32_16x16x32_bf16 v[64:67], v[120:123], v[104:107], v[64:67]
    ds_read_b64_tr_b16 v[186:187], v28 offset:4256
    ds_read_b64_tr_b16 v[188:189], v28 offset:448
    ds_read_b64_tr_b16 v[190:191], v28 offset:4288
    v_mfma_f32_16x16x32_bf16 v[68:71], v[124:127], v[104:107], v[68:71]
    s_mov_b32 m0, 144384
    s_nop 0
    buffer_load_dwordx4 v22, s[44:47], s10 offen lds
    v_mfma_f32_16x16x32_bf16 v[72:75], v[128:131], v[104:107], v[72:75]
    s_waitcnt vmcnt(5) lgkmcnt(0)
    ds_add_u32 v19, v3 offset:144
    v_mfma_f32_16x16x32_bf16 v[76:79], v[132:135], v[104:107], v[76:79]
    s_add_u32 m0, s65, 8192
    s_lshl3_add_u32 s11, s65, 40960
    buffer_load_dwordx4 v13, s[48:51], s11 offen lds
    v_mfma_f32_16x16x32_bf16 v[80:83], v[136:139], v[104:107], v[80:83]
    s_add_u32 m0, s65, 9216
    s_nop 0
    buffer_load_dwordx4 v14, s[48:51], s11 offen lds
    v_mfma_f32_16x16x32_bf16 v[84:87], v[140:143], v[104:107], v[84:87]
    v_mfma_f32_16x16x32_bf16 v[88:91], v[144:147], v[104:107], v[88:91]
    v_mfma_f32_16x16x32_bf16 v[32:35], v[160:163], v[152:155], v[32:35]
    ds_read_b32 v29, v2 offset:144
    v_mfma_f32_16x16x32_bf16 v[36:39], v[164:167], v[152:155], v[36:39]
    s_waitcnt lgkmcnt(0)
    s_setprio 2
    v_readfirstlane_b32 s76, v29
    s_setprio 0
    s_cmp_lt_u32 s76, 64
    s_cbranch_scc1 Lslow_397
Lback_398:
    ds_read_b128 v[104:107], v26 offset:24576
    ds_read_b128 v[108:111], v26 offset:26624
    ds_read_b64_tr_b16 v[116:117], v28 offset:15584
    v_mfma_f32_16x16x32_bf16 v[40:43], v[168:171], v[152:155], v[40:43]
    ds_read_b64_tr_b16 v[118:119], v28 offset:19424
    ds_read_b64_tr_b16 v[120:121], v28 offset:15616
    ds_read_b64_tr_b16 v[122:123], v28 offset:19456
    v_mfma_f32_16x16x32_bf16 v[44:47], v[172:175], v[152:155], v[44:47]
    s_mov_b32 m0, 105472
    s_add_u32 s10, s9, 983040
    buffer_load_dwordx4 v20, s[44:47], s10 offen lds
    v_mfma_f32_16x16x32_bf16 v[48:51], v[176:179], v[152:155], v[48:51]
    ds_read_b64_tr_b16 v[124:125], v28 offset:15648
    ds_read_b64_tr_b16 v[126:127], v28 offset:19488
    ds_read_b64_tr_b16 v[128:129], v28 offset:15680
    v_mfma_f32_16x16x32_bf16 v[52:55], v[180:183], v[152:155], v[52:55]
    ds_read_b64_tr_b16 v[130:131], v28 offset:19520
    ds_read_b64_tr_b16 v[132:133], v28 offset:15712
    ds_read_b64_tr_b16 v[134:135], v28 offset:19552
    v_mfma_f32_16x16x32_bf16 v[56:59], v[184:187], v[152:155], v[56:59]
    s_mov_b32 m0, 109568
    s_nop 0
    buffer_load_dwordx4 v21, s[44:47], s10 offen lds
    v_mfma_f32_16x16x32_bf16 v[60:63], v[188:191], v[152:155], v[60:63]
    ds_read_b64_tr_b16 v[136:137], v28 offset:15744
    ds_read_b64_tr_b16 v[138:139], v28 offset:19584
    ds_read_b64_tr_b16 v[140:141], v28 offset:15776
    v_mfma_f32_16x16x32_bf16 v[64:67], v[164:167], v[148:151], v[64:67]
    ds_read_b64_tr_b16 v[142:143], v28 offset:19616
    ds_read_b64_tr_b16 v[144:145], v28 offset:15808
    ds_read_b64_tr_b16 v[146:147], v28 offset:19648
    v_mfma_f32_16x16x32_bf16 v[68:71], v[168:171], v[148:151], v[68:71]
    s_mov_b32 m0, 113664
    s_nop 0
    buffer_load_dwordx4 v22, s[44:47], s10 offen lds
    v_mfma_f32_16x16x32_bf16 v[72:75], v[172:175], v[148:151], v[72:75]
    s_waitcnt vmcnt(5) lgkmcnt(0)
    ds_add_u32 v19, v3 offset:144
    v_mfma_f32_16x16x32_bf16 v[76:79], v[176:179], v[148:151], v[76:79]
    s_add_u32 m0, s65, 13312
    s_lshl3_add_u32 s11, s65, 81920
    buffer_load_dwordx4 v13, s[48:51], s11 offen lds
    v_mfma_f32_16x16x32_bf16 v[80:83], v[180:183], v[148:151], v[80:83]
    s_add_u32 m0, s65, 14336
    s_nop 0
    buffer_load_dwordx4 v14, s[48:51], s11 offen lds
    v_mfma_f32_16x16x32_bf16 v[84:87], v[184:187], v[148:151], v[84:87]
    v_mfma_f32_16x16x32_bf16 v[88:91], v[188:191], v[148:151], v[88:91]
    v_mfma_f32_16x16x32_bf16 v[32:35], v[116:119], v[108:111], v[32:35]
    ds_read_b32 v29, v2 offset:144
    v_mfma_f32_16x16x32_bf16 v[36:39], v[120:123], v[108:111], v[36:39]
    s_waitcnt lgkmcnt(0)
    s_setprio 2
    v_readfirstlane_b32 s76, v29
    s_setprio 0
    s_cmp_lt_u32 s76, 68
    s_cbranch_scc1 Lslow_401
Lback_402:
    ds_read_b128 v[148:151], v27 offset:24576
    ds_read_b128 v[152:155], v27 offset:26624
    ds_read_b64_tr_b16 v[160:161], v28 offset:30944
    v_mfma_f32_16x16x32_bf16 v[40:43], v[124:127], v[108:111], v[40:43]
    ds_read_b64_tr_b16 v[162:163], v28 offset:34784
    ds_read_b64_tr_b16 v[164:165], v28 offset:30976
    ds_read_b64_tr_b16 v[166:167], v28 offset:34816
    v_mfma_f32_16x16x32_bf16 v[44:47], v[128:131], v[108:111], v[44:47]
    s_mov_b32 m0, 120832
    s_add_u32 s10, s9, 1105920
    buffer_load_dwordx4 v20, s[44:47], s10 offen lds
    v_mfma_f32_16x16x32_bf16 v[48:51], v[132:135], v[108:111], v[48:51]
    ds_read_b64_tr_b16 v[168:169], v28 offset:31008
    ds_read_b64_tr_b16 v[170:171], v28 offset:34848
    ds_read_b64_tr_b16 v[172:173], v28 offset:31040
    v_mfma_f32_16x16x32_bf16 v[52:55], v[136:139], v[108:111], v[52:55]
    ds_read_b64_tr_b16 v[174:175], v28 offset:34880
    ds_read_b64_tr_b16 v[176:177], v28 offset:31072
    ds_read_b64_tr_b16 v[178:179], v28 offset:34912
    v_mfma_f32_16x16x32_bf16 v[56:59], v[140:143], v[108:111], v[56:59]
    s_mov_b32 m0, 124928
    s_nop 0
    buffer_load_dwordx4 v21, s[44:47], s10 offen lds
    v_mfma_f32_16x16x32_bf16 v[60:63], v[144:147], v[108:111], v[60:63]
    ds_read_b64_tr_b16 v[180:181], v28 offset:31104
    ds_read_b64_tr_b16 v[182:183], v28 offset:34944
    ds_read_b64_tr_b16 v[184:185], v28 offset:31136
    v_mfma_f32_16x16x32_bf16 v[64:67], v[120:123], v[104:107], v[64:67]
    ds_read_b64_tr_b16 v[186:187], v28 offset:34976
    ds_read_b64_tr_b16 v[188:189], v28 offset:31168
    ds_read_b64_tr_b16 v[190:191], v28 offset:35008
    v_mfma_f32_16x16x32_bf16 v[68:71], v[124:127], v[104:107], v[68:71]
    s_mov_b32 m0, 129024
    s_nop 0
    buffer_load_dwordx4 v22, s[44:47], s10 offen lds
    v_mfma_f32_16x16x32_bf16 v[72:75], v[128:131], v[104:107], v[72:75]
    s_waitcnt vmcnt(5) lgkmcnt(0)
    ds_add_u32 v19, v3 offset:144
    v_mfma_f32_16x16x32_bf16 v[76:79], v[132:135], v[104:107], v[76:79]
    s_add_u32 m0, s65, 18432
    s_lshl3_add_u32 s11, s65, 122880
    buffer_load_dwordx4 v13, s[48:51], s11 offen lds
    v_mfma_f32_16x16x32_bf16 v[80:83], v[136:139], v[104:107], v[80:83]
    s_add_u32 m0, s65, 19456
    s_nop 0
    buffer_load_dwordx4 v14, s[48:51], s11 offen lds
    v_mfma_f32_16x16x32_bf16 v[84:87], v[140:143], v[104:107], v[84:87]
    v_mfma_f32_16x16x32_bf16 v[88:91], v[144:147], v[104:107], v[88:91]
    v_mfma_f32_16x16x32_bf16 v[32:35], v[160:163], v[152:155], v[32:35]
    ds_read_b32 v29, v2 offset:144
    v_mfma_f32_16x16x32_bf16 v[36:39], v[164:167], v[152:155], v[36:39]
    s_waitcnt lgkmcnt(0)
    s_setprio 2
    v_readfirstlane_b32 s76, v29
    s_setprio 0
    s_cmp_lt_u32 s76, 72
    s_cbranch_scc1 Lslow_405
Lback_406:
    ds_read_b128 v[104:107], v26 offset:32768
    ds_read_b128 v[108:111], v26 offset:34816
    ds_read_b64_tr_b16 v[116:117], v28 offset:224
    v_mfma_f32_16x16x32_bf16 v[40:43], v[168:171], v[152:155], v[40:43]
    ds_read_b64_tr_b16 v[118:119], v28 offset:4064
    ds_read_b64_tr_b16 v[120:121], v28 offset:256
    ds_read_b64_tr_b16 v[122:123], v28 offset:4096
    v_mfma_f32_16x16x32_bf16 v[44:47], v[172:175], v[152:155], v[44:47]
    ds_read_b64_tr_b16 v[124:125], v28 offset:288
    ds_read_b64_tr_b16 v[126:127], v28 offset:4128
    ds_read_b64_tr_b16 v[128:129], v28 offset:320
    v_mfma_f32_16x16x32_bf16 v[48:51], v[176:179], v[152:155], v[48:51]
    ds_read_b64_tr_b16 v[130:131], v28 offset:4160
    ds_read_b64_tr_b16 v[132:133], v28 offset:352
    ds_read_b64_tr_b16 v[134:135], v28 offset:4192
    v_mfma_f32_16x16x32_bf16 v[52:55], v[180:183], v[152:155], v[52:55]
    ds_read_b64_tr_b16 v[136:137], v28 offset:384
    ds_read_b64_tr_b16 v[138:139], v28 offset:4224
    ds_read_b64_tr_b16 v[140:141], v28 offset:416
    v_mfma_f32_16x16x32_bf16 v[56:59], v[184:187], v[152:155], v[56:59]
    ds_read_b64_tr_b16 v[142:143], v28 offset:4256
    ds_read_b64_tr_b16 v[144:145], v28 offset:448
    ds_read_b64_tr_b16 v[146:147], v28 offset:4288
    v_mfma_f32_16x16x32_bf16 v[60:63], v[188:191], v[152:155], v[60:63]
    s_waitcnt vmcnt(2) lgkmcnt(0)
    ds_add_u32 v19, v3 offset:144
    v_mfma_f32_16x16x32_bf16 v[64:67], v[164:167], v[148:151], v[64:67]
    s_add_u32 m0, s65, 23552
    s_lshl3_add_u32 s11, s65, 163840
    buffer_load_dwordx4 v13, s[48:51], s11 offen lds
    v_mfma_f32_16x16x32_bf16 v[68:71], v[168:171], v[148:151], v[68:71]
    s_add_u32 m0, s65, 24576
    s_nop 0
    buffer_load_dwordx4 v14, s[48:51], s11 offen lds
    v_mfma_f32_16x16x32_bf16 v[72:75], v[172:175], v[148:151], v[72:75]
    v_mfma_f32_16x16x32_bf16 v[76:79], v[176:179], v[148:151], v[76:79]
    v_mfma_f32_16x16x32_bf16 v[80:83], v[180:183], v[148:151], v[80:83]
    v_mfma_f32_16x16x32_bf16 v[84:87], v[184:187], v[148:151], v[84:87]
    v_mfma_f32_16x16x32_bf16 v[88:91], v[188:191], v[148:151], v[88:91]
    v_mfma_f32_16x16x32_bf16 v[32:35], v[116:119], v[108:111], v[32:35]
    ds_read_b32 v29, v2 offset:144
    v_mfma_f32_16x16x32_bf16 v[36:39], v[120:123], v[108:111], v[36:39]
    s_waitcnt lgkmcnt(0)
    s_setprio 2
    v_readfirstlane_b32 s76, v29
    s_setprio 0
    s_cmp_lt_u32 s76, 76
    s_cbranch_scc1 Lslow_409
Lback_410:
    ds_read_b128 v[148:151], v27 offset:32768
    ds_read_b128 v[152:155], v27 offset:34816
    ds_read_b64_tr_b16 v[160:161], v28 offset:15584
    v_mfma_f32_16x16x32_bf16 v[40:43], v[124:127], v[108:111], v[40:43]
    ds_read_b64_tr_b16 v[162:163], v28 offset:19424
    ds_read_b64_tr_b16 v[164:165], v28 offset:15616
    ds_read_b64_tr_b16 v[166:167], v28 offset:19456
    v_mfma_f32_16x16x32_bf16 v[44:47], v[128:131], v[108:111], v[44:47]
    ds_read_b64_tr_b16 v[168:169], v28 offset:15648
    ds_read_b64_tr_b16 v[170:171], v28 offset:19488
    ds_read_b64_tr_b16 v[172:173], v28 offset:15680
    v_mfma_f32_16x16x32_bf16 v[48:51], v[132:135], v[108:111], v[48:51]
    ds_read_b64_tr_b16 v[174:175], v28 offset:19520
    ds_read_b64_tr_b16 v[176:177], v28 offset:15712
    ds_read_b64_tr_b16 v[178:179], v28 offset:19552
    v_mfma_f32_16x16x32_bf16 v[52:55], v[136:139], v[108:111], v[52:55]
    ds_read_b64_tr_b16 v[180:181], v28 offset:15744
    ds_read_b64_tr_b16 v[182:183], v28 offset:19584
    ds_read_b64_tr_b16 v[184:185], v28 offset:15776
    v_mfma_f32_16x16x32_bf16 v[56:59], v[140:143], v[108:111], v[56:59]
    ds_read_b64_tr_b16 v[186:187], v28 offset:19616
    ds_read_b64_tr_b16 v[188:189], v28 offset:15808
    ds_read_b64_tr_b16 v[190:191], v28 offset:19648
    v_mfma_f32_16x16x32_bf16 v[60:63], v[144:147], v[108:111], v[60:63]
    s_waitcnt lgkmcnt(0)
    ds_add_u32 v19, v3 offset:124
    v_mfma_f32_16x16x32_bf16 v[64:67], v[120:123], v[104:107], v[64:67]
    s_add_u32 m0, s65, 28672
    s_lshl3_add_u32 s11, s65, 204800
    buffer_load_dwordx4 v13, s[48:51], s11 offen lds
    v_mfma_f32_16x16x32_bf16 v[68:71], v[124:127], v[104:107], v[68:71]
    s_add_u32 m0, s65, 29696
    s_nop 0
    buffer_load_dwordx4 v14, s[48:51], s11 offen lds
    v_mfma_f32_16x16x32_bf16 v[72:75], v[128:131], v[104:107], v[72:75]
    v_mfma_f32_16x16x32_bf16 v[76:79], v[132:135], v[104:107], v[76:79]
    v_mfma_f32_16x16x32_bf16 v[80:83], v[136:139], v[104:107], v[80:83]
    v_mfma_f32_16x16x32_bf16 v[84:87], v[140:143], v[104:107], v[84:87]
    v_mfma_f32_16x16x32_bf16 v[88:91], v[144:147], v[104:107], v[88:91]
    s_lshl3_add_u32 s84, s4, s5
    s_mul_i32 s85, s84, 5120
    s_add_u32 s85, s85, 16777216
    s_add_u32 s83, s85, 4096
    s_lshl_b32 s84, s84, 7
    s_add_u32 s84, s84, 786432
    s_mov_b32 s86, s39
    s_and_b32 s87, s4, 3
    s_cmp_eq_u32 s87, 3
    s_cselect_b32 s39, 0, s39
    v_mfma_f32_16x16x32_bf16 v[32:35], v[160:163], v[152:155], v[32:35]
    v_mfma_f32_16x16x32_bf16 v[36:39], v[164:167], v[152:155], v[36:39]
    ds_read_b32 v29, v2 offset:124
    v_mfma_f32_16x16x32_bf16 v[40:43], v[168:171], v[152:155], v[40:43]
    s_waitcnt lgkmcnt(0)
    s_setprio 2
    v_readfirstlane_b32 s76, v29
    s_setprio 0
    s_cmp_lt_u32 s76, 4
    s_cbranch_scc1 Lslow_413
Lback_414:
    v_mfma_f32_16x16x32_bf16 v[44:47], v[172:175], v[152:155], v[44:47]
    s_setprio 2
    v_cvt_pk_bf16_f32 v32, v32, v33
    v_cvt_pk_bf16_f32 v33, v34, v35
    s_setprio 0
    ds_write_b64 v205, v[32:33] offset:20544
    buffer_store_dwordx2 v[32:33], v224, s[72:75], s85 offen offset:1024 sc1
    v_mfma_f32_16x16x32_bf16 v[48:51], v[176:179], v[152:155], v[48:51]
    s_setprio 2
    v_cvt_pk_bf16_f32 v36, v36, v37
    v_cvt_pk_bf16_f32 v37, v38, v39
    s_setprio 0
    ds_write_b64 v205, v[36:37] offset:20576
    buffer_store_dwordx2 v[36:37], v224, s[72:75], s85 offen offset:1536 sc1
    v_mfma_f32_16x16x32_bf16 v[52:55], v[180:183], v[152:155], v[52:55]
    s_setprio 2
    v_cvt_pk_bf16_f32 v40, v40, v41
    v_cvt_pk_bf16_f32 v41, v42, v43
    s_setprio 0
    ds_write_b64 v205, v[40:41] offset:20608
    buffer_store_dwordx2 v[40:41], v224, s[72:75], s85 offen offset:2048 sc1
    v_mfma_f32_16x16x32_bf16 v[56:59], v[184:187], v[152:155], v[56:59]
    s_setprio 2
    v_cvt_pk_bf16_f32 v44, v44, v45
    v_cvt_pk_bf16_f32 v45, v46, v47
    s_setprio 0
    ds_write_b64 v205, v[44:45] offset:33280
    buffer_store_dwordx2 v[44:45], v224, s[72:75], s85 offen offset:2560 sc1
    v_mfma_f32_16x16x32_bf16 v[60:63], v[188:191], v[152:155], v[60:63]
    s_setprio 2
    v_cvt_pk_bf16_f32 v48, v48, v49
    v_cvt_pk_bf16_f32 v49, v50, v51
    s_setprio 0
    ds_write_b64 v205, v[48:49] offset:33312
    buffer_store_dwordx2 v[48:49], v224, s[72:75], s85 offen offset:3072 sc1
    v_mfma_f32_16x16x32_bf16 v[64:67], v[164:167], v[148:151], v[64:67]
    s_setprio 2
    v_cvt_pk_bf16_f32 v52, v52, v53
    v_cvt_pk_bf16_f32 v53, v54, v55
    s_setprio 0
    ds_write_b64 v205, v[52:53] offset:33344
    buffer_store_dwordx2 v[52:53], v224, s[72:75], s85 offen offset:3584 sc1
    v_mfma_f32_16x16x32_bf16 v[68:71], v[168:171], v[148:151], v[68:71]
    s_setprio 2
    v_cvt_pk_bf16_f32 v56, v56, v57
    v_cvt_pk_bf16_f32 v57, v58, v59
    s_setprio 0
    ds_write_b64 v205, v[56:57] offset:33376
    buffer_store_dwordx2 v[56:57], v224, s[72:75], s83 offen offset:0 sc1
    v_mfma_f32_16x16x32_bf16 v[72:75], v[172:175], v[148:151], v[72:75]
    s_setprio 2
    v_cvt_pk_bf16_f32 v60, v60, v61
    v_cvt_pk_bf16_f32 v61, v62, v63
    s_setprio 0
    ds_write_b64 v205, v[60:61] offset:33408
    buffer_store_dwordx2 v[60:61], v224, s[72:75], s83 offen offset:512 sc1
    v_mfma_f32_16x16x32_bf16 v[76:79], v[176:179], v[148:151], v[76:79]
    s_setprio 2
    v_cvt_pk_bf16_f32 v64, v64, v65
    v_cvt_pk_bf16_f32 v65, v66, v67
    s_setprio 0
    ds_write_b64 v205, v[64:65] offset:18016
    v_mfma_f32_16x16x32_bf16 v[80:83], v[180:183], v[148:151], v[80:83]
    s_setprio 2
    v_cvt_pk_bf16_f32 v68, v68, v69
    v_cvt_pk_bf16_f32 v69, v70, v71
    s_setprio 0
    ds_write_b64 v205, v[68:69] offset:18048
    v_mfma_f32_16x16x32_bf16 v[84:87], v[184:187], v[148:151], v[84:87]
    s_setprio 2
    v_cvt_pk_bf16_f32 v72, v72, v73
    v_cvt_pk_bf16_f32 v73, v74, v75
    s_setprio 0
    ds_write_b64 v205, v[72:73] offset:30720
    s_setprio 2
    v_mov_b32 v4, 0
    v_mov_b32 v5, s6
    s_setprio 0
    s_mov_b64 exec, 1
    s_waitcnt vmcnt(0)
    s_cmp_eq_u32 s39, 0
    s_cbranch_scc1 Lxs_417
    buffer_store_dword v5, v4, s[72:75], s84 offen offset:4
Lxb_418:
    s_mov_b64 exec, -1
    v_mfma_f32_16x16x32_bf16 v[88:91], v[188:191], v[148:151], v[88:91]
    s_setprio 2
    v_cvt_pk_bf16_f32 v76, v76, v77
    v_cvt_pk_bf16_f32 v77, v78, v79
    s_setprio 0
    ds_write_b64 v205, v[76:77] offset:30752
    s_setprio 2
    v_cvt_pk_bf16_f32 v80, v80, v81
    v_cvt_pk_bf16_f32 v81, v82, v83
    s_setprio 0
    ds_write_b64 v205, v[80:81] offset:30784
    s_setprio 2
    v_cvt_pk_bf16_f32 v84, v84, v85
    v_cvt_pk_bf16_f32 v85, v86, v87
    s_setprio 0
    ds_write_b64 v205, v[84:85] offset:30816
    s_setprio 2
    v_cvt_pk_bf16_f32 v88, v88, v89
    v_cvt_pk_bf16_f32 v89, v90, v91
    s_setprio 0
    ds_write_b64 v205, v[88:89] offset:30848
    ds_add_u32 v19, v3 offset:564
    s_mov_b32 s39, s86
    s_waitcnt lgkmcnt(0)
    s_add_u32 m0, s65, 33792
    s_lshl3_add_u32 s11, s65, 245760
    buffer_load_dwordx4 v13, s[48:51], s11 offen lds
    s_add_u32 m0, s65, 34816
    s_nop 0
    buffer_load_dwordx4 v14, s[48:51], s11 offen lds
    s_add_u32 m0, s65, 38912
    s_lshl3_add_u32 s11, s65, 286720
    buffer_load_dwordx4 v13, s[48:51], s11 offen lds
    s_add_u32 m0, s65, 39936
    s_nop 0
    buffer_load_dwordx4 v14, s[48:51], s11 offen lds
L_bg_done:
    s_setprio 2
    v_mov_b64 v[104:105], 0
    v_mov_b64 v[106:107], 0
    v_mov_b64 v[108:109], 0
    v_mov_b64 v[110:111], 0
    v_mov_b64 v[112:113], 0
    v_mov_b64 v[114:115], 0
    v_mov_b64 v[116:117], 0
    v_mov_b64 v[118:119], 0
    ds_read_b64 v[184:185], v207 offset:256
    s_mov_b32 s10, 1051011932
    s_mul_i32 s64, s4, 163840
    s_add_u32 s64, s64, 1048576
    s_mul_i32 s84, s15, 40960
    s_add_u32 s84, s84, s64
    s_mul_i32 s78, s5, 2560
    s_add_u32 s64, s64, s78
    s_lshr_b32 s78, s15, 1
    s_mul_i32 s78, s78, 1280
    s_add_u32 s64, s64, s78
    s_and_b32 s78, s15, 1
    s_mul_i32 s79, s78, 81920
    s_add_u32 s64, s64, s79
    s_cmp_eq_u32 s78, 1
    s_cbranch_scc1 L_la_nh
    s_mov_b32 s7, 0x20000
Lp_419:
    ds_read_b32 v4, v2 offset:604
    s_waitcnt lgkmcnt(0)
    v_readfirstlane_b32 s76, v4
    s_nop 0
    s_cmp_ge_u32 s76, 2
    s_cbranch_scc1 Lpd_420
    s_sub_u32 s7, s7, 1
    s_cmp_lg_u32 s7, 0
    s_cbranch_scc1 Lp_419
Lpd_420:
L_la_nh:
    s_mov_b32 s7, 0x20000
Lp_421:
    ds_read_b32 v4, v2 offset:564
    s_waitcnt lgkmcnt(0)
    v_readfirstlane_b32 s76, v4
    s_nop 0
    s_cmp_ge_u32 s76, 4
    s_cbranch_scc1 Lpd_422
    s_sub_u32 s7, s7, 1
    s_cmp_lg_u32 s7, 0
    s_cbranch_scc1 Lp_421
Lpd_422:
    s_mov_b32 exec_hi, 0xffff
    ds_read_b64 v[104:105], v192 offset:0
    ds_read_b64 v[108:109], v192 offset:160
    ds_read_b64 v[112:113], v192 offset:40
    ds_read_b64 v[116:117], v192 offset:200
    s_mov_b32 exec_hi, 0
    ds_read_b64 v[106:107], v192 offset:8
    ds_read_b64 v[110:111], v192 offset:168
    ds_read_b64 v[114:115], v192 offset:48
    ds_read_b64 v[118:119], v192 offset:208
    s_mov_b32 exec_hi, -1
    ds_read_b64 v[120:121], v193 offset:0
    ds_read_b64 v[122:123], v193 offset:8
    ds_read_b64 v[124:125], v194 offset:5120
    ds_read_b64 v[126:127], v194 offset:5128
    ds_read_b64 v[128:129], v193 offset:160
    ds_read_b64 v[130:131], v193 offset:168
    ds_read_b64 v[132:133], v194 offset:5280
    ds_read_b64 v[134:135], v194 offset:5288
    ds_read_b64 v[136:137], v193 offset:40
    ds_read_b64 v[138:139], v193 offset:48
    ds_read_b64 v[140:141], v194 offset:5160
    ds_read_b64 v[142:143], v194 offset:5168
    ds_read_b64 v[144:145], v193 offset:200
    ds_read_b64 v[146:147], v193 offset:208
    ds_read_b64 v[148:149], v194 offset:5320
    ds_read_b64 v[150:151], v194 offset:5328
    s_waitcnt lgkmcnt(12)
    v_mfma_f32_16x16x32_bf16 v[32:35], v[120:123], v[104:107], v[208:211]
    v_mfma_f32_16x16x32_bf16 v[36:39], v[124:127], v[104:107], v[212:215]
    ds_read_b64_tr_b16 v[152:153], v195 offset:0
    ds_read_b64_tr_b16 v[154:155], v196 offset:5120
    ds_read_b64_tr_b16 v[156:157], v197
    ds_read_b64_tr_b16 v[158:159], v198
    s_waitcnt lgkmcnt(12)
    v_mfma_f32_16x16x32_bf16 v[40:43], v[128:131], v[108:111], v[208:211]
    v_mfma_f32_16x16x32_bf16 v[44:47], v[132:135], v[108:111], v[212:215]
    ds_read_b64_tr_b16 v[160:161], v195 offset:160
    ds_read_b64_tr_b16 v[162:163], v196 offset:5280
    ds_read_b64_tr_b16 v[164:165], v199
    ds_read_b64_tr_b16 v[166:167], v200
    s_waitcnt lgkmcnt(12)
    v_mfma_f32_16x16x32_bf16 v[48:51], v[136:139], v[112:115], v[208:211]
    v_mfma_f32_16x16x32_bf16 v[52:55], v[140:143], v[112:115], v[212:215]
    ds_read_b64_tr_b16 v[168:169], v195 offset:48
    ds_read_b64_tr_b16 v[170:171], v196 offset:5168
    ds_read_b64_tr_b16 v[172:173], v201
    ds_read_b64_tr_b16 v[174:175], v202
    s_waitcnt lgkmcnt(12)
    v_mfma_f32_16x16x32_bf16 v[56:59], v[144:147], v[116:119], v[208:211]
    v_mfma_f32_16x16x32_bf16 v[60:63], v[148:151], v[116:119], v[212:215]
    ds_read_b64_tr_b16 v[176:177], v195 offset:208
    ds_read_b64_tr_b16 v[178:179], v196 offset:5328
    ds_read_b64_tr_b16 v[180:181], v203
    ds_read_b64_tr_b16 v[182:183], v204
    v_max3_f32 v20, v32, v33, v34
    v_max3_f32 v22, v40, v41, v42
    v_max3_f32 v24, v48, v49, v50
    v_max3_f32 v26, v56, v57, v58
    v_max3_f32 v20, v20, v35, v36
    v_max3_f32 v22, v22, v43, v44
    v_max3_f32 v24, v24, v51, v52
    v_max3_f32 v26, v26, v59, v60
    v_max3_f32 v20, v20, v37, v38
    v_max3_f32 v22, v22, v45, v46
    v_max3_f32 v24, v24, v53, v54
    v_max3_f32 v26, v26, v61, v62
    v_max_f32 v20, v20, v39
    v_max_f32 v22, v22, v47
    v_max_f32 v24, v24, v55
    v_max_f32 v26, v26, v63
    v_mov_b32 v21, v20
    v_mov_b32 v23, v22
    v_mov_b32 v25, v24
    v_mov_b32 v27, v26
    v_permlane16_swap_b32 v20, v21
    v_permlane16_swap_b32 v22, v23
    v_permlane16_swap_b32 v24, v25
    v_permlane16_swap_b32 v26, v27
    v_max_f32 v20, v20, v21
    v_max_f32 v22, v22, v23
    v_max_f32 v24, v24, v25
    v_max_f32 v26, v26, v27
    v_mov_b32 v21, v20
    v_mov_b32 v23, v22
    v_mov_b32 v25, v24
    v_mov_b32 v27, v26
    v_permlane32_swap_b32 v20, v21
    v_permlane32_swap_b32 v22, v23
    v_permlane32_swap_b32 v24, v25
    v_permlane32_swap_b32 v26, v27
    v_max_f32 v20, v20, v21
    v_max_f32 v22, v22, v23
    v_max_f32 v24, v24, v25
    v_max_f32 v26, v26, v27
    v_mul_f32 v20, s10, v20
    v_mul_f32 v22, s10, v22
    v_mul_f32 v24, s10, v24
    v_mul_f32 v26, s10, v26
    v_fma_f32 v32, v32, s10, -v20
    v_fma_f32 v33, v33, s10, -v20
    v_fma_f32 v34, v34, s10, -v20
    v_fma_f32 v35, v35, s10, -v20
    v_fma_f32 v36, v36, s10, -v20
    v_fma_f32 v37, v37, s10, -v20
    v_fma_f32 v38, v38, s10, -v20
    v_fma_f32 v39, v39, s10, -v20
    v_fma_f32 v40, v40, s10, -v22
    v_fma_f32 v41, v41, s10, -v22
    v_fma_f32 v42, v42, s10, -v22
    v_fma_f32 v43, v43, s10, -v22
    v_fma_f32 v44, v44, s10, -v22
    v_fma_f32 v45, v45, s10, -v22
    v_fma_f32 v46, v46, s10, -v22
    v_fma_f32 v47, v47, s10, -v22
    v_fma_f32 v48, v48, s10, -v24
    v_fma_f32 v49, v49, s10, -v24
    v_fma_f32 v50, v50, s10, -v24
    v_fma_f32 v51, v51, s10, -v24
    v_fma_f32 v52, v52, s10, -v24
    v_fma_f32 v53, v53, s10, -v24
    v_fma_f32 v54, v54, s10, -v24
    v_fma_f32 v55, v55, s10, -v24
    v_fma_f32 v56, v56, s10, -v26
    v_fma_f32 v57, v57, s10, -v26
    v_fma_f32 v58, v58, s10, -v26
    v_fma_f32 v59, v59, s10, -v26
    v_fma_f32 v60, v60, s10, -v26
    v_fma_f32 v61, v61, s10, -v26
    v_fma_f32 v62, v62, s10, -v26
    v_fma_f32 v63, v63, s10, -v26
    s_waitcnt lgkmcnt(0)
    v_exp_f32 v32, v32
    v_exp_f32 v33, v33
    v_exp_f32 v34, v34
    v_exp_f32 v35, v35
    v_exp_f32 v36, v36
    v_exp_f32 v37, v37
    v_exp_f32 v38, v38
    v_exp_f32 v39, v39
    v_exp_f32 v40, v40
    v_exp_f32 v41, v41
    v_exp_f32 v42, v42
    v_exp_f32 v43, v43
    v_exp_f32 v44, v44
    v_exp_f32 v45, v45
    v_exp_f32 v46, v46
    v_exp_f32 v47, v47
    v_exp_f32 v48, v48
    v_exp_f32 v49, v49
    v_exp_f32 v50, v50
    v_exp_f32 v51, v51
    v_exp_f32 v52, v52
    v_exp_f32 v53, v53
    v_exp_f32 v54, v54
    v_exp_f32 v55, v55
    v_exp_f32 v56, v56
    v_exp_f32 v57, v57
    v_exp_f32 v58, v58
    v_exp_f32 v59, v59
    v_exp_f32 v60, v60
    v_exp_f32 v61, v61
    v_exp_f32 v62, v62
    v_exp_f32 v63, v63
    v_cvt_pk_bf16_f32 v64, v32, v33
    v_cvt_pk_bf16_f32 v65, v34, v35
    v_cvt_pk_bf16_f32 v66, v36, v37
    v_cvt_pk_bf16_f32 v67, v38, v39
    s_nop 1
    v_mfma_f32_16x16x32_bf16 v[84:87], v[156:159], v[64:67], 0
    v_mfma_f32_16x16x32_bf16 v[80:83], v[152:155], v[64:67], 0
    v_cvt_pk_bf16_f32 v68, v40, v41
    v_cvt_pk_bf16_f32 v69, v42, v43
    v_cvt_pk_bf16_f32 v70, v44, v45
    v_cvt_pk_bf16_f32 v71, v46, v47
    s_nop 1
    v_mfma_f32_16x16x32_bf16 v[92:95], v[164:167], v[68:71], 0
    v_mfma_f32_16x16x32_bf16 v[88:91], v[160:163], v[68:71], 0
    v_cvt_pk_bf16_f32 v72, v48, v49
    v_cvt_pk_bf16_f32 v73, v50, v51
    v_cvt_pk_bf16_f32 v74, v52, v53
    v_cvt_pk_bf16_f32 v75, v54, v55
    s_nop 1
    v_mfma_f32_16x16x32_bf16 v[100:103], v[172:175], v[72:75], 0
    v_mfma_f32_16x16x32_bf16 v[96:99], v[168:171], v[72:75], 0
    v_cvt_pk_bf16_f32 v76, v56, v57
    v_cvt_pk_bf16_f32 v77, v58, v59
    v_cvt_pk_bf16_f32 v78, v60, v61
    v_cvt_pk_bf16_f32 v79, v62, v63
    s_nop 1
    v_mfma_f32_16x16x32_bf16 v[108:111], v[180:183], v[76:79], 0
    v_mfma_f32_16x16x32_bf16 v[104:107], v[176:179], v[76:79], 0
    v_mov_b32 v20, v84
    v_mov_b32 v21, v84
    v_mov_b32 v22, v92
    v_mov_b32 v23, v92
    v_mov_b32 v24, v100
    v_mov_b32 v25, v100
    s_nop 0
    v_mov_b32 v26, v108
    v_mov_b32 v27, v108
    v_permlane16_swap_b32 v20, v21
    v_permlane16_swap_b32 v22, v23
    v_permlane16_swap_b32 v24, v25
    v_permlane16_swap_b32 v26, v27
    v_rcp_f32 v21, v21
    v_rcp_f32 v23, v23
    v_rcp_f32 v25, v25
    v_rcp_f32 v27, v27
    v_mul_f32 v20, v21, v184
    v_mul_f32 v22, v23, v185
    v_mul_f32 v24, v25, v184
    v_mul_f32 v26, v27, v185
    v_pk_mul_f32 v[80:81], v[80:81], v[20:21] op_sel_hi:[1,0]
    v_pk_mul_f32 v[82:83], v[82:83], v[20:21] op_sel_hi:[1,0]
    v_pk_mul_f32 v[84:85], v[84:85], v[20:21] op_sel_hi:[1,0]
    v_pk_mul_f32 v[86:87], v[86:87], v[20:21] op_sel_hi:[1,0]
    v_pk_mul_f32 v[88:89], v[88:89], v[22:23] op_sel_hi:[1,0]
    v_pk_mul_f32 v[90:91], v[90:91], v[22:23] op_sel_hi:[1,0]
    v_pk_mul_f32 v[92:93], v[92:93], v[22:23] op_sel_hi:[1,0]
    v_pk_mul_f32 v[94:95], v[94:95], v[22:23] op_sel_hi:[1,0]
    v_pk_mul_f32 v[96:97], v[96:97], v[24:25] op_sel_hi:[1,0]
    v_pk_mul_f32 v[98:99], v[98:99], v[24:25] op_sel_hi:[1,0]
    v_pk_mul_f32 v[100:101], v[100:101], v[24:25] op_sel_hi:[1,0]
    v_pk_mul_f32 v[102:103], v[102:103], v[24:25] op_sel_hi:[1,0]
    v_pk_mul_f32 v[104:105], v[104:105], v[26:27] op_sel_hi:[1,0]
    v_pk_mul_f32 v[106:107], v[106:107], v[26:27] op_sel_hi:[1,0]
    v_pk_mul_f32 v[108:109], v[108:109], v[26:27] op_sel_hi:[1,0]
    v_pk_mul_f32 v[110:111], v[110:111], v[26:27] op_sel_hi:[1,0]
    v_cvt_pk_bf16_f32 v32, v80, v81
    v_cvt_pk_bf16_f32 v33, v82, v83
    v_cvt_pk_bf16_f32 v48, v84, v85
    v_cvt_pk_bf16_f32 v49, v86, v87
    v_cvt_pk_bf16_f32 v34, v88, v89
    v_cvt_pk_bf16_f32 v35, v90, v91
    v_cvt_pk_bf16_f32 v52, v92, v93
    v_cvt_pk_bf16_f32 v53, v94, v95
    v_cvt_pk_bf16_f32 v36, v96, v97
    v_cvt_pk_bf16_f32 v37, v98, v99
    v_cvt_pk_bf16_f32 v50, v100, v101
    v_cvt_pk_bf16_f32 v51, v102, v103
    v_cvt_pk_bf16_f32 v38, v104, v105
    v_cvt_pk_bf16_f32 v39, v106, v107
    v_cvt_pk_bf16_f32 v54, v108, v109
    v_cvt_pk_bf16_f32 v55, v110, v111
    v_permlane16_swap_b32 v32, v34
    v_permlane16_swap_b32 v33, v35
    v_permlane16_swap_b32 v36, v38
    v_permlane16_swap_b32 v37, v39
    v_permlane16_swap_b32 v48, v52
    v_permlane16_swap_b32 v49, v53
    v_permlane16_swap_b32 v50, v54
    v_permlane16_swap_b32 v51, v55
    buffer_store_dwordx4 v[32:35], v206, s[72:75], s64 offen offset:0 sc1
    buffer_store_dwordx4 v[36:39], v206, s[72:75], s64 offen offset:768 sc1
    s_mov_b32 exec_hi, 0
    buffer_store_dwordx4 v[48:51], v206, s[72:75], s64 offen offset:512 sc1
    s_mov_b32 exec_hi, -1
    v_lshrrev_b32 v4, 5, v1
    v_bfe_u32 v5, v1, 2, 3
    v_lshl_add_u32 v4, v4, 4, v5
    v_mul_u32_u24 v4, 160, v4
    v_and_b32 v5, 3, v1
    v_lshl_add_u32 v20, v5, 3, v4
    v_add_u32 v21, 51200, v20
    s_lshl_b32 s77, s15, 2
    v_add_u32 v24, s77, v19
    s_mul_i32 s77, s15, 5120
    s_add_u32 s77, s77, 81920
    v_add_u32 v25, s77, v17
    s_lshl_b32 s76, s4, 3
    s_add_u32 s76, s76, s5
    s_lshl_b32 s76, s76, 7
    s_lshl2_add_u32 s76, s15, s76
    s_add_u32 s76, s76, 524288
    v_mov_b32 v4, 0
    v_mov_b32 v5, s6
    s_mov_b64 exec, 1
    s_waitcnt vmcnt(0)
    s_cmp_eq_u32 s39, 0
    s_cbranch_scc1 Lxs_423
    buffer_store_dword v5, v4, s[72:75], s76 offen
Lxb_424:
    s_mov_b64 exec, -1
    ds_add_u32 v19, v3 offset:512
    s_setprio 0
    s_mul_i32 s85, s15, 5120
    s_lshl_b32 s86, s85, 3
    s_mov_b32 s7, 0x20000
Lp_425:
    ds_read_b32 v4, v2 offset:512
    s_waitcnt lgkmcnt(0)
    s_setprio 2
    v_readfirstlane_b32 s76, v4
    s_setprio 0
    s_cmp_ge_u32 s76, 4
    s_cbranch_scc1 Lpd_426
    s_sub_u32 s7, s7, 1
    s_cmp_lg_u32 s7, 0
    s_cbranch_scc1 Lp_425
Lpd_426:
    s_cmp_eq_u32 s15, 3
    s_cbranch_scc1 L_ga_poll
    s_add_u32 m0, s85, 102400
    s_add_u32 s80, s86, 0
    buffer_load_dwordx4 v10, s[60:63], s80 offen lds
    s_add_u32 m0, s85, 103424
    s_nop 0
    buffer_load_dwordx4 v11, s[60:63], s80 offen lds
    s_add_u32 m0, s85, 104448
    s_nop 0
    buffer_load_dwordx4 v12, s[60:63], s80 offen lds
    s_add_u32 m0, s85, 105472
    s_nop 0
    buffer_load_dwordx4 v13, s[60:63], s80 offen lds
    s_add_u32 m0, s85, 106496
    s_nop 0
    buffer_load_dwordx4 v14, s[60:63], s80 offen lds
    s_add_u32 m0, s85, 117760
    s_add_u32 s80, s86, 122880
    buffer_load_dwordx4 v10, s[60:63], s80 offen lds
    s_add_u32 m0, s85, 118784
    s_nop 0
    buffer_load_dwordx4 v11, s[60:63], s80 offen lds
    s_add_u32 m0, s85, 119808
    s_nop 0
    buffer_load_dwordx4 v12, s[60:63], s80 offen lds
    s_add_u32 m0, s85, 120832
    s_nop 0
    buffer_load_dwordx4 v13, s[60:63], s80 offen lds
    s_add_u32 m0, s85, 121856
    s_nop 0
    buffer_load_dwordx4 v14, s[60:63], s80 offen lds
    ds_read_b64_tr_b16 v[132:133], v20 offset:0
    ds_read_b64_tr_b16 v[134:135], v20 offset:1280
    ds_read_b64_tr_b16 v[136:137], v20 offset:32
    ds_read_b64_tr_b16 v[138:139], v20 offset:1312
    ds_read_b64_tr_b16 v[140:141], v20 offset:64
    ds_read_b64_tr_b16 v[142:143], v20 offset:1344
    ds_read_b64_tr_b16 v[144:145], v20 offset:96
    ds_read_b64_tr_b16 v[146:147], v20 offset:1376
    ds_read_b64_tr_b16 v[148:149], v20 offset:128
    ds_read_b64_tr_b16 v[150:151], v20 offset:1408
    ds_read_b64_tr_b16 v[152:153], v20 offset:5120
    ds_read_b64_tr_b16 v[154:155], v20 offset:6400
    ds_read_b64_tr_b16 v[156:157], v20 offset:5152
    ds_read_b64_tr_b16 v[158:159], v20 offset:6432
    ds_read_b64_tr_b16 v[160:161], v20 offset:5184
    ds_read_b64_tr_b16 v[162:163], v20 offset:6464
    ds_read_b64_tr_b16 v[164:165], v20 offset:5216
    ds_read_b64_tr_b16 v[166:167], v20 offset:6496
    ds_read_b64_tr_b16 v[168:169], v20 offset:5248
    ds_read_b64_tr_b16 v[170:171], v20 offset:6528
    ds_read_b64_tr_b16 v[172:173], v20 offset:10240
    ds_read_b64_tr_b16 v[174:175], v20 offset:11520
    ds_read_b64_tr_b16 v[176:177], v20 offset:10272
    ds_read_b64_tr_b16 v[178:179], v20 offset:11552
    ds_read_b64_tr_b16 v[180:181], v20 offset:10304
    ds_read_b64_tr_b16 v[182:183], v20 offset:11584
    ds_read_b64_tr_b16 v[184:185], v20 offset:10336
    ds_read_b64_tr_b16 v[186:187], v20 offset:11616
    ds_read_b64_tr_b16 v[188:189], v20 offset:10368
    ds_read_b64_tr_b16 v[190:191], v20 offset:11648
    ds_read_b64_tr_b16 v[192:193], v20 offset:15360
    ds_read_b64_tr_b16 v[194:195], v20 offset:16640
    ds_read_b64_tr_b16 v[196:197], v20 offset:15392
    ds_read_b64_tr_b16 v[198:199], v20 offset:16672
    ds_read_b64_tr_b16 v[200:201], v20 offset:15424
    ds_read_b64_tr_b16 v[202:203], v20 offset:16704
    ds_read_b64_tr_b16 v[204:205], v20 offset:15456
    ds_read_b64_tr_b16 v[206:207], v20 offset:16736
    ds_read_b64_tr_b16 v[208:209], v20 offset:15488
    ds_read_b64_tr_b16 v[210:211], v20 offset:16768
    ds_read_b64_tr_b16 v[212:213], v20 offset:20480
    ds_read_b64_tr_b16 v[214:215], v20 offset:21760
    ds_read_b64_tr_b16 v[216:217], v20 offset:20512
    ds_read_b64_tr_b16 v[218:219], v20 offset:21792
    ds_read_b64_tr_b16 v[220:221], v20 offset:20544
    ds_read_b64_tr_b16 v[222:223], v20 offset:21824
    ds_read_b64_tr_b16 v[224:225], v20 offset:20576
    ds_read_b64_tr_b16 v[226:227], v20 offset:21856
    ds_read_b64_tr_b16 v[228:229], v20 offset:20608
    ds_read_b64_tr_b16 v[230:231], v20 offset:21888
    ds_read_b64_tr_b16 v[232:233], v20 offset:25600
    ds_read_b64_tr_b16 v[234:235], v20 offset:26880
    ds_read_b64_tr_b16 v[236:237], v20 offset:25632
    ds_read_b64_tr_b16 v[238:239], v20 offset:26912
    ds_read_b64_tr_b16 v[240:241], v20 offset:25664
    ds_read_b64_tr_b16 v[242:243], v20 offset:26944
    ds_read_b64_tr_b16 v[244:245], v20 offset:25696
    ds_read_b64_tr_b16 v[246:247], v20 offset:26976
    ds_read_b64_tr_b16 v[248:249], v20 offset:25728
    ds_read_b64_tr_b16 v[250:251], v20 offset:27008
    ds_add_u32 v19, v3 offset:512
    s_mov_b32 s7, 0x20000
Lp_427:
    ds_read_b32 v4, v2 offset:592
    s_waitcnt lgkmcnt(0)
    s_setprio 2
    v_readfirstlane_b32 s76, v4
    s_setprio 0
    s_cmp_ge_u32 s76, 1
    s_cbranch_scc1 Lpd_428
    s_sub_u32 s7, s7, 1
    s_cmp_lg_u32 s7, 0
    s_cbranch_scc1 Lp_427
Lpd_428:
    s_branch L_ga_go
L_ga_poll:
    ds_read_b64_tr_b16 v[132:133], v20 offset:0
    ds_read_b64_tr_b16 v[134:135], v20 offset:1280
    ds_read_b64_tr_b16 v[136:137], v20 offset:32
    ds_read_b64_tr_b16 v[138:139], v20 offset:1312
    ds_read_b64_tr_b16 v[140:141], v20 offset:64
    ds_read_b64_tr_b16 v[142:143], v20 offset:1344
    ds_read_b64_tr_b16 v[144:145], v20 offset:96
    ds_read_b64_tr_b16 v[146:147], v20 offset:1376
    ds_read_b64_tr_b16 v[148:149], v20 offset:128
    ds_read_b64_tr_b16 v[150:151], v20 offset:1408
    ds_read_b64_tr_b16 v[152:153], v20 offset:5120
    ds_read_b64_tr_b16 v[154:155], v20 offset:6400
    ds_read_b64_tr_b16 v[156:157], v20 offset:5152
    ds_read_b64_tr_b16 v[158:159], v20 offset:6432
    ds_read_b64_tr_b16 v[160:161], v20 offset:5184
    ds_read_b64_tr_b16 v[162:163], v20 offset:6464
    ds_read_b64_tr_b16 v[164:165], v20 offset:5216
    ds_read_b64_tr_b16 v[166:167], v20 offset:6496
    ds_read_b64_tr_b16 v[168:169], v20 offset:5248
    ds_read_b64_tr_b16 v[170:171], v20 offset:6528
    ds_read_b64_tr_b16 v[172:173], v20 offset:10240
    ds_read_b64_tr_b16 v[174:175], v20 offset:11520
    ds_read_b64_tr_b16 v[176:177], v20 offset:10272
    ds_read_b64_tr_b16 v[178:179], v20 offset:11552
    ds_read_b64_tr_b16 v[180:181], v20 offset:10304
    ds_read_b64_tr_b16 v[182:183], v20 offset:11584
    ds_read_b64_tr_b16 v[184:185], v20 offset:10336
    ds_read_b64_tr_b16 v[186:187], v20 offset:11616
    ds_read_b64_tr_b16 v[188:189], v20 offset:10368
    ds_read_b64_tr_b16 v[190:191], v20 offset:11648
    ds_read_b64_tr_b16 v[192:193], v20 offset:15360
    ds_read_b64_tr_b16 v[194:195], v20 offset:16640
    ds_read_b64_tr_b16 v[196:197], v20 offset:15392
    ds_read_b64_tr_b16 v[198:199], v20 offset:16672
    ds_read_b64_tr_b16 v[200:201], v20 offset:15424
    ds_read_b64_tr_b16 v[202:203], v20 offset:16704
    ds_read_b64_tr_b16 v[204:205], v20 offset:15456
    ds_read_b64_tr_b16 v[206:207], v20 offset:16736
    ds_read_b64_tr_b16 v[208:209], v20 offset:15488
    ds_read_b64_tr_b16 v[210:211], v20 offset:16768
    ds_read_b64_tr_b16 v[212:213], v20 offset:20480
    ds_read_b64_tr_b16 v[214:215], v20 offset:21760
    ds_read_b64_tr_b16 v[216:217], v20 offset:20512
    ds_read_b64_tr_b16 v[218:219], v20 offset:21792
    ds_read_b64_tr_b16 v[220:221], v20 offset:20544
    ds_read_b64_tr_b16 v[222:223], v20 offset:21824
    ds_read_b64_tr_b16 v[224:225], v20 offset:20576
    ds_read_b64_tr_b16 v[226:227], v20 offset:21856
    ds_read_b64_tr_b16 v[228:229], v20 offset:20608
    ds_read_b64_tr_b16 v[230:231], v20 offset:21888
    ds_read_b64_tr_b16 v[232:233], v20 offset:25600
    ds_read_b64_tr_b16 v[234:235], v20 offset:26880
    ds_read_b64_tr_b16 v[236:237], v20 offset:25632
    ds_read_b64_tr_b16 v[238:239], v20 offset:26912
    ds_read_b64_tr_b16 v[240:241], v20 offset:25664
    ds_read_b64_tr_b16 v[242:243], v20 offset:26944
    ds_read_b64_tr_b16 v[244:245], v20 offset:25696
    ds_read_b64_tr_b16 v[246:247], v20 offset:26976
    ds_read_b64_tr_b16 v[248:249], v20 offset:25728
    ds_read_b64_tr_b16 v[250:251], v20 offset:27008
    ds_add_u32 v19, v3 offset:512
    s_setprio 2
    v_lshlrev_b32 v4, 7, v1
    s_lshl_b32 s76, s4, 10
    s_add_u32 s76, s76, 524288
    s_mov_b32 s7, 0x8000
    s_mov_b64 exec, 0xff
Lf_429:
    buffer_load_dwordx4 v[252:255], v4, s[72:75], s76 offen sc1
    s_waitcnt vmcnt(0)
    v_cmp_eq_u32 vcc, s6, v252
    v_cmp_eq_u32 s[78:79], s6, v253
    v_cmp_eq_u32 s[80:81], s6, v254
    v_cmp_eq_u32 s[82:83], s6, v255
    s_and_b32 s78, s78, vcc_lo
    s_and_b32 s80, s80, s82
    s_and_b32 s78, s78, s80
    s_cmp_eq_u32 s78, 0xff
    s_cbranch_scc1 Lfd_430
    s_sleep 2
    s_sub_u32 s7, s7, 1
    s_cmp_lg_u32 s7, 0
    s_cbranch_scc1 Lf_429
Lfd_430:
    s_mov_b64 exec, -1
    s_setprio 0
    ds_add_u32 v19, v3 offset:592
L_ga_go:
    s_add_u32 s64, s84, 4096
    s_add_u32 s65, s84, 8192
    s_add_u32 s66, s84, 12288
    s_add_u32 s67, s84, 16384
    buffer_load_dwordx4 v[32:35], v17, s[72:75], s84 offen offset:0 sc1
    buffer_load_dwordx4 v[36:39], v17, s[72:75], s84 offen offset:1024 sc1
    buffer_load_dwordx4 v[40:43], v17, s[72:75], s84 offen offset:2048 sc1
    buffer_load_dwordx4 v[44:47], v17, s[72:75], s84 offen offset:3072 sc1
    buffer_load_dwordx4 v[48:51], v17, s[72:75], s64 offen offset:0 sc1
    buffer_load_dwordx4 v[52:55], v17, s[72:75], s64 offen offset:1024 sc1
    buffer_load_dwordx4 v[56:59], v17, s[72:75], s64 offen offset:2048 sc1
    buffer_load_dwordx4 v[60:63], v17, s[72:75], s64 offen offset:3072 sc1
    s_waitcnt vmcnt(7)
    ds_add_u32 v19, v3 offset:596
    v_mfma_f32_16x16x32_bf16 v[112:115], v[132:135], v[32:35], 0
    ds_read_b64_tr_b16 v[132:133], v20 offset:30720
    ds_read_b64_tr_b16 v[134:135], v20 offset:32000
    buffer_load_dwordx4 v[64:67], v17, s[72:75], s65 offen offset:0 sc1
    v_mfma_f32_16x16x32_bf16 v[116:119], v[136:139], v[32:35], 0
    ds_read_b64_tr_b16 v[136:137], v20 offset:30752
    ds_read_b64_tr_b16 v[138:139], v20 offset:32032
    buffer_load_dwordx4 v[68:71], v17, s[72:75], s65 offen offset:1024 sc1
    v_mfma_f32_16x16x32_bf16 v[120:123], v[140:143], v[32:35], 0
    ds_read_b64_tr_b16 v[140:141], v20 offset:30784
    ds_read_b64_tr_b16 v[142:143], v20 offset:32064
    buffer_load_dwordx4 v[72:75], v17, s[72:75], s65 offen offset:2048 sc1
    v_mfma_f32_16x16x32_bf16 v[124:127], v[144:147], v[32:35], 0
    ds_read_b64_tr_b16 v[144:145], v20 offset:30816
    ds_read_b64_tr_b16 v[146:147], v20 offset:32096
    buffer_load_dwordx4 v[76:79], v17, s[72:75], s65 offen offset:3072 sc1
    v_mfma_f32_16x16x32_bf16 v[128:131], v[148:151], v[32:35], 0
    ds_read_b64_tr_b16 v[148:149], v20 offset:30848
    ds_read_b64_tr_b16 v[150:151], v20 offset:32128
    s_waitcnt vmcnt(10)
    v_mfma_f32_16x16x32_bf16 v[112:115], v[152:155], v[36:39], v[112:115]
    ds_read_b64_tr_b16 v[152:153], v20 offset:35840
    ds_read_b64_tr_b16 v[154:155], v20 offset:37120
    buffer_load_dwordx4 v[80:83], v17, s[72:75], s66 offen offset:0 sc1
    v_mfma_f32_16x16x32_bf16 v[116:119], v[156:159], v[36:39], v[116:119]
    ds_read_b64_tr_b16 v[156:157], v20 offset:35872
    ds_read_b64_tr_b16 v[158:159], v20 offset:37152
    buffer_load_dwordx4 v[84:87], v17, s[72:75], s66 offen offset:1024 sc1
    v_mfma_f32_16x16x32_bf16 v[120:123], v[160:163], v[36:39], v[120:123]
    ds_read_b64_tr_b16 v[160:161], v20 offset:35904
    ds_read_b64_tr_b16 v[162:163], v20 offset:37184
    buffer_load_dwordx4 v[88:91], v17, s[72:75], s66 offen offset:2048 sc1
    v_mfma_f32_16x16x32_bf16 v[124:127], v[164:167], v[36:39], v[124:127]
    ds_read_b64_tr_b16 v[164:165], v20 offset:35936
    ds_read_b64_tr_b16 v[166:167], v20 offset:37216
    buffer_load_dwordx4 v[92:95], v17, s[72:75], s66 offen offset:3072 sc1
    v_mfma_f32_16x16x32_bf16 v[128:131], v[168:171], v[36:39], v[128:131]
    ds_read_b64_tr_b16 v[168:169], v20 offset:35968
    ds_read_b64_tr_b16 v[170:171], v20 offset:37248
    s_waitcnt vmcnt(13)
    v_mfma_f32_16x16x32_bf16 v[112:115], v[172:175], v[40:43], v[112:115]
    ds_read_b64_tr_b16 v[172:173], v20 offset:40960
    ds_read_b64_tr_b16 v[174:175], v20 offset:42240
    buffer_load_dwordx4 v[96:99], v17, s[72:75], s67 offen offset:0 sc1
    v_mfma_f32_16x16x32_bf16 v[116:119], v[176:179], v[40:43], v[116:119]
    ds_read_b64_tr_b16 v[176:177], v20 offset:40992
    ds_read_b64_tr_b16 v[178:179], v20 offset:42272
    buffer_load_dwordx4 v[100:103], v17, s[72:75], s67 offen offset:1024 sc1
    v_mfma_f32_16x16x32_bf16 v[120:123], v[180:183], v[40:43], v[120:123]
    ds_read_b64_tr_b16 v[180:181], v20 offset:41024
    ds_read_b64_tr_b16 v[182:183], v20 offset:42304
    buffer_load_dwordx4 v[104:107], v17, s[72:75], s67 offen offset:2048 sc1
    v_mfma_f32_16x16x32_bf16 v[124:127], v[184:187], v[40:43], v[124:127]
    ds_read_b64_tr_b16 v[184:185], v20 offset:41056
    ds_read_b64_tr_b16 v[186:187], v20 offset:42336
    buffer_load_dwordx4 v[108:111], v17, s[72:75], s67 offen offset:3072 sc1
    v_mfma_f32_16x16x32_bf16 v[128:131], v[188:191], v[40:43], v[128:131]
    ds_read_b64_tr_b16 v[188:189], v20 offset:41088
    ds_read_b64_tr_b16 v[190:191], v20 offset:42368
    s_waitcnt vmcnt(16)
    v_mfma_f32_16x16x32_bf16 v[112:115], v[192:195], v[44:47], v[112:115]
    ds_read_b64_tr_b16 v[192:193], v20 offset:46080
    ds_read_b64_tr_b16 v[194:195], v20 offset:47360
    v_mfma_f32_16x16x32_bf16 v[116:119], v[196:199], v[44:47], v[116:119]
    ds_read_b64_tr_b16 v[196:197], v20 offset:46112
    ds_read_b64_tr_b16 v[198:199], v20 offset:47392
    v_mfma_f32_16x16x32_bf16 v[120:123], v[200:203], v[44:47], v[120:123]
    ds_read_b64_tr_b16 v[200:201], v20 offset:46144
    ds_read_b64_tr_b16 v[202:203], v20 offset:47424
    v_mfma_f32_16x16x32_bf16 v[124:127], v[204:207], v[44:47], v[124:127]
    ds_read_b64_tr_b16 v[204:205], v20 offset:46176
    ds_read_b64_tr_b16 v[206:207], v20 offset:47456
    v_mfma_f32_16x16x32_bf16 v[128:131], v[208:211], v[44:47], v[128:131]
    ds_read_b64_tr_b16 v[208:209], v20 offset:46208
    ds_read_b64_tr_b16 v[210:211], v20 offset:47488
    s_waitcnt vmcnt(15)
    v_mfma_f32_16x16x32_bf16 v[112:115], v[212:215], v[48:51], v[112:115]
    ds_read_b64_tr_b16 v[212:213], v21 offset:0
    ds_read_b64_tr_b16 v[214:215], v21 offset:1280
    v_mfma_f32_16x16x32_bf16 v[116:119], v[216:219], v[48:51], v[116:119]
    ds_read_b64_tr_b16 v[216:217], v21 offset:32
    ds_read_b64_tr_b16 v[218:219], v21 offset:1312
    v_mfma_f32_16x16x32_bf16 v[120:123], v[220:223], v[48:51], v[120:123]
    ds_read_b64_tr_b16 v[220:221], v21 offset:64
    ds_read_b64_tr_b16 v[222:223], v21 offset:1344
    v_mfma_f32_16x16x32_bf16 v[124:127], v[224:227], v[48:51], v[124:127]
    ds_read_b64_tr_b16 v[224:225], v21 offset:96
    ds_read_b64_tr_b16 v[226:227], v21 offset:1376
    v_mfma_f32_16x16x32_bf16 v[128:131], v[228:231], v[48:51], v[128:131]
    ds_read_b64_tr_b16 v[228:229], v21 offset:128
    ds_read_b64_tr_b16 v[230:231], v21 offset:1408
    s_waitcnt vmcnt(0)
    s_mov_b32 s7, 0x20000
Lp_442:
    ds_read_b32 v4, v2 offset:512
    s_waitcnt lgkmcnt(0)
    s_setprio 2
    v_readfirstlane_b32 s76, v4
    s_setprio 0
    s_cmp_ge_u32 s76, 8
    s_cbranch_scc1 Lpd_443
    s_sub_u32 s7, s7, 1
    s_cmp_lg_u32 s7, 0
    s_cbranch_scc1 Lp_442
Lpd_443:
    v_mfma_f32_16x16x32_bf16 v[112:115], v[232:235], v[52:55], v[112:115]
    ds_read_b64_tr_b16 v[232:233], v21 offset:5120
    ds_read_b64_tr_b16 v[234:235], v21 offset:6400
    s_add_u32 m0, s85, 0
    s_add_u32 s80, s86, 286720
    buffer_load_dwordx4 v10, s[60:63], s80 offen lds
    v_mfma_f32_16x16x32_bf16 v[116:119], v[236:239], v[52:55], v[116:119]
    ds_read_b64_tr_b16 v[236:237], v21 offset:5152
    ds_read_b64_tr_b16 v[238:239], v21 offset:6432
    s_add_u32 m0, s85, 1024
    s_nop 0
    buffer_load_dwordx4 v11, s[60:63], s80 offen lds
    v_mfma_f32_16x16x32_bf16 v[120:123], v[240:243], v[52:55], v[120:123]
    ds_read_b64_tr_b16 v[240:241], v21 offset:5184
    ds_read_b64_tr_b16 v[242:243], v21 offset:6464
    s_add_u32 m0, s85, 2048
    s_nop 0
    buffer_load_dwordx4 v12, s[60:63], s80 offen lds
    v_mfma_f32_16x16x32_bf16 v[124:127], v[244:247], v[52:55], v[124:127]
    ds_read_b64_tr_b16 v[244:245], v21 offset:5216
    ds_read_b64_tr_b16 v[246:247], v21 offset:6496
    s_add_u32 m0, s85, 3072
    s_nop 0
    buffer_load_dwordx4 v13, s[60:63], s80 offen lds
    v_mfma_f32_16x16x32_bf16 v[128:131], v[248:251], v[52:55], v[128:131]
    ds_read_b64_tr_b16 v[248:249], v21 offset:5248
    ds_read_b64_tr_b16 v[250:251], v21 offset:6528
    s_waitcnt lgkmcnt(10)
    v_mfma_f32_16x16x32_bf16 v[112:115], v[132:135], v[56:59], v[112:115]
    ds_read_b64_tr_b16 v[132:133], v21 offset:10240
    ds_read_b64_tr_b16 v[134:135], v21 offset:11520
    s_add_u32 m0, s85, 4096
    s_nop 0
    buffer_load_dwordx4 v14, s[60:63], s80 offen lds
    v_mfma_f32_16x16x32_bf16 v[116:119], v[136:139], v[56:59], v[116:119]
    ds_read_b64_tr_b16 v[136:137], v21 offset:10272
    ds_read_b64_tr_b16 v[138:139], v21 offset:11552
    s_cmp_ge_u32 s15, 2
    s_cbranch_scc1 Lbi_432
    s_add_u32 m0, s85, 20480
    s_add_u32 s80, s86, 450560
    buffer_load_dwordx4 v10, s[60:63], s80 offen lds
Lbi_432:
    v_mfma_f32_16x16x32_bf16 v[120:123], v[140:143], v[56:59], v[120:123]
    ds_read_b64_tr_b16 v[140:141], v21 offset:10304
    ds_read_b64_tr_b16 v[142:143], v21 offset:11584
    s_cmp_ge_u32 s15, 2
    s_cbranch_scc1 Lbi_433
    s_add_u32 m0, s85, 21504
    s_nop 0
    buffer_load_dwordx4 v11, s[60:63], s80 offen lds
Lbi_433:
    v_mfma_f32_16x16x32_bf16 v[124:127], v[144:147], v[56:59], v[124:127]
    ds_read_b64_tr_b16 v[144:145], v21 offset:10336
    ds_read_b64_tr_b16 v[146:147], v21 offset:11616
    s_cmp_ge_u32 s15, 2
    s_cbranch_scc1 Lbi_434
    s_add_u32 m0, s85, 22528
    s_nop 0
    buffer_load_dwordx4 v12, s[60:63], s80 offen lds
Lbi_434:
    v_mfma_f32_16x16x32_bf16 v[128:131], v[148:151], v[56:59], v[128:131]
    ds_read_b64_tr_b16 v[148:149], v21 offset:10368
    ds_read_b64_tr_b16 v[150:151], v21 offset:11648
    ds_add_u32 v19, v3 offset:512
    s_waitcnt lgkmcnt(10)
    v_mfma_f32_16x16x32_bf16 v[112:115], v[152:155], v[60:63], v[112:115]
    ds_read_b64_tr_b16 v[152:153], v21 offset:15360
    ds_read_b64_tr_b16 v[154:155], v21 offset:16640
    s_cmp_ge_u32 s15, 2
    s_cbranch_scc1 Lbi_435
    s_add_u32 m0, s85, 23552
    s_nop 0
    buffer_load_dwordx4 v13, s[60:63], s80 offen lds
Lbi_435:
    v_mfma_f32_16x16x32_bf16 v[116:119], v[156:159], v[60:63], v[116:119]
    ds_read_b64_tr_b16 v[156:157], v21 offset:15392
    ds_read_b64_tr_b16 v[158:159], v21 offset:16672
    s_cmp_ge_u32 s15, 2
    s_cbranch_scc1 Lbi_436
    s_add_u32 m0, s85, 24576
    s_nop 0
    buffer_load_dwordx4 v14, s[60:63], s80 offen lds
Lbi_436:
    v_mfma_f32_16x16x32_bf16 v[120:123], v[160:163], v[60:63], v[120:123]
    ds_read_b64_tr_b16 v[160:161], v21 offset:15424
    ds_read_b64_tr_b16 v[162:163], v21 offset:16704
    s_cmp_lg_u32 s15, 3
    s_cbranch_scc1 Lb6_431
    s_add_u32 m0, s85, 117760
    s_add_u32 s80, s86, 122880
    buffer_load_dwordx4 v10, s[60:63], s80 offen lds
    s_add_u32 m0, s85, 118784
    s_nop 0
    buffer_load_dwordx4 v11, s[60:63], s80 offen lds
    s_add_u32 m0, s85, 119808
    s_nop 0
    buffer_load_dwordx4 v12, s[60:63], s80 offen lds
    s_add_u32 m0, s85, 120832
    s_nop 0
    buffer_load_dwordx4 v13, s[60:63], s80 offen lds
    s_add_u32 m0, s85, 121856
    s_nop 0
    buffer_load_dwordx4 v14, s[60:63], s80 offen lds
Lb6_431:
    v_mfma_f32_16x16x32_bf16 v[124:127], v[164:167], v[60:63], v[124:127]
    ds_read_b64_tr_b16 v[164:165], v21 offset:15456
    ds_read_b64_tr_b16 v[166:167], v21 offset:16736
    v_mfma_f32_16x16x32_bf16 v[128:131], v[168:171], v[60:63], v[128:131]
    ds_read_b64_tr_b16 v[168:169], v21 offset:15488
    ds_read_b64_tr_b16 v[170:171], v21 offset:16768
    s_waitcnt lgkmcnt(10)
    v_mfma_f32_16x16x32_bf16 v[112:115], v[172:175], v[64:67], v[112:115]
    ds_read_b64_tr_b16 v[172:173], v21 offset:20480
    ds_read_b64_tr_b16 v[174:175], v21 offset:21760
    v_mfma_f32_16x16x32_bf16 v[116:119], v[176:179], v[64:67], v[116:119]
    ds_read_b64_tr_b16 v[176:177], v21 offset:20512
    ds_read_b64_tr_b16 v[178:179], v21 offset:21792
    v_mfma_f32_16x16x32_bf16 v[120:123], v[180:183], v[64:67], v[120:123]
    ds_read_b64_tr_b16 v[180:181], v21 offset:20544
    ds_read_b64_tr_b16 v[182:183], v21 offset:21824
    v_mfma_f32_16x16x32_bf16 v[124:127], v[184:187], v[64:67], v[124:127]
    ds_read_b64_tr_b16 v[184:185], v21 offset:20576
    ds_read_b64_tr_b16 v[186:187], v21 offset:21856
    v_mfma_f32_16x16x32_bf16 v[128:131], v[188:191], v[64:67], v[128:131]
    ds_read_b64_tr_b16 v[188:189], v21 offset:20608
    ds_read_b64_tr_b16 v[190:191], v21 offset:21888
    s_waitcnt lgkmcnt(10)
    v_mfma_f32_16x16x32_bf16 v[112:115], v[192:195], v[68:71], v[112:115]
    ds_read_b64_tr_b16 v[192:193], v21 offset:25600
    ds_read_b64_tr_b16 v[194:195], v21 offset:26880
    v_mfma_f32_16x16x32_bf16 v[116:119], v[196:199], v[68:71], v[116:119]
    ds_read_b64_tr_b16 v[196:197], v21 offset:25632
    ds_read_b64_tr_b16 v[198:199], v21 offset:26912
    v_mfma_f32_16x16x32_bf16 v[120:123], v[200:203], v[68:71], v[120:123]
    ds_read_b64_tr_b16 v[200:201], v21 offset:25664
    ds_read_b64_tr_b16 v[202:203], v21 offset:26944
    v_mfma_f32_16x16x32_bf16 v[124:127], v[204:207], v[68:71], v[124:127]
    ds_read_b64_tr_b16 v[204:205], v21 offset:25696
    ds_read_b64_tr_b16 v[206:207], v21 offset:26976
    v_mfma_f32_16x16x32_bf16 v[128:131], v[208:211], v[68:71], v[128:131]
    ds_read_b64_tr_b16 v[208:209], v21 offset:25728
    ds_read_b64_tr_b16 v[210:211], v21 offset:27008
    s_waitcnt vmcnt(0)
    ds_add_u32 v19, v3 offset:560
    s_mov_b32 s7, 0x20000
Lp_444:
    ds_read_b32 v4, v2 offset:512
    s_waitcnt lgkmcnt(0)
    s_setprio 2
    v_readfirstlane_b32 s76, v4
    s_setprio 0
    s_cmp_ge_u32 s76, 12
    s_cbranch_scc1 Lpd_445
    s_sub_u32 s7, s7, 1
    s_cmp_lg_u32 s7, 0
    s_cbranch_scc1 Lp_444
Lpd_445:
    s_waitcnt lgkmcnt(10)
    v_mfma_f32_16x16x32_bf16 v[112:115], v[212:215], v[72:75], v[112:115]
    ds_read_b64_tr_b16 v[212:213], v21 offset:30720
    ds_read_b64_tr_b16 v[214:215], v21 offset:32000
    s_add_u32 m0, s85, 30720
    s_add_u32 s80, s86, 532480
    buffer_load_dwordx4 v10, s[60:63], s80 offen lds
    v_mfma_f32_16x16x32_bf16 v[116:119], v[216:219], v[72:75], v[116:119]
    ds_read_b64_tr_b16 v[216:217], v21 offset:30752
    ds_read_b64_tr_b16 v[218:219], v21 offset:32032
    s_add_u32 m0, s85, 31744
    s_nop 0
    buffer_load_dwordx4 v11, s[60:63], s80 offen lds
    v_mfma_f32_16x16x32_bf16 v[120:123], v[220:223], v[72:75], v[120:123]
    ds_read_b64_tr_b16 v[220:221], v21 offset:30784
    ds_read_b64_tr_b16 v[222:223], v21 offset:32064
    s_add_u32 m0, s85, 32768
    s_nop 0
    buffer_load_dwordx4 v12, s[60:63], s80 offen lds
    v_mfma_f32_16x16x32_bf16 v[124:127], v[224:227], v[72:75], v[124:127]
    ds_read_b64_tr_b16 v[224:225], v21 offset:30816
    ds_read_b64_tr_b16 v[226:227], v21 offset:32096
    s_add_u32 m0, s85, 33792
    s_nop 0
    buffer_load_dwordx4 v13, s[60:63], s80 offen lds
    v_mfma_f32_16x16x32_bf16 v[128:131], v[228:231], v[72:75], v[128:131]
    ds_read_b64_tr_b16 v[228:229], v21 offset:30848
    ds_read_b64_tr_b16 v[230:231], v21 offset:32128
    s_waitcnt lgkmcnt(10)
    v_mfma_f32_16x16x32_bf16 v[112:115], v[232:235], v[76:79], v[112:115]
    ds_read_b64_tr_b16 v[232:233], v21 offset:35840
    ds_read_b64_tr_b16 v[234:235], v21 offset:37120
    s_add_u32 m0, s85, 34816
    s_nop 0
    buffer_load_dwordx4 v14, s[60:63], s80 offen lds
    v_mfma_f32_16x16x32_bf16 v[116:119], v[236:239], v[76:79], v[116:119]
    ds_read_b64_tr_b16 v[236:237], v21 offset:35872
    ds_read_b64_tr_b16 v[238:239], v21 offset:37152
    s_cmp_ge_u32 s15, 3
    s_cbranch_scc1 Lbi_437
    s_add_u32 m0, s85, 51200
    s_add_u32 s80, s86, 696320
    buffer_load_dwordx4 v10, s[60:63], s80 offen lds
Lbi_437:
    v_mfma_f32_16x16x32_bf16 v[120:123], v[240:243], v[76:79], v[120:123]
    ds_read_b64_tr_b16 v[240:241], v21 offset:35904
    ds_read_b64_tr_b16 v[242:243], v21 offset:37184
    s_cmp_ge_u32 s15, 3
    s_cbranch_scc1 Lbi_438
    s_add_u32 m0, s85, 52224
    s_nop 0
    buffer_load_dwordx4 v11, s[60:63], s80 offen lds
Lbi_438:
    v_mfma_f32_16x16x32_bf16 v[124:127], v[244:247], v[76:79], v[124:127]
    ds_read_b64_tr_b16 v[244:245], v21 offset:35936
    ds_read_b64_tr_b16 v[246:247], v21 offset:37216
    s_cmp_ge_u32 s15, 3
    s_cbranch_scc1 Lbi_439
    s_add_u32 m0, s85, 53248
    s_nop 0
    buffer_load_dwordx4 v12, s[60:63], s80 offen lds
Lbi_439:
    v_mfma_f32_16x16x32_bf16 v[128:131], v[248:251], v[76:79], v[128:131]
    ds_read_b64_tr_b16 v[248:249], v21 offset:35968
    ds_read_b64_tr_b16 v[250:251], v21 offset:37248
    s_waitcnt lgkmcnt(10)
    v_mfma_f32_16x16x32_bf16 v[112:115], v[132:135], v[80:83], v[112:115]
    ds_read_b64_tr_b16 v[132:133], v21 offset:40960
    ds_read_b64_tr_b16 v[134:135], v21 offset:42240
    s_cmp_ge_u32 s15, 3
    s_cbranch_scc1 Lbi_440
    s_add_u32 m0, s85, 54272
    s_nop 0
    buffer_load_dwordx4 v13, s[60:63], s80 offen lds
Lbi_440:
    v_mfma_f32_16x16x32_bf16 v[116:119], v[136:139], v[80:83], v[116:119]
    ds_read_b64_tr_b16 v[136:137], v21 offset:40992
    ds_read_b64_tr_b16 v[138:139], v21 offset:42272
    s_cmp_ge_u32 s15, 3
    s_cbranch_scc1 Lbi_441
    s_add_u32 m0, s85, 55296
    s_nop 0
    buffer_load_dwordx4 v14, s[60:63], s80 offen lds
Lbi_441:
    v_mfma_f32_16x16x32_bf16 v[120:123], v[140:143], v[80:83], v[120:123]
    ds_read_b64_tr_b16 v[140:141], v21 offset:41024
    ds_read_b64_tr_b16 v[142:143], v21 offset:42304
    v_mfma_f32_16x16x32_bf16 v[124:127], v[144:147], v[80:83], v[124:127]
    ds_read_b64_tr_b16 v[144:145], v21 offset:41056
    ds_read_b64_tr_b16 v[146:147], v21 offset:42336
    v_mfma_f32_16x16x32_bf16 v[128:131], v[148:151], v[80:83], v[128:131]
    ds_read_b64_tr_b16 v[148:149], v21 offset:41088
    ds_read_b64_tr_b16 v[150:151], v21 offset:42368
    s_waitcnt lgkmcnt(10)
    v_mfma_f32_16x16x32_bf16 v[112:115], v[152:155], v[84:87], v[112:115]
    ds_read_b64_tr_b16 v[152:153], v21 offset:46080
    ds_read_b64_tr_b16 v[154:155], v21 offset:47360
    v_mfma_f32_16x16x32_bf16 v[116:119], v[156:159], v[84:87], v[116:119]
    ds_read_b64_tr_b16 v[156:157], v21 offset:46112
    ds_read_b64_tr_b16 v[158:159], v21 offset:47392
    v_mfma_f32_16x16x32_bf16 v[120:123], v[160:163], v[84:87], v[120:123]
    ds_read_b64_tr_b16 v[160:161], v21 offset:46144
    ds_read_b64_tr_b16 v[162:163], v21 offset:47424
    v_mfma_f32_16x16x32_bf16 v[124:127], v[164:167], v[84:87], v[124:127]
    ds_read_b64_tr_b16 v[164:165], v21 offset:46176
    ds_read_b64_tr_b16 v[166:167], v21 offset:47456
    v_mfma_f32_16x16x32_bf16 v[128:131], v[168:171], v[84:87], v[128:131]
    ds_read_b64_tr_b16 v[168:169], v21 offset:46208
    ds_read_b64_tr_b16 v[170:171], v21 offset:47488
    ds_add_u32 v19, v3 offset:512
    s_waitcnt lgkmcnt(10)
    v_mfma_f32_16x16x32_bf16 v[112:115], v[172:175], v[88:91], v[112:115]
    v_mfma_f32_16x16x32_bf16 v[116:119], v[176:179], v[88:91], v[116:119]
    v_mfma_f32_16x16x32_bf16 v[120:123], v[180:183], v[88:91], v[120:123]
    v_mfma_f32_16x16x32_bf16 v[124:127], v[184:187], v[88:91], v[124:127]
    v_mfma_f32_16x16x32_bf16 v[128:131], v[188:191], v[88:91], v[128:131]
    s_waitcnt lgkmcnt(10)
    v_mfma_f32_16x16x32_bf16 v[112:115], v[192:195], v[92:95], v[112:115]
    v_mfma_f32_16x16x32_bf16 v[116:119], v[196:199], v[92:95], v[116:119]
    v_mfma_f32_16x16x32_bf16 v[120:123], v[200:203], v[92:95], v[120:123]
    v_mfma_f32_16x16x32_bf16 v[124:127], v[204:207], v[92:95], v[124:127]
    v_mfma_f32_16x16x32_bf16 v[128:131], v[208:211], v[92:95], v[128:131]
    s_waitcnt lgkmcnt(10)
    v_mfma_f32_16x16x32_bf16 v[112:115], v[212:215], v[96:99], v[112:115]
    v_mfma_f32_16x16x32_bf16 v[116:119], v[216:219], v[96:99], v[116:119]
    v_mfma_f32_16x16x32_bf16 v[120:123], v[220:223], v[96:99], v[120:123]
    v_mfma_f32_16x16x32_bf16 v[124:127], v[224:227], v[96:99], v[124:127]
    v_mfma_f32_16x16x32_bf16 v[128:131], v[228:231], v[96:99], v[128:131]
    s_waitcnt lgkmcnt(10)
    v_mfma_f32_16x16x32_bf16 v[112:115], v[232:235], v[100:103], v[112:115]
    v_mfma_f32_16x16x32_bf16 v[116:119], v[236:239], v[100:103], v[116:119]
    v_mfma_f32_16x16x32_bf16 v[120:123], v[240:243], v[100:103], v[120:123]
    v_mfma_f32_16x16x32_bf16 v[124:127], v[244:247], v[100:103], v[124:127]
    v_mfma_f32_16x16x32_bf16 v[128:131], v[248:251], v[100:103], v[128:131]
    s_waitcnt vmcnt(0)
    ds_add_u32 v19, v3 offset:568
    ds_read_b32 v4, v2 offset:512
    s_waitcnt lgkmcnt(10)
    v_mfma_f32_16x16x32_bf16 v[112:115], v[132:135], v[104:107], v[112:115]
    v_mfma_f32_16x16x32_bf16 v[116:119], v[136:139], v[104:107], v[116:119]
    v_mfma_f32_16x16x32_bf16 v[120:123], v[140:143], v[104:107], v[120:123]
    v_mfma_f32_16x16x32_bf16 v[124:127], v[144:147], v[104:107], v[124:127]
    v_mfma_f32_16x16x32_bf16 v[128:131], v[148:151], v[104:107], v[128:131]
    s_waitcnt lgkmcnt(0)
    v_mfma_f32_16x16x32_bf16 v[112:115], v[152:155], v[108:111], v[112:115]
    v_mfma_f32_16x16x32_bf16 v[116:119], v[156:159], v[108:111], v[116:119]
    v_mfma_f32_16x16x32_bf16 v[120:123], v[160:163], v[108:111], v[120:123]
    v_mfma_f32_16x16x32_bf16 v[124:127], v[164:167], v[108:111], v[124:127]
    v_mfma_f32_16x16x32_bf16 v[128:131], v[168:171], v[108:111], v[128:131]
    s_setprio 2
    v_readfirstlane_b32 s76, v4
    s_setprio 0
    s_cmp_lt_u32 s76, 16
    s_cbranch_scc1 Lslow_446
Lback_447:
    ds_write_b128 v25, v[112:115] offset:0
    ds_write_b128 v25, v[116:119] offset:1024
    ds_write_b128 v25, v[120:123] offset:2048
    ds_write_b128 v25, v[124:127] offset:3072
    ds_write_b128 v25, v[128:131] offset:4096
    ds_add_u32 v24, v3 offset:608
L_fin:
L_end:
    s_endpgm
Lslow_23:
    s_mov_b32 s7, 0x20000
Lp_25:
    ds_read_b32 v80, v2 offset:4
    s_waitcnt lgkmcnt(0)
    v_readfirstlane_b32 s76, v80
    s_nop 0
    s_cmp_ge_u32 s76, 1
    s_cbranch_scc1 Lpd_26
    s_sub_u32 s7, s7, 1
    s_cmp_lg_u32 s7, 0
    s_cbranch_scc1 Lp_25
Lpd_26:
    s_branch Lback_24
Lslow_27:
    s_mov_b32 s7, 0x20000
Lp_29:
    ds_read_b32 v80, v2 offset:8
    s_waitcnt lgkmcnt(0)
    v_readfirstlane_b32 s76, v80
    s_nop 0
    s_cmp_ge_u32 s76, 1
    s_cbranch_scc1 Lpd_30
    s_sub_u32 s7, s7, 1
    s_cmp_lg_u32 s7, 0
    s_cbranch_scc1 Lp_29
Lpd_30:
    s_branch Lback_28
Lslow_31:
    s_mov_b32 s7, 0x20000
Lp_33:
    ds_read_b32 v80, v2 offset:12
    s_waitcnt lgkmcnt(0)
    v_readfirstlane_b32 s76, v80
    s_nop 0
    s_cmp_ge_u32 s76, 1
    s_cbranch_scc1 Lpd_34
    s_sub_u32 s7, s7, 1
    s_cmp_lg_u32 s7, 0
    s_cbranch_scc1 Lp_33
Lpd_34:
    s_branch Lback_32
Lslow_35:
    s_mov_b32 s7, 0x20000
Lp_37:
    ds_read_b32 v80, v2 offset:16
    s_waitcnt lgkmcnt(0)
    v_readfirstlane_b32 s76, v80
    s_nop 0
    s_cmp_ge_u32 s76, 1
    s_cbranch_scc1 Lpd_38
    s_sub_u32 s7, s7, 1
    s_cmp_lg_u32 s7, 0
    s_cbranch_scc1 Lp_37
Lpd_38:
    s_branch Lback_36
Lslow_39:
    s_mov_b32 s7, 0x20000
Lp_41:
    ds_read_b32 v80, v2 offset:20
    s_waitcnt lgkmcnt(0)
    v_readfirstlane_b32 s76, v80
    s_nop 0
    s_cmp_ge_u32 s76, 1
    s_cbranch_scc1 Lpd_42
    s_sub_u32 s7, s7, 1
    s_cmp_lg_u32 s7, 0
    s_cbranch_scc1 Lp_41
Lpd_42:
    s_branch Lback_40
Lslow_43:
    s_mov_b32 s7, 0x20000
Lp_45:
    ds_read_b32 v80, v2 offset:24
    s_waitcnt lgkmcnt(0)
    v_readfirstlane_b32 s76, v80
    s_nop 0
    s_cmp_ge_u32 s76, 1
    s_cbranch_scc1 Lpd_46
    s_sub_u32 s7, s7, 1
    s_cmp_lg_u32 s7, 0
    s_cbranch_scc1 Lp_45
Lpd_46:
    s_branch Lback_44
Lslow_47:
    s_mov_b32 s7, 0x20000
Lp_49:
    ds_read_b32 v80, v2 offset:28
    s_waitcnt lgkmcnt(0)
    v_readfirstlane_b32 s76, v80
    s_nop 0
    s_cmp_ge_u32 s76, 1
    s_cbranch_scc1 Lpd_50
    s_sub_u32 s7, s7, 1
    s_cmp_lg_u32 s7, 0
    s_cbranch_scc1 Lp_49
Lpd_50:
    s_branch Lback_48
Lslow_51:
    s_mov_b32 s7, 0x20000
Lp_53:
    ds_read_b32 v80, v2 offset:32
    s_waitcnt lgkmcnt(0)
    v_readfirstlane_b32 s76, v80
    s_nop 0
    s_cmp_ge_u32 s76, 1
    s_cbranch_scc1 Lpd_54
    s_sub_u32 s7, s7, 1
    s_cmp_lg_u32 s7, 0
    s_cbranch_scc1 Lp_53
Lpd_54:
    s_branch Lback_52
Lslow_55:
    s_mov_b32 s7, 0x20000
Lp_57:
    ds_read_b32 v80, v2 offset:36
    s_waitcnt lgkmcnt(0)
    v_readfirstlane_b32 s76, v80
    s_nop 0
    s_cmp_ge_u32 s76, 1
    s_cbranch_scc1 Lpd_58
    s_sub_u32 s7, s7, 1
    s_cmp_lg_u32 s7, 0
    s_cbranch_scc1 Lp_57
Lpd_58:
    s_branch Lback_56
Lslow_59:
    s_mov_b32 s7, 0x20000
Lp_61:
    ds_read_b32 v81, v2 offset:76
    s_waitcnt lgkmcnt(0)
    v_readfirstlane_b32 s76, v81
    s_nop 0
    s_cmp_ge_u32 s76, 4
    s_cbranch_scc1 Lpd_62
    s_sub_u32 s7, s7, 1
    s_cmp_lg_u32 s7, 0
    s_cbranch_scc1 Lp_61
Lpd_62:
    s_branch Lback_60
Lslow_63:
    s_mov_b32 s7, 0x20000
Lp_65:
    ds_read_b32 v14, v2 offset:124
    s_waitcnt lgkmcnt(0)
    v_readfirstlane_b32 s76, v14
    s_nop 0
    s_cmp_ge_u32 s76, 4
    s_cbranch_scc1 Lpd_66
    s_sub_u32 s7, s7, 1
    s_cmp_lg_u32 s7, 0
    s_cbranch_scc1 Lp_65
Lpd_66:
    s_branch Lback_64
Lxs_69:
    buffer_store_dword v5, v4, s[72:75], s76 offen sc1
    s_branch Lxb_70
Lslow_71:
    s_mov_b32 s7, 0x20000
Lp_73:
    ds_read_b32 v14, v2 offset:596
    s_waitcnt lgkmcnt(0)
    v_readfirstlane_b32 s76, v14
    s_nop 0
    s_cmp_ge_u32 s76, 4
    s_cbranch_scc1 Lpd_74
    s_sub_u32 s7, s7, 1
    s_cmp_lg_u32 s7, 0
    s_cbranch_scc1 Lp_73
Lpd_74:
    s_branch Lback_72
Lslow_77:
    s_mov_b32 s7, 0x20000
Lp_79:
    ds_read_b32 v14, v2 offset:560
    s_waitcnt lgkmcnt(0)
    v_readfirstlane_b32 s76, v14
    s_nop 0
    s_cmp_ge_u32 s76, 4
    s_cbranch_scc1 Lpd_80
    s_sub_u32 s7, s7, 1
    s_cmp_lg_u32 s7, 0
    s_cbranch_scc1 Lp_79
Lpd_80:
    s_branch Lback_78
Lslow_81:
    s_mov_b32 s7, 0x20000
Lp_83:
    ds_read_b32 v14, v2 offset:568
    s_waitcnt lgkmcnt(0)
    v_readfirstlane_b32 s76, v14
    s_nop 0
    s_cmp_ge_u32 s76, 4
    s_cbranch_scc1 Lpd_84
    s_sub_u32 s7, s7, 1
    s_cmp_lg_u32 s7, 0
    s_cbranch_scc1 Lp_83
Lpd_84:
    s_branch Lback_82
Lslow_85:
    s_mov_b32 s7, 0x20000
Lp_87:
    ds_read_b32 v14, v245 offset:608
    s_waitcnt lgkmcnt(0)
    v_readfirstlane_b32 s76, v14
    s_nop 0
    s_cmp_ge_u32 s76, 1
    s_cbranch_scc1 Lpd_88
    s_sub_u32 s7, s7, 1
    s_cmp_lg_u32 s7, 0
    s_cbranch_scc1 Lp_87
Lpd_88:
    s_branch Lback_86
Lslow_89:
    s_mov_b32 s7, 0x20000
Lp_91:
    ds_read_b32 v29, v2 offset:144
    s_waitcnt lgkmcnt(0)
    s_setprio 2
    v_readfirstlane_b32 s76, v29
    s_setprio 0
    s_cmp_ge_u32 s76, 4
    s_cbranch_scc1 Lpd_92
    s_sub_u32 s7, s7, 1
    s_cmp_lg_u32 s7, 0
    s_cbranch_scc1 Lp_91
Lpd_92:
    s_branch Lback_90
Lslow_93:
    s_mov_b32 s7, 0x20000
Lp_95:
    ds_read_b32 v29, v2 offset:144
    s_waitcnt lgkmcnt(0)
    s_setprio 2
    v_readfirstlane_b32 s76, v29
    s_setprio 0
    s_cmp_ge_u32 s76, 8
    s_cbranch_scc1 Lpd_96
    s_sub_u32 s7, s7, 1
    s_cmp_lg_u32 s7, 0
    s_cbranch_scc1 Lp_95
Lpd_96:
    s_branch Lback_94
Lslow_97:
    s_mov_b32 s7, 0x20000
Lp_99:
    ds_read_b32 v29, v2 offset:144
    s_waitcnt lgkmcnt(0)
    s_setprio 2
    v_readfirstlane_b32 s76, v29
    s_setprio 0
    s_cmp_ge_u32 s76, 12
    s_cbranch_scc1 Lpd_100
    s_sub_u32 s7, s7, 1
    s_cmp_lg_u32 s7, 0
    s_cbranch_scc1 Lp_99
Lpd_100:
    s_branch Lback_98
Lslow_101:
    s_mov_b32 s7, 0x20000
Lp_103:
    ds_read_b32 v29, v2 offset:144
    s_waitcnt lgkmcnt(0)
    s_setprio 2
    v_readfirstlane_b32 s76, v29
    s_setprio 0
    s_cmp_ge_u32 s76, 16
    s_cbranch_scc1 Lpd_104
    s_sub_u32 s7, s7, 1
    s_cmp_lg_u32 s7, 0
    s_cbranch_scc1 Lp_103
Lpd_104:
    s_branch Lback_102
Lslow_105:
    s_mov_b32 s7, 0x20000
Lp_107:
    ds_read_b32 v29, v2 offset:144
    s_waitcnt lgkmcnt(0)
    s_setprio 2
    v_readfirstlane_b32 s76, v29
    s_setprio 0
    s_cmp_ge_u32 s76, 20
    s_cbranch_scc1 Lpd_108
    s_sub_u32 s7, s7, 1
    s_cmp_lg_u32 s7, 0
    s_cbranch_scc1 Lp_107
Lpd_108:
    s_branch Lback_106
Lslow_109:
    s_mov_b32 s7, 0x20000
Lp_111:
    ds_read_b32 v29, v2 offset:144
    s_waitcnt lgkmcnt(0)
    s_setprio 2
    v_readfirstlane_b32 s76, v29
    s_setprio 0
    s_cmp_ge_u32 s76, 24
    s_cbranch_scc1 Lpd_112
    s_sub_u32 s7, s7, 1
    s_cmp_lg_u32 s7, 0
    s_cbranch_scc1 Lp_111
Lpd_112:
    s_branch Lback_110
Lslow_113:
    s_mov_b32 s7, 0x20000
Lp_115:
    ds_read_b32 v29, v2 offset:144
    s_waitcnt lgkmcnt(0)
    s_setprio 2
    v_readfirstlane_b32 s76, v29
    s_setprio 0
    s_cmp_ge_u32 s76, 28
    s_cbranch_scc1 Lpd_116
    s_sub_u32 s7, s7, 1
    s_cmp_lg_u32 s7, 0
    s_cbranch_scc1 Lp_115
Lpd_116:
    s_branch Lback_114
Lslow_117:
    s_mov_b32 s7, 0x20000
Lp_119:
    ds_read_b32 v29, v2 offset:144
    s_waitcnt lgkmcnt(0)
    s_setprio 2
    v_readfirstlane_b32 s76, v29
    s_setprio 0
    s_cmp_ge_u32 s76, 32
    s_cbranch_scc1 Lpd_120
    s_sub_u32 s7, s7, 1
    s_cmp_lg_u32 s7, 0
    s_cbranch_scc1 Lp_119
Lpd_120:
    s_branch Lback_118
Lslow_121:
    s_mov_b32 s7, 0x20000
Lp_123:
    ds_read_b32 v29, v2 offset:144
    s_waitcnt lgkmcnt(0)
    s_setprio 2
    v_readfirstlane_b32 s76, v29
    s_setprio 0
    s_cmp_ge_u32 s76, 36
    s_cbranch_scc1 Lpd_124
    s_sub_u32 s7, s7, 1
    s_cmp_lg_u32 s7, 0
    s_cbranch_scc1 Lp_123
Lpd_124:
    s_branch Lback_122
Lslow_125:
    s_mov_b32 s7, 0x20000
Lp_127:
    ds_read_b32 v29, v2 offset:144
    s_waitcnt lgkmcnt(0)
    s_setprio 2
    v_readfirstlane_b32 s76, v29
    s_setprio 0
    s_cmp_ge_u32 s76, 40
    s_cbranch_scc1 Lpd_128
    s_sub_u32 s7, s7, 1
    s_cmp_lg_u32 s7, 0
    s_cbranch_scc1 Lp_127
Lpd_128:
    s_branch Lback_126
Lslow_129:
    s_mov_b32 s7, 0x20000
Lp_131:
    ds_read_b32 v29, v2 offset:144
    s_waitcnt lgkmcnt(0)
    s_setprio 2
    v_readfirstlane_b32 s76, v29
    s_setprio 0
    s_cmp_ge_u32 s76, 44
    s_cbranch_scc1 Lpd_132
    s_sub_u32 s7, s7, 1
    s_cmp_lg_u32 s7, 0
    s_cbranch_scc1 Lp_131
Lpd_132:
    s_branch Lback_130
Lslow_133:
    s_mov_b32 s7, 0x20000
Lp_135:
    ds_read_b32 v29, v2 offset:144
    s_waitcnt lgkmcnt(0)
    s_setprio 2
    v_readfirstlane_b32 s76, v29
    s_setprio 0
    s_cmp_ge_u32 s76, 48
    s_cbranch_scc1 Lpd_136
    s_sub_u32 s7, s7, 1
    s_cmp_lg_u32 s7, 0
    s_cbranch_scc1 Lp_135
Lpd_136:
    s_branch Lback_134
Lslow_137:
    s_mov_b32 s7, 0x20000
Lp_139:
    ds_read_b32 v29, v2 offset:144
    s_waitcnt lgkmcnt(0)
    s_setprio 2
    v_readfirstlane_b32 s76, v29
    s_setprio 0
    s_cmp_ge_u32 s76, 52
    s_cbranch_scc1 Lpd_140
    s_sub_u32 s7, s7, 1
    s_cmp_lg_u32 s7, 0
    s_cbranch_scc1 Lp_139
Lpd_140:
    s_branch Lback_138
Lslow_141:
    s_mov_b32 s7, 0x20000
Lp_143:
    ds_read_b32 v29, v2 offset:144
    s_waitcnt lgkmcnt(0)
    s_setprio 2
    v_readfirstlane_b32 s76, v29
    s_setprio 0
    s_cmp_ge_u32 s76, 56
    s_cbranch_scc1 Lpd_144
    s_sub_u32 s7, s7, 1
    s_cmp_lg_u32 s7, 0
    s_cbranch_scc1 Lp_143
Lpd_144:
    s_branch Lback_142
Lslow_145:
    s_mov_b32 s7, 0x20000
Lp_147:
    ds_read_b32 v29, v2 offset:144
    s_waitcnt lgkmcnt(0)
    s_setprio 2
    v_readfirstlane_b32 s76, v29
    s_setprio 0
    s_cmp_ge_u32 s76, 60
    s_cbranch_scc1 Lpd_148
    s_sub_u32 s7, s7, 1
    s_cmp_lg_u32 s7, 0
    s_cbranch_scc1 Lp_147
Lpd_148:
    s_branch Lback_146
Lslow_149:
    s_mov_b32 s7, 0x20000
Lp_151:
    ds_read_b32 v29, v2 offset:144
    s_waitcnt lgkmcnt(0)
    s_setprio 2
    v_readfirstlane_b32 s76, v29
    s_setprio 0
    s_cmp_ge_u32 s76, 64
    s_cbranch_scc1 Lpd_152
    s_sub_u32 s7, s7, 1
    s_cmp_lg_u32 s7, 0
    s_cbranch_scc1 Lp_151
Lpd_152:
    s_branch Lback_150
Lslow_153:
    s_mov_b32 s7, 0x20000
Lp_155:
    ds_read_b32 v29, v2 offset:144
    s_waitcnt lgkmcnt(0)
    s_setprio 2
    v_readfirstlane_b32 s76, v29
    s_setprio 0
    s_cmp_ge_u32 s76, 68
    s_cbranch_scc1 Lpd_156
    s_sub_u32 s7, s7, 1
    s_cmp_lg_u32 s7, 0
    s_cbranch_scc1 Lp_155
Lpd_156:
    s_branch Lback_154
Lslow_157:
    s_mov_b32 s7, 0x20000
Lp_159:
    ds_read_b32 v29, v2 offset:144
    s_waitcnt lgkmcnt(0)
    s_setprio 2
    v_readfirstlane_b32 s76, v29
    s_setprio 0
    s_cmp_ge_u32 s76, 72
    s_cbranch_scc1 Lpd_160
    s_sub_u32 s7, s7, 1
    s_cmp_lg_u32 s7, 0
    s_cbranch_scc1 Lp_159
Lpd_160:
    s_branch Lback_158
Lslow_161:
    s_mov_b32 s7, 0x20000
Lp_163:
    ds_read_b32 v29, v2 offset:144
    s_waitcnt lgkmcnt(0)
    s_setprio 2
    v_readfirstlane_b32 s76, v29
    s_setprio 0
    s_cmp_ge_u32 s76, 76
    s_cbranch_scc1 Lpd_164
    s_sub_u32 s7, s7, 1
    s_cmp_lg_u32 s7, 0
    s_cbranch_scc1 Lp_163
Lpd_164:
    s_branch Lback_162
Lslow_165:
    s_mov_b32 s7, 0x20000
Lp_167:
    ds_read_b32 v29, v2 offset:124
    s_waitcnt lgkmcnt(0)
    s_setprio 2
    v_readfirstlane_b32 s76, v29
    s_setprio 0
    s_cmp_ge_u32 s76, 4
    s_cbranch_scc1 Lpd_168
    s_sub_u32 s7, s7, 1
    s_cmp_lg_u32 s7, 0
    s_cbranch_scc1 Lp_167
Lpd_168:
    s_branch Lback_166
Lslow_172:
    s_mov_b32 s7, 0x20000
Lp_174:
    ds_read_b32 v29, v2 offset:144
    s_waitcnt lgkmcnt(0)
    s_setprio 2
    v_readfirstlane_b32 s76, v29
    s_setprio 0
    s_cmp_ge_u32 s76, 4
    s_cbranch_scc1 Lpd_175
    s_sub_u32 s7, s7, 1
    s_cmp_lg_u32 s7, 0
    s_cbranch_scc1 Lp_174
Lpd_175:
    s_branch Lback_173
Lslow_176:
    s_mov_b32 s7, 0x20000
Lp_178:
    ds_read_b32 v29, v2 offset:144
    s_waitcnt lgkmcnt(0)
    s_setprio 2
    v_readfirstlane_b32 s76, v29
    s_setprio 0
    s_cmp_ge_u32 s76, 8
    s_cbranch_scc1 Lpd_179
    s_sub_u32 s7, s7, 1
    s_cmp_lg_u32 s7, 0
    s_cbranch_scc1 Lp_178
Lpd_179:
    s_branch Lback_177
Lslow_180:
    s_mov_b32 s7, 0x20000
Lp_182:
    ds_read_b32 v29, v2 offset:144
    s_waitcnt lgkmcnt(0)
    s_setprio 2
    v_readfirstlane_b32 s76, v29
    s_setprio 0
    s_cmp_ge_u32 s76, 12
    s_cbranch_scc1 Lpd_183
    s_sub_u32 s7, s7, 1
    s_cmp_lg_u32 s7, 0
    s_cbranch_scc1 Lp_182
Lpd_183:
    s_branch Lback_181
Lslow_184:
    s_mov_b32 s7, 0x20000
Lp_186:
    ds_read_b32 v29, v2 offset:144
    s_waitcnt lgkmcnt(0)
    s_setprio 2
    v_readfirstlane_b32 s76, v29
    s_setprio 0
    s_cmp_ge_u32 s76, 16
    s_cbranch_scc1 Lpd_187
    s_sub_u32 s7, s7, 1
    s_cmp_lg_u32 s7, 0
    s_cbranch_scc1 Lp_186
Lpd_187:
    s_branch Lback_185
Lslow_188:
    s_mov_b32 s7, 0x20000
Lp_190:
    ds_read_b32 v29, v2 offset:144
    s_waitcnt lgkmcnt(0)
    s_setprio 2
    v_readfirstlane_b32 s76, v29
    s_setprio 0
    s_cmp_ge_u32 s76, 20
    s_cbranch_scc1 Lpd_191
    s_sub_u32 s7, s7, 1
    s_cmp_lg_u32 s7, 0
    s_cbranch_scc1 Lp_190
Lpd_191:
    s_branch Lback_189
Lslow_192:
    s_mov_b32 s7, 0x20000
Lp_194:
    ds_read_b32 v29, v2 offset:144
    s_waitcnt lgkmcnt(0)
    s_setprio 2
    v_readfirstlane_b32 s76, v29
    s_setprio 0
    s_cmp_ge_u32 s76, 24
    s_cbranch_scc1 Lpd_195
    s_sub_u32 s7, s7, 1
    s_cmp_lg_u32 s7, 0
    s_cbranch_scc1 Lp_194
Lpd_195:
    s_branch Lback_193
Lslow_196:
    s_mov_b32 s7, 0x20000
Lp_198:
    ds_read_b32 v29, v2 offset:144
    s_waitcnt lgkmcnt(0)
    s_setprio 2
    v_readfirstlane_b32 s76, v29
    s_setprio 0
    s_cmp_ge_u32 s76, 28
    s_cbranch_scc1 Lpd_199
    s_sub_u32 s7, s7, 1
    s_cmp_lg_u32 s7, 0
    s_cbranch_scc1 Lp_198
Lpd_199:
    s_branch Lback_197
Lslow_200:
    s_mov_b32 s7, 0x20000
Lp_202:
    ds_read_b32 v29, v2 offset:144
    s_waitcnt lgkmcnt(0)
    s_setprio 2
    v_readfirstlane_b32 s76, v29
    s_setprio 0
    s_cmp_ge_u32 s76, 32
    s_cbranch_scc1 Lpd_203
    s_sub_u32 s7, s7, 1
    s_cmp_lg_u32 s7, 0
    s_cbranch_scc1 Lp_202
Lpd_203:
    s_branch Lback_201
Lslow_204:
    s_mov_b32 s7, 0x20000
Lp_206:
    ds_read_b32 v29, v2 offset:144
    s_waitcnt lgkmcnt(0)
    s_setprio 2
    v_readfirstlane_b32 s76, v29
    s_setprio 0
    s_cmp_ge_u32 s76, 36
    s_cbranch_scc1 Lpd_207
    s_sub_u32 s7, s7, 1
    s_cmp_lg_u32 s7, 0
    s_cbranch_scc1 Lp_206
Lpd_207:
    s_branch Lback_205
Lslow_208:
    s_mov_b32 s7, 0x20000
Lp_210:
    ds_read_b32 v29, v2 offset:144
    s_waitcnt lgkmcnt(0)
    s_setprio 2
    v_readfirstlane_b32 s76, v29
    s_setprio 0
    s_cmp_ge_u32 s76, 40
    s_cbranch_scc1 Lpd_211
    s_sub_u32 s7, s7, 1
    s_cmp_lg_u32 s7, 0
    s_cbranch_scc1 Lp_210
Lpd_211:
    s_branch Lback_209
Lslow_212:
    s_mov_b32 s7, 0x20000
Lp_214:
    ds_read_b32 v29, v2 offset:144
    s_waitcnt lgkmcnt(0)
    s_setprio 2
    v_readfirstlane_b32 s76, v29
    s_setprio 0
    s_cmp_ge_u32 s76, 44
    s_cbranch_scc1 Lpd_215
    s_sub_u32 s7, s7, 1
    s_cmp_lg_u32 s7, 0
    s_cbranch_scc1 Lp_214
Lpd_215:
    s_branch Lback_213
Lslow_216:
    s_mov_b32 s7, 0x20000
Lp_218:
    ds_read_b32 v29, v2 offset:144
    s_waitcnt lgkmcnt(0)
    s_setprio 2
    v_readfirstlane_b32 s76, v29
    s_setprio 0
    s_cmp_ge_u32 s76, 48
    s_cbranch_scc1 Lpd_219
    s_sub_u32 s7, s7, 1
    s_cmp_lg_u32 s7, 0
    s_cbranch_scc1 Lp_218
Lpd_219:
    s_branch Lback_217
Lslow_220:
    s_mov_b32 s7, 0x20000
Lp_222:
    ds_read_b32 v29, v2 offset:144
    s_waitcnt lgkmcnt(0)
    s_setprio 2
    v_readfirstlane_b32 s76, v29
    s_setprio 0
    s_cmp_ge_u32 s76, 52
    s_cbranch_scc1 Lpd_223
    s_sub_u32 s7, s7, 1
    s_cmp_lg_u32 s7, 0
    s_cbranch_scc1 Lp_222
Lpd_223:
    s_branch Lback_221
Lslow_224:
    s_mov_b32 s7, 0x20000
Lp_226:
    ds_read_b32 v29, v2 offset:144
    s_waitcnt lgkmcnt(0)
    s_setprio 2
    v_readfirstlane_b32 s76, v29
    s_setprio 0
    s_cmp_ge_u32 s76, 56
    s_cbranch_scc1 Lpd_227
    s_sub_u32 s7, s7, 1
    s_cmp_lg_u32 s7, 0
    s_cbranch_scc1 Lp_226
Lpd_227:
    s_branch Lback_225
Lslow_228:
    s_mov_b32 s7, 0x20000
Lp_230:
    ds_read_b32 v29, v2 offset:144
    s_waitcnt lgkmcnt(0)
    s_setprio 2
    v_readfirstlane_b32 s76, v29
    s_setprio 0
    s_cmp_ge_u32 s76, 60
    s_cbranch_scc1 Lpd_231
    s_sub_u32 s7, s7, 1
    s_cmp_lg_u32 s7, 0
    s_cbranch_scc1 Lp_230
Lpd_231:
    s_branch Lback_229
Lslow_232:
    s_mov_b32 s7, 0x20000
Lp_234:
    ds_read_b32 v29, v2 offset:144
    s_waitcnt lgkmcnt(0)
    s_setprio 2
    v_readfirstlane_b32 s76, v29
    s_setprio 0
    s_cmp_ge_u32 s76, 64
    s_cbranch_scc1 Lpd_235
    s_sub_u32 s7, s7, 1
    s_cmp_lg_u32 s7, 0
    s_cbranch_scc1 Lp_234
Lpd_235:
    s_branch Lback_233
Lslow_236:
    s_mov_b32 s7, 0x20000
Lp_238:
    ds_read_b32 v29, v2 offset:144
    s_waitcnt lgkmcnt(0)
    s_setprio 2
    v_readfirstlane_b32 s76, v29
    s_setprio 0
    s_cmp_ge_u32 s76, 68
    s_cbranch_scc1 Lpd_239
    s_sub_u32 s7, s7, 1
    s_cmp_lg_u32 s7, 0
    s_cbranch_scc1 Lp_238
Lpd_239:
    s_branch Lback_237
Lslow_240:
    s_mov_b32 s7, 0x20000
Lp_242:
    ds_read_b32 v29, v2 offset:144
    s_waitcnt lgkmcnt(0)
    s_setprio 2
    v_readfirstlane_b32 s76, v29
    s_setprio 0
    s_cmp_ge_u32 s76, 72
    s_cbranch_scc1 Lpd_243
    s_sub_u32 s7, s7, 1
    s_cmp_lg_u32 s7, 0
    s_cbranch_scc1 Lp_242
Lpd_243:
    s_branch Lback_241
Lslow_244:
    s_mov_b32 s7, 0x20000
Lp_246:
    ds_read_b32 v29, v2 offset:144
    s_waitcnt lgkmcnt(0)
    s_setprio 2
    v_readfirstlane_b32 s76, v29
    s_setprio 0
    s_cmp_ge_u32 s76, 76
    s_cbranch_scc1 Lpd_247
    s_sub_u32 s7, s7, 1
    s_cmp_lg_u32 s7, 0
    s_cbranch_scc1 Lp_246
Lpd_247:
    s_branch Lback_245
Lslow_248:
    s_mov_b32 s7, 0x20000
Lp_250:
    ds_read_b32 v29, v2 offset:124
    s_waitcnt lgkmcnt(0)
    s_setprio 2
    v_readfirstlane_b32 s76, v29
    s_setprio 0
    s_cmp_ge_u32 s76, 4
    s_cbranch_scc1 Lpd_251
    s_sub_u32 s7, s7, 1
    s_cmp_lg_u32 s7, 0
    s_cbranch_scc1 Lp_250
Lpd_251:
    s_branch Lback_249
Lxs_252:
    buffer_store_dword v5, v4, s[72:75], s84 offen offset:0 sc1
    s_branch Lxb_253
Lslow_254:
    s_mov_b32 s7, 0x20000
Lp_256:
    ds_read_b32 v29, v2 offset:144
    s_waitcnt lgkmcnt(0)
    s_setprio 2
    v_readfirstlane_b32 s76, v29
    s_setprio 0
    s_cmp_ge_u32 s76, 4
    s_cbranch_scc1 Lpd_257
    s_sub_u32 s7, s7, 1
    s_cmp_lg_u32 s7, 0
    s_cbranch_scc1 Lp_256
Lpd_257:
    s_branch Lback_255
Lslow_258:
    s_mov_b32 s7, 0x20000
Lp_260:
    ds_read_b32 v29, v2 offset:144
    s_waitcnt lgkmcnt(0)
    s_setprio 2
    v_readfirstlane_b32 s76, v29
    s_setprio 0
    s_cmp_ge_u32 s76, 8
    s_cbranch_scc1 Lpd_261
    s_sub_u32 s7, s7, 1
    s_cmp_lg_u32 s7, 0
    s_cbranch_scc1 Lp_260
Lpd_261:
    s_branch Lback_259
Lslow_262:
    s_mov_b32 s7, 0x20000
Lp_264:
    ds_read_b32 v29, v2 offset:144
    s_waitcnt lgkmcnt(0)
    s_setprio 2
    v_readfirstlane_b32 s76, v29
    s_setprio 0
    s_cmp_ge_u32 s76, 12
    s_cbranch_scc1 Lpd_265
    s_sub_u32 s7, s7, 1
    s_cmp_lg_u32 s7, 0
    s_cbranch_scc1 Lp_264
Lpd_265:
    s_branch Lback_263
Lslow_266:
    s_mov_b32 s7, 0x20000
Lp_268:
    ds_read_b32 v29, v2 offset:144
    s_waitcnt lgkmcnt(0)
    s_setprio 2
    v_readfirstlane_b32 s76, v29
    s_setprio 0
    s_cmp_ge_u32 s76, 16
    s_cbranch_scc1 Lpd_269
    s_sub_u32 s7, s7, 1
    s_cmp_lg_u32 s7, 0
    s_cbranch_scc1 Lp_268
Lpd_269:
    s_branch Lback_267
Lslow_270:
    s_mov_b32 s7, 0x20000
Lp_272:
    ds_read_b32 v29, v2 offset:144
    s_waitcnt lgkmcnt(0)
    s_setprio 2
    v_readfirstlane_b32 s76, v29
    s_setprio 0
    s_cmp_ge_u32 s76, 20
    s_cbranch_scc1 Lpd_273
    s_sub_u32 s7, s7, 1
    s_cmp_lg_u32 s7, 0
    s_cbranch_scc1 Lp_272
Lpd_273:
    s_branch Lback_271
Lslow_274:
    s_mov_b32 s7, 0x20000
Lp_276:
    ds_read_b32 v29, v2 offset:144
    s_waitcnt lgkmcnt(0)
    s_setprio 2
    v_readfirstlane_b32 s76, v29
    s_setprio 0
    s_cmp_ge_u32 s76, 24
    s_cbranch_scc1 Lpd_277
    s_sub_u32 s7, s7, 1
    s_cmp_lg_u32 s7, 0
    s_cbranch_scc1 Lp_276
Lpd_277:
    s_branch Lback_275
Lslow_278:
    s_mov_b32 s7, 0x20000
Lp_280:
    ds_read_b32 v29, v2 offset:144
    s_waitcnt lgkmcnt(0)
    s_setprio 2
    v_readfirstlane_b32 s76, v29
    s_setprio 0
    s_cmp_ge_u32 s76, 28
    s_cbranch_scc1 Lpd_281
    s_sub_u32 s7, s7, 1
    s_cmp_lg_u32 s7, 0
    s_cbranch_scc1 Lp_280
Lpd_281:
    s_branch Lback_279
Lslow_282:
    s_mov_b32 s7, 0x20000
Lp_284:
    ds_read_b32 v29, v2 offset:144
    s_waitcnt lgkmcnt(0)
    s_setprio 2
    v_readfirstlane_b32 s76, v29
    s_setprio 0
    s_cmp_ge_u32 s76, 32
    s_cbranch_scc1 Lpd_285
    s_sub_u32 s7, s7, 1
    s_cmp_lg_u32 s7, 0
    s_cbranch_scc1 Lp_284
Lpd_285:
    s_branch Lback_283
Lslow_286:
    s_mov_b32 s7, 0x20000
Lp_288:
    ds_read_b32 v29, v2 offset:144
    s_waitcnt lgkmcnt(0)
    s_setprio 2
    v_readfirstlane_b32 s76, v29
    s_setprio 0
    s_cmp_ge_u32 s76, 36
    s_cbranch_scc1 Lpd_289
    s_sub_u32 s7, s7, 1
    s_cmp_lg_u32 s7, 0
    s_cbranch_scc1 Lp_288
Lpd_289:
    s_branch Lback_287
Lslow_290:
    s_mov_b32 s7, 0x20000
Lp_292:
    ds_read_b32 v29, v2 offset:144
    s_waitcnt lgkmcnt(0)
    s_setprio 2
    v_readfirstlane_b32 s76, v29
    s_setprio 0
    s_cmp_ge_u32 s76, 40
    s_cbranch_scc1 Lpd_293
    s_sub_u32 s7, s7, 1
    s_cmp_lg_u32 s7, 0
    s_cbranch_scc1 Lp_292
Lpd_293:
    s_branch Lback_291
Lslow_294:
    s_mov_b32 s7, 0x20000
Lp_296:
    ds_read_b32 v29, v2 offset:144
    s_waitcnt lgkmcnt(0)
    s_setprio 2
    v_readfirstlane_b32 s76, v29
    s_setprio 0
    s_cmp_ge_u32 s76, 44
    s_cbranch_scc1 Lpd_297
    s_sub_u32 s7, s7, 1
    s_cmp_lg_u32 s7, 0
    s_cbranch_scc1 Lp_296
Lpd_297:
    s_branch Lback_295
Lslow_298:
    s_mov_b32 s7, 0x20000
Lp_300:
    ds_read_b32 v29, v2 offset:144
    s_waitcnt lgkmcnt(0)
    s_setprio 2
    v_readfirstlane_b32 s76, v29
    s_setprio 0
    s_cmp_ge_u32 s76, 48
    s_cbranch_scc1 Lpd_301
    s_sub_u32 s7, s7, 1
    s_cmp_lg_u32 s7, 0
    s_cbranch_scc1 Lp_300
Lpd_301:
    s_branch Lback_299
Lslow_302:
    s_mov_b32 s7, 0x20000
Lp_304:
    ds_read_b32 v29, v2 offset:144
    s_waitcnt lgkmcnt(0)
    s_setprio 2
    v_readfirstlane_b32 s76, v29
    s_setprio 0
    s_cmp_ge_u32 s76, 52
    s_cbranch_scc1 Lpd_305
    s_sub_u32 s7, s7, 1
    s_cmp_lg_u32 s7, 0
    s_cbranch_scc1 Lp_304
Lpd_305:
    s_branch Lback_303
Lslow_306:
    s_mov_b32 s7, 0x20000
Lp_308:
    ds_read_b32 v29, v2 offset:144
    s_waitcnt lgkmcnt(0)
    s_setprio 2
    v_readfirstlane_b32 s76, v29
    s_setprio 0
    s_cmp_ge_u32 s76, 56
    s_cbranch_scc1 Lpd_309
    s_sub_u32 s7, s7, 1
    s_cmp_lg_u32 s7, 0
    s_cbranch_scc1 Lp_308
Lpd_309:
    s_branch Lback_307
Lslow_310:
    s_mov_b32 s7, 0x20000
Lp_312:
    ds_read_b32 v29, v2 offset:144
    s_waitcnt lgkmcnt(0)
    s_setprio 2
    v_readfirstlane_b32 s76, v29
    s_setprio 0
    s_cmp_ge_u32 s76, 60
    s_cbranch_scc1 Lpd_313
    s_sub_u32 s7, s7, 1
    s_cmp_lg_u32 s7, 0
    s_cbranch_scc1 Lp_312
Lpd_313:
    s_branch Lback_311
Lslow_314:
    s_mov_b32 s7, 0x20000
Lp_316:
    ds_read_b32 v29, v2 offset:144
    s_waitcnt lgkmcnt(0)
    s_setprio 2
    v_readfirstlane_b32 s76, v29
    s_setprio 0
    s_cmp_ge_u32 s76, 64
    s_cbranch_scc1 Lpd_317
    s_sub_u32 s7, s7, 1
    s_cmp_lg_u32 s7, 0
    s_cbranch_scc1 Lp_316
Lpd_317:
    s_branch Lback_315
Lslow_318:
    s_mov_b32 s7, 0x20000
Lp_320:
    ds_read_b32 v29, v2 offset:144
    s_waitcnt lgkmcnt(0)
    s_setprio 2
    v_readfirstlane_b32 s76, v29
    s_setprio 0
    s_cmp_ge_u32 s76, 68
    s_cbranch_scc1 Lpd_321
    s_sub_u32 s7, s7, 1
    s_cmp_lg_u32 s7, 0
    s_cbranch_scc1 Lp_320
Lpd_321:
    s_branch Lback_319
Lslow_322:
    s_mov_b32 s7, 0x20000
Lp_324:
    ds_read_b32 v29, v2 offset:144
    s_waitcnt lgkmcnt(0)
    s_setprio 2
    v_readfirstlane_b32 s76, v29
    s_setprio 0
    s_cmp_ge_u32 s76, 72
    s_cbranch_scc1 Lpd_325
    s_sub_u32 s7, s7, 1
    s_cmp_lg_u32 s7, 0
    s_cbranch_scc1 Lp_324
Lpd_325:
    s_branch Lback_323
Lslow_326:
    s_mov_b32 s7, 0x20000
Lp_328:
    ds_read_b32 v29, v2 offset:144
    s_waitcnt lgkmcnt(0)
    s_setprio 2
    v_readfirstlane_b32 s76, v29
    s_setprio 0
    s_cmp_ge_u32 s76, 76
    s_cbranch_scc1 Lpd_329
    s_sub_u32 s7, s7, 1
    s_cmp_lg_u32 s7, 0
    s_cbranch_scc1 Lp_328
Lpd_329:
    s_branch Lback_327
Lslow_330:
    s_mov_b32 s7, 0x20000
Lp_332:
    ds_read_b32 v29, v2 offset:124
    s_waitcnt lgkmcnt(0)
    s_setprio 2
    v_readfirstlane_b32 s76, v29
    s_setprio 0
    s_cmp_ge_u32 s76, 4
    s_cbranch_scc1 Lpd_333
    s_sub_u32 s7, s7, 1
    s_cmp_lg_u32 s7, 0
    s_cbranch_scc1 Lp_332
Lpd_333:
    s_branch Lback_331
Lslow_337:
    s_mov_b32 s7, 0x20000
Lp_339:
    ds_read_b32 v29, v2 offset:144
    s_waitcnt lgkmcnt(0)
    s_setprio 2
    v_readfirstlane_b32 s76, v29
    s_setprio 0
    s_cmp_ge_u32 s76, 4
    s_cbranch_scc1 Lpd_340
    s_sub_u32 s7, s7, 1
    s_cmp_lg_u32 s7, 0
    s_cbranch_scc1 Lp_339
Lpd_340:
    s_branch Lback_338
Lslow_341:
    s_mov_b32 s7, 0x20000
Lp_343:
    ds_read_b32 v29, v2 offset:144
    s_waitcnt lgkmcnt(0)
    s_setprio 2
    v_readfirstlane_b32 s76, v29
    s_setprio 0
    s_cmp_ge_u32 s76, 8
    s_cbranch_scc1 Lpd_344
    s_sub_u32 s7, s7, 1
    s_cmp_lg_u32 s7, 0
    s_cbranch_scc1 Lp_343
Lpd_344:
    s_branch Lback_342
Lslow_345:
    s_mov_b32 s7, 0x20000
Lp_347:
    ds_read_b32 v29, v2 offset:144
    s_waitcnt lgkmcnt(0)
    s_setprio 2
    v_readfirstlane_b32 s76, v29
    s_setprio 0
    s_cmp_ge_u32 s76, 12
    s_cbranch_scc1 Lpd_348
    s_sub_u32 s7, s7, 1
    s_cmp_lg_u32 s7, 0
    s_cbranch_scc1 Lp_347
Lpd_348:
    s_branch Lback_346
Lslow_349:
    s_mov_b32 s7, 0x20000
Lp_351:
    ds_read_b32 v29, v2 offset:144
    s_waitcnt lgkmcnt(0)
    s_setprio 2
    v_readfirstlane_b32 s76, v29
    s_setprio 0
    s_cmp_ge_u32 s76, 16
    s_cbranch_scc1 Lpd_352
    s_sub_u32 s7, s7, 1
    s_cmp_lg_u32 s7, 0
    s_cbranch_scc1 Lp_351
Lpd_352:
    s_branch Lback_350
Lslow_353:
    s_mov_b32 s7, 0x20000
Lp_355:
    ds_read_b32 v29, v2 offset:144
    s_waitcnt lgkmcnt(0)
    s_setprio 2
    v_readfirstlane_b32 s76, v29
    s_setprio 0
    s_cmp_ge_u32 s76, 20
    s_cbranch_scc1 Lpd_356
    s_sub_u32 s7, s7, 1
    s_cmp_lg_u32 s7, 0
    s_cbranch_scc1 Lp_355
Lpd_356:
    s_branch Lback_354
Lslow_357:
    s_mov_b32 s7, 0x20000
Lp_359:
    ds_read_b32 v29, v2 offset:144
    s_waitcnt lgkmcnt(0)
    s_setprio 2
    v_readfirstlane_b32 s76, v29
    s_setprio 0
    s_cmp_ge_u32 s76, 24
    s_cbranch_scc1 Lpd_360
    s_sub_u32 s7, s7, 1
    s_cmp_lg_u32 s7, 0
    s_cbranch_scc1 Lp_359
Lpd_360:
    s_branch Lback_358
Lslow_361:
    s_mov_b32 s7, 0x20000
Lp_363:
    ds_read_b32 v29, v2 offset:144
    s_waitcnt lgkmcnt(0)
    s_setprio 2
    v_readfirstlane_b32 s76, v29
    s_setprio 0
    s_cmp_ge_u32 s76, 28
    s_cbranch_scc1 Lpd_364
    s_sub_u32 s7, s7, 1
    s_cmp_lg_u32 s7, 0
    s_cbranch_scc1 Lp_363
Lpd_364:
    s_branch Lback_362
Lslow_365:
    s_mov_b32 s7, 0x20000
Lp_367:
    ds_read_b32 v29, v2 offset:144
    s_waitcnt lgkmcnt(0)
    s_setprio 2
    v_readfirstlane_b32 s76, v29
    s_setprio 0
    s_cmp_ge_u32 s76, 32
    s_cbranch_scc1 Lpd_368
    s_sub_u32 s7, s7, 1
    s_cmp_lg_u32 s7, 0
    s_cbranch_scc1 Lp_367
Lpd_368:
    s_branch Lback_366
Lslow_369:
    s_mov_b32 s7, 0x20000
Lp_371:
    ds_read_b32 v29, v2 offset:144
    s_waitcnt lgkmcnt(0)
    s_setprio 2
    v_readfirstlane_b32 s76, v29
    s_setprio 0
    s_cmp_ge_u32 s76, 36
    s_cbranch_scc1 Lpd_372
    s_sub_u32 s7, s7, 1
    s_cmp_lg_u32 s7, 0
    s_cbranch_scc1 Lp_371
Lpd_372:
    s_branch Lback_370
Lslow_373:
    s_mov_b32 s7, 0x20000
Lp_375:
    ds_read_b32 v29, v2 offset:144
    s_waitcnt lgkmcnt(0)
    s_setprio 2
    v_readfirstlane_b32 s76, v29
    s_setprio 0
    s_cmp_ge_u32 s76, 40
    s_cbranch_scc1 Lpd_376
    s_sub_u32 s7, s7, 1
    s_cmp_lg_u32 s7, 0
    s_cbranch_scc1 Lp_375
Lpd_376:
    s_branch Lback_374
Lslow_377:
    s_mov_b32 s7, 0x20000
Lp_379:
    ds_read_b32 v29, v2 offset:144
    s_waitcnt lgkmcnt(0)
    s_setprio 2
    v_readfirstlane_b32 s76, v29
    s_setprio 0
    s_cmp_ge_u32 s76, 44
    s_cbranch_scc1 Lpd_380
    s_sub_u32 s7, s7, 1
    s_cmp_lg_u32 s7, 0
    s_cbranch_scc1 Lp_379
Lpd_380:
    s_branch Lback_378
Lslow_381:
    s_mov_b32 s7, 0x20000
Lp_383:
    ds_read_b32 v29, v2 offset:144
    s_waitcnt lgkmcnt(0)
    s_setprio 2
    v_readfirstlane_b32 s76, v29
    s_setprio 0
    s_cmp_ge_u32 s76, 48
    s_cbranch_scc1 Lpd_384
    s_sub_u32 s7, s7, 1
    s_cmp_lg_u32 s7, 0
    s_cbranch_scc1 Lp_383
Lpd_384:
    s_branch Lback_382
Lslow_385:
    s_mov_b32 s7, 0x20000
Lp_387:
    ds_read_b32 v29, v2 offset:144
    s_waitcnt lgkmcnt(0)
    s_setprio 2
    v_readfirstlane_b32 s76, v29
    s_setprio 0
    s_cmp_ge_u32 s76, 52
    s_cbranch_scc1 Lpd_388
    s_sub_u32 s7, s7, 1
    s_cmp_lg_u32 s7, 0
    s_cbranch_scc1 Lp_387
Lpd_388:
    s_branch Lback_386
Lslow_389:
    s_mov_b32 s7, 0x20000
Lp_391:
    ds_read_b32 v29, v2 offset:144
    s_waitcnt lgkmcnt(0)
    s_setprio 2
    v_readfirstlane_b32 s76, v29
    s_setprio 0
    s_cmp_ge_u32 s76, 56
    s_cbranch_scc1 Lpd_392
    s_sub_u32 s7, s7, 1
    s_cmp_lg_u32 s7, 0
    s_cbranch_scc1 Lp_391
Lpd_392:
    s_branch Lback_390
Lslow_393:
    s_mov_b32 s7, 0x20000
Lp_395:
    ds_read_b32 v29, v2 offset:144
    s_waitcnt lgkmcnt(0)
    s_setprio 2
    v_readfirstlane_b32 s76, v29
    s_setprio 0
    s_cmp_ge_u32 s76, 60
    s_cbranch_scc1 Lpd_396
    s_sub_u32 s7, s7, 1
    s_cmp_lg_u32 s7, 0
    s_cbranch_scc1 Lp_395
Lpd_396:
    s_branch Lback_394
Lslow_397:
    s_mov_b32 s7, 0x20000
Lp_399:
    ds_read_b32 v29, v2 offset:144
    s_waitcnt lgkmcnt(0)
    s_setprio 2
    v_readfirstlane_b32 s76, v29
    s_setprio 0
    s_cmp_ge_u32 s76, 64
    s_cbranch_scc1 Lpd_400
    s_sub_u32 s7, s7, 1
    s_cmp_lg_u32 s7, 0
    s_cbranch_scc1 Lp_399
Lpd_400:
    s_branch Lback_398
Lslow_401:
    s_mov_b32 s7, 0x20000
Lp_403:
    ds_read_b32 v29, v2 offset:144
    s_waitcnt lgkmcnt(0)
    s_setprio 2
    v_readfirstlane_b32 s76, v29
    s_setprio 0
    s_cmp_ge_u32 s76, 68
    s_cbranch_scc1 Lpd_404
    s_sub_u32 s7, s7, 1
    s_cmp_lg_u32 s7, 0
    s_cbranch_scc1 Lp_403
Lpd_404:
    s_branch Lback_402
Lslow_405:
    s_mov_b32 s7, 0x20000
Lp_407:
    ds_read_b32 v29, v2 offset:144
    s_waitcnt lgkmcnt(0)
    s_setprio 2
    v_readfirstlane_b32 s76, v29
    s_setprio 0
    s_cmp_ge_u32 s76, 72
    s_cbranch_scc1 Lpd_408
    s_sub_u32 s7, s7, 1
    s_cmp_lg_u32 s7, 0
    s_cbranch_scc1 Lp_407
Lpd_408:
    s_branch Lback_406
Lslow_409:
    s_mov_b32 s7, 0x20000
Lp_411:
    ds_read_b32 v29, v2 offset:144
    s_waitcnt lgkmcnt(0)
    s_setprio 2
    v_readfirstlane_b32 s76, v29
    s_setprio 0
    s_cmp_ge_u32 s76, 76
    s_cbranch_scc1 Lpd_412
    s_sub_u32 s7, s7, 1
    s_cmp_lg_u32 s7, 0
    s_cbranch_scc1 Lp_411
Lpd_412:
    s_branch Lback_410
Lslow_413:
    s_mov_b32 s7, 0x20000
Lp_415:
    ds_read_b32 v29, v2 offset:124
    s_waitcnt lgkmcnt(0)
    s_setprio 2
    v_readfirstlane_b32 s76, v29
    s_setprio 0
    s_cmp_ge_u32 s76, 4
    s_cbranch_scc1 Lpd_416
    s_sub_u32 s7, s7, 1
    s_cmp_lg_u32 s7, 0
    s_cbranch_scc1 Lp_415
Lpd_416:
    s_branch Lback_414
Lxs_417:
    buffer_store_dword v5, v4, s[72:75], s84 offen offset:4 sc1
    s_branch Lxb_418
Lxs_423:
    buffer_store_dword v5, v4, s[72:75], s76 offen sc1
    s_branch Lxb_424
Lslow_446:
    s_mov_b32 s7, 0x20000
Lp_448:
    ds_read_b32 v4, v2 offset:512
    s_waitcnt lgkmcnt(0)
    s_setprio 2
    v_readfirstlane_b32 s76, v4
    s_setprio 0
    s_cmp_ge_u32 s76, 16
    s_cbranch_scc1 Lpd_449
    s_sub_u32 s7, s7, 1
    s_cmp_lg_u32 s7, 0
    s_cbranch_scc1 Lp_448
Lpd_449:
    s_branch Lback_447
L_code_end:

.section .rodata,"a"
.p2align 6
.amdhsa_kernel gated_mix__sliding_local_dilated__grouped_kv_mqa__prompt_kernel
  .amdhsa_next_free_vgpr 256
  .amdhsa_next_free_sgpr 102
  .amdhsa_accum_offset 256
  .amdhsa_group_segment_fixed_size 0
  .amdhsa_kernarg_size 96
  .amdhsa_user_sgpr_count 2
  .amdhsa_user_sgpr_kernarg_segment_ptr 1
  .amdhsa_system_sgpr_workgroup_id_x 1
.end_amdhsa_kernel
```
